```python
import torch

def _softmax(x, axis=-1):
    return torch.softmax(x, dim=axis)
def _gelu(x):
    return torch.nn.functional.gelu(x, approximate="tanh")
def _silu(x):
    return torch.nn.functional.silu(x)
def _sigmoid(x):
    return torch.sigmoid(x)
def _layernorm(x, axis=-1, eps=1e-5):
    m = x.mean(dim=axis, keepdim=True)
    v = x.var(dim=axis, keepdim=True, unbiased=False)
    return (x - m) / torch.sqrt(v + eps)
def _scatter_add(tgt, idx, src, axis=0):
    return tgt.clone().index_add_(axis, idx, src)
def _segment_sum(src, seg, n):
    out = torch.zeros((n,) + src.shape[1:], dtype=src.dtype)
    return out.index_add_(0, seg, src)
def _pad(x, pw):
    flat = tuple(v for pair in reversed(pw) for v in pair)
    return torch.nn.functional.pad(x, flat)

kernel_name = 'concat_heads__gqa_block_cached__mha_block_cached__near_ridge'

def setup_inputs():

    _w = (lambda a: (lambda t: t.to(torch.bfloat16) if t.is_floating_point() else t)(torch.as_tensor(a)))
    def _A_setup():
        B, Sq, D = 8, 112, 448
        Hq, Hkv, Sk, Dh = 16, 8, 2048, 256
        assert Hq % Hkv == 0, (Hq, Hkv)
        return {
            "x": _w((lambda *s: torch.randn(*s, dtype=torch.bfloat16) * 0.8)(B, Sq, D)),
            "k_cache": _w((lambda *s: torch.randn(*s, dtype=torch.bfloat16) * 0.8)(B, Hkv, Sk, Dh)),
            "v_cache": _w((lambda *s: torch.randn(*s, dtype=torch.bfloat16) * 0.05)(B, Hkv, Sk, Dh)),
            "wq": _w((lambda *s: torch.randn(*s, dtype=torch.bfloat16) * 0.8)(D, Hq * Dh) * (D ** -0.5)),
            "wo": _w((lambda *s: torch.randn(*s, dtype=torch.bfloat16) * 0.05)(Hq * Dh, D) * ((Hq * Dh) ** -0.5)),
        }
    _A_in = _A_setup()

    def _B_setup():
        B, Sq, D = 8, 112, 448
        H, Sk, Dh = 16, 2048, 256
        return {
            "x": _w((lambda *s: torch.randn(*s, dtype=torch.bfloat16) * 0.8)(B, Sq, D)),
            "k_cache": _w((lambda *s: torch.randn(*s, dtype=torch.bfloat16) * 0.8)(B, H, Sk, Dh)),
            "v_cache": _w((lambda *s: torch.randn(*s, dtype=torch.bfloat16) * 0.05)(B, H, Sk, Dh)),
            "wq": _w((lambda *s: torch.randn(*s, dtype=torch.bfloat16) * 0.8)(D, H * Dh) * (D ** -0.5)),
            "wo": _w((lambda *s: torch.randn(*s, dtype=torch.bfloat16) * 0.05)(H * Dh, D) * ((H * Dh) ** -0.5)),
        }
    _B_in = _B_setup()

    return {
        "A_x": _A_in["x"],
        "A_k_cache": _A_in["k_cache"],
        "A_v_cache": _A_in["v_cache"],
        "A_wq": _A_in["wq"],
        "A_wo": _A_in["wo"],
        "B_x": _B_in["x"],
        "B_k_cache": _B_in["k_cache"],
        "B_v_cache": _B_in["v_cache"],
        "B_wq": _B_in["wq"],
        "B_wo": _B_in["wo"],
    }

def reference(A_x, A_k_cache, A_v_cache, A_wq, A_wo, B_x, B_k_cache, B_v_cache, B_wq, B_wo):
    def _A_ref(x, k_cache, v_cache, wq, wo):
        B, Sq, D = x.shape
        Hq, Dh = 16, 256
        Hkv = k_cache.shape[1]
        rep = Hq // Hkv
        q = (lambda x, *d: x.permute(*d))((x @ wq).reshape(B, Sq, Hq, Dh), 0, 2, 1, 3)
        k = (lambda x, n, axis: torch.repeat_interleave(x, n, dim=axis))(k_cache, rep, axis=1)
        v = (lambda x, n, axis: torch.repeat_interleave(x, n, dim=axis))(v_cache, rep, axis=1)
        scores = torch.einsum("bhqd,bhkd->bhqk", q, k) * (Dh ** -0.5)
        p = _softmax(scores, axis=-1)
        o = torch.einsum("bhqk,bhkd->bhqd", p, v)
        return (lambda x, *d: x.permute(*d))(o, 0, 2, 1, 3).reshape(B, Sq, Hq * Dh) @ wo

    def _B_ref(x, k_cache, v_cache, wq, wo):
        B, Sq, D = x.shape
        H, Dh = 16, 256
        q = (lambda x, *d: x.permute(*d))((x @ wq).reshape(B, Sq, H, Dh), 0, 2, 1, 3)
        scores = torch.einsum("bhqd,bhkd->bhqk", q, k_cache) * (Dh ** -0.5)
        p = _softmax(scores, axis=-1)
        o = torch.einsum("bhqk,bhkd->bhqd", p, v_cache)
        return (lambda x, *d: x.permute(*d))(o, 0, 2, 1, 3).reshape(B, Sq, H * Dh) @ wo

    a = _A_ref(A_x, A_k_cache, A_v_cache, A_wq, A_wo)
    b = _B_ref(B_x, B_k_cache, B_v_cache, B_wq, B_wo)
    return torch.concatenate([a, b], axis=-1)
```

```asm
; @launch kernel=concat_heads__gqa_block_cached__mha_block_cached__near_ridge_kernel grid=(256,1,1) block=(256,1,1) lds=163840
; @launch kernel=reduce_kernel grid=(224,1,1) block=(448,1,1) lds=0
.amdgcn_target "amdgcn-amd-amdhsa--gfx950"
.text
.globl concat_heads__gqa_block_cached__mha_block_cached__near_ridge_kernel
.p2align 8
.type concat_heads__gqa_block_cached__mha_block_cached__near_ridge_kernel,@function
concat_heads__gqa_block_cached__mha_block_cached__near_ridge_kernel:
    s_cmp_ge_u32 s2, 256
    s_cbranch_scc1 L_end
    s_getpc_b64 s[98:99]
    s_lshr_b32 s3, s2, 3
    s_mul_i32 s3, s3, 2100
    v_and_b32 v68, 63, v0
    v_min_u32 v68, 16, v68
    v_lshl_add_u32 v68, v68, 7, s3
    s_load_dwordx16 s[32:47], s[0:1], 0
    s_load_dwordx8 s[48:55], s[0:1], 64
    s_load_dwordx2 s[56:57], s[0:1], 96
    v_lshrrev_b32 v113, 6, v0
    v_and_b32 v112, 63, v0
    v_readfirstlane_b32 s58, v113
    s_and_b32 s3, s2, 7
    s_lshr_b32 s4, s2, 7
    s_bfe_u32 s5, s2, 0x30004
    s_bfe_u32 s6, s2, 0x10003
    s_lshl_b32 s68, s3, 1
    s_add_u32 s6, s6, s68
    s_lshl_b32 s63, s5, 3
    s_add_u32 s63, s63, s3
    s_lshl_b32 s64, s5, 4
    s_add_u32 s64, s64, s6
    s_lshl_b32 s59, s58, 12
    s_lshl_b32 s62, s58, 11
    s_and_b32 s68, s58, 1
    s_lshl_b32 s68, s68, 14
    s_lshr_b32 s69, s58, 1
    s_lshl_b32 s60, s69, 12
    s_add_u32 s60, s60, s68
    s_lshl_b32 s61, s69, 13
    s_add_u32 s61, s61, s68
    v_lshrrev_b32 v114, 5, v112
    v_and_b32 v115, 31, v112
    v_and_b32 v120, 1, v113
    v_lshrrev_b32 v121, 1, v113
    v_lshl_add_u32 v116, v113, 3, v114
    v_and_b32 v117, 3, v116
    v_lshlrev_b32 v117, 2, v117
    v_xor_b32 v117, v117, v115
    v_lshlrev_b32 v117, 4, v117
    v_lshl_add_u32 v104, v116, 13, v117
    v_lshl_add_u32 v116, v113, 3, v114
    v_add_u32 v116, 2, v116
    v_and_b32 v117, 3, v116
    v_lshlrev_b32 v117, 2, v117
    v_xor_b32 v117, v117, v115
    v_lshlrev_b32 v117, 4, v117
    v_lshl_add_u32 v105, v116, 13, v117
    v_subrev_u32 v105, 1024, v105
    v_lshl_add_u32 v116, v113, 3, v114
    v_add_u32 v116, 4, v116
    v_and_b32 v117, 3, v116
    v_lshlrev_b32 v117, 2, v117
    v_xor_b32 v117, v117, v115
    v_lshlrev_b32 v117, 4, v117
    v_lshl_add_u32 v106, v116, 13, v117
    v_subrev_u32 v106, 2048, v106
    v_lshl_add_u32 v116, v113, 3, v114
    v_add_u32 v116, 6, v116
    v_and_b32 v117, 3, v116
    v_lshlrev_b32 v117, 2, v117
    v_xor_b32 v117, v117, v115
    v_lshlrev_b32 v117, 4, v117
    v_lshl_add_u32 v107, v116, 13, v117
    v_subrev_u32 v107, 3072, v107
    v_lshrrev_b32 v122, 4, v112
    v_and_b32 v124, 3, v112
    v_lshrrev_b32 v116, 3, v112
    v_lshl_add_u32 v116, v113, 5, v116
    v_mul_u32_u24 v116, 896, v116
    v_and_b32 v117, 7, v112
    v_xor_b32 v117, v117, v122
    v_xor_b32 v118, 4, v117
    v_lshl_add_u32 v108, v117, 4, v116
    v_lshl_add_u32 v109, v118, 4, v116
    v_add_u32 v109, 6144, v109
    v_lshl_add_u32 v110, v117, 4, v116
    v_add_u32 v110, 12288, v110
    v_lshl_add_u32 v111, v118, 4, v116
    v_add_u32 v111, 18432, v111
    s_waitcnt lgkmcnt(0)
    s_cmp_eq_u32 s4, 0
    s_cselect_b32 s63, s63, s64
    s_cselect_b32 s8, s32, s42
    s_cselect_b32 s9, s33, s43
    s_cselect_b32 s12, s34, s44
    s_cselect_b32 s13, s35, s45
    s_cselect_b32 s16, s36, s46
    s_cselect_b32 s17, s37, s47
    s_cselect_b32 s20, s38, s48
    s_cselect_b32 s21, s39, s49
    s_cselect_b32 s24, s40, s50
    s_cselect_b32 s25, s41, s51
    s_lshl_b32 s3, s6, 9
    s_add_u32 s20, s20, s3
    s_addc_u32 s21, s21, 0
    s_sub_u32 s22, 3670016, s3
    s_mov_b32 s23, 0x20000
    s_mul_i32 s3, s5, 100352
    s_add_u32 s8, s8, s3
    s_addc_u32 s9, s9, 0
    s_mov_b32 s10, 100352
    s_mov_b32 s11, 0x20000
    s_add_u32 m0, s59, 131072
    s_mov_b32 s68, 0
    buffer_load_dwordx4 v108, s[8:11], s68 offen offset:0  lds
    buffer_load_dwordx4 v109, s[8:11], s68 offen offset:1024  lds
    buffer_load_dwordx4 v110, s[8:11], s68 offen offset:2048  lds
    buffer_load_dwordx4 v111, s[8:11], s68 offen offset:3072  lds
    s_add_u32 m0, s59, 98304
    s_mov_b32 s68, 0
    buffer_load_dwordx4 v104, s[20:23], s68 offen offset:0  lds
    buffer_load_dwordx4 v105, s[20:23], s68 offen offset:1024  lds
    buffer_load_dwordx4 v106, s[20:23], s68 offen offset:2048  lds
    buffer_load_dwordx4 v107, s[20:23], s68 offen offset:3072  lds
    s_add_u32 m0, s59, 114688
    s_mov_b32 s68, 262144
    buffer_load_dwordx4 v104, s[20:23], s68 offen offset:0  lds
    buffer_load_dwordx4 v105, s[20:23], s68 offen offset:1024  lds
    buffer_load_dwordx4 v106, s[20:23], s68 offen offset:2048  lds
    buffer_load_dwordx4 v107, s[20:23], s68 offen offset:3072  lds
    s_add_u32 m0, s59, 147456
    s_mov_b32 s68, 128
    buffer_load_dwordx4 v108, s[8:11], s68 offen offset:0  lds
    buffer_load_dwordx4 v109, s[8:11], s68 offen offset:1024  lds
    buffer_load_dwordx4 v110, s[8:11], s68 offen offset:2048  lds
    buffer_load_dwordx4 v111, s[8:11], s68 offen offset:3072  lds
    s_lshl_b32 s3, s63, 20
    s_lshr_b32 s68, s63, 12
    s_add_u32 s12, s12, s3
    s_addc_u32 s13, s13, s68
    s_mov_b32 s14, 0x100000
    s_mov_b32 s15, 0x20000
    s_add_u32 s16, s16, s3
    s_addc_u32 s17, s17, s68
    s_mov_b32 s18, 0x100000
    s_mov_b32 s19, 0x20000
    s_mov_b32 s63, 0
    s_mov_b32 s64, 0
    v_lshl_add_u32 v116, v121, 3, v114
    v_lshlrev_b32 v119, 9, v116
    v_lshl_add_u32 v117, v120, 4, v116
    v_xor_b32 v117, v117, v115
    v_lshl_add_u32 v117, v117, 4, v119
    v_lshl_add_u32 v12, v120, 14, v117
    v_and_b32 v117, 7, v116
    v_lshlrev_b32 v117, 1, v117
    v_xor_b32 v117, v117, v115
    v_lshl_add_u32 v117, v117, 4, v119
    v_lshrrev_b32 v118, 4, v115
    v_xor_b32 v118, v118, v120
    v_lshl_add_u32 v16, v118, 14, v117
    v_lshl_add_u32 v116, v121, 3, v114
    v_lshlrev_b32 v119, 9, v116
    v_add_u32 v116, 2, v116
    v_lshl_add_u32 v117, v120, 4, v116
    v_xor_b32 v117, v117, v115
    v_lshl_add_u32 v117, v117, 4, v119
    v_lshl_add_u32 v13, v120, 14, v117
    v_and_b32 v117, 7, v116
    v_lshlrev_b32 v117, 1, v117
    v_xor_b32 v117, v117, v115
    v_lshl_add_u32 v117, v117, 4, v119
    v_lshrrev_b32 v118, 4, v115
    v_xor_b32 v118, v118, v120
    v_lshl_add_u32 v17, v118, 14, v117
    v_lshl_add_u32 v116, v121, 3, v114
    v_lshlrev_b32 v119, 9, v116
    v_add_u32 v116, 4, v116
    v_lshl_add_u32 v117, v120, 4, v116
    v_xor_b32 v117, v117, v115
    v_lshl_add_u32 v117, v117, 4, v119
    v_lshl_add_u32 v14, v120, 14, v117
    v_and_b32 v117, 7, v116
    v_lshlrev_b32 v117, 1, v117
    v_xor_b32 v117, v117, v115
    v_lshl_add_u32 v117, v117, 4, v119
    v_lshrrev_b32 v118, 4, v115
    v_xor_b32 v118, v118, v120
    v_lshl_add_u32 v18, v118, 14, v117
    v_lshl_add_u32 v116, v121, 3, v114
    v_lshlrev_b32 v119, 9, v116
    v_add_u32 v116, 6, v116
    v_lshl_add_u32 v117, v120, 4, v116
    v_xor_b32 v117, v117, v115
    v_lshl_add_u32 v117, v117, 4, v119
    v_lshl_add_u32 v15, v120, 14, v117
    v_and_b32 v117, 7, v116
    v_lshlrev_b32 v117, 1, v117
    v_xor_b32 v117, v117, v115
    v_lshl_add_u32 v117, v117, 4, v119
    v_lshrrev_b32 v118, 4, v115
    v_xor_b32 v118, v118, v120
    v_lshl_add_u32 v19, v118, 14, v117
    s_mul_i32 s3, s6, 229376
    s_add_u32 s24, s24, s3
    s_addc_u32 s25, s25, 0
    s_mov_b32 s26, 229376
    s_mov_b32 s27, 0x20000
    s_lshl_b32 s3, s4, 3
    s_add_u32 s3, s3, s5
    s_lshl_b32 s3, s3, 4
    s_add_u32 s3, s3, s6
    s_mul_i32 s3, s3, 100352
    s_add_u32 s28, s56, s3
    s_addc_u32 s29, s57, 0
    s_mov_b32 s30, 100352
    s_mov_b32 s31, 0x20000
    s_mov_b32 s66, 0x41000000
    s_mov_b32 s67, 0x3db8aa3b
    s_mov_b32 s70, s67
    s_mov_b32 s71, s67
    v_and_b32 v116, 15, v112
    v_bfe_u32 v123, v112, 2, 2
    v_lshrrev_b32 v117, 1, v116
    v_xor_b32 v117, v117, v122
    v_lshlrev_b32 v117, 4, v117
    v_lshl_add_u32 v117, v116, 7, v117
    v_lshl_add_u32 v117, v121, 13, v117
    v_add_u32 v64, 131072, v117
    v_xor_b32 v65, 64, v64
    v_lshlrev_b32 v117, 4, v116
    v_lshl_add_u32 v117, v113, 8, v117
    v_add_u32 v22, 142336, v117
    v_xor_b32 v23, 256, v22
    v_lshl_add_u32 v117, v122, 3, v123
    v_lshlrev_b32 v117, 9, v117
    v_lshl_add_u32 v117, v120, 8, v117
    v_lshl_add_u32 v117, v123, 6, v117
    v_lshl_add_u32 v117, v124, 4, v117
    v_xor_b32 v96, 0, v117
    v_add_u32 v100, 65536, v96
    v_xor_b32 v97, 64, v117
    v_add_u32 v101, 65536, v97
    v_xor_b32 v98, 128, v117
    v_add_u32 v102, 65536, v98
    v_xor_b32 v99, 192, v117
    v_add_u32 v103, 65536, v99
    v_xor_b32 v117, v122, v116
    v_lshlrev_b32 v117, 4, v117
    v_lshl_add_u32 v117, v116, 9, v117
    v_lshl_add_u32 v117, v120, 14, v117
    v_xor_b32 v0, 0, v117
    v_xor_b32 v1, 64, v117
    v_xor_b32 v2, 128, v117
    v_xor_b32 v3, 192, v117
    v_lshl_add_u32 v118, v122, 2, v123
    v_and_b32 v117, 7, v118
    v_lshlrev_b32 v117, 5, v117
    v_lshl_add_u32 v117, v118, 9, v117
    v_lshl_add_u32 v117, v120, 8, v117
    v_lshl_add_u32 v117, v124, 3, v117
    v_add_u32 v117, 65536, v117
    v_xor_b32 v4, 0, v117
    v_xor_b32 v5, 32, v117
    v_xor_b32 v6, 64, v117
    v_xor_b32 v7, 96, v117
    v_xor_b32 v8, 128, v117
    v_xor_b32 v9, 160, v117
    v_xor_b32 v10, 192, v117
    v_xor_b32 v11, 224, v117
    v_bfe_u32 v117, v118, 1, 2
    v_lshlrev_b32 v119, 1, v120
    v_xor_b32 v117, v117, v119
    v_lshlrev_b32 v117, 5, v117
    v_lshl_add_u32 v117, v118, 7, v117
    v_lshl_add_u32 v117, v124, 3, v117
    v_accvgpr_write_b32 a176, v117
    v_and_b32 v117, 7, v112
    v_lshlrev_b32 v118, 1, v122
    v_xor_b32 v117, v117, v118
    v_lshl_add_u32 v118, v120, 1, v121
    v_lshrrev_b32 v119, 3, v112
    v_lshl_add_u32 v118, v118, 6, v119
    v_mul_u32_u24 v118, 896, v118
    v_lshl_add_u32 v117, v117, 4, v118
    v_accvgpr_write_b32 a177, v117
    v_lshrrev_b32 v117, 1, v112
    v_lshl_add_u32 v117, v113, 3, v117
    s_lshl_b32 s3, s5, 5
    v_add_u32 v117, s3, v117
    v_mul_u32_u24 v117, 896, v117
    v_and_b32 v118, 1, v112
    v_lshl_add_u32 v117, v118, 7, v117
    v_cmp_gt_u32 vcc, 16, v112
    v_mov_b32 v119, 0x7ff00000
    s_nop 0
    v_cndmask_b32 v117, v119, v117, vcc
    v_accvgpr_write_b32 a180, v117
    v_mul_u32_u24 v117, 56, v121
    v_add_u32 v117, v117, v120
    v_lshlrev_b32 v117, 10, v117
    v_lshl_add_u32 v20, v112, 4, v117
    v_lshlrev_b32 v117, 4, v112
    v_lshl_add_u32 v117, v113, 12, v117
    v_add_u32 v29, 131072, v117
    v_xor_b32 v30, 4096, v29
    v_mov_b32 v31, 163824
    v_mov_b32 v24, 0
    v_mov_b32 v25, 0
    v_mov_b32 v26, 0
    v_mov_b32 v27, 0
    v_mov_b32 v32, 0
    v_mov_b32 v33, 0
    v_mov_b32 v34, 0
    v_mov_b32 v35, 0
    v_mov_b32 v36, 0
    v_mov_b32 v37, 0
    v_mov_b32 v38, 0
    v_mov_b32 v39, 0
    v_mov_b32 v40, 0
    v_mov_b32 v41, 0
    v_mov_b32 v42, 0
    v_mov_b32 v43, 0
    v_mov_b32 v44, 0
    v_mov_b32 v45, 0
    v_mov_b32 v46, 0
    v_mov_b32 v47, 0
    s_add_u32 m0, s59, 32768
    s_mov_b32 s68, 524288
    buffer_load_dwordx4 v104, s[20:23], s68 offen offset:0  lds
    buffer_load_dwordx4 v105, s[20:23], s68 offen offset:1024  lds
    buffer_load_dwordx4 v106, s[20:23], s68 offen offset:2048  lds
    buffer_load_dwordx4 v107, s[20:23], s68 offen offset:3072  lds
    s_add_u32 m0, s59, 49152
    s_mov_b32 s68, 786432
    buffer_load_dwordx4 v104, s[20:23], s68 offen offset:0  lds
    buffer_load_dwordx4 v105, s[20:23], s68 offen offset:1024  lds
    buffer_load_dwordx4 v106, s[20:23], s68 offen offset:2048  lds
    buffer_load_dwordx4 v107, s[20:23], s68 offen offset:3072  lds
    global_load_dword v68, v68, s[98:99]
    s_mov_b32 s65, 14
    s_cmp_ge_u32 s58, 2
    s_cbranch_scc1 L_path3
    s_waitcnt vmcnt(17)
    s_barrier
    ds_read_b128 a[192:195], v64 offset:0
    ds_read_b128 a[196:199], v64 offset:2048
    ds_read_b128 a[200:203], v64 offset:4096
    ds_read_b128 a[204:207], v64 offset:6144
    ds_read_b64_tr_b16 a[144:145], v100 offset:32768
    ds_read_b64_tr_b16 a[146:147], v100 offset:34816
    ds_read_b64_tr_b16 a[148:149], v100 offset:32776
    ds_read_b64_tr_b16 a[150:151], v100 offset:34824
    ds_read_b64_tr_b16 a[152:153], v101 offset:32768
    ds_read_b64_tr_b16 a[154:155], v101 offset:34816
    s_waitcnt lgkmcnt(4)
    v_mfma_f32_16x16x32_bf16 v[128:131], a[144:147], a[192:195], 0
    s_waitcnt vmcnt(13)
    s_barrier
    ds_read_b64_tr_b16 a[156:157], v101 offset:32776
    v_mfma_f32_16x16x32_bf16 v[132:135], a[144:147], a[196:199], 0
    ds_read_b64_tr_b16 a[158:159], v101 offset:34824
    s_add_u32 m0, s59, 65536
    s_mov_b32 s68, 1048576
    v_mfma_f32_16x16x32_bf16 v[136:139], a[144:147], a[200:203], 0
    buffer_load_dwordx4 v104, s[20:23], s68 offen offset:0  lds
    v_mfma_f32_16x16x32_bf16 v[140:143], a[144:147], a[204:207], 0
    ds_read_b128 a[208:211], v65 offset:0
    s_waitcnt lgkmcnt(5)
    v_mfma_f32_16x16x32_bf16 v[156:159], a[148:151], a[204:207], 0
    ds_read_b64_tr_b16 a[160:161], v102 offset:32768
    v_mfma_f32_16x16x32_bf16 v[152:155], a[148:151], a[200:203], 0
    ds_read_b64_tr_b16 a[162:163], v102 offset:34816
    ds_read_b128 a[212:215], v65 offset:2048
    v_mfma_f32_16x16x32_bf16 v[148:151], a[148:151], a[196:199], 0
    buffer_load_dwordx4 v105, s[20:23], s68 offen offset:1024  lds
    v_mfma_f32_16x16x32_bf16 v[144:147], a[148:151], a[192:195], 0
    s_waitcnt lgkmcnt(6)
    v_mfma_f32_16x16x32_bf16 v[160:163], a[152:155], a[192:195], 0
    ds_read_b64_tr_b16 a[164:165], v102 offset:32776
    v_mfma_f32_16x16x32_bf16 v[164:167], a[152:155], a[196:199], 0
    ds_read_b64_tr_b16 a[166:167], v102 offset:34824
    v_mfma_f32_16x16x32_bf16 v[168:171], a[152:155], a[200:203], 0
    buffer_load_dwordx4 v106, s[20:23], s68 offen offset:2048  lds
    v_mfma_f32_16x16x32_bf16 v[172:175], a[152:155], a[204:207], 0
    ds_read_b128 a[216:219], v65 offset:4096
    s_waitcnt lgkmcnt(7)
    v_mfma_f32_16x16x32_bf16 v[188:191], a[156:159], a[204:207], 0
    ds_read_b64_tr_b16 a[168:169], v103 offset:32768
    v_mfma_f32_16x16x32_bf16 v[184:187], a[156:159], a[200:203], 0
    ds_read_b64_tr_b16 a[170:171], v103 offset:34816
    v_mfma_f32_16x16x32_bf16 v[180:183], a[156:159], a[196:199], 0
    buffer_load_dwordx4 v107, s[20:23], s68 offen offset:3072  lds
    v_mfma_f32_16x16x32_bf16 v[176:179], a[156:159], a[192:195], 0
    ds_read_b128 a[220:223], v65 offset:6144
    s_waitcnt lgkmcnt(7)
    v_mfma_f32_16x16x32_bf16 v[192:195], a[160:163], a[192:195], 0
    ds_read_b64_tr_b16 a[172:173], v103 offset:32776
    v_mfma_f32_16x16x32_bf16 v[196:199], a[160:163], a[196:199], 0
    ds_read_b64_tr_b16 a[174:175], v103 offset:34824
    s_add_u32 m0, s59, 81920
    s_mov_b32 s68, 1310720
    v_mfma_f32_16x16x32_bf16 v[200:203], a[160:163], a[200:203], 0
    buffer_load_dwordx4 v104, s[20:23], s68 offen offset:0  lds
    v_mfma_f32_16x16x32_bf16 v[204:207], a[160:163], a[204:207], 0
    s_waitcnt lgkmcnt(6)
    v_mfma_f32_16x16x32_bf16 v[220:223], a[164:167], a[204:207], 0
    ds_read_b64_tr_b16 a[144:145], v100 offset:49152
    v_mfma_f32_16x16x32_bf16 v[216:219], a[164:167], a[200:203], 0
    ds_read_b64_tr_b16 a[146:147], v100 offset:51200
    v_mfma_f32_16x16x32_bf16 v[212:215], a[164:167], a[196:199], 0
    buffer_load_dwordx4 v105, s[20:23], s68 offen offset:1024  lds
    v_mfma_f32_16x16x32_bf16 v[208:211], a[164:167], a[192:195], 0
    s_waitcnt lgkmcnt(5)
    v_mfma_f32_16x16x32_bf16 v[224:227], a[168:171], a[192:195], 0
    ds_read_b64_tr_b16 a[148:149], v100 offset:49160
    v_mfma_f32_16x16x32_bf16 v[228:231], a[168:171], a[196:199], 0
    ds_read_b64_tr_b16 a[150:151], v100 offset:51208
    v_mfma_f32_16x16x32_bf16 v[232:235], a[168:171], a[200:203], 0
    buffer_load_dwordx4 v106, s[20:23], s68 offen offset:2048  lds
    v_mfma_f32_16x16x32_bf16 v[236:239], a[168:171], a[204:207], 0
    s_waitcnt lgkmcnt(4)
    v_mfma_f32_16x16x32_bf16 v[252:255], a[172:175], a[204:207], 0
    ds_read_b64_tr_b16 a[152:153], v101 offset:49152
    v_mfma_f32_16x16x32_bf16 v[248:251], a[172:175], a[200:203], 0
    ds_read_b64_tr_b16 a[154:155], v101 offset:51200
    v_mfma_f32_16x16x32_bf16 v[244:247], a[172:175], a[196:199], 0
    buffer_load_dwordx4 v107, s[20:23], s68 offen offset:3072  lds
    v_mfma_f32_16x16x32_bf16 v[240:243], a[172:175], a[192:195], 0
    s_waitcnt lgkmcnt(4)
    v_mfma_f32_16x16x32_bf16 v[128:131], a[144:147], a[208:211], v[128:131]
    s_waitcnt vmcnt(13)
    s_waitcnt vmcnt(63)
    s_barrier
    ds_read_b64_tr_b16 a[156:157], v101 offset:49160
    v_mfma_f32_16x16x32_bf16 v[132:135], a[144:147], a[212:215], v[132:135]
    ds_read_b64_tr_b16 a[158:159], v101 offset:51208
    s_add_u32 m0, s59, 131072
    s_mov_b32 s68, 256
    v_mfma_f32_16x16x32_bf16 v[136:139], a[144:147], a[216:219], v[136:139]
    buffer_load_dwordx4 v108, s[8:11], s68 offen offset:0  lds
    v_mfma_f32_16x16x32_bf16 v[140:143], a[144:147], a[220:223], v[140:143]
    ds_read_b128 a[192:195], v64 offset:16384
    s_waitcnt lgkmcnt(5)
    v_mfma_f32_16x16x32_bf16 v[156:159], a[148:151], a[220:223], v[156:159]
    ds_read_b64_tr_b16 a[160:161], v102 offset:49152
    v_mfma_f32_16x16x32_bf16 v[152:155], a[148:151], a[216:219], v[152:155]
    ds_read_b64_tr_b16 a[162:163], v102 offset:51200
    ds_read_b128 a[196:199], v64 offset:18432
    v_mfma_f32_16x16x32_bf16 v[148:151], a[148:151], a[212:215], v[148:151]
    buffer_load_dwordx4 v109, s[8:11], s68 offen offset:1024  lds
    v_mfma_f32_16x16x32_bf16 v[144:147], a[148:151], a[208:211], v[144:147]
    s_waitcnt lgkmcnt(6)
    v_mfma_f32_16x16x32_bf16 v[160:163], a[152:155], a[208:211], v[160:163]
    ds_read_b64_tr_b16 a[164:165], v102 offset:49160
    v_mfma_f32_16x16x32_bf16 v[164:167], a[152:155], a[212:215], v[164:167]
    ds_read_b64_tr_b16 a[166:167], v102 offset:51208
    v_mfma_f32_16x16x32_bf16 v[168:171], a[152:155], a[216:219], v[168:171]
    buffer_load_dwordx4 v110, s[8:11], s68 offen offset:2048  lds
    v_mfma_f32_16x16x32_bf16 v[172:175], a[152:155], a[220:223], v[172:175]
    ds_read_b128 a[200:203], v64 offset:20480
    s_waitcnt lgkmcnt(7)
    v_mfma_f32_16x16x32_bf16 v[188:191], a[156:159], a[220:223], v[188:191]
    ds_read_b64_tr_b16 a[168:169], v103 offset:49152
    v_mfma_f32_16x16x32_bf16 v[184:187], a[156:159], a[216:219], v[184:187]
    ds_read_b64_tr_b16 a[170:171], v103 offset:51200
    v_mfma_f32_16x16x32_bf16 v[180:183], a[156:159], a[212:215], v[180:183]
    buffer_load_dwordx4 v111, s[8:11], s68 offen offset:3072  lds
    v_mfma_f32_16x16x32_bf16 v[176:179], a[156:159], a[208:211], v[176:179]
    ds_read_b128 a[204:207], v64 offset:22528
    s_waitcnt lgkmcnt(7)
    v_mfma_f32_16x16x32_bf16 v[192:195], a[160:163], a[208:211], v[192:195]
    ds_read_b64_tr_b16 a[172:173], v103 offset:49160
    v_mfma_f32_16x16x32_bf16 v[196:199], a[160:163], a[212:215], v[196:199]
    ds_read_b64_tr_b16 a[174:175], v103 offset:51208
    s_add_u32 m0, s59, 98304
    s_mov_b32 s68, 1572864
    v_mfma_f32_16x16x32_bf16 v[200:203], a[160:163], a[216:219], v[200:203]
    buffer_load_dwordx4 v104, s[20:23], s68 offen offset:0  lds
    v_mfma_f32_16x16x32_bf16 v[204:207], a[160:163], a[220:223], v[204:207]
    s_waitcnt lgkmcnt(6)
    v_mfma_f32_16x16x32_bf16 v[220:223], a[164:167], a[220:223], v[220:223]
    ds_read_b64_tr_b16 a[144:145], v96 offset:32768
    v_mfma_f32_16x16x32_bf16 v[216:219], a[164:167], a[216:219], v[216:219]
    ds_read_b64_tr_b16 a[146:147], v96 offset:34816
    v_mfma_f32_16x16x32_bf16 v[212:215], a[164:167], a[212:215], v[212:215]
    buffer_load_dwordx4 v105, s[20:23], s68 offen offset:1024  lds
    v_mfma_f32_16x16x32_bf16 v[208:211], a[164:167], a[208:211], v[208:211]
    s_waitcnt lgkmcnt(5)
    v_mfma_f32_16x16x32_bf16 v[224:227], a[168:171], a[208:211], v[224:227]
    ds_read_b64_tr_b16 a[148:149], v96 offset:32776
    v_mfma_f32_16x16x32_bf16 v[228:231], a[168:171], a[212:215], v[228:231]
    ds_read_b64_tr_b16 a[150:151], v96 offset:34824
    v_mfma_f32_16x16x32_bf16 v[232:235], a[168:171], a[216:219], v[232:235]
    buffer_load_dwordx4 v106, s[20:23], s68 offen offset:2048  lds
    v_mfma_f32_16x16x32_bf16 v[236:239], a[168:171], a[220:223], v[236:239]
    s_waitcnt lgkmcnt(4)
    v_mfma_f32_16x16x32_bf16 v[252:255], a[172:175], a[220:223], v[252:255]
    ds_read_b64_tr_b16 a[152:153], v97 offset:32768
    v_mfma_f32_16x16x32_bf16 v[248:251], a[172:175], a[216:219], v[248:251]
    ds_read_b64_tr_b16 a[154:155], v97 offset:34816
    v_mfma_f32_16x16x32_bf16 v[244:247], a[172:175], a[212:215], v[244:247]
    buffer_load_dwordx4 v107, s[20:23], s68 offen offset:3072  lds
    v_mfma_f32_16x16x32_bf16 v[240:243], a[172:175], a[208:211], v[240:243]
    s_waitcnt lgkmcnt(4)
    v_mfma_f32_16x16x32_bf16 v[128:131], a[144:147], a[192:195], v[128:131]
    s_waitcnt vmcnt(17)
    s_barrier
    ds_read_b64_tr_b16 a[156:157], v97 offset:32776
    v_mfma_f32_16x16x32_bf16 v[132:135], a[144:147], a[196:199], v[132:135]
    ds_read_b64_tr_b16 a[158:159], v97 offset:34824
    s_add_u32 m0, s59, 114688
    s_mov_b32 s68, 1835008
    v_mfma_f32_16x16x32_bf16 v[136:139], a[144:147], a[200:203], v[136:139]
    buffer_load_dwordx4 v104, s[20:23], s68 offen offset:0  lds
    v_mfma_f32_16x16x32_bf16 v[140:143], a[144:147], a[204:207], v[140:143]
    ds_read_b128 a[208:211], v65 offset:16384
    s_waitcnt lgkmcnt(5)
    v_mfma_f32_16x16x32_bf16 v[156:159], a[148:151], a[204:207], v[156:159]
    ds_read_b64_tr_b16 a[160:161], v98 offset:32768
    v_mfma_f32_16x16x32_bf16 v[152:155], a[148:151], a[200:203], v[152:155]
    ds_read_b64_tr_b16 a[162:163], v98 offset:34816
    ds_read_b128 a[212:215], v65 offset:18432
    v_mfma_f32_16x16x32_bf16 v[148:151], a[148:151], a[196:199], v[148:151]
    v_mfma_f32_16x16x32_bf16 v[144:147], a[148:151], a[192:195], v[144:147]
    s_waitcnt lgkmcnt(6)
    v_mfma_f32_16x16x32_bf16 v[160:163], a[152:155], a[192:195], v[160:163]
    ds_read_b64_tr_b16 a[164:165], v98 offset:32776
    v_mfma_f32_16x16x32_bf16 v[164:167], a[152:155], a[196:199], v[164:167]
    ds_read_b64_tr_b16 a[166:167], v98 offset:34824
    v_mfma_f32_16x16x32_bf16 v[168:171], a[152:155], a[200:203], v[168:171]
    ds_read_b128 a[216:219], v65 offset:20480
    v_mfma_f32_16x16x32_bf16 v[172:175], a[152:155], a[204:207], v[172:175]
    buffer_load_dwordx4 v105, s[20:23], s68 offen offset:1024  lds
    s_waitcnt lgkmcnt(7)
    v_mfma_f32_16x16x32_bf16 v[188:191], a[156:159], a[204:207], v[188:191]
    ds_read_b64_tr_b16 a[168:169], v99 offset:32768
    v_mfma_f32_16x16x32_bf16 v[184:187], a[156:159], a[200:203], v[184:187]
    ds_read_b64_tr_b16 a[170:171], v99 offset:34816
    v_mfma_f32_16x16x32_bf16 v[180:183], a[156:159], a[196:199], v[180:183]
    ds_read_b128 a[220:223], v65 offset:22528
    v_mfma_f32_16x16x32_bf16 v[176:179], a[156:159], a[192:195], v[176:179]
    s_waitcnt lgkmcnt(7)
    v_mfma_f32_16x16x32_bf16 v[192:195], a[160:163], a[192:195], v[192:195]
    ds_read_b64_tr_b16 a[172:173], v99 offset:32776
    v_mfma_f32_16x16x32_bf16 v[196:199], a[160:163], a[196:199], v[196:199]
    ds_read_b64_tr_b16 a[174:175], v99 offset:34824
    v_mfma_f32_16x16x32_bf16 v[200:203], a[160:163], a[200:203], v[200:203]
    v_mfma_f32_16x16x32_bf16 v[204:207], a[160:163], a[204:207], v[204:207]
    s_waitcnt lgkmcnt(6)
    v_mfma_f32_16x16x32_bf16 v[220:223], a[164:167], a[204:207], v[220:223]
    ds_read_b64_tr_b16 a[144:145], v96 offset:49152
    v_mfma_f32_16x16x32_bf16 v[216:219], a[164:167], a[200:203], v[216:219]
    ds_read_b64_tr_b16 a[146:147], v96 offset:51200
    v_mfma_f32_16x16x32_bf16 v[212:215], a[164:167], a[196:199], v[212:215]
    buffer_load_dwordx4 v106, s[20:23], s68 offen offset:2048  lds
    v_mfma_f32_16x16x32_bf16 v[208:211], a[164:167], a[192:195], v[208:211]
    s_waitcnt lgkmcnt(5)
    v_mfma_f32_16x16x32_bf16 v[224:227], a[168:171], a[192:195], v[224:227]
    ds_read_b64_tr_b16 a[148:149], v96 offset:49160
    v_mfma_f32_16x16x32_bf16 v[228:231], a[168:171], a[196:199], v[228:231]
    ds_read_b64_tr_b16 a[150:151], v96 offset:51208
    v_mfma_f32_16x16x32_bf16 v[232:235], a[168:171], a[200:203], v[232:235]
    v_mfma_f32_16x16x32_bf16 v[236:239], a[168:171], a[204:207], v[236:239]
    s_waitcnt lgkmcnt(4)
    v_mfma_f32_16x16x32_bf16 v[252:255], a[172:175], a[204:207], v[252:255]
    ds_read_b64_tr_b16 a[152:153], v97 offset:49152
    v_mfma_f32_16x16x32_bf16 v[248:251], a[172:175], a[200:203], v[248:251]
    ds_read_b64_tr_b16 a[154:155], v97 offset:51200
    v_mfma_f32_16x16x32_bf16 v[244:247], a[172:175], a[196:199], v[244:247]
    buffer_load_dwordx4 v107, s[20:23], s68 offen offset:3072  lds
    v_mfma_f32_16x16x32_bf16 v[240:243], a[172:175], a[192:195], v[240:243]
    s_waitcnt lgkmcnt(4)
    v_mfma_f32_16x16x32_bf16 v[128:131], a[144:147], a[208:211], v[128:131]
    s_waitcnt vmcnt(16)
    s_waitcnt vmcnt(8)
    s_barrier
    ds_read_b64_tr_b16 a[156:157], v97 offset:49160
    v_mfma_f32_16x16x32_bf16 v[132:135], a[144:147], a[212:215], v[132:135]
    ds_read_b64_tr_b16 a[158:159], v97 offset:51208
    s_add_u32 m0, s59, 147456
    s_mov_b32 s68, 384
    v_mfma_f32_16x16x32_bf16 v[136:139], a[144:147], a[216:219], v[136:139]
    buffer_load_dwordx4 v108, s[8:11], s68 offen offset:0  lds
    v_mfma_f32_16x16x32_bf16 v[140:143], a[144:147], a[220:223], v[140:143]
    ds_read_b128 a[192:195], v64 offset:0
    s_waitcnt lgkmcnt(5)
    v_mfma_f32_16x16x32_bf16 v[156:159], a[148:151], a[220:223], v[156:159]
    ds_read_b64_tr_b16 a[160:161], v98 offset:49152
    v_mfma_f32_16x16x32_bf16 v[152:155], a[148:151], a[216:219], v[152:155]
    ds_read_b64_tr_b16 a[162:163], v98 offset:51200
    ds_read_b128 a[196:199], v64 offset:2048
    v_mfma_f32_16x16x32_bf16 v[148:151], a[148:151], a[212:215], v[148:151]
    buffer_load_dwordx4 v109, s[8:11], s68 offen offset:1024  lds
    v_mfma_f32_16x16x32_bf16 v[144:147], a[148:151], a[208:211], v[144:147]
    s_waitcnt lgkmcnt(6)
    v_mfma_f32_16x16x32_bf16 v[160:163], a[152:155], a[208:211], v[160:163]
    ds_read_b64_tr_b16 a[164:165], v98 offset:49160
    v_mfma_f32_16x16x32_bf16 v[164:167], a[152:155], a[212:215], v[164:167]
    ds_read_b64_tr_b16 a[166:167], v98 offset:51208
    v_mfma_f32_16x16x32_bf16 v[168:171], a[152:155], a[216:219], v[168:171]
    buffer_load_dwordx4 v110, s[8:11], s68 offen offset:2048  lds
    v_mfma_f32_16x16x32_bf16 v[172:175], a[152:155], a[220:223], v[172:175]
    ds_read_b128 a[200:203], v64 offset:4096
    s_waitcnt lgkmcnt(7)
    v_mfma_f32_16x16x32_bf16 v[188:191], a[156:159], a[220:223], v[188:191]
    ds_read_b64_tr_b16 a[168:169], v99 offset:49152
    v_mfma_f32_16x16x32_bf16 v[184:187], a[156:159], a[216:219], v[184:187]
    ds_read_b64_tr_b16 a[170:171], v99 offset:51200
    v_mfma_f32_16x16x32_bf16 v[180:183], a[156:159], a[212:215], v[180:183]
    buffer_load_dwordx4 v111, s[8:11], s68 offen offset:3072  lds
    v_mfma_f32_16x16x32_bf16 v[176:179], a[156:159], a[208:211], v[176:179]
    ds_read_b128 a[204:207], v64 offset:6144
    s_waitcnt lgkmcnt(7)
    v_mfma_f32_16x16x32_bf16 v[192:195], a[160:163], a[208:211], v[192:195]
    ds_read_b64_tr_b16 a[172:173], v99 offset:49160
    v_mfma_f32_16x16x32_bf16 v[196:199], a[160:163], a[212:215], v[196:199]
    ds_read_b64_tr_b16 a[174:175], v99 offset:51208
    s_add_u32 m0, s59, 32768
    s_mov_b32 s68, 2097152
    v_mfma_f32_16x16x32_bf16 v[200:203], a[160:163], a[216:219], v[200:203]
    buffer_load_dwordx4 v104, s[20:23], s68 offen offset:0  lds
    v_mfma_f32_16x16x32_bf16 v[204:207], a[160:163], a[220:223], v[204:207]
    s_waitcnt lgkmcnt(6)
    v_mfma_f32_16x16x32_bf16 v[220:223], a[164:167], a[220:223], v[220:223]
    ds_read_b64_tr_b16 a[144:145], v100 offset:0
    v_mfma_f32_16x16x32_bf16 v[216:219], a[164:167], a[216:219], v[216:219]
    ds_read_b64_tr_b16 a[146:147], v100 offset:2048
    v_mfma_f32_16x16x32_bf16 v[212:215], a[164:167], a[212:215], v[212:215]
    buffer_load_dwordx4 v105, s[20:23], s68 offen offset:1024  lds
    v_mfma_f32_16x16x32_bf16 v[208:211], a[164:167], a[208:211], v[208:211]
    s_waitcnt lgkmcnt(5)
    v_mfma_f32_16x16x32_bf16 v[224:227], a[168:171], a[208:211], v[224:227]
    ds_read_b64_tr_b16 a[148:149], v100 offset:8
    v_mfma_f32_16x16x32_bf16 v[228:231], a[168:171], a[212:215], v[228:231]
    ds_read_b64_tr_b16 a[150:151], v100 offset:2056
    v_mfma_f32_16x16x32_bf16 v[232:235], a[168:171], a[216:219], v[232:235]
    buffer_load_dwordx4 v106, s[20:23], s68 offen offset:2048  lds
    v_mfma_f32_16x16x32_bf16 v[236:239], a[168:171], a[220:223], v[236:239]
    s_waitcnt lgkmcnt(4)
    v_mfma_f32_16x16x32_bf16 v[252:255], a[172:175], a[220:223], v[252:255]
    ds_read_b64_tr_b16 a[152:153], v101 offset:0
    v_mfma_f32_16x16x32_bf16 v[248:251], a[172:175], a[216:219], v[248:251]
    ds_read_b64_tr_b16 a[154:155], v101 offset:2048
    v_mfma_f32_16x16x32_bf16 v[244:247], a[172:175], a[212:215], v[244:247]
    buffer_load_dwordx4 v107, s[20:23], s68 offen offset:3072  lds
    v_mfma_f32_16x16x32_bf16 v[240:243], a[172:175], a[208:211], v[240:243]
    s_waitcnt lgkmcnt(4)
    v_mfma_f32_16x16x32_bf16 v[128:131], a[144:147], a[192:195], v[128:131]
    s_waitcnt vmcnt(63)
    s_barrier
    ds_read_b64_tr_b16 a[156:157], v101 offset:8
    v_mfma_f32_16x16x32_bf16 v[132:135], a[144:147], a[196:199], v[132:135]
    ds_read_b64_tr_b16 a[158:159], v101 offset:2056
    s_add_u32 m0, s59, 49152
    s_mov_b32 s68, 2359296
    v_mfma_f32_16x16x32_bf16 v[136:139], a[144:147], a[200:203], v[136:139]
    buffer_load_dwordx4 v104, s[20:23], s68 offen offset:0  lds
    v_mfma_f32_16x16x32_bf16 v[140:143], a[144:147], a[204:207], v[140:143]
    ds_read_b128 a[208:211], v65 offset:0
    s_waitcnt lgkmcnt(5)
    v_mfma_f32_16x16x32_bf16 v[156:159], a[148:151], a[204:207], v[156:159]
    ds_read_b64_tr_b16 a[160:161], v102 offset:0
    v_mfma_f32_16x16x32_bf16 v[152:155], a[148:151], a[200:203], v[152:155]
    ds_read_b64_tr_b16 a[162:163], v102 offset:2048
    ds_read_b128 a[212:215], v65 offset:2048
    v_mfma_f32_16x16x32_bf16 v[148:151], a[148:151], a[196:199], v[148:151]
    v_mfma_f32_16x16x32_bf16 v[144:147], a[148:151], a[192:195], v[144:147]
    s_waitcnt lgkmcnt(6)
    v_mfma_f32_16x16x32_bf16 v[160:163], a[152:155], a[192:195], v[160:163]
    ds_read_b64_tr_b16 a[164:165], v102 offset:8
    v_mfma_f32_16x16x32_bf16 v[164:167], a[152:155], a[196:199], v[164:167]
    ds_read_b64_tr_b16 a[166:167], v102 offset:2056
    v_mfma_f32_16x16x32_bf16 v[168:171], a[152:155], a[200:203], v[168:171]
    ds_read_b128 a[216:219], v65 offset:4096
    v_mfma_f32_16x16x32_bf16 v[172:175], a[152:155], a[204:207], v[172:175]
    buffer_load_dwordx4 v105, s[20:23], s68 offen offset:1024  lds
    s_waitcnt lgkmcnt(7)
    v_mfma_f32_16x16x32_bf16 v[188:191], a[156:159], a[204:207], v[188:191]
    ds_read_b64_tr_b16 a[168:169], v103 offset:0
    v_mfma_f32_16x16x32_bf16 v[184:187], a[156:159], a[200:203], v[184:187]
    ds_read_b64_tr_b16 a[170:171], v103 offset:2048
    v_mfma_f32_16x16x32_bf16 v[180:183], a[156:159], a[196:199], v[180:183]
    ds_read_b128 a[220:223], v65 offset:6144
    v_mfma_f32_16x16x32_bf16 v[176:179], a[156:159], a[192:195], v[176:179]
    s_waitcnt lgkmcnt(7)
    v_mfma_f32_16x16x32_bf16 v[192:195], a[160:163], a[192:195], v[192:195]
    ds_read_b64_tr_b16 a[172:173], v103 offset:8
    v_mfma_f32_16x16x32_bf16 v[196:199], a[160:163], a[196:199], v[196:199]
    ds_read_b64_tr_b16 a[174:175], v103 offset:2056
    v_mfma_f32_16x16x32_bf16 v[200:203], a[160:163], a[200:203], v[200:203]
    v_mfma_f32_16x16x32_bf16 v[204:207], a[160:163], a[204:207], v[204:207]
    s_waitcnt lgkmcnt(6)
    v_mfma_f32_16x16x32_bf16 v[220:223], a[164:167], a[204:207], v[220:223]
    ds_read_b64_tr_b16 a[144:145], v100 offset:16384
    v_mfma_f32_16x16x32_bf16 v[216:219], a[164:167], a[200:203], v[216:219]
    ds_read_b64_tr_b16 a[146:147], v100 offset:18432
    v_mfma_f32_16x16x32_bf16 v[212:215], a[164:167], a[196:199], v[212:215]
    buffer_load_dwordx4 v106, s[20:23], s68 offen offset:2048  lds
    v_mfma_f32_16x16x32_bf16 v[208:211], a[164:167], a[192:195], v[208:211]
    s_waitcnt lgkmcnt(5)
    v_mfma_f32_16x16x32_bf16 v[224:227], a[168:171], a[192:195], v[224:227]
    ds_read_b64_tr_b16 a[148:149], v100 offset:16392
    v_mfma_f32_16x16x32_bf16 v[228:231], a[168:171], a[196:199], v[228:231]
    ds_read_b64_tr_b16 a[150:151], v100 offset:18440
    v_mfma_f32_16x16x32_bf16 v[232:235], a[168:171], a[200:203], v[232:235]
    v_mfma_f32_16x16x32_bf16 v[236:239], a[168:171], a[204:207], v[236:239]
    s_waitcnt lgkmcnt(4)
    v_mfma_f32_16x16x32_bf16 v[252:255], a[172:175], a[204:207], v[252:255]
    ds_read_b64_tr_b16 a[152:153], v101 offset:16384
    v_mfma_f32_16x16x32_bf16 v[248:251], a[172:175], a[200:203], v[248:251]
    ds_read_b64_tr_b16 a[154:155], v101 offset:18432
    v_mfma_f32_16x16x32_bf16 v[244:247], a[172:175], a[196:199], v[244:247]
    buffer_load_dwordx4 v107, s[20:23], s68 offen offset:3072  lds
    v_mfma_f32_16x16x32_bf16 v[240:243], a[172:175], a[192:195], v[240:243]
    s_waitcnt lgkmcnt(4)
    v_mfma_f32_16x16x32_bf16 v[128:131], a[144:147], a[208:211], v[128:131]
    s_waitcnt vmcnt(16)
    s_waitcnt vmcnt(8)
    s_barrier
    ds_read_b64_tr_b16 a[156:157], v101 offset:16392
    v_mfma_f32_16x16x32_bf16 v[132:135], a[144:147], a[212:215], v[132:135]
    ds_read_b64_tr_b16 a[158:159], v101 offset:18440
    s_add_u32 m0, s59, 131072
    s_mov_b32 s68, 512
    v_mfma_f32_16x16x32_bf16 v[136:139], a[144:147], a[216:219], v[136:139]
    buffer_load_dwordx4 v108, s[8:11], s68 offen offset:0  lds
    v_mfma_f32_16x16x32_bf16 v[140:143], a[144:147], a[220:223], v[140:143]
    ds_read_b128 a[192:195], v64 offset:16384
    s_waitcnt lgkmcnt(5)
    v_mfma_f32_16x16x32_bf16 v[156:159], a[148:151], a[220:223], v[156:159]
    ds_read_b64_tr_b16 a[160:161], v102 offset:16384
    v_mfma_f32_16x16x32_bf16 v[152:155], a[148:151], a[216:219], v[152:155]
    ds_read_b64_tr_b16 a[162:163], v102 offset:18432
    ds_read_b128 a[196:199], v64 offset:18432
    v_mfma_f32_16x16x32_bf16 v[148:151], a[148:151], a[212:215], v[148:151]
    buffer_load_dwordx4 v109, s[8:11], s68 offen offset:1024  lds
    v_mfma_f32_16x16x32_bf16 v[144:147], a[148:151], a[208:211], v[144:147]
    s_waitcnt lgkmcnt(6)
    v_mfma_f32_16x16x32_bf16 v[160:163], a[152:155], a[208:211], v[160:163]
    ds_read_b64_tr_b16 a[164:165], v102 offset:16392
    v_mfma_f32_16x16x32_bf16 v[164:167], a[152:155], a[212:215], v[164:167]
    ds_read_b64_tr_b16 a[166:167], v102 offset:18440
    v_mfma_f32_16x16x32_bf16 v[168:171], a[152:155], a[216:219], v[168:171]
    buffer_load_dwordx4 v110, s[8:11], s68 offen offset:2048  lds
    v_mfma_f32_16x16x32_bf16 v[172:175], a[152:155], a[220:223], v[172:175]
    ds_read_b128 a[200:203], v64 offset:20480
    s_waitcnt lgkmcnt(7)
    v_mfma_f32_16x16x32_bf16 v[188:191], a[156:159], a[220:223], v[188:191]
    ds_read_b64_tr_b16 a[168:169], v103 offset:16384
    v_mfma_f32_16x16x32_bf16 v[184:187], a[156:159], a[216:219], v[184:187]
    ds_read_b64_tr_b16 a[170:171], v103 offset:18432
    v_mfma_f32_16x16x32_bf16 v[180:183], a[156:159], a[212:215], v[180:183]
    buffer_load_dwordx4 v111, s[8:11], s68 offen offset:3072  lds
    v_mfma_f32_16x16x32_bf16 v[176:179], a[156:159], a[208:211], v[176:179]
    ds_read_b128 a[204:207], v64 offset:22528
    s_waitcnt lgkmcnt(7)
    v_mfma_f32_16x16x32_bf16 v[192:195], a[160:163], a[208:211], v[192:195]
    ds_read_b64_tr_b16 a[172:173], v103 offset:16392
    v_mfma_f32_16x16x32_bf16 v[196:199], a[160:163], a[212:215], v[196:199]
    ds_read_b64_tr_b16 a[174:175], v103 offset:18440
    s_add_u32 m0, s59, 65536
    s_mov_b32 s68, 2621440
    v_mfma_f32_16x16x32_bf16 v[200:203], a[160:163], a[216:219], v[200:203]
    buffer_load_dwordx4 v104, s[20:23], s68 offen offset:0  lds
    v_mfma_f32_16x16x32_bf16 v[204:207], a[160:163], a[220:223], v[204:207]
    s_waitcnt lgkmcnt(6)
    v_mfma_f32_16x16x32_bf16 v[220:223], a[164:167], a[220:223], v[220:223]
    ds_read_b64_tr_b16 a[144:145], v100 offset:32768
    v_mfma_f32_16x16x32_bf16 v[216:219], a[164:167], a[216:219], v[216:219]
    ds_read_b64_tr_b16 a[146:147], v100 offset:34816
    v_mfma_f32_16x16x32_bf16 v[212:215], a[164:167], a[212:215], v[212:215]
    buffer_load_dwordx4 v105, s[20:23], s68 offen offset:1024  lds
    v_mfma_f32_16x16x32_bf16 v[208:211], a[164:167], a[208:211], v[208:211]
    s_waitcnt lgkmcnt(5)
    v_mfma_f32_16x16x32_bf16 v[224:227], a[168:171], a[208:211], v[224:227]
    ds_read_b64_tr_b16 a[148:149], v100 offset:32776
    v_mfma_f32_16x16x32_bf16 v[228:231], a[168:171], a[212:215], v[228:231]
    ds_read_b64_tr_b16 a[150:151], v100 offset:34824
    v_mfma_f32_16x16x32_bf16 v[232:235], a[168:171], a[216:219], v[232:235]
    buffer_load_dwordx4 v106, s[20:23], s68 offen offset:2048  lds
    v_mfma_f32_16x16x32_bf16 v[236:239], a[168:171], a[220:223], v[236:239]
    s_waitcnt lgkmcnt(4)
    v_mfma_f32_16x16x32_bf16 v[252:255], a[172:175], a[220:223], v[252:255]
    ds_read_b64_tr_b16 a[152:153], v101 offset:32768
    v_mfma_f32_16x16x32_bf16 v[248:251], a[172:175], a[216:219], v[248:251]
    ds_read_b64_tr_b16 a[154:155], v101 offset:34816
    v_mfma_f32_16x16x32_bf16 v[244:247], a[172:175], a[212:215], v[244:247]
    buffer_load_dwordx4 v107, s[20:23], s68 offen offset:3072  lds
    v_mfma_f32_16x16x32_bf16 v[240:243], a[172:175], a[208:211], v[240:243]
    s_waitcnt lgkmcnt(4)
    v_mfma_f32_16x16x32_bf16 v[128:131], a[144:147], a[192:195], v[128:131]
    s_waitcnt vmcnt(63)
    s_barrier
    ds_read_b64_tr_b16 a[156:157], v101 offset:32776
    v_mfma_f32_16x16x32_bf16 v[132:135], a[144:147], a[196:199], v[132:135]
    ds_read_b64_tr_b16 a[158:159], v101 offset:34824
    s_add_u32 m0, s59, 81920
    s_mov_b32 s68, 2883584
    v_mfma_f32_16x16x32_bf16 v[136:139], a[144:147], a[200:203], v[136:139]
    buffer_load_dwordx4 v104, s[20:23], s68 offen offset:0  lds
    v_mfma_f32_16x16x32_bf16 v[140:143], a[144:147], a[204:207], v[140:143]
    ds_read_b128 a[208:211], v65 offset:16384
    s_waitcnt lgkmcnt(5)
    v_mfma_f32_16x16x32_bf16 v[156:159], a[148:151], a[204:207], v[156:159]
    ds_read_b64_tr_b16 a[160:161], v102 offset:32768
    v_mfma_f32_16x16x32_bf16 v[152:155], a[148:151], a[200:203], v[152:155]
    ds_read_b64_tr_b16 a[162:163], v102 offset:34816
    ds_read_b128 a[212:215], v65 offset:18432
    v_mfma_f32_16x16x32_bf16 v[148:151], a[148:151], a[196:199], v[148:151]
    buffer_load_dwordx4 v105, s[20:23], s68 offen offset:1024  lds
    v_mfma_f32_16x16x32_bf16 v[144:147], a[148:151], a[192:195], v[144:147]
    s_waitcnt lgkmcnt(6)
    v_mfma_f32_16x16x32_bf16 v[160:163], a[152:155], a[192:195], v[160:163]
    ds_read_b64_tr_b16 a[164:165], v102 offset:32776
    v_mfma_f32_16x16x32_bf16 v[164:167], a[152:155], a[196:199], v[164:167]
    ds_read_b64_tr_b16 a[166:167], v102 offset:34824
    v_mfma_f32_16x16x32_bf16 v[168:171], a[152:155], a[200:203], v[168:171]
    buffer_load_dwordx4 v106, s[20:23], s68 offen offset:2048  lds
    v_mfma_f32_16x16x32_bf16 v[172:175], a[152:155], a[204:207], v[172:175]
    ds_read_b128 a[216:219], v65 offset:20480
    s_waitcnt lgkmcnt(7)
    v_mfma_f32_16x16x32_bf16 v[188:191], a[156:159], a[204:207], v[188:191]
    ds_read_b64_tr_b16 a[168:169], v103 offset:32768
    v_mfma_f32_16x16x32_bf16 v[184:187], a[156:159], a[200:203], v[184:187]
    ds_read_b64_tr_b16 a[170:171], v103 offset:34816
    v_mfma_f32_16x16x32_bf16 v[180:183], a[156:159], a[196:199], v[180:183]
    buffer_load_dwordx4 v107, s[20:23], s68 offen offset:3072  lds
    v_mfma_f32_16x16x32_bf16 v[176:179], a[156:159], a[192:195], v[176:179]
    ds_read_b128 a[220:223], v65 offset:22528
    s_waitcnt lgkmcnt(7)
    v_mfma_f32_16x16x32_bf16 v[192:195], a[160:163], a[192:195], v[192:195]
    ds_read_b64_tr_b16 a[172:173], v103 offset:32776
    v_mfma_f32_16x16x32_bf16 v[196:199], a[160:163], a[196:199], v[196:199]
    ds_read_b64_tr_b16 a[174:175], v103 offset:34824
    s_add_u32 m0, s60, 0
    v_mfma_f32_16x16x32_bf16 v[200:203], a[160:163], a[200:203], v[200:203]
    buffer_load_dwordx4 v12, s[12:15], s63 offen offset:0 nt lds
    v_mfma_f32_16x16x32_bf16 v[204:207], a[160:163], a[204:207], v[204:207]
    s_waitcnt lgkmcnt(6)
    v_mfma_f32_16x16x32_bf16 v[220:223], a[164:167], a[204:207], v[220:223]
    ds_read_b64_tr_b16 a[144:145], v100 offset:49152
    v_mfma_f32_16x16x32_bf16 v[216:219], a[164:167], a[200:203], v[216:219]
    ds_read_b64_tr_b16 a[146:147], v100 offset:51200
    v_mfma_f32_16x16x32_bf16 v[212:215], a[164:167], a[196:199], v[212:215]
    buffer_load_dwordx4 v13, s[12:15], s63 offen offset:1024 nt lds
    v_mfma_f32_16x16x32_bf16 v[208:211], a[164:167], a[192:195], v[208:211]
    s_waitcnt lgkmcnt(5)
    v_mfma_f32_16x16x32_bf16 v[224:227], a[168:171], a[192:195], v[224:227]
    ds_read_b64_tr_b16 a[148:149], v100 offset:49160
    v_mfma_f32_16x16x32_bf16 v[228:231], a[168:171], a[196:199], v[228:231]
    ds_read_b64_tr_b16 a[150:151], v100 offset:51208
    v_mfma_f32_16x16x32_bf16 v[232:235], a[168:171], a[200:203], v[232:235]
    buffer_load_dwordx4 v14, s[12:15], s63 offen offset:2048 nt lds
    v_mfma_f32_16x16x32_bf16 v[236:239], a[168:171], a[204:207], v[236:239]
    s_waitcnt lgkmcnt(4)
    v_mfma_f32_16x16x32_bf16 v[252:255], a[172:175], a[204:207], v[252:255]
    ds_read_b64_tr_b16 a[152:153], v101 offset:49152
    v_mfma_f32_16x16x32_bf16 v[248:251], a[172:175], a[200:203], v[248:251]
    ds_read_b64_tr_b16 a[154:155], v101 offset:51200
    v_mfma_f32_16x16x32_bf16 v[244:247], a[172:175], a[196:199], v[244:247]
    buffer_load_dwordx4 v15, s[12:15], s63 offen offset:3072 nt lds
    s_add_u32 s63, s63, 8192
    v_mfma_f32_16x16x32_bf16 v[240:243], a[172:175], a[192:195], v[240:243]
    s_waitcnt lgkmcnt(4)
    v_mfma_f32_16x16x32_bf16 v[128:131], a[144:147], a[208:211], v[128:131]
    s_waitcnt vmcnt(20)
    s_waitcnt vmcnt(12)
    s_barrier
    ds_read_b64_tr_b16 a[156:157], v101 offset:49160
    v_mfma_f32_16x16x32_bf16 v[132:135], a[144:147], a[212:215], v[132:135]
    ds_read_b64_tr_b16 a[158:159], v101 offset:51208
    s_add_u32 m0, s59, 147456
    s_mov_b32 s68, 640
    v_mfma_f32_16x16x32_bf16 v[136:139], a[144:147], a[216:219], v[136:139]
    buffer_load_dwordx4 v108, s[8:11], s68 offen offset:0  lds
    v_mfma_f32_16x16x32_bf16 v[140:143], a[144:147], a[220:223], v[140:143]
    ds_read_b128 a[192:195], v64 offset:0
    s_waitcnt lgkmcnt(5)
    v_mfma_f32_16x16x32_bf16 v[156:159], a[148:151], a[220:223], v[156:159]
    ds_read_b64_tr_b16 a[160:161], v102 offset:49152
    v_mfma_f32_16x16x32_bf16 v[152:155], a[148:151], a[216:219], v[152:155]
    ds_read_b64_tr_b16 a[162:163], v102 offset:51200
    ds_read_b128 a[196:199], v64 offset:2048
    v_mfma_f32_16x16x32_bf16 v[148:151], a[148:151], a[212:215], v[148:151]
    buffer_load_dwordx4 v109, s[8:11], s68 offen offset:1024  lds
    v_mfma_f32_16x16x32_bf16 v[144:147], a[148:151], a[208:211], v[144:147]
    s_waitcnt lgkmcnt(6)
    v_mfma_f32_16x16x32_bf16 v[160:163], a[152:155], a[208:211], v[160:163]
    ds_read_b64_tr_b16 a[164:165], v102 offset:49160
    v_mfma_f32_16x16x32_bf16 v[164:167], a[152:155], a[212:215], v[164:167]
    ds_read_b64_tr_b16 a[166:167], v102 offset:51208
    v_mfma_f32_16x16x32_bf16 v[168:171], a[152:155], a[216:219], v[168:171]
    buffer_load_dwordx4 v110, s[8:11], s68 offen offset:2048  lds
    v_mfma_f32_16x16x32_bf16 v[172:175], a[152:155], a[220:223], v[172:175]
    ds_read_b128 a[200:203], v64 offset:4096
    s_waitcnt lgkmcnt(7)
    v_mfma_f32_16x16x32_bf16 v[188:191], a[156:159], a[220:223], v[188:191]
    ds_read_b64_tr_b16 a[168:169], v103 offset:49152
    v_mfma_f32_16x16x32_bf16 v[184:187], a[156:159], a[216:219], v[184:187]
    ds_read_b64_tr_b16 a[170:171], v103 offset:51200
    v_mfma_f32_16x16x32_bf16 v[180:183], a[156:159], a[212:215], v[180:183]
    buffer_load_dwordx4 v111, s[8:11], s68 offen offset:3072  lds
    v_mfma_f32_16x16x32_bf16 v[176:179], a[156:159], a[208:211], v[176:179]
    ds_read_b128 a[204:207], v64 offset:6144
    s_waitcnt lgkmcnt(7)
    v_mfma_f32_16x16x32_bf16 v[192:195], a[160:163], a[208:211], v[192:195]
    ds_read_b64_tr_b16 a[172:173], v103 offset:49160
    v_mfma_f32_16x16x32_bf16 v[196:199], a[160:163], a[212:215], v[196:199]
    ds_read_b64_tr_b16 a[174:175], v103 offset:51208
    s_add_u32 m0, s59, 98304
    s_mov_b32 s68, 3145728
    v_mfma_f32_16x16x32_bf16 v[200:203], a[160:163], a[216:219], v[200:203]
    buffer_load_dwordx4 v104, s[20:23], s68 offen offset:0  lds
    v_mfma_f32_16x16x32_bf16 v[204:207], a[160:163], a[220:223], v[204:207]
    s_waitcnt lgkmcnt(6)
    v_mfma_f32_16x16x32_bf16 v[220:223], a[164:167], a[220:223], v[220:223]
    ds_read_b64_tr_b16 a[144:145], v96 offset:32768
    v_mfma_f32_16x16x32_bf16 v[216:219], a[164:167], a[216:219], v[216:219]
    ds_read_b64_tr_b16 a[146:147], v96 offset:34816
    v_mfma_f32_16x16x32_bf16 v[212:215], a[164:167], a[212:215], v[212:215]
    buffer_load_dwordx4 v105, s[20:23], s68 offen offset:1024  lds
    v_mfma_f32_16x16x32_bf16 v[208:211], a[164:167], a[208:211], v[208:211]
    s_waitcnt lgkmcnt(5)
    v_mfma_f32_16x16x32_bf16 v[224:227], a[168:171], a[208:211], v[224:227]
    ds_read_b64_tr_b16 a[148:149], v96 offset:32776
    v_mfma_f32_16x16x32_bf16 v[228:231], a[168:171], a[212:215], v[228:231]
    ds_read_b64_tr_b16 a[150:151], v96 offset:34824
    v_mfma_f32_16x16x32_bf16 v[232:235], a[168:171], a[216:219], v[232:235]
    buffer_load_dwordx4 v106, s[20:23], s68 offen offset:2048  lds
    v_mfma_f32_16x16x32_bf16 v[236:239], a[168:171], a[220:223], v[236:239]
    s_waitcnt lgkmcnt(4)
    v_mfma_f32_16x16x32_bf16 v[252:255], a[172:175], a[220:223], v[252:255]
    ds_read_b64_tr_b16 a[152:153], v97 offset:32768
    v_mfma_f32_16x16x32_bf16 v[248:251], a[172:175], a[216:219], v[248:251]
    ds_read_b64_tr_b16 a[154:155], v97 offset:34816
    v_mfma_f32_16x16x32_bf16 v[244:247], a[172:175], a[212:215], v[244:247]
    buffer_load_dwordx4 v107, s[20:23], s68 offen offset:3072  lds
    v_mfma_f32_16x16x32_bf16 v[240:243], a[172:175], a[208:211], v[240:243]
    s_waitcnt lgkmcnt(4)
    v_mfma_f32_16x16x32_bf16 v[128:131], a[144:147], a[192:195], v[128:131]
    s_waitcnt vmcnt(63)
    s_barrier
    ds_read_b64_tr_b16 a[156:157], v97 offset:32776
    v_mfma_f32_16x16x32_bf16 v[132:135], a[144:147], a[196:199], v[132:135]
    ds_read_b64_tr_b16 a[158:159], v97 offset:34824
    s_add_u32 m0, s59, 114688
    s_mov_b32 s68, 3407872
    v_mfma_f32_16x16x32_bf16 v[136:139], a[144:147], a[200:203], v[136:139]
    buffer_load_dwordx4 v104, s[20:23], s68 offen offset:0  lds
    v_mfma_f32_16x16x32_bf16 v[140:143], a[144:147], a[204:207], v[140:143]
    ds_read_b128 a[208:211], v65 offset:0
    s_waitcnt lgkmcnt(5)
    v_mfma_f32_16x16x32_bf16 v[156:159], a[148:151], a[204:207], v[156:159]
    ds_read_b64_tr_b16 a[160:161], v98 offset:32768
    v_mfma_f32_16x16x32_bf16 v[152:155], a[148:151], a[200:203], v[152:155]
    ds_read_b64_tr_b16 a[162:163], v98 offset:34816
    ds_read_b128 a[212:215], v65 offset:2048
    v_mfma_f32_16x16x32_bf16 v[148:151], a[148:151], a[196:199], v[148:151]
    buffer_load_dwordx4 v105, s[20:23], s68 offen offset:1024  lds
    v_mfma_f32_16x16x32_bf16 v[144:147], a[148:151], a[192:195], v[144:147]
    s_waitcnt lgkmcnt(6)
    v_mfma_f32_16x16x32_bf16 v[160:163], a[152:155], a[192:195], v[160:163]
    ds_read_b64_tr_b16 a[164:165], v98 offset:32776
    v_mfma_f32_16x16x32_bf16 v[164:167], a[152:155], a[196:199], v[164:167]
    ds_read_b64_tr_b16 a[166:167], v98 offset:34824
    v_mfma_f32_16x16x32_bf16 v[168:171], a[152:155], a[200:203], v[168:171]
    buffer_load_dwordx4 v106, s[20:23], s68 offen offset:2048  lds
    v_mfma_f32_16x16x32_bf16 v[172:175], a[152:155], a[204:207], v[172:175]
    ds_read_b128 a[216:219], v65 offset:4096
    s_waitcnt lgkmcnt(7)
    v_mfma_f32_16x16x32_bf16 v[188:191], a[156:159], a[204:207], v[188:191]
    ds_read_b64_tr_b16 a[168:169], v99 offset:32768
    v_mfma_f32_16x16x32_bf16 v[184:187], a[156:159], a[200:203], v[184:187]
    ds_read_b64_tr_b16 a[170:171], v99 offset:34816
    v_mfma_f32_16x16x32_bf16 v[180:183], a[156:159], a[196:199], v[180:183]
    buffer_load_dwordx4 v107, s[20:23], s68 offen offset:3072  lds
    v_mfma_f32_16x16x32_bf16 v[176:179], a[156:159], a[192:195], v[176:179]
    ds_read_b128 a[220:223], v65 offset:6144
    s_waitcnt lgkmcnt(7)
    v_mfma_f32_16x16x32_bf16 v[192:195], a[160:163], a[192:195], v[192:195]
    ds_read_b64_tr_b16 a[172:173], v99 offset:32776
    v_mfma_f32_16x16x32_bf16 v[196:199], a[160:163], a[196:199], v[196:199]
    ds_read_b64_tr_b16 a[174:175], v99 offset:34824
    s_add_u32 m0, s60, 8192
    v_mfma_f32_16x16x32_bf16 v[200:203], a[160:163], a[200:203], v[200:203]
    buffer_load_dwordx4 v12, s[12:15], s63 offen offset:0 nt lds
    v_mfma_f32_16x16x32_bf16 v[204:207], a[160:163], a[204:207], v[204:207]
    s_waitcnt lgkmcnt(6)
    v_mfma_f32_16x16x32_bf16 v[220:223], a[164:167], a[204:207], v[220:223]
    ds_read_b64_tr_b16 a[144:145], v96 offset:49152
    v_mfma_f32_16x16x32_bf16 v[216:219], a[164:167], a[200:203], v[216:219]
    ds_read_b64_tr_b16 a[146:147], v96 offset:51200
    v_mfma_f32_16x16x32_bf16 v[212:215], a[164:167], a[196:199], v[212:215]
    buffer_load_dwordx4 v13, s[12:15], s63 offen offset:1024 nt lds
    v_mfma_f32_16x16x32_bf16 v[208:211], a[164:167], a[192:195], v[208:211]
    s_waitcnt lgkmcnt(5)
    v_mfma_f32_16x16x32_bf16 v[224:227], a[168:171], a[192:195], v[224:227]
    ds_read_b64_tr_b16 a[148:149], v96 offset:49160
    v_mfma_f32_16x16x32_bf16 v[228:231], a[168:171], a[196:199], v[228:231]
    ds_read_b64_tr_b16 a[150:151], v96 offset:51208
    v_mfma_f32_16x16x32_bf16 v[232:235], a[168:171], a[200:203], v[232:235]
    buffer_load_dwordx4 v14, s[12:15], s63 offen offset:2048 nt lds
    v_mfma_f32_16x16x32_bf16 v[236:239], a[168:171], a[204:207], v[236:239]
    s_waitcnt lgkmcnt(4)
    v_mfma_f32_16x16x32_bf16 v[252:255], a[172:175], a[204:207], v[252:255]
    ds_read_b64_tr_b16 a[152:153], v97 offset:49152
    v_mfma_f32_16x16x32_bf16 v[248:251], a[172:175], a[200:203], v[248:251]
    ds_read_b64_tr_b16 a[154:155], v97 offset:51200
    v_mfma_f32_16x16x32_bf16 v[244:247], a[172:175], a[196:199], v[244:247]
    buffer_load_dwordx4 v15, s[12:15], s63 offen offset:3072 nt lds
    s_add_u32 s63, s63, 24576
    v_mfma_f32_16x16x32_bf16 v[240:243], a[172:175], a[192:195], v[240:243]
    s_waitcnt lgkmcnt(4)
    v_mfma_f32_16x16x32_bf16 v[128:131], a[144:147], a[208:211], v[128:131]
    s_waitcnt vmcnt(24)
    s_waitcnt vmcnt(12)
    s_barrier
    ds_read_b64_tr_b16 a[156:157], v97 offset:49160
    v_mfma_f32_16x16x32_bf16 v[132:135], a[144:147], a[212:215], v[132:135]
    ds_read_b64_tr_b16 a[158:159], v97 offset:51208
    s_add_u32 m0, s59, 131072
    s_mov_b32 s68, 768
    v_mfma_f32_16x16x32_bf16 v[136:139], a[144:147], a[216:219], v[136:139]
    buffer_load_dwordx4 v108, s[8:11], s68 offen offset:0  lds
    v_mfma_f32_16x16x32_bf16 v[140:143], a[144:147], a[220:223], v[140:143]
    ds_read_b128 a[192:195], v64 offset:16384
    s_waitcnt lgkmcnt(5)
    v_mfma_f32_16x16x32_bf16 v[156:159], a[148:151], a[220:223], v[156:159]
    ds_read_b64_tr_b16 a[160:161], v98 offset:49152
    v_mfma_f32_16x16x32_bf16 v[152:155], a[148:151], a[216:219], v[152:155]
    ds_read_b64_tr_b16 a[162:163], v98 offset:51200
    ds_read_b128 a[196:199], v64 offset:18432
    v_mfma_f32_16x16x32_bf16 v[148:151], a[148:151], a[212:215], v[148:151]
    v_mfma_f32_16x16x32_bf16 v[144:147], a[148:151], a[208:211], v[144:147]
    s_waitcnt lgkmcnt(6)
    v_mfma_f32_16x16x32_bf16 v[160:163], a[152:155], a[208:211], v[160:163]
    ds_read_b64_tr_b16 a[164:165], v98 offset:49160
    v_mfma_f32_16x16x32_bf16 v[164:167], a[152:155], a[212:215], v[164:167]
    ds_read_b64_tr_b16 a[166:167], v98 offset:51208
    v_mfma_f32_16x16x32_bf16 v[168:171], a[152:155], a[216:219], v[168:171]
    ds_read_b128 a[200:203], v64 offset:20480
    v_mfma_f32_16x16x32_bf16 v[172:175], a[152:155], a[220:223], v[172:175]
    buffer_load_dwordx4 v109, s[8:11], s68 offen offset:1024  lds
    s_waitcnt lgkmcnt(7)
    v_mfma_f32_16x16x32_bf16 v[188:191], a[156:159], a[220:223], v[188:191]
    ds_read_b64_tr_b16 a[168:169], v99 offset:49152
    v_mfma_f32_16x16x32_bf16 v[184:187], a[156:159], a[216:219], v[184:187]
    ds_read_b64_tr_b16 a[170:171], v99 offset:51200
    v_mfma_f32_16x16x32_bf16 v[180:183], a[156:159], a[212:215], v[180:183]
    ds_read_b128 a[204:207], v64 offset:22528
    v_mfma_f32_16x16x32_bf16 v[176:179], a[156:159], a[208:211], v[176:179]
    s_waitcnt lgkmcnt(7)
    v_mfma_f32_16x16x32_bf16 v[192:195], a[160:163], a[208:211], v[192:195]
    ds_read_b64_tr_b16 a[172:173], v99 offset:49160
    v_mfma_f32_16x16x32_bf16 v[196:199], a[160:163], a[212:215], v[196:199]
    ds_read_b64_tr_b16 a[174:175], v99 offset:51208
    v_mfma_f32_16x16x32_bf16 v[200:203], a[160:163], a[216:219], v[200:203]
    v_mfma_f32_16x16x32_bf16 v[204:207], a[160:163], a[220:223], v[204:207]
    s_waitcnt lgkmcnt(6)
    v_mfma_f32_16x16x32_bf16 v[220:223], a[164:167], a[220:223], v[220:223]
    ds_read_b64_tr_b16 a[144:145], v100 offset:0
    v_mfma_f32_16x16x32_bf16 v[216:219], a[164:167], a[216:219], v[216:219]
    ds_read_b64_tr_b16 a[146:147], v100 offset:2048
    v_mfma_f32_16x16x32_bf16 v[212:215], a[164:167], a[212:215], v[212:215]
    buffer_load_dwordx4 v110, s[8:11], s68 offen offset:2048  lds
    v_mfma_f32_16x16x32_bf16 v[208:211], a[164:167], a[208:211], v[208:211]
    s_waitcnt lgkmcnt(5)
    v_mfma_f32_16x16x32_bf16 v[224:227], a[168:171], a[208:211], v[224:227]
    ds_read_b64_tr_b16 a[148:149], v100 offset:8
    v_mfma_f32_16x16x32_bf16 v[228:231], a[168:171], a[212:215], v[228:231]
    ds_read_b64_tr_b16 a[150:151], v100 offset:2056
    v_mfma_f32_16x16x32_bf16 v[232:235], a[168:171], a[216:219], v[232:235]
    v_mfma_f32_16x16x32_bf16 v[236:239], a[168:171], a[220:223], v[236:239]
    s_waitcnt lgkmcnt(4)
    v_mfma_f32_16x16x32_bf16 v[252:255], a[172:175], a[220:223], v[252:255]
    ds_read_b64_tr_b16 a[152:153], v101 offset:0
    v_mfma_f32_16x16x32_bf16 v[248:251], a[172:175], a[216:219], v[248:251]
    ds_read_b64_tr_b16 a[154:155], v101 offset:2048
    v_mfma_f32_16x16x32_bf16 v[244:247], a[172:175], a[212:215], v[244:247]
    buffer_load_dwordx4 v111, s[8:11], s68 offen offset:3072  lds
    v_mfma_f32_16x16x32_bf16 v[240:243], a[172:175], a[208:211], v[240:243]
    s_waitcnt lgkmcnt(4)
    v_mfma_f32_16x16x32_bf16 v[128:131], a[144:147], a[192:195], v[128:131]
    s_waitcnt vmcnt(63)
    s_barrier
    ds_read_b64_tr_b16 a[156:157], v101 offset:8
    v_mfma_f32_16x16x32_bf16 v[132:135], a[144:147], a[196:199], v[132:135]
    ds_read_b64_tr_b16 a[158:159], v101 offset:2056
    s_add_u32 m0, s60, 32768
    v_mfma_f32_16x16x32_bf16 v[136:139], a[144:147], a[200:203], v[136:139]
    buffer_load_dwordx4 v12, s[12:15], s63 offen offset:0 nt lds
    v_mfma_f32_16x16x32_bf16 v[140:143], a[144:147], a[204:207], v[140:143]
    ds_read_b128 a[208:211], v65 offset:16384
    s_waitcnt lgkmcnt(5)
    v_mfma_f32_16x16x32_bf16 v[156:159], a[148:151], a[204:207], v[156:159]
    ds_read_b64_tr_b16 a[160:161], v102 offset:0
    v_mfma_f32_16x16x32_bf16 v[152:155], a[148:151], a[200:203], v[152:155]
    ds_read_b64_tr_b16 a[162:163], v102 offset:2048
    ds_read_b128 a[212:215], v65 offset:18432
    v_mfma_f32_16x16x32_bf16 v[148:151], a[148:151], a[196:199], v[148:151]
    buffer_load_dwordx4 v13, s[12:15], s63 offen offset:1024 nt lds
    v_mfma_f32_16x16x32_bf16 v[144:147], a[148:151], a[192:195], v[144:147]
    s_waitcnt lgkmcnt(6)
    v_mfma_f32_16x16x32_bf16 v[160:163], a[152:155], a[192:195], v[160:163]
    ds_read_b64_tr_b16 a[164:165], v102 offset:8
    v_mfma_f32_16x16x32_bf16 v[164:167], a[152:155], a[196:199], v[164:167]
    ds_read_b64_tr_b16 a[166:167], v102 offset:2056
    v_mfma_f32_16x16x32_bf16 v[168:171], a[152:155], a[200:203], v[168:171]
    buffer_load_dwordx4 v14, s[12:15], s63 offen offset:2048 nt lds
    v_mfma_f32_16x16x32_bf16 v[172:175], a[152:155], a[204:207], v[172:175]
    ds_read_b128 a[216:219], v65 offset:20480
    s_waitcnt lgkmcnt(7)
    v_mfma_f32_16x16x32_bf16 v[188:191], a[156:159], a[204:207], v[188:191]
    ds_read_b64_tr_b16 a[168:169], v103 offset:0
    v_mfma_f32_16x16x32_bf16 v[184:187], a[156:159], a[200:203], v[184:187]
    ds_read_b64_tr_b16 a[170:171], v103 offset:2048
    v_mfma_f32_16x16x32_bf16 v[180:183], a[156:159], a[196:199], v[180:183]
    buffer_load_dwordx4 v15, s[12:15], s63 offen offset:3072 nt lds
    s_add_u32 s63, s63, 8192
    v_mfma_f32_16x16x32_bf16 v[176:179], a[156:159], a[192:195], v[176:179]
    ds_read_b128 a[220:223], v65 offset:22528
    s_waitcnt lgkmcnt(7)
    v_mfma_f32_16x16x32_bf16 v[192:195], a[160:163], a[192:195], v[192:195]
    ds_read_b64_tr_b16 a[172:173], v103 offset:8
    v_mfma_f32_16x16x32_bf16 v[196:199], a[160:163], a[196:199], v[196:199]
    ds_read_b64_tr_b16 a[174:175], v103 offset:2056
    s_add_u32 m0, s60, 40960
    v_mfma_f32_16x16x32_bf16 v[200:203], a[160:163], a[200:203], v[200:203]
    buffer_load_dwordx4 v12, s[12:15], s63 offen offset:0 nt lds
    v_mfma_f32_16x16x32_bf16 v[204:207], a[160:163], a[204:207], v[204:207]
    s_waitcnt lgkmcnt(6)
    v_mfma_f32_16x16x32_bf16 v[220:223], a[164:167], a[204:207], v[220:223]
    ds_read_b64_tr_b16 a[144:145], v100 offset:16384
    v_mfma_f32_16x16x32_bf16 v[216:219], a[164:167], a[200:203], v[216:219]
    ds_read_b64_tr_b16 a[146:147], v100 offset:18432
    v_mfma_f32_16x16x32_bf16 v[212:215], a[164:167], a[196:199], v[212:215]
    buffer_load_dwordx4 v13, s[12:15], s63 offen offset:1024 nt lds
    v_mfma_f32_16x16x32_bf16 v[208:211], a[164:167], a[192:195], v[208:211]
    s_waitcnt lgkmcnt(5)
    v_mfma_f32_16x16x32_bf16 v[224:227], a[168:171], a[192:195], v[224:227]
    ds_read_b64_tr_b16 a[148:149], v100 offset:16392
    v_mfma_f32_16x16x32_bf16 v[228:231], a[168:171], a[196:199], v[228:231]
    ds_read_b64_tr_b16 a[150:151], v100 offset:18440
    v_mfma_f32_16x16x32_bf16 v[232:235], a[168:171], a[200:203], v[232:235]
    buffer_load_dwordx4 v14, s[12:15], s63 offen offset:2048 nt lds
    v_mfma_f32_16x16x32_bf16 v[236:239], a[168:171], a[204:207], v[236:239]
    s_waitcnt lgkmcnt(4)
    v_mfma_f32_16x16x32_bf16 v[252:255], a[172:175], a[204:207], v[252:255]
    ds_read_b64_tr_b16 a[152:153], v101 offset:16384
    v_mfma_f32_16x16x32_bf16 v[248:251], a[172:175], a[200:203], v[248:251]
    ds_read_b64_tr_b16 a[154:155], v101 offset:18432
    v_mfma_f32_16x16x32_bf16 v[244:247], a[172:175], a[196:199], v[244:247]
    buffer_load_dwordx4 v15, s[12:15], s63 offen offset:3072 nt lds
    s_add_u32 s63, s63, 24576
    v_mfma_f32_16x16x32_bf16 v[240:243], a[172:175], a[192:195], v[240:243]
    s_waitcnt lgkmcnt(4)
    v_mfma_f32_16x16x32_bf16 v[128:131], a[144:147], a[208:211], v[128:131]
    s_waitcnt vmcnt(20)
    s_waitcnt vmcnt(8)
    s_barrier
    ds_read_b64_tr_b16 a[156:157], v101 offset:16392
    v_mfma_f32_16x16x32_bf16 v[132:135], a[144:147], a[212:215], v[132:135]
    ds_read_b64_tr_b16 a[158:159], v101 offset:18440
    v_mfma_f32_16x16x32_bf16 v[136:139], a[144:147], a[216:219], v[136:139]
    ds_read_b128 a[192:195], v64 offset:0
    v_mfma_f32_16x16x32_bf16 v[140:143], a[144:147], a[220:223], v[140:143]
    s_waitcnt lgkmcnt(5)
    v_mfma_f32_16x16x32_bf16 v[156:159], a[148:151], a[220:223], v[156:159]
    ds_read_b64_tr_b16 a[160:161], v102 offset:16384
    v_mfma_f32_16x16x32_bf16 v[152:155], a[148:151], a[216:219], v[152:155]
    ds_read_b64_tr_b16 a[162:163], v102 offset:18432
    ds_read_b128 a[196:199], v64 offset:2048
    v_mfma_f32_16x16x32_bf16 v[148:151], a[148:151], a[212:215], v[148:151]
    v_mfma_f32_16x16x32_bf16 v[144:147], a[148:151], a[208:211], v[144:147]
    s_waitcnt lgkmcnt(6)
    v_mfma_f32_16x16x32_bf16 v[160:163], a[152:155], a[208:211], v[160:163]
    ds_read_b64_tr_b16 a[164:165], v102 offset:16392
    v_mfma_f32_16x16x32_bf16 v[164:167], a[152:155], a[212:215], v[164:167]
    ds_read_b64_tr_b16 a[166:167], v102 offset:18440
    v_mfma_f32_16x16x32_bf16 v[168:171], a[152:155], a[216:219], v[168:171]
    ds_read_b128 a[200:203], v64 offset:4096
    v_mfma_f32_16x16x32_bf16 v[172:175], a[152:155], a[220:223], v[172:175]
    s_waitcnt lgkmcnt(7)
    v_mfma_f32_16x16x32_bf16 v[188:191], a[156:159], a[220:223], v[188:191]
    ds_read_b64_tr_b16 a[168:169], v103 offset:16384
    v_mfma_f32_16x16x32_bf16 v[184:187], a[156:159], a[216:219], v[184:187]
    ds_read_b64_tr_b16 a[170:171], v103 offset:18432
    v_mfma_f32_16x16x32_bf16 v[180:183], a[156:159], a[212:215], v[180:183]
    ds_read_b128 a[204:207], v64 offset:6144
    v_mfma_f32_16x16x32_bf16 v[176:179], a[156:159], a[208:211], v[176:179]
    s_waitcnt lgkmcnt(7)
    v_mfma_f32_16x16x32_bf16 v[192:195], a[160:163], a[208:211], v[192:195]
    ds_read_b64_tr_b16 a[172:173], v103 offset:16392
    v_mfma_f32_16x16x32_bf16 v[196:199], a[160:163], a[212:215], v[196:199]
    ds_read_b64_tr_b16 a[174:175], v103 offset:18440
    v_mfma_f32_16x16x32_bf16 v[200:203], a[160:163], a[216:219], v[200:203]
    v_mfma_f32_16x16x32_bf16 v[204:207], a[160:163], a[220:223], v[204:207]
    s_waitcnt lgkmcnt(6)
    v_mfma_f32_16x16x32_bf16 v[220:223], a[164:167], a[220:223], v[220:223]
    ds_read_b64_tr_b16 a[144:145], v100 offset:32768
    v_mfma_f32_16x16x32_bf16 v[216:219], a[164:167], a[216:219], v[216:219]
    ds_read_b64_tr_b16 a[146:147], v100 offset:34816
    v_mfma_f32_16x16x32_bf16 v[212:215], a[164:167], a[212:215], v[212:215]
    v_mfma_f32_16x16x32_bf16 v[208:211], a[164:167], a[208:211], v[208:211]
    s_waitcnt lgkmcnt(5)
    v_mfma_f32_16x16x32_bf16 v[224:227], a[168:171], a[208:211], v[224:227]
    ds_read_b64_tr_b16 a[148:149], v100 offset:32776
    v_mfma_f32_16x16x32_bf16 v[228:231], a[168:171], a[212:215], v[228:231]
    ds_read_b64_tr_b16 a[150:151], v100 offset:34824
    v_mfma_f32_16x16x32_bf16 v[232:235], a[168:171], a[216:219], v[232:235]
    v_mfma_f32_16x16x32_bf16 v[236:239], a[168:171], a[220:223], v[236:239]
    s_waitcnt lgkmcnt(4)
    v_mfma_f32_16x16x32_bf16 v[252:255], a[172:175], a[220:223], v[252:255]
    ds_read_b64_tr_b16 a[152:153], v101 offset:32768
    v_mfma_f32_16x16x32_bf16 v[248:251], a[172:175], a[216:219], v[248:251]
    ds_read_b64_tr_b16 a[154:155], v101 offset:34816
    v_mfma_f32_16x16x32_bf16 v[244:247], a[172:175], a[212:215], v[244:247]
    v_mfma_f32_16x16x32_bf16 v[240:243], a[172:175], a[208:211], v[240:243]
    s_waitcnt lgkmcnt(4)
    v_mfma_f32_16x16x32_bf16 v[128:131], a[144:147], a[192:195], v[128:131]
    s_waitcnt vmcnt(63)
    s_barrier
    ds_read_b64_tr_b16 a[156:157], v101 offset:32776
    v_mfma_f32_16x16x32_bf16 v[132:135], a[144:147], a[196:199], v[132:135]
    ds_read_b64_tr_b16 a[158:159], v101 offset:34824
    s_add_u32 m0, s60, 65536
    v_mfma_f32_16x16x32_bf16 v[136:139], a[144:147], a[200:203], v[136:139]
    buffer_load_dwordx4 v16, s[16:19], s64 offen offset:0 nt lds
    v_mfma_f32_16x16x32_bf16 v[140:143], a[144:147], a[204:207], v[140:143]
    ds_read_b128 a[208:211], v65 offset:0
    s_waitcnt lgkmcnt(5)
    v_mfma_f32_16x16x32_bf16 v[156:159], a[148:151], a[204:207], v[156:159]
    ds_read_b64_tr_b16 a[160:161], v102 offset:32768
    v_mfma_f32_16x16x32_bf16 v[152:155], a[148:151], a[200:203], v[152:155]
    ds_read_b64_tr_b16 a[162:163], v102 offset:34816
    ds_read_b128 a[212:215], v65 offset:2048
    v_mfma_f32_16x16x32_bf16 v[148:151], a[148:151], a[196:199], v[148:151]
    buffer_load_dwordx4 v17, s[16:19], s64 offen offset:1024 nt lds
    v_mfma_f32_16x16x32_bf16 v[144:147], a[148:151], a[192:195], v[144:147]
    s_waitcnt lgkmcnt(6)
    v_mfma_f32_16x16x32_bf16 v[160:163], a[152:155], a[192:195], v[160:163]
    ds_read_b64_tr_b16 a[164:165], v102 offset:32776
    v_mfma_f32_16x16x32_bf16 v[164:167], a[152:155], a[196:199], v[164:167]
    ds_read_b64_tr_b16 a[166:167], v102 offset:34824
    v_mfma_f32_16x16x32_bf16 v[168:171], a[152:155], a[200:203], v[168:171]
    buffer_load_dwordx4 v18, s[16:19], s64 offen offset:2048 nt lds
    v_mfma_f32_16x16x32_bf16 v[172:175], a[152:155], a[204:207], v[172:175]
    ds_read_b128 a[216:219], v65 offset:4096
    s_waitcnt lgkmcnt(7)
    v_mfma_f32_16x16x32_bf16 v[188:191], a[156:159], a[204:207], v[188:191]
    ds_read_b64_tr_b16 a[168:169], v103 offset:32768
    v_mfma_f32_16x16x32_bf16 v[184:187], a[156:159], a[200:203], v[184:187]
    ds_read_b64_tr_b16 a[170:171], v103 offset:34816
    v_mfma_f32_16x16x32_bf16 v[180:183], a[156:159], a[196:199], v[180:183]
    buffer_load_dwordx4 v19, s[16:19], s64 offen offset:3072 nt lds
    s_add_u32 s64, s64, 8192
    v_mfma_f32_16x16x32_bf16 v[176:179], a[156:159], a[192:195], v[176:179]
    ds_read_b128 a[220:223], v65 offset:6144
    s_waitcnt lgkmcnt(7)
    v_mfma_f32_16x16x32_bf16 v[192:195], a[160:163], a[192:195], v[192:195]
    ds_read_b64_tr_b16 a[172:173], v103 offset:32776
    v_mfma_f32_16x16x32_bf16 v[196:199], a[160:163], a[196:199], v[196:199]
    ds_read_b64_tr_b16 a[174:175], v103 offset:34824
    s_add_u32 m0, s60, 73728
    v_mfma_f32_16x16x32_bf16 v[200:203], a[160:163], a[200:203], v[200:203]
    buffer_load_dwordx4 v16, s[16:19], s64 offen offset:0 nt lds
    v_mfma_f32_16x16x32_bf16 v[204:207], a[160:163], a[204:207], v[204:207]
    s_waitcnt lgkmcnt(6)
    v_mfma_f32_16x16x32_bf16 v[220:223], a[164:167], a[204:207], v[220:223]
    ds_read_b64_tr_b16 a[144:145], v100 offset:49152
    v_mfma_f32_16x16x32_bf16 v[216:219], a[164:167], a[200:203], v[216:219]
    ds_read_b64_tr_b16 a[146:147], v100 offset:51200
    v_mfma_f32_16x16x32_bf16 v[212:215], a[164:167], a[196:199], v[212:215]
    buffer_load_dwordx4 v17, s[16:19], s64 offen offset:1024 nt lds
    v_mfma_f32_16x16x32_bf16 v[208:211], a[164:167], a[192:195], v[208:211]
    s_waitcnt lgkmcnt(5)
    v_mfma_f32_16x16x32_bf16 v[224:227], a[168:171], a[192:195], v[224:227]
    ds_read_b64_tr_b16 a[148:149], v100 offset:49160
    v_mfma_f32_16x16x32_bf16 v[228:231], a[168:171], a[196:199], v[228:231]
    ds_read_b64_tr_b16 a[150:151], v100 offset:51208
    v_mfma_f32_16x16x32_bf16 v[232:235], a[168:171], a[200:203], v[232:235]
    buffer_load_dwordx4 v18, s[16:19], s64 offen offset:2048 nt lds
    v_mfma_f32_16x16x32_bf16 v[236:239], a[168:171], a[204:207], v[236:239]
    s_waitcnt lgkmcnt(4)
    v_mfma_f32_16x16x32_bf16 v[252:255], a[172:175], a[204:207], v[252:255]
    ds_read_b64_tr_b16 a[152:153], v101 offset:49152
    v_mfma_f32_16x16x32_bf16 v[248:251], a[172:175], a[200:203], v[248:251]
    ds_read_b64_tr_b16 a[154:155], v101 offset:51200
    v_mfma_f32_16x16x32_bf16 v[244:247], a[172:175], a[196:199], v[244:247]
    buffer_load_dwordx4 v19, s[16:19], s64 offen offset:3072 nt lds
    s_add_u32 s64, s64, 24576
    v_mfma_f32_16x16x32_bf16 v[240:243], a[172:175], a[192:195], v[240:243]
    s_waitcnt lgkmcnt(4)
    v_mfma_f32_16x16x32_bf16 v[128:131], a[144:147], a[208:211], v[128:131]
    s_waitcnt vmcnt(63)
    s_barrier
    ds_read_b64_tr_b16 a[156:157], v101 offset:49160
    v_mfma_f32_16x16x32_bf16 v[132:135], a[144:147], a[212:215], v[132:135]
    ds_read_b64_tr_b16 a[158:159], v101 offset:51208
    v_mfma_f32_16x16x32_bf16 v[136:139], a[144:147], a[216:219], v[136:139]
    v_mfma_f32_16x16x32_bf16 v[140:143], a[144:147], a[220:223], v[140:143]
    s_waitcnt lgkmcnt(4)
    v_mfma_f32_16x16x32_bf16 v[156:159], a[148:151], a[220:223], v[156:159]
    ds_read_b64_tr_b16 a[160:161], v102 offset:49152
    v_mfma_f32_16x16x32_bf16 v[152:155], a[148:151], a[216:219], v[152:155]
    ds_read_b64_tr_b16 a[162:163], v102 offset:51200
    v_mfma_f32_16x16x32_bf16 v[148:151], a[148:151], a[212:215], v[148:151]
    v_mfma_f32_16x16x32_bf16 v[144:147], a[148:151], a[208:211], v[144:147]
    s_waitcnt lgkmcnt(4)
    v_mfma_f32_16x16x32_bf16 v[160:163], a[152:155], a[208:211], v[160:163]
    ds_read_b64_tr_b16 a[164:165], v102 offset:49160
    v_mfma_f32_16x16x32_bf16 v[164:167], a[152:155], a[212:215], v[164:167]
    ds_read_b64_tr_b16 a[166:167], v102 offset:51208
    v_mfma_f32_16x16x32_bf16 v[168:171], a[152:155], a[216:219], v[168:171]
    v_mfma_f32_16x16x32_bf16 v[172:175], a[152:155], a[220:223], v[172:175]
    v_mul_f32 v128, s67, v128
    v_mul_f32 v129, s67, v129
    s_waitcnt lgkmcnt(4)
    v_mfma_f32_16x16x32_bf16 v[188:191], a[156:159], a[220:223], v[188:191]
    ds_read_b64_tr_b16 a[168:169], v103 offset:49152
    v_mul_f32 v130, s67, v130
    v_mfma_f32_16x16x32_bf16 v[184:187], a[156:159], a[216:219], v[184:187]
    ds_read_b64_tr_b16 a[170:171], v103 offset:51200
    v_mul_f32 v131, s67, v131
    v_mfma_f32_16x16x32_bf16 v[180:183], a[156:159], a[212:215], v[180:183]
    v_mul_f32 v144, s67, v144
    v_mul_f32 v145, s67, v145
    v_mfma_f32_16x16x32_bf16 v[176:179], a[156:159], a[208:211], v[176:179]
    v_mul_f32 v146, s67, v146
    v_mul_f32 v147, s67, v147
    s_waitcnt lgkmcnt(4)
    v_mfma_f32_16x16x32_bf16 v[192:195], a[160:163], a[208:211], v[192:195]
    ds_read_b64_tr_b16 a[172:173], v103 offset:49160
    v_cvt_pk_bf16_f32 v128, v128, v129
    v_mfma_f32_16x16x32_bf16 v[196:199], a[160:163], a[212:215], v[196:199]
    ds_read_b64_tr_b16 a[174:175], v103 offset:51208
    v_cvt_pk_bf16_f32 v129, v130, v131
    v_mfma_f32_16x16x32_bf16 v[200:203], a[160:163], a[216:219], v[200:203]
    v_cvt_pk_bf16_f32 v130, v144, v145
    v_cvt_pk_bf16_f32 v131, v146, v147
    v_mfma_f32_16x16x32_bf16 v[204:207], a[160:163], a[220:223], v[204:207]
    ds_write_b128 v29, v[128:131] offset:0
    s_waitcnt lgkmcnt(5)
    v_mfma_f32_16x16x32_bf16 v[220:223], a[164:167], a[220:223], v[220:223]
    ds_read_b128 a[144:147], v0 offset:0
    ds_read_b128 a[0:3], v29 offset:0
    v_mfma_f32_16x16x32_bf16 v[216:219], a[164:167], a[216:219], v[216:219]
    v_mul_f32 v132, s67, v132
    v_mul_f32 v133, s67, v133
    v_mfma_f32_16x16x32_bf16 v[212:215], a[164:167], a[212:215], v[212:215]
    v_mul_f32 v134, s67, v134
    v_mul_f32 v135, s67, v135
    v_mfma_f32_16x16x32_bf16 v[208:211], a[164:167], a[208:211], v[208:211]
    v_mul_f32 v148, s67, v148
    v_mul_f32 v149, s67, v149
    s_waitcnt lgkmcnt(5)
    v_mfma_f32_16x16x32_bf16 v[224:227], a[168:171], a[208:211], v[224:227]
    ds_read_b128 a[148:151], v0 offset:8192
    v_mul_f32 v150, s67, v150
    v_mfma_f32_16x16x32_bf16 v[228:231], a[168:171], a[212:215], v[228:231]
    v_mul_f32 v151, s67, v151
    v_cvt_pk_bf16_f32 v132, v132, v133
    v_mfma_f32_16x16x32_bf16 v[232:235], a[168:171], a[216:219], v[232:235]
    v_cvt_pk_bf16_f32 v133, v134, v135
    v_cvt_pk_bf16_f32 v134, v148, v149
    v_mfma_f32_16x16x32_bf16 v[236:239], a[168:171], a[220:223], v[236:239]
    v_cvt_pk_bf16_f32 v135, v150, v151
    s_waitcnt lgkmcnt(4)
    v_mfma_f32_16x16x32_bf16 v[252:255], a[172:175], a[220:223], v[252:255]
    ds_read_b128 a[152:155], v1 offset:0
    v_mfma_f32_16x16x32_bf16 v[248:251], a[172:175], a[216:219], v[248:251]
    ds_write_b128 v29, v[132:135] offset:1024
    ds_read_b128 a[32:35], v29 offset:1024
    v_mfma_f32_16x16x32_bf16 v[244:247], a[172:175], a[212:215], v[244:247]
    v_mul_f32 v136, s67, v136
    v_mul_f32 v137, s67, v137
    v_mul_f32 v138, s67, v138
    v_mfma_f32_16x16x32_bf16 v[240:243], a[172:175], a[208:211], v[240:243]
    v_mul_f32 v139, s67, v139
    v_mul_f32 v152, s67, v152
    v_mul_f32 v153, s67, v153
    v_mul_f32 v154, s67, v154
    v_mul_f32 v155, s67, v155
    v_cvt_pk_bf16_f32 v136, v136, v137
    v_cvt_pk_bf16_f32 v137, v138, v139
    v_cvt_pk_bf16_f32 v138, v152, v153
    v_cvt_pk_bf16_f32 v139, v154, v155
    ds_write_b128 v29, v[136:139] offset:2048
    ds_read_b128 a[64:67], v29 offset:2048
    v_mul_f32 v140, s67, v140
    v_mul_f32 v141, s67, v141
    v_mul_f32 v142, s67, v142
    v_mul_f32 v143, s67, v143
    v_mul_f32 v156, s67, v156
    v_mul_f32 v157, s67, v157
    v_mul_f32 v158, s67, v158
    v_mul_f32 v159, s67, v159
    v_cvt_pk_bf16_f32 v140, v140, v141
    v_cvt_pk_bf16_f32 v141, v142, v143
    v_cvt_pk_bf16_f32 v142, v156, v157
    v_cvt_pk_bf16_f32 v143, v158, v159
    ds_write_b128 v29, v[140:143] offset:3072
    ds_read_b128 a[96:99], v29 offset:3072
    v_pk_mul_f32 v[160:161], v[160:161], s[70:71]
    v_pk_mul_f32 v[162:163], v[162:163], s[70:71]
    v_pk_mul_f32 v[176:177], v[176:177], s[70:71]
    v_pk_mul_f32 v[178:179], v[178:179], s[70:71]
    v_cvt_pk_bf16_f32 v160, v160, v161
    v_cvt_pk_bf16_f32 v161, v162, v163
    v_cvt_pk_bf16_f32 v162, v176, v177
    v_cvt_pk_bf16_f32 v163, v178, v179
    ds_write_b128 v29, v[160:163] offset:16384
    ds_read_b128 a[4:7], v29 offset:16384
    v_pk_mul_f32 v[164:165], v[164:165], s[70:71]
    v_pk_mul_f32 v[166:167], v[166:167], s[70:71]
    v_pk_mul_f32 v[180:181], v[180:181], s[70:71]
    v_pk_mul_f32 v[182:183], v[182:183], s[70:71]
    v_cvt_pk_bf16_f32 v164, v164, v165
    v_cvt_pk_bf16_f32 v165, v166, v167
    v_cvt_pk_bf16_f32 v166, v180, v181
    v_cvt_pk_bf16_f32 v167, v182, v183
    ds_write_b128 v29, v[164:167] offset:17408
    ds_read_b128 a[36:39], v29 offset:17408
    v_pk_mul_f32 v[168:169], v[168:169], s[70:71]
    v_pk_mul_f32 v[170:171], v[170:171], s[70:71]
    v_pk_mul_f32 v[184:185], v[184:185], s[70:71]
    v_pk_mul_f32 v[186:187], v[186:187], s[70:71]
    v_cvt_pk_bf16_f32 v168, v168, v169
    v_cvt_pk_bf16_f32 v169, v170, v171
    v_cvt_pk_bf16_f32 v170, v184, v185
    v_cvt_pk_bf16_f32 v171, v186, v187
    ds_write_b128 v29, v[168:171] offset:18432
    ds_read_b128 a[68:71], v29 offset:18432
    v_pk_mul_f32 v[172:173], v[172:173], s[70:71]
    v_pk_mul_f32 v[174:175], v[174:175], s[70:71]
    v_pk_mul_f32 v[188:189], v[188:189], s[70:71]
    v_pk_mul_f32 v[190:191], v[190:191], s[70:71]
    v_cvt_pk_bf16_f32 v172, v172, v173
    v_cvt_pk_bf16_f32 v173, v174, v175
    v_cvt_pk_bf16_f32 v174, v188, v189
    v_cvt_pk_bf16_f32 v175, v190, v191
    ds_write_b128 v29, v[172:175] offset:19456
    ds_read_b128 a[100:103], v29 offset:19456
    s_waitcnt lgkmcnt(9)
    s_barrier
    ds_read_b128 a[16:19], v30 offset:0
    ds_read_b128 a[48:51], v30 offset:1024
    ds_read_b128 a[80:83], v30 offset:2048
    ds_read_b128 a[112:115], v30 offset:3072
    v_mfma_f32_16x16x32_bf16 v[64:67], a[144:147], a[0:3], v[32:35]
    ds_read_b128 a[156:159], v1 offset:8192
    v_mul_f32 v192, s67, v192
    v_mul_f32 v193, s67, v193
    v_mul_f32 v194, s67, v194
    v_mul_f32 v195, s67, v195
    v_mul_f32 v208, s67, v208
    v_mul_f32 v209, s67, v209
    v_mul_f32 v210, s67, v210
    v_mfma_f32_16x16x32_bf16 v[72:75], a[144:147], a[32:35], v[36:39]
    v_mul_f32 v211, s67, v211
    v_cvt_pk_bf16_f32 v192, v192, v193
    v_cvt_pk_bf16_f32 v193, v194, v195
    v_cvt_pk_bf16_f32 v194, v208, v209
    v_cvt_pk_bf16_f32 v195, v210, v211
    v_mul_f32 v196, s67, v196
    v_mul_f32 v197, s67, v197
    v_mfma_f32_16x16x32_bf16 v[80:83], a[144:147], a[64:67], v[40:43]
    v_mul_f32 v198, s67, v198
    v_mul_f32 v199, s67, v199
    v_mul_f32 v212, s67, v212
    v_mul_f32 v213, s67, v213
    v_mul_f32 v214, s67, v214
    v_mul_f32 v215, s67, v215
    v_cvt_pk_bf16_f32 v196, v196, v197
    s_waitcnt lgkmcnt(13)
    v_mfma_f32_16x16x32_bf16 v[88:91], a[144:147], a[96:99], v[44:47]
    v_cvt_pk_bf16_f32 v197, v198, v199
    v_cvt_pk_bf16_f32 v198, v212, v213
    v_cvt_pk_bf16_f32 v199, v214, v215
    v_mul_f32 v200, s67, v200
    v_mul_f32 v201, s67, v201
    v_mul_f32 v202, s67, v202
    v_mul_f32 v203, s67, v203
    v_mfma_f32_16x16x32_bf16 v[92:95], a[148:151], a[96:99], v[44:47]
    ds_read_b128 a[160:163], v2 offset:0
    v_mul_f32 v216, s67, v216
    v_mul_f32 v217, s67, v217
    v_mul_f32 v218, s67, v218
    v_mul_f32 v219, s67, v219
    v_cvt_pk_bf16_f32 v200, v200, v201
    v_cvt_pk_bf16_f32 v201, v202, v203
    v_cvt_pk_bf16_f32 v202, v216, v217
    v_mfma_f32_16x16x32_bf16 v[84:87], a[148:151], a[64:67], v[40:43]
    v_cvt_pk_bf16_f32 v203, v218, v219
    v_mul_f32 v204, s67, v204
    v_mul_f32 v205, s67, v205
    v_mul_f32 v206, s67, v206
    v_mul_f32 v207, s67, v207
    v_mul_f32 v220, s67, v220
    v_mul_f32 v221, s67, v221
    v_mfma_f32_16x16x32_bf16 v[76:79], a[148:151], a[32:35], v[36:39]
    v_mul_f32 v222, s67, v222
    v_mul_f32 v223, s67, v223
    v_cvt_pk_bf16_f32 v204, v204, v205
    v_cvt_pk_bf16_f32 v205, v206, v207
    v_cvt_pk_bf16_f32 v206, v220, v221
    v_cvt_pk_bf16_f32 v207, v222, v223
    v_mfma_f32_16x16x32_bf16 v[68:71], a[148:151], a[0:3], v[32:35]
    s_waitcnt lgkmcnt(2)
    s_barrier
    ds_read_b128 a[20:23], v30 offset:16384
    ds_read_b128 a[52:55], v30 offset:17408
    ds_read_b128 a[84:87], v30 offset:18432
    ds_read_b128 a[116:119], v30 offset:19456
    v_mfma_f32_16x16x32_bf16 v[64:67], a[152:155], a[4:7], v[64:67]
    ds_read_b128 a[164:167], v2 offset:8192
    ds_write_b128 v29, v[192:195] offset:0
    ds_read_b128 a[8:11], v29 offset:0
    v_mul_f32 v224, s67, v224
    v_mul_f32 v225, s67, v225
    v_mul_f32 v226, s67, v226
    v_mul_f32 v227, s67, v227
    v_mul_f32 v240, s67, v240
    v_mul_f32 v241, s67, v241
    v_mfma_f32_16x16x32_bf16 v[72:75], a[152:155], a[36:39], v[72:75]
    v_mul_f32 v242, s67, v242
    v_mul_f32 v243, s67, v243
    v_cvt_pk_bf16_f32 v224, v224, v225
    v_cvt_pk_bf16_f32 v225, v226, v227
    v_cvt_pk_bf16_f32 v226, v240, v241
    v_cvt_pk_bf16_f32 v227, v242, v243
    ds_write_b128 v29, v[196:199] offset:1024
    ds_read_b128 a[40:43], v29 offset:1024
    v_mfma_f32_16x16x32_bf16 v[80:83], a[152:155], a[68:71], v[80:83]
    v_mul_f32 v228, s67, v228
    v_mul_f32 v229, s67, v229
    v_mul_f32 v230, s67, v230
    v_mul_f32 v231, s67, v231
    v_mul_f32 v244, s67, v244
    v_mul_f32 v245, s67, v245
    v_mul_f32 v246, s67, v246
    v_mul_f32 v247, s67, v247
    v_mfma_f32_16x16x32_bf16 v[88:91], a[152:155], a[100:103], v[88:91]
    v_cvt_pk_bf16_f32 v228, v228, v229
    v_cvt_pk_bf16_f32 v229, v230, v231
    v_cvt_pk_bf16_f32 v230, v244, v245
    v_cvt_pk_bf16_f32 v231, v246, v247
    ds_write_b128 v29, v[200:203] offset:2048
    ds_read_b128 a[72:75], v29 offset:2048
    v_mul_f32 v232, s67, v232
    v_mul_f32 v233, s67, v233
    s_waitcnt lgkmcnt(12)
    v_mfma_f32_16x16x32_bf16 v[92:95], a[156:159], a[100:103], v[92:95]
    ds_read_b128 a[168:171], v3 offset:0
    v_mul_f32 v234, s67, v234
    v_mul_f32 v235, s67, v235
    v_mul_f32 v248, s67, v248
    v_mul_f32 v249, s67, v249
    v_mul_f32 v250, s67, v250
    v_mul_f32 v251, s67, v251
    v_cvt_pk_bf16_f32 v232, v232, v233
    v_cvt_pk_bf16_f32 v233, v234, v235
    v_mfma_f32_16x16x32_bf16 v[84:87], a[156:159], a[68:71], v[84:87]
    v_cvt_pk_bf16_f32 v234, v248, v249
    v_cvt_pk_bf16_f32 v235, v250, v251
    ds_write_b128 v29, v[204:207] offset:3072
    ds_read_b128 a[104:107], v29 offset:3072
    v_mul_f32 v236, s67, v236
    v_mul_f32 v237, s67, v237
    v_mul_f32 v238, s67, v238
    v_mul_f32 v239, s67, v239
    v_mfma_f32_16x16x32_bf16 v[76:79], a[156:159], a[36:39], v[76:79]
    v_mul_f32 v252, s67, v252
    v_mul_f32 v253, s67, v253
    v_mul_f32 v254, s67, v254
    v_mul_f32 v255, s67, v255
    v_cvt_pk_bf16_f32 v236, v236, v237
    v_cvt_pk_bf16_f32 v237, v238, v239
    v_cvt_pk_bf16_f32 v238, v252, v253
    v_cvt_pk_bf16_f32 v239, v254, v255
    v_mfma_f32_16x16x32_bf16 v[68:71], a[156:159], a[4:7], v[68:71]
    s_waitcnt lgkmcnt(10)
    s_waitcnt lgkmcnt(1)
    s_barrier
    ds_read_b128 a[24:27], v30 offset:0
    ds_read_b128 a[56:59], v30 offset:1024
    ds_read_b128 a[88:91], v30 offset:2048
    ds_read_b128 a[120:123], v30 offset:3072
    v_mfma_f32_16x16x32_bf16 v[64:67], a[160:163], a[8:11], v[64:67]
    ds_read_b128 a[172:175], v3 offset:8192
    ds_write_b128 v29, v[224:227] offset:16384
    ds_read_b128 a[12:15], v29 offset:16384
    v_mfma_f32_16x16x32_bf16 v[72:75], a[160:163], a[40:43], v[72:75]
    ds_write_b128 v29, v[228:231] offset:17408
    ds_read_b128 a[44:47], v29 offset:17408
    v_mfma_f32_16x16x32_bf16 v[80:83], a[160:163], a[72:75], v[80:83]
    ds_write_b128 v29, v[232:235] offset:18432
    s_waitcnt lgkmcnt(10)
    v_mfma_f32_16x16x32_bf16 v[88:91], a[160:163], a[104:107], v[88:91]
    ds_read_b128 a[76:79], v29 offset:18432
    ds_write_b128 v29, v[236:239] offset:19456
    v_mfma_f32_16x16x32_bf16 v[92:95], a[164:167], a[104:107], v[92:95]
    ds_read_b128 a[144:147], v0 offset:256
    ds_read_b128 a[108:111], v29 offset:19456
    v_mfma_f32_16x16x32_bf16 v[84:87], a[164:167], a[72:75], v[84:87]
    v_mfma_f32_16x16x32_bf16 v[76:79], a[164:167], a[40:43], v[76:79]
    v_mfma_f32_16x16x32_bf16 v[68:71], a[164:167], a[8:11], v[68:71]
    s_waitcnt lgkmcnt(7)
    v_mfma_f32_16x16x32_bf16 v[64:67], a[168:171], a[12:15], v[64:67]
    ds_read_b128 a[148:151], v0 offset:8448
    s_waitcnt lgkmcnt(6)
    v_mfma_f32_16x16x32_bf16 v[72:75], a[168:171], a[44:47], v[72:75]
    s_waitcnt lgkmcnt(3)
    s_waitcnt vmcnt(8)
    s_barrier
    ds_read_b128 a[28:31], v30 offset:16384
    ds_read_b128 a[60:63], v30 offset:17408
    ds_read_b128 a[92:95], v30 offset:18432
    ds_read_b128 a[124:127], v30 offset:19456
    v_mfma_f32_16x16x32_bf16 v[80:83], a[168:171], a[76:79], v[80:83]
    s_add_u32 m0, s60, 98304
    s_waitcnt lgkmcnt(5)
    v_mfma_f32_16x16x32_bf16 v[88:91], a[168:171], a[108:111], v[88:91]
    buffer_load_dwordx4 v16, s[16:19], s64 offen offset:0 nt lds
    v_mfma_f32_16x16x32_bf16 v[92:95], a[172:175], a[108:111], v[92:95]
    ds_read_b128 a[152:155], v1 offset:256
    v_mfma_f32_16x16x32_bf16 v[84:87], a[172:175], a[76:79], v[84:87]
    v_mfma_f32_16x16x32_bf16 v[76:79], a[172:175], a[44:47], v[76:79]
    v_mfma_f32_16x16x32_bf16 v[68:71], a[172:175], a[12:15], v[68:71]
    v_mfma_f32_16x16x32_bf16 v[64:67], a[144:147], a[16:19], v[64:67]
    ds_read_b128 a[156:159], v1 offset:8448
    v_mfma_f32_16x16x32_bf16 v[72:75], a[144:147], a[48:51], v[72:75]
    buffer_load_dwordx4 v17, s[16:19], s64 offen offset:1024 nt lds
    v_mfma_f32_16x16x32_bf16 v[80:83], a[144:147], a[80:83], v[80:83]
    v_mfma_f32_16x16x32_bf16 v[88:91], a[144:147], a[112:115], v[88:91]
    s_waitcnt lgkmcnt(6)
    v_mfma_f32_16x16x32_bf16 v[92:95], a[148:151], a[112:115], v[92:95]
    ds_read_b128 a[160:163], v2 offset:256
    v_mfma_f32_16x16x32_bf16 v[84:87], a[148:151], a[80:83], v[84:87]
    buffer_load_dwordx4 v18, s[16:19], s64 offen offset:2048 nt lds
    v_mfma_f32_16x16x32_bf16 v[76:79], a[148:151], a[48:51], v[76:79]
    v_mfma_f32_16x16x32_bf16 v[68:71], a[148:151], a[16:19], v[68:71]
    s_waitcnt lgkmcnt(2)
    v_mfma_f32_16x16x32_bf16 v[64:67], a[152:155], a[20:23], v[64:67]
    ds_read_b128 a[164:167], v2 offset:8448
    v_mfma_f32_16x16x32_bf16 v[72:75], a[152:155], a[52:55], v[72:75]
    v_mfma_f32_16x16x32_bf16 v[80:83], a[152:155], a[84:87], v[80:83]
    buffer_load_dwordx4 v19, s[16:19], s64 offen offset:3072 nt lds
    s_add_u32 s64, s64, 8192
    v_mfma_f32_16x16x32_bf16 v[88:91], a[152:155], a[116:119], v[88:91]
    s_waitcnt lgkmcnt(2)
    v_mfma_f32_16x16x32_bf16 v[92:95], a[156:159], a[116:119], v[92:95]
    ds_read_b128 a[168:171], v3 offset:256
    v_mfma_f32_16x16x32_bf16 v[84:87], a[156:159], a[84:87], v[84:87]
    s_add_u32 m0, s60, 106496
    v_mfma_f32_16x16x32_bf16 v[76:79], a[156:159], a[52:55], v[76:79]
    buffer_load_dwordx4 v16, s[16:19], s64 offen offset:0 nt lds
    v_mfma_f32_16x16x32_bf16 v[68:71], a[156:159], a[20:23], v[68:71]
    s_waitcnt lgkmcnt(2)
    v_mfma_f32_16x16x32_bf16 v[64:67], a[160:163], a[24:27], v[64:67]
    ds_read_b128 a[172:175], v3 offset:8448
    v_mfma_f32_16x16x32_bf16 v[72:75], a[160:163], a[56:59], v[72:75]
    v_mfma_f32_16x16x32_bf16 v[80:83], a[160:163], a[88:91], v[80:83]
    v_mfma_f32_16x16x32_bf16 v[88:91], a[160:163], a[120:123], v[88:91]
    buffer_load_dwordx4 v17, s[16:19], s64 offen offset:1024 nt lds
    s_waitcnt lgkmcnt(2)
    v_mfma_f32_16x16x32_bf16 v[92:95], a[164:167], a[120:123], v[92:95]
    ds_read_b128 a[144:147], v0 offset:32768
    v_mfma_f32_16x16x32_bf16 v[84:87], a[164:167], a[88:91], v[84:87]
    v_mfma_f32_16x16x32_bf16 v[76:79], a[164:167], a[56:59], v[76:79]
    v_mfma_f32_16x16x32_bf16 v[68:71], a[164:167], a[24:27], v[68:71]
    s_waitcnt lgkmcnt(2)
    v_mfma_f32_16x16x32_bf16 v[64:67], a[168:171], a[28:31], v[64:67]
    ds_read_b128 a[148:151], v0 offset:40960
    v_mfma_f32_16x16x32_bf16 v[72:75], a[168:171], a[60:63], v[72:75]
    buffer_load_dwordx4 v18, s[16:19], s64 offen offset:2048 nt lds
    v_mfma_f32_16x16x32_bf16 v[80:83], a[168:171], a[92:95], v[80:83]
    v_mfma_f32_16x16x32_bf16 v[88:91], a[168:171], a[124:127], v[88:91]
    s_waitcnt lgkmcnt(2)
    v_mfma_f32_16x16x32_bf16 v[92:95], a[172:175], a[124:127], v[92:95]
    ds_read_b128 a[152:155], v1 offset:32768
    v_mfma_f32_16x16x32_bf16 v[84:87], a[172:175], a[92:95], v[84:87]
    buffer_load_dwordx4 v19, s[16:19], s64 offen offset:3072 nt lds
    s_add_u32 s64, s64, 24576
    v_mfma_f32_16x16x32_bf16 v[76:79], a[172:175], a[60:63], v[76:79]
    v_mfma_f32_16x16x32_bf16 v[68:71], a[172:175], a[28:31], v[68:71]
    v_max3_f32 v48, v64, v65, v66
    v_max3_f32 v49, v72, v73, v74
    v_max3_f32 v50, v80, v81, v82
    v_max3_f32 v51, v88, v89, v90
    s_nop 3
    v_max3_f32 v48, v48, v67, v68
    v_max3_f32 v49, v49, v75, v76
    v_max3_f32 v50, v50, v83, v84
    v_max3_f32 v51, v51, v91, v92
    v_max3_f32 v48, v48, v69, v70
    v_max3_f32 v49, v49, v77, v78
    v_max3_f32 v50, v50, v85, v86
    v_max3_f32 v51, v51, v93, v94
    v_max_f32 v48, v48, v71
    v_max_f32 v49, v49, v79
    v_max_f32 v50, v50, v87
    v_max_f32 v51, v51, v95
    v_mov_b32 v52, v48
    v_mov_b32 v53, v49
    v_mov_b32 v54, v50
    v_mov_b32 v55, v51
    v_permlane32_swap_b32 v52, v48
    v_permlane32_swap_b32 v53, v49
    v_permlane32_swap_b32 v54, v50
    v_permlane32_swap_b32 v55, v51
    v_max_f32 v48, v48, v52
    v_max_f32 v49, v49, v53
    v_max_f32 v50, v50, v54
    v_max_f32 v51, v51, v55
    v_mov_b32 v52, v48
    v_mov_b32 v53, v49
    v_mov_b32 v54, v50
    v_mov_b32 v55, v51
    v_permlane16_swap_b32 v52, v48
    v_permlane16_swap_b32 v53, v49
    v_permlane16_swap_b32 v54, v50
    v_permlane16_swap_b32 v55, v51
    v_max_f32 v48, v48, v52
    v_max_f32 v49, v49, v53
    v_max_f32 v50, v50, v54
    v_max_f32 v51, v51, v55
    v_mov_b32 v21, 0
    ds_write_b128 v22, v[48:51]
    ds_write_b32 v31, v21
    s_waitcnt lgkmcnt(0)
    s_barrier
    ds_read_b128 v[52:55], v23
    s_waitcnt lgkmcnt(0)
    v_max_f32 v48, v48, v52
    v_max_f32 v49, v49, v53
    v_max_f32 v50, v50, v54
    v_max_f32 v51, v51, v55
    v_sub_f32 v32, 0, v48
    v_sub_f32 v33, 0, v48
    v_sub_f32 v34, 0, v48
    v_sub_f32 v35, 0, v48
    v_sub_f32 v36, 0, v49
    v_sub_f32 v37, 0, v49
    v_sub_f32 v38, 0, v49
    v_sub_f32 v39, 0, v49
    v_sub_f32 v40, 0, v50
    v_sub_f32 v41, 0, v50
    v_sub_f32 v42, 0, v50
    v_sub_f32 v43, 0, v50
    v_sub_f32 v44, 0, v51
    v_sub_f32 v45, 0, v51
    v_sub_f32 v46, 0, v51
    v_sub_f32 v47, 0, v51
    v_sub_f32 v64, v64, v48
    v_sub_f32 v65, v65, v48
    v_sub_f32 v66, v66, v48
    v_sub_f32 v67, v67, v48
    v_sub_f32 v68, v68, v48
    v_sub_f32 v69, v69, v48
    v_sub_f32 v70, v70, v48
    v_sub_f32 v71, v71, v48
    v_sub_f32 v72, v72, v49
    v_sub_f32 v73, v73, v49
    v_sub_f32 v74, v74, v49
    v_sub_f32 v75, v75, v49
    v_sub_f32 v76, v76, v49
    v_sub_f32 v77, v77, v49
    v_sub_f32 v78, v78, v49
    v_sub_f32 v79, v79, v49
    v_sub_f32 v80, v80, v50
    v_sub_f32 v81, v81, v50
    v_sub_f32 v82, v82, v50
    v_sub_f32 v83, v83, v50
    v_sub_f32 v84, v84, v50
    v_sub_f32 v85, v85, v50
    v_sub_f32 v86, v86, v50
    v_sub_f32 v87, v87, v50
    v_sub_f32 v88, v88, v51
    v_sub_f32 v89, v89, v51
    v_sub_f32 v90, v90, v51
    v_sub_f32 v91, v91, v51
    v_sub_f32 v92, v92, v51
    v_sub_f32 v93, v93, v51
    v_sub_f32 v94, v94, v51
    v_sub_f32 v95, v95, v51
    v_mfma_f32_16x16x32_bf16 v[96:99], a[144:147], a[0:3], v[32:35]
    s_waitcnt vmcnt(8)
    s_barrier
    ds_read_b128 a[156:159], v1 offset:40960
    v_mfma_f32_16x16x32_bf16 v[104:107], a[144:147], a[32:35], v[36:39]
    v_exp_f32 v64, v64
    s_add_u32 m0, s60, 0
    v_mfma_f32_16x16x32_bf16 v[112:115], a[144:147], a[64:67], v[40:43]
    s_waitcnt vmcnt(7)
    buffer_load_dwordx4 v12, s[12:15], s63 offen offset:0 nt lds
    v_mfma_f32_16x16x32_bf16 v[120:123], a[144:147], a[96:99], v[44:47]
    v_exp_f32 v65, v65
    v_mfma_f32_16x16x32_bf16 v[124:127], a[148:151], a[96:99], v[44:47]
    ds_read_b128 a[160:163], v2 offset:32768
    v_mfma_f32_16x16x32_bf16 v[116:119], a[148:151], a[64:67], v[40:43]
    v_exp_f32 v66, v66
    v_mfma_f32_16x16x32_bf16 v[108:111], a[148:151], a[32:35], v[36:39]
    v_exp_f32 v67, v67
    v_mfma_f32_16x16x32_bf16 v[100:103], a[148:151], a[0:3], v[32:35]
    v_exp_f32 v68, v68
    v_mfma_f32_16x16x32_bf16 v[96:99], a[152:155], a[4:7], v[96:99]
    ds_read_b128 a[164:167], v2 offset:40960
    v_cvt_pk_bf16_f32 v48, v64, v65
    v_mfma_f32_16x16x32_bf16 v[104:107], a[152:155], a[36:39], v[104:107]
    v_exp_f32 v69, v69
    v_mfma_f32_16x16x32_bf16 v[112:115], a[152:155], a[68:71], v[112:115]
    s_waitcnt vmcnt(7)
    buffer_load_dwordx4 v13, s[12:15], s63 offen offset:1024 nt lds
    v_mfma_f32_16x16x32_bf16 v[120:123], a[152:155], a[100:103], v[120:123]
    v_exp_f32 v70, v70
    s_waitcnt lgkmcnt(2)
    v_mfma_f32_16x16x32_bf16 v[124:127], a[156:159], a[100:103], v[124:127]
    ds_read_b128 a[168:171], v3 offset:32768
    v_cvt_pk_bf16_f32 v49, v66, v67
    v_mfma_f32_16x16x32_bf16 v[116:119], a[156:159], a[68:71], v[116:119]
    v_exp_f32 v71, v71
    v_mfma_f32_16x16x32_bf16 v[108:111], a[156:159], a[36:39], v[108:111]
    v_exp_f32 v72, v72
    v_mfma_f32_16x16x32_bf16 v[100:103], a[156:159], a[4:7], v[100:103]
    v_exp_f32 v73, v73
    s_waitcnt lgkmcnt(2)
    v_mfma_f32_16x16x32_bf16 v[96:99], a[160:163], a[8:11], v[96:99]
    ds_read_b128 a[172:175], v3 offset:40960
    v_cvt_pk_bf16_f32 v50, v68, v69
    v_mfma_f32_16x16x32_bf16 v[104:107], a[160:163], a[40:43], v[104:107]
    s_waitcnt vmcnt(7)
    buffer_load_dwordx4 v14, s[12:15], s63 offen offset:2048 nt lds
    v_mfma_f32_16x16x32_bf16 v[112:115], a[160:163], a[72:75], v[112:115]
    v_exp_f32 v74, v74
    v_mfma_f32_16x16x32_bf16 v[120:123], a[160:163], a[104:107], v[120:123]
    v_exp_f32 v75, v75
    s_waitcnt lgkmcnt(2)
    v_mfma_f32_16x16x32_bf16 v[124:127], a[164:167], a[104:107], v[124:127]
    ds_read_b128 a[144:147], v0 offset:33024
    v_cvt_pk_bf16_f32 v51, v70, v71
    v_mfma_f32_16x16x32_bf16 v[116:119], a[164:167], a[72:75], v[116:119]
    ds_write_b128 v29, v[48:51] offset:0
    v_mfma_f32_16x16x32_bf16 v[108:111], a[164:167], a[40:43], v[108:111]
    v_exp_f32 v76, v76
    v_mfma_f32_16x16x32_bf16 v[100:103], a[164:167], a[8:11], v[100:103]
    v_exp_f32 v77, v77
    s_waitcnt lgkmcnt(3)
    v_mfma_f32_16x16x32_bf16 v[96:99], a[168:171], a[12:15], v[96:99]
    ds_read_b128 a[148:151], v0 offset:41216
    v_cvt_pk_bf16_f32 v52, v72, v73
    v_mfma_f32_16x16x32_bf16 v[104:107], a[168:171], a[44:47], v[104:107]
    s_waitcnt vmcnt(7)
    buffer_load_dwordx4 v15, s[12:15], s63 offen offset:3072 nt lds
    s_add_u32 s63, s63, 8192
    v_mfma_f32_16x16x32_bf16 v[112:115], a[168:171], a[76:79], v[112:115]
    v_exp_f32 v78, v78
    v_mfma_f32_16x16x32_bf16 v[120:123], a[168:171], a[108:111], v[120:123]
    v_exp_f32 v79, v79
    s_waitcnt lgkmcnt(3)
    v_mfma_f32_16x16x32_bf16 v[124:127], a[172:175], a[108:111], v[124:127]
    ds_read_b128 a[152:155], v1 offset:33024
    v_cvt_pk_bf16_f32 v53, v74, v75
    v_mfma_f32_16x16x32_bf16 v[116:119], a[172:175], a[76:79], v[116:119]
    v_exp_f32 v80, v80
    v_mfma_f32_16x16x32_bf16 v[108:111], a[172:175], a[44:47], v[108:111]
    v_exp_f32 v81, v81
    s_add_u32 m0, s60, 8192
    v_mfma_f32_16x16x32_bf16 v[100:103], a[172:175], a[12:15], v[100:103]
    s_waitcnt vmcnt(7)
    buffer_load_dwordx4 v12, s[12:15], s63 offen offset:0 nt lds
    s_waitcnt lgkmcnt(3)
    v_mfma_f32_16x16x32_bf16 v[96:99], a[144:147], a[16:19], v[96:99]
    ds_read_b128 a[156:159], v1 offset:41216
    v_cvt_pk_bf16_f32 v54, v76, v77
    v_mfma_f32_16x16x32_bf16 v[104:107], a[144:147], a[48:51], v[104:107]
    v_exp_f32 v82, v82
    v_mfma_f32_16x16x32_bf16 v[112:115], a[144:147], a[80:83], v[112:115]
    v_exp_f32 v83, v83
    v_mfma_f32_16x16x32_bf16 v[120:123], a[144:147], a[112:115], v[120:123]
    v_exp_f32 v84, v84
    s_waitcnt lgkmcnt(2)
    v_mfma_f32_16x16x32_bf16 v[124:127], a[148:151], a[112:115], v[124:127]
    ds_read_b128 a[160:163], v2 offset:33024
    v_cvt_pk_bf16_f32 v55, v78, v79
    v_mfma_f32_16x16x32_bf16 v[116:119], a[148:151], a[80:83], v[116:119]
    ds_write_b128 v29, v[52:55] offset:1024
    v_mfma_f32_16x16x32_bf16 v[108:111], a[148:151], a[48:51], v[108:111]
    s_waitcnt vmcnt(7)
    buffer_load_dwordx4 v13, s[12:15], s63 offen offset:1024 nt lds
    v_mfma_f32_16x16x32_bf16 v[100:103], a[148:151], a[16:19], v[100:103]
    v_cvt_pk_bf16_f32 v56, v80, v81
    v_cvt_pk_bf16_f32 v57, v82, v83
    s_waitcnt lgkmcnt(3)
    v_mfma_f32_16x16x32_bf16 v[96:99], a[152:155], a[20:23], v[96:99]
    ds_read_b128 a[164:167], v2 offset:41216
    v_mfma_f32_16x16x32_bf16 v[104:107], a[152:155], a[52:55], v[104:107]
    v_exp_f32 v85, v85
    v_mfma_f32_16x16x32_bf16 v[112:115], a[152:155], a[84:87], v[112:115]
    v_exp_f32 v86, v86
    v_mfma_f32_16x16x32_bf16 v[120:123], a[152:155], a[116:119], v[120:123]
    v_exp_f32 v87, v87
    s_waitcnt lgkmcnt(3)
    v_mfma_f32_16x16x32_bf16 v[124:127], a[156:159], a[116:119], v[124:127]
    ds_read_b128 a[168:171], v3 offset:33024
    v_cvt_pk_bf16_f32 v58, v84, v85
    v_mfma_f32_16x16x32_bf16 v[116:119], a[156:159], a[84:87], v[116:119]
    s_waitcnt vmcnt(7)
    buffer_load_dwordx4 v14, s[12:15], s63 offen offset:2048 nt lds
    v_mfma_f32_16x16x32_bf16 v[108:111], a[156:159], a[52:55], v[108:111]
    v_exp_f32 v88, v88
    v_mfma_f32_16x16x32_bf16 v[100:103], a[156:159], a[20:23], v[100:103]
    v_exp_f32 v89, v89
    s_waitcnt lgkmcnt(3)
    v_mfma_f32_16x16x32_bf16 v[96:99], a[160:163], a[24:27], v[96:99]
    ds_read_b128 a[172:175], v3 offset:41216
    v_cvt_pk_bf16_f32 v59, v86, v87
    v_mfma_f32_16x16x32_bf16 v[104:107], a[160:163], a[56:59], v[104:107]
    ds_write_b128 v29, v[56:59] offset:2048
    v_mfma_f32_16x16x32_bf16 v[112:115], a[160:163], a[88:91], v[112:115]
    v_exp_f32 v90, v90
    v_mfma_f32_16x16x32_bf16 v[120:123], a[160:163], a[120:123], v[120:123]
    v_exp_f32 v91, v91
    s_waitcnt lgkmcnt(3)
    v_mfma_f32_16x16x32_bf16 v[124:127], a[164:167], a[120:123], v[124:127]
    ds_read_b64_tr_b16 a[144:145], v4 offset:0
    v_cvt_pk_bf16_f32 v60, v88, v89
    v_mfma_f32_16x16x32_bf16 v[116:119], a[164:167], a[88:91], v[116:119]
    ds_read_b64_tr_b16 a[146:147], v4 offset:8192
    v_cvt_pk_bf16_f32 v61, v90, v91
    v_mfma_f32_16x16x32_bf16 v[108:111], a[164:167], a[56:59], v[108:111]
    s_waitcnt vmcnt(7)
    buffer_load_dwordx4 v15, s[12:15], s63 offen offset:3072 nt lds
    s_add_u32 s63, s63, 24576
    v_mfma_f32_16x16x32_bf16 v[100:103], a[164:167], a[24:27], v[100:103]
    v_exp_f32 v92, v92
    s_waitcnt lgkmcnt(4)
    v_mfma_f32_16x16x32_bf16 v[96:99], a[168:171], a[28:31], v[96:99]
    ds_read_b64_tr_b16 a[148:149], v5 offset:0
    v_mfma_f32_16x16x32_bf16 v[104:107], a[168:171], a[60:63], v[104:107]
    ds_read_b64_tr_b16 a[150:151], v5 offset:8192
    v_mfma_f32_16x16x32_bf16 v[112:115], a[168:171], a[92:95], v[112:115]
    v_exp_f32 v93, v93
    v_mfma_f32_16x16x32_bf16 v[120:123], a[168:171], a[124:127], v[120:123]
    v_exp_f32 v94, v94
    s_waitcnt lgkmcnt(5)
    v_mfma_f32_16x16x32_bf16 v[124:127], a[172:175], a[124:127], v[124:127]
    ds_read_b64_tr_b16 a[152:153], v6 offset:0
    v_cvt_pk_bf16_f32 v62, v92, v93
    v_mfma_f32_16x16x32_bf16 v[116:119], a[172:175], a[92:95], v[116:119]
    ds_read_b64_tr_b16 a[154:155], v6 offset:8192
    v_mfma_f32_16x16x32_bf16 v[108:111], a[172:175], a[60:63], v[108:111]
    v_exp_f32 v95, v95
    v_mfma_f32_16x16x32_bf16 v[100:103], a[172:175], a[28:31], v[100:103]
    v_cvt_pk_bf16_f32 v63, v94, v95
    s_waitcnt lgkmcnt(4)
    v_mfma_f32_16x16x32_bf16 v[128:131], a[144:147], v[48:51], 0
    ds_read_b64_tr_b16 a[156:157], v7 offset:0
    ds_write_b128 v29, v[60:63] offset:3072
    v_mfma_f32_16x16x32_bf16 v[132:135], a[144:147], v[52:55], 0
    ds_read_b64_tr_b16 a[158:159], v7 offset:8192
    v_mfma_f32_16x16x32_bf16 v[136:139], a[144:147], v[56:59], 0
    v_mfma_f32_16x16x32_bf16 v[140:143], a[144:147], v[60:63], 0
    v_max3_f32 v28, v96, v97, v98
    v_max3_f32 v28, v28, v99, v100
    s_waitcnt lgkmcnt(5)
    v_mfma_f32_16x16x32_bf16 v[156:159], a[148:151], v[60:63], 0
    ds_read_b64_tr_b16 a[160:161], v8 offset:0
    v_max3_f32 v28, v28, v101, v102
    v_mfma_f32_16x16x32_bf16 v[152:155], a[148:151], v[56:59], 0
    s_waitcnt lgkmcnt(2)
    s_barrier
    ds_read_b64_tr_b16 a[162:163], v8 offset:8192
    v_max3_f32 v28, v28, v103, v104
    v_mfma_f32_16x16x32_bf16 v[148:151], a[148:151], v[52:55], 0
    ds_read_b128 a[128:131], v30 offset:0
    v_max3_f32 v28, v28, v105, v106
    s_add_u32 m0, s60, 32768
    v_mfma_f32_16x16x32_bf16 v[144:147], a[148:151], v[48:51], 0
    s_waitcnt vmcnt(7)
    buffer_load_dwordx4 v12, s[12:15], s63 offen offset:0 nt lds
    v_mfma_f32_16x16x32_bf16 v[160:163], a[152:155], v[48:51], 0
    ds_read_b64_tr_b16 a[164:165], v9 offset:0
    v_max3_f32 v28, v28, v107, v108
    v_mfma_f32_16x16x32_bf16 v[164:167], a[152:155], v[52:55], 0
    ds_read_b64_tr_b16 a[166:167], v9 offset:8192
    ds_read_b128 a[132:135], v30 offset:1024
    v_mfma_f32_16x16x32_bf16 v[168:171], a[152:155], v[56:59], 0
    v_max3_f32 v28, v28, v109, v110
    v_max3_f32 v28, v28, v111, v112
    v_mfma_f32_16x16x32_bf16 v[172:175], a[152:155], v[60:63], 0
    v_max3_f32 v28, v28, v113, v114
    v_max3_f32 v28, v28, v115, v116
    s_waitcnt lgkmcnt(6)
    v_mfma_f32_16x16x32_bf16 v[188:191], a[156:159], v[60:63], 0
    ds_read_b64_tr_b16 a[168:169], v10 offset:0
    v_max3_f32 v28, v28, v117, v118
    v_mfma_f32_16x16x32_bf16 v[184:187], a[156:159], v[56:59], 0
    ds_read_b64_tr_b16 a[170:171], v10 offset:8192
    v_max3_f32 v28, v28, v119, v120
    v_mfma_f32_16x16x32_bf16 v[180:183], a[156:159], v[52:55], 0
    s_waitcnt vmcnt(7)
    buffer_load_dwordx4 v13, s[12:15], s63 offen offset:1024 nt lds
    v_mfma_f32_16x16x32_bf16 v[176:179], a[156:159], v[48:51], 0
    ds_read_b128 a[136:139], v30 offset:2048
    v_max3_f32 v28, v28, v121, v122
    s_waitcnt lgkmcnt(7)
    v_mfma_f32_16x16x32_bf16 v[192:195], a[160:163], v[48:51], 0
    ds_read_b64_tr_b16 a[172:173], v11 offset:0
    v_add_f32 v24, v24, v64
    v_mfma_f32_16x16x32_bf16 v[196:199], a[160:163], v[52:55], 0
    ds_read_b64_tr_b16 a[174:175], v11 offset:8192
    v_add_f32 v25, v25, v72
    v_mfma_f32_16x16x32_bf16 v[200:203], a[160:163], v[56:59], 0
    ds_read_b128 a[140:143], v30 offset:3072
    v_add_f32 v26, v26, v80
    v_mfma_f32_16x16x32_bf16 v[204:207], a[160:163], v[60:63], 0
    v_add_f32 v27, v27, v88
    v_add_f32 v24, v24, v65
    s_waitcnt lgkmcnt(7)
    v_mfma_f32_16x16x32_bf16 v[220:223], a[164:167], v[60:63], 0
    ds_read_b64_tr_b16 a[144:145], v4 offset:16384
    v_add_f32 v25, v25, v73
    v_mfma_f32_16x16x32_bf16 v[216:219], a[164:167], v[56:59], 0
    ds_read_b64_tr_b16 a[146:147], v4 offset:24576
    v_max3_f32 v28, v28, v123, v124
    v_mfma_f32_16x16x32_bf16 v[212:215], a[164:167], v[52:55], 0
    s_waitcnt vmcnt(7)
    buffer_load_dwordx4 v14, s[12:15], s63 offen offset:2048 nt lds
    v_mfma_f32_16x16x32_bf16 v[208:211], a[164:167], v[48:51], 0
    v_add_f32 v26, v26, v81
    v_max3_f32 v28, v28, v125, v126
    s_waitcnt lgkmcnt(6)
    v_mfma_f32_16x16x32_bf16 v[224:227], a[168:171], v[48:51], 0
    ds_read_b64_tr_b16 a[148:149], v5 offset:16384
    v_add_f32 v27, v27, v89
    v_mfma_f32_16x16x32_bf16 v[228:231], a[168:171], v[52:55], 0
    ds_read_b64_tr_b16 a[150:151], v5 offset:24576
    v_add_f32 v24, v24, v66
    v_mfma_f32_16x16x32_bf16 v[232:235], a[168:171], v[56:59], 0
    v_max_f32 v28, v28, v127
    v_add_f32 v25, v25, v74
    v_mfma_f32_16x16x32_bf16 v[236:239], a[168:171], v[60:63], 0
    v_add_f32 v26, v26, v82
    v_add_f32 v27, v27, v90
    s_waitcnt lgkmcnt(5)
    v_mfma_f32_16x16x32_bf16 v[252:255], a[172:175], v[60:63], 0
    ds_read_b64_tr_b16 a[152:153], v6 offset:16384
    v_add_f32 v24, v24, v67
    v_mfma_f32_16x16x32_bf16 v[248:251], a[172:175], v[56:59], 0
    ds_read_b64_tr_b16 a[154:155], v6 offset:24576
    v_mfma_f32_16x16x32_bf16 v[244:247], a[172:175], v[52:55], 0
    s_waitcnt vmcnt(7)
    buffer_load_dwordx4 v15, s[12:15], s63 offen offset:3072 nt lds
    s_add_u32 s63, s63, 8192
    v_mfma_f32_16x16x32_bf16 v[240:243], a[172:175], v[48:51], 0
    v_add_f32 v25, v25, v75
    v_add_f32 v26, v26, v83
    v_cmp_lt_f32 vcc, s66, v28
    s_cbranch_vccnz L_flag_p4_t0
L_flagback_p4_t0:
    s_waitcnt lgkmcnt(4)
    v_mfma_f32_16x16x32_bf16 v[128:131], a[144:147], a[128:131], v[128:131]
    s_waitcnt vmcnt(4)
    s_barrier
    ds_read_b32 v28, v31
    ds_read_b64_tr_b16 a[156:157], v7 offset:16384
    v_mfma_f32_16x16x32_bf16 v[132:135], a[144:147], a[132:135], v[132:135]
    ds_read_b64_tr_b16 a[158:159], v7 offset:24576
    v_add_f32 v27, v27, v91
    v_mfma_f32_16x16x32_bf16 v[136:139], a[144:147], a[136:139], v[136:139]
    v_add_f32 v24, v24, v68
    s_add_u32 m0, s60, 40960
    v_mfma_f32_16x16x32_bf16 v[140:143], a[144:147], a[140:143], v[140:143]
    s_waitcnt vmcnt(7)
    buffer_load_dwordx4 v12, s[12:15], s63 offen offset:0 nt lds
    s_waitcnt lgkmcnt(5)
    v_mfma_f32_16x16x32_bf16 v[156:159], a[148:151], a[140:143], v[156:159]
    ds_read_b64_tr_b16 a[160:161], v8 offset:16384
    v_add_f32 v25, v25, v76
    v_mfma_f32_16x16x32_bf16 v[152:155], a[148:151], a[136:139], v[152:155]
    ds_read_b64_tr_b16 a[162:163], v8 offset:24576
    v_add_f32 v26, v26, v84
    v_mfma_f32_16x16x32_bf16 v[148:151], a[148:151], a[132:135], v[148:151]
    v_mfma_f32_16x16x32_bf16 v[144:147], a[148:151], a[128:131], v[144:147]
    v_add_f32 v27, v27, v92
    s_waitcnt lgkmcnt(5)
    v_mfma_f32_16x16x32_bf16 v[160:163], a[152:155], a[128:131], v[160:163]
    ds_read_b64_tr_b16 a[164:165], v9 offset:16384
    v_add_f32 v24, v24, v69
    v_mfma_f32_16x16x32_bf16 v[164:167], a[152:155], a[132:135], v[164:167]
    ds_read_b64_tr_b16 a[166:167], v9 offset:24576
    v_mfma_f32_16x16x32_bf16 v[168:171], a[152:155], a[136:139], v[168:171]
    s_waitcnt vmcnt(7)
    buffer_load_dwordx4 v13, s[12:15], s63 offen offset:1024 nt lds
    v_mfma_f32_16x16x32_bf16 v[172:175], a[152:155], a[140:143], v[172:175]
    v_add_f32 v25, v25, v77
    v_add_f32 v26, v26, v85
    s_waitcnt lgkmcnt(4)
    v_mfma_f32_16x16x32_bf16 v[188:191], a[156:159], a[140:143], v[188:191]
    ds_read_b64_tr_b16 a[168:169], v10 offset:16384
    v_mfma_f32_16x16x32_bf16 v[184:187], a[156:159], a[136:139], v[184:187]
    ds_read_b64_tr_b16 a[170:171], v10 offset:24576
    v_add_f32 v27, v27, v93
    v_mfma_f32_16x16x32_bf16 v[180:183], a[156:159], a[132:135], v[180:183]
    v_add_f32 v24, v24, v70
    v_mfma_f32_16x16x32_bf16 v[176:179], a[156:159], a[128:131], v[176:179]
    s_waitcnt lgkmcnt(4)
    v_mfma_f32_16x16x32_bf16 v[192:195], a[160:163], a[128:131], v[192:195]
    ds_read_b64_tr_b16 a[172:173], v11 offset:16384
    v_add_f32 v25, v25, v78
    v_mfma_f32_16x16x32_bf16 v[196:199], a[160:163], a[132:135], v[196:199]
    ds_read_b64_tr_b16 a[174:175], v11 offset:24576
    v_add_f32 v26, v26, v86
    v_mfma_f32_16x16x32_bf16 v[200:203], a[160:163], a[136:139], v[200:203]
    s_waitcnt vmcnt(7)
    buffer_load_dwordx4 v14, s[12:15], s63 offen offset:2048 nt lds
    v_mfma_f32_16x16x32_bf16 v[204:207], a[160:163], a[140:143], v[204:207]
    v_add_f32 v27, v27, v94
    s_waitcnt lgkmcnt(4)
    v_mfma_f32_16x16x32_bf16 v[220:223], a[164:167], a[140:143], v[220:223]
    ds_read_b128 a[144:147], v0 offset:0
    v_add_f32 v24, v24, v71
    v_mfma_f32_16x16x32_bf16 v[216:219], a[164:167], a[136:139], v[216:219]
    v_mfma_f32_16x16x32_bf16 v[212:215], a[164:167], a[132:135], v[212:215]
    v_add_f32 v25, v25, v79
    v_mfma_f32_16x16x32_bf16 v[208:211], a[164:167], a[128:131], v[208:211]
    v_add_f32 v26, v26, v87
    s_waitcnt lgkmcnt(3)
    v_mfma_f32_16x16x32_bf16 v[224:227], a[168:171], a[128:131], v[224:227]
    ds_read_b128 a[148:151], v0 offset:8192
    v_add_f32 v27, v27, v95
    v_mfma_f32_16x16x32_bf16 v[228:231], a[168:171], a[132:135], v[228:231]
    s_waitcnt vmcnt(7)
    buffer_load_dwordx4 v15, s[12:15], s63 offen offset:3072 nt lds
    s_add_u32 s63, s63, 24576
    v_mfma_f32_16x16x32_bf16 v[232:235], a[168:171], a[136:139], v[232:235]
    v_mfma_f32_16x16x32_bf16 v[236:239], a[168:171], a[140:143], v[236:239]
    s_waitcnt lgkmcnt(2)
    v_mfma_f32_16x16x32_bf16 v[252:255], a[172:175], a[140:143], v[252:255]
    ds_read_b128 a[152:155], v1 offset:0
    v_mfma_f32_16x16x32_bf16 v[248:251], a[172:175], a[136:139], v[248:251]
    v_mfma_f32_16x16x32_bf16 v[244:247], a[172:175], a[132:135], v[244:247]
    v_cmp_ne_u32 vcc, 0, v28
    v_mfma_f32_16x16x32_bf16 v[240:243], a[172:175], a[128:131], v[240:243]
    s_cbranch_vccnz L_rare_p4_t0
L_rareback_p4_t0:
    s_waitcnt lgkmcnt(2)
    v_mfma_f32_16x16x32_bf16 v[64:67], a[144:147], a[0:3], v[32:35]
    s_waitcnt vmcnt(63)
    s_barrier
    ds_read_b128 a[156:159], v1 offset:8192
    v_mfma_f32_16x16x32_bf16 v[72:75], a[144:147], a[32:35], v[36:39]
    v_exp_f32 v96, v96
    s_add_u32 m0, s60, 65536
    v_mfma_f32_16x16x32_bf16 v[80:83], a[144:147], a[64:67], v[40:43]
    s_waitcnt vmcnt(7)
    buffer_load_dwordx4 v16, s[16:19], s64 offen offset:0 nt lds
    v_mfma_f32_16x16x32_bf16 v[88:91], a[144:147], a[96:99], v[44:47]
    v_exp_f32 v97, v97
    s_waitcnt lgkmcnt(2)
    v_mfma_f32_16x16x32_bf16 v[92:95], a[148:151], a[96:99], v[44:47]
    ds_read_b128 a[160:163], v2 offset:0
    v_mfma_f32_16x16x32_bf16 v[84:87], a[148:151], a[64:67], v[40:43]
    v_exp_f32 v98, v98
    v_mfma_f32_16x16x32_bf16 v[76:79], a[148:151], a[32:35], v[36:39]
    v_exp_f32 v99, v99
    v_mfma_f32_16x16x32_bf16 v[68:71], a[148:151], a[0:3], v[32:35]
    v_exp_f32 v100, v100
    s_waitcnt lgkmcnt(2)
    v_mfma_f32_16x16x32_bf16 v[64:67], a[152:155], a[4:7], v[64:67]
    ds_read_b128 a[164:167], v2 offset:8192
    v_cvt_pk_bf16_f32 v48, v96, v97
    v_mfma_f32_16x16x32_bf16 v[72:75], a[152:155], a[36:39], v[72:75]
    v_exp_f32 v101, v101
    v_mfma_f32_16x16x32_bf16 v[80:83], a[152:155], a[68:71], v[80:83]
    s_waitcnt vmcnt(7)
    buffer_load_dwordx4 v17, s[16:19], s64 offen offset:1024 nt lds
    v_mfma_f32_16x16x32_bf16 v[88:91], a[152:155], a[100:103], v[88:91]
    v_exp_f32 v102, v102
    s_waitcnt lgkmcnt(2)
    v_mfma_f32_16x16x32_bf16 v[92:95], a[156:159], a[100:103], v[92:95]
    ds_read_b128 a[168:171], v3 offset:0
    v_cvt_pk_bf16_f32 v49, v98, v99
    v_mfma_f32_16x16x32_bf16 v[84:87], a[156:159], a[68:71], v[84:87]
    v_exp_f32 v103, v103
    v_mfma_f32_16x16x32_bf16 v[76:79], a[156:159], a[36:39], v[76:79]
    v_exp_f32 v104, v104
    v_mfma_f32_16x16x32_bf16 v[68:71], a[156:159], a[4:7], v[68:71]
    v_exp_f32 v105, v105
    s_waitcnt lgkmcnt(2)
    v_mfma_f32_16x16x32_bf16 v[64:67], a[160:163], a[8:11], v[64:67]
    ds_read_b128 a[172:175], v3 offset:8192
    v_cvt_pk_bf16_f32 v50, v100, v101
    v_mfma_f32_16x16x32_bf16 v[72:75], a[160:163], a[40:43], v[72:75]
    s_waitcnt vmcnt(7)
    buffer_load_dwordx4 v18, s[16:19], s64 offen offset:2048 nt lds
    v_mfma_f32_16x16x32_bf16 v[80:83], a[160:163], a[72:75], v[80:83]
    v_exp_f32 v106, v106
    v_mfma_f32_16x16x32_bf16 v[88:91], a[160:163], a[104:107], v[88:91]
    v_exp_f32 v107, v107
    s_waitcnt lgkmcnt(2)
    v_mfma_f32_16x16x32_bf16 v[92:95], a[164:167], a[104:107], v[92:95]
    ds_read_b128 a[144:147], v0 offset:256
    v_cvt_pk_bf16_f32 v51, v102, v103
    v_mfma_f32_16x16x32_bf16 v[84:87], a[164:167], a[72:75], v[84:87]
    ds_write_b128 v29, v[48:51] offset:0
    v_mfma_f32_16x16x32_bf16 v[76:79], a[164:167], a[40:43], v[76:79]
    v_exp_f32 v108, v108
    v_mfma_f32_16x16x32_bf16 v[68:71], a[164:167], a[8:11], v[68:71]
    v_exp_f32 v109, v109
    s_waitcnt lgkmcnt(3)
    v_mfma_f32_16x16x32_bf16 v[64:67], a[168:171], a[12:15], v[64:67]
    ds_read_b128 a[148:151], v0 offset:8448
    v_cvt_pk_bf16_f32 v52, v104, v105
    v_mfma_f32_16x16x32_bf16 v[72:75], a[168:171], a[44:47], v[72:75]
    s_waitcnt vmcnt(7)
    buffer_load_dwordx4 v19, s[16:19], s64 offen offset:3072 nt lds
    s_add_u32 s64, s64, 8192
    v_mfma_f32_16x16x32_bf16 v[80:83], a[168:171], a[76:79], v[80:83]
    v_exp_f32 v110, v110
    v_mfma_f32_16x16x32_bf16 v[88:91], a[168:171], a[108:111], v[88:91]
    v_exp_f32 v111, v111
    s_waitcnt lgkmcnt(3)
    v_mfma_f32_16x16x32_bf16 v[92:95], a[172:175], a[108:111], v[92:95]
    ds_read_b128 a[152:155], v1 offset:256
    v_cvt_pk_bf16_f32 v53, v106, v107
    v_mfma_f32_16x16x32_bf16 v[84:87], a[172:175], a[76:79], v[84:87]
    v_exp_f32 v112, v112
    v_mfma_f32_16x16x32_bf16 v[76:79], a[172:175], a[44:47], v[76:79]
    v_exp_f32 v113, v113
    s_add_u32 m0, s60, 73728
    v_mfma_f32_16x16x32_bf16 v[68:71], a[172:175], a[12:15], v[68:71]
    s_waitcnt vmcnt(7)
    buffer_load_dwordx4 v16, s[16:19], s64 offen offset:0 nt lds
    s_waitcnt lgkmcnt(3)
    v_mfma_f32_16x16x32_bf16 v[64:67], a[144:147], a[16:19], v[64:67]
    ds_read_b128 a[156:159], v1 offset:8448
    v_cvt_pk_bf16_f32 v54, v108, v109
    v_mfma_f32_16x16x32_bf16 v[72:75], a[144:147], a[48:51], v[72:75]
    v_exp_f32 v114, v114
    v_mfma_f32_16x16x32_bf16 v[80:83], a[144:147], a[80:83], v[80:83]
    v_exp_f32 v115, v115
    v_mfma_f32_16x16x32_bf16 v[88:91], a[144:147], a[112:115], v[88:91]
    v_exp_f32 v116, v116
    s_waitcnt lgkmcnt(2)
    v_mfma_f32_16x16x32_bf16 v[92:95], a[148:151], a[112:115], v[92:95]
    ds_read_b128 a[160:163], v2 offset:256
    v_cvt_pk_bf16_f32 v55, v110, v111
    v_mfma_f32_16x16x32_bf16 v[84:87], a[148:151], a[80:83], v[84:87]
    ds_write_b128 v29, v[52:55] offset:1024
    v_mfma_f32_16x16x32_bf16 v[76:79], a[148:151], a[48:51], v[76:79]
    s_waitcnt vmcnt(7)
    buffer_load_dwordx4 v17, s[16:19], s64 offen offset:1024 nt lds
    v_mfma_f32_16x16x32_bf16 v[68:71], a[148:151], a[16:19], v[68:71]
    v_cvt_pk_bf16_f32 v56, v112, v113
    v_cvt_pk_bf16_f32 v57, v114, v115
    s_waitcnt lgkmcnt(3)
    v_mfma_f32_16x16x32_bf16 v[64:67], a[152:155], a[20:23], v[64:67]
    ds_read_b128 a[164:167], v2 offset:8448
    v_mfma_f32_16x16x32_bf16 v[72:75], a[152:155], a[52:55], v[72:75]
    v_exp_f32 v117, v117
    v_mfma_f32_16x16x32_bf16 v[80:83], a[152:155], a[84:87], v[80:83]
    v_exp_f32 v118, v118
    v_mfma_f32_16x16x32_bf16 v[88:91], a[152:155], a[116:119], v[88:91]
    v_exp_f32 v119, v119
    s_waitcnt lgkmcnt(3)
    v_mfma_f32_16x16x32_bf16 v[92:95], a[156:159], a[116:119], v[92:95]
    ds_read_b128 a[168:171], v3 offset:256
    v_cvt_pk_bf16_f32 v58, v116, v117
    v_mfma_f32_16x16x32_bf16 v[84:87], a[156:159], a[84:87], v[84:87]
    s_waitcnt vmcnt(7)
    buffer_load_dwordx4 v18, s[16:19], s64 offen offset:2048 nt lds
    v_mfma_f32_16x16x32_bf16 v[76:79], a[156:159], a[52:55], v[76:79]
    v_exp_f32 v120, v120
    v_mfma_f32_16x16x32_bf16 v[68:71], a[156:159], a[20:23], v[68:71]
    v_exp_f32 v121, v121
    s_waitcnt lgkmcnt(3)
    v_mfma_f32_16x16x32_bf16 v[64:67], a[160:163], a[24:27], v[64:67]
    ds_read_b128 a[172:175], v3 offset:8448
    v_cvt_pk_bf16_f32 v59, v118, v119
    v_mfma_f32_16x16x32_bf16 v[72:75], a[160:163], a[56:59], v[72:75]
    ds_write_b128 v29, v[56:59] offset:2048
    v_mfma_f32_16x16x32_bf16 v[80:83], a[160:163], a[88:91], v[80:83]
    v_exp_f32 v122, v122
    v_mfma_f32_16x16x32_bf16 v[88:91], a[160:163], a[120:123], v[88:91]
    v_exp_f32 v123, v123
    s_waitcnt lgkmcnt(3)
    v_mfma_f32_16x16x32_bf16 v[92:95], a[164:167], a[120:123], v[92:95]
    ds_read_b64_tr_b16 a[144:145], v4 offset:32768
    v_cvt_pk_bf16_f32 v60, v120, v121
    v_mfma_f32_16x16x32_bf16 v[84:87], a[164:167], a[88:91], v[84:87]
    ds_read_b64_tr_b16 a[146:147], v4 offset:40960
    v_cvt_pk_bf16_f32 v61, v122, v123
    v_mfma_f32_16x16x32_bf16 v[76:79], a[164:167], a[56:59], v[76:79]
    s_waitcnt vmcnt(7)
    buffer_load_dwordx4 v19, s[16:19], s64 offen offset:3072 nt lds
    s_add_u32 s64, s64, 24576
    v_mfma_f32_16x16x32_bf16 v[68:71], a[164:167], a[24:27], v[68:71]
    v_exp_f32 v124, v124
    s_waitcnt lgkmcnt(4)
    v_mfma_f32_16x16x32_bf16 v[64:67], a[168:171], a[28:31], v[64:67]
    ds_read_b64_tr_b16 a[148:149], v5 offset:32768
    v_mfma_f32_16x16x32_bf16 v[72:75], a[168:171], a[60:63], v[72:75]
    ds_read_b64_tr_b16 a[150:151], v5 offset:40960
    v_mfma_f32_16x16x32_bf16 v[80:83], a[168:171], a[92:95], v[80:83]
    v_exp_f32 v125, v125
    v_mfma_f32_16x16x32_bf16 v[88:91], a[168:171], a[124:127], v[88:91]
    v_exp_f32 v126, v126
    s_waitcnt lgkmcnt(5)
    v_mfma_f32_16x16x32_bf16 v[92:95], a[172:175], a[124:127], v[92:95]
    ds_read_b64_tr_b16 a[152:153], v6 offset:32768
    v_cvt_pk_bf16_f32 v62, v124, v125
    v_mfma_f32_16x16x32_bf16 v[84:87], a[172:175], a[92:95], v[84:87]
    ds_read_b64_tr_b16 a[154:155], v6 offset:40960
    v_mfma_f32_16x16x32_bf16 v[76:79], a[172:175], a[60:63], v[76:79]
    v_exp_f32 v127, v127
    v_mfma_f32_16x16x32_bf16 v[68:71], a[172:175], a[28:31], v[68:71]
    v_cvt_pk_bf16_f32 v63, v126, v127
    s_mov_b32 s65, 14
L_loop_p4:
    s_waitcnt lgkmcnt(4)
    v_mfma_f32_16x16x32_bf16 v[128:131], a[144:147], v[48:51], v[128:131]
    ds_read_b64_tr_b16 a[156:157], v7 offset:32768
    ds_write_b128 v29, v[60:63] offset:3072
    v_mfma_f32_16x16x32_bf16 v[132:135], a[144:147], v[52:55], v[132:135]
    ds_read_b64_tr_b16 a[158:159], v7 offset:40960
    v_mfma_f32_16x16x32_bf16 v[136:139], a[144:147], v[56:59], v[136:139]
    v_mfma_f32_16x16x32_bf16 v[140:143], a[144:147], v[60:63], v[140:143]
    v_max3_f32 v28, v64, v65, v66
    v_max3_f32 v28, v28, v67, v68
    s_waitcnt lgkmcnt(5)
    v_mfma_f32_16x16x32_bf16 v[156:159], a[148:151], v[60:63], v[156:159]
    ds_read_b64_tr_b16 a[160:161], v8 offset:32768
    v_max3_f32 v28, v28, v69, v70
    v_mfma_f32_16x16x32_bf16 v[152:155], a[148:151], v[56:59], v[152:155]
    s_waitcnt lgkmcnt(2)
    s_barrier
    ds_read_b64_tr_b16 a[162:163], v8 offset:40960
    v_max3_f32 v28, v28, v71, v72
    v_mfma_f32_16x16x32_bf16 v[148:151], a[148:151], v[52:55], v[148:151]
    ds_read_b128 a[128:131], v30 offset:0
    v_max3_f32 v28, v28, v73, v74
    s_add_u32 m0, s60, 0
    v_mfma_f32_16x16x32_bf16 v[144:147], a[148:151], v[48:51], v[144:147]
    s_waitcnt vmcnt(7)
    buffer_load_dwordx4 v12, s[12:15], s63 offen offset:0 nt lds
    v_mfma_f32_16x16x32_bf16 v[160:163], a[152:155], v[48:51], v[160:163]
    ds_read_b64_tr_b16 a[164:165], v9 offset:32768
    v_max3_f32 v28, v28, v75, v76
    v_mfma_f32_16x16x32_bf16 v[164:167], a[152:155], v[52:55], v[164:167]
    ds_read_b64_tr_b16 a[166:167], v9 offset:40960
    ds_read_b128 a[132:135], v30 offset:1024
    v_mfma_f32_16x16x32_bf16 v[168:171], a[152:155], v[56:59], v[168:171]
    v_max3_f32 v28, v28, v77, v78
    v_max3_f32 v28, v28, v79, v80
    v_mfma_f32_16x16x32_bf16 v[172:175], a[152:155], v[60:63], v[172:175]
    v_max3_f32 v28, v28, v81, v82
    v_max3_f32 v28, v28, v83, v84
    s_waitcnt lgkmcnt(6)
    v_mfma_f32_16x16x32_bf16 v[188:191], a[156:159], v[60:63], v[188:191]
    ds_read_b64_tr_b16 a[168:169], v10 offset:32768
    v_max3_f32 v28, v28, v85, v86
    v_mfma_f32_16x16x32_bf16 v[184:187], a[156:159], v[56:59], v[184:187]
    ds_read_b64_tr_b16 a[170:171], v10 offset:40960
    v_max3_f32 v28, v28, v87, v88
    v_mfma_f32_16x16x32_bf16 v[180:183], a[156:159], v[52:55], v[180:183]
    s_waitcnt vmcnt(7)
    buffer_load_dwordx4 v13, s[12:15], s63 offen offset:1024 nt lds
    v_mfma_f32_16x16x32_bf16 v[176:179], a[156:159], v[48:51], v[176:179]
    ds_read_b128 a[136:139], v30 offset:2048
    v_max3_f32 v28, v28, v89, v90
    s_waitcnt lgkmcnt(7)
    v_mfma_f32_16x16x32_bf16 v[192:195], a[160:163], v[48:51], v[192:195]
    ds_read_b64_tr_b16 a[172:173], v11 offset:32768
    v_add_f32 v24, v24, v96
    v_mfma_f32_16x16x32_bf16 v[196:199], a[160:163], v[52:55], v[196:199]
    ds_read_b64_tr_b16 a[174:175], v11 offset:40960
    v_add_f32 v25, v25, v104
    v_mfma_f32_16x16x32_bf16 v[200:203], a[160:163], v[56:59], v[200:203]
    ds_read_b128 a[140:143], v30 offset:3072
    v_add_f32 v26, v26, v112
    v_mfma_f32_16x16x32_bf16 v[204:207], a[160:163], v[60:63], v[204:207]
    v_add_f32 v27, v27, v120
    v_add_f32 v24, v24, v97
    s_waitcnt lgkmcnt(7)
    v_mfma_f32_16x16x32_bf16 v[220:223], a[164:167], v[60:63], v[220:223]
    ds_read_b64_tr_b16 a[144:145], v4 offset:49152
    v_add_f32 v25, v25, v105
    v_mfma_f32_16x16x32_bf16 v[216:219], a[164:167], v[56:59], v[216:219]
    ds_read_b64_tr_b16 a[146:147], v4 offset:57344
    v_max3_f32 v28, v28, v91, v92
    v_mfma_f32_16x16x32_bf16 v[212:215], a[164:167], v[52:55], v[212:215]
    s_waitcnt vmcnt(7)
    buffer_load_dwordx4 v14, s[12:15], s63 offen offset:2048 nt lds
    v_mfma_f32_16x16x32_bf16 v[208:211], a[164:167], v[48:51], v[208:211]
    v_add_f32 v26, v26, v113
    v_max3_f32 v28, v28, v93, v94
    s_waitcnt lgkmcnt(6)
    v_mfma_f32_16x16x32_bf16 v[224:227], a[168:171], v[48:51], v[224:227]
    ds_read_b64_tr_b16 a[148:149], v5 offset:49152
    v_add_f32 v27, v27, v121
    v_mfma_f32_16x16x32_bf16 v[228:231], a[168:171], v[52:55], v[228:231]
    ds_read_b64_tr_b16 a[150:151], v5 offset:57344
    v_add_f32 v24, v24, v98
    v_mfma_f32_16x16x32_bf16 v[232:235], a[168:171], v[56:59], v[232:235]
    v_max_f32 v28, v28, v95
    v_add_f32 v25, v25, v106
    v_mfma_f32_16x16x32_bf16 v[236:239], a[168:171], v[60:63], v[236:239]
    v_add_f32 v26, v26, v114
    v_add_f32 v27, v27, v122
    s_waitcnt lgkmcnt(5)
    v_mfma_f32_16x16x32_bf16 v[252:255], a[172:175], v[60:63], v[252:255]
    ds_read_b64_tr_b16 a[152:153], v6 offset:49152
    v_add_f32 v24, v24, v99
    v_mfma_f32_16x16x32_bf16 v[248:251], a[172:175], v[56:59], v[248:251]
    ds_read_b64_tr_b16 a[154:155], v6 offset:57344
    v_mfma_f32_16x16x32_bf16 v[244:247], a[172:175], v[52:55], v[244:247]
    s_waitcnt vmcnt(7)
    buffer_load_dwordx4 v15, s[12:15], s63 offen offset:3072 nt lds
    s_add_u32 s63, s63, 8192
    v_mfma_f32_16x16x32_bf16 v[240:243], a[172:175], v[48:51], v[240:243]
    v_add_f32 v25, v25, v107
    v_add_f32 v26, v26, v115
    v_cmp_lt_f32 vcc, s66, v28
    s_cbranch_vccnz L_flag_p4_l1
L_flagback_p4_l1:
    s_waitcnt lgkmcnt(4)
    v_mfma_f32_16x16x32_bf16 v[128:131], a[144:147], a[128:131], v[128:131]
    s_waitcnt vmcnt(63)
    s_barrier
    ds_read_b32 v28, v31
    ds_read_b64_tr_b16 a[156:157], v7 offset:49152
    v_mfma_f32_16x16x32_bf16 v[132:135], a[144:147], a[132:135], v[132:135]
    ds_read_b64_tr_b16 a[158:159], v7 offset:57344
    v_add_f32 v27, v27, v123
    v_mfma_f32_16x16x32_bf16 v[136:139], a[144:147], a[136:139], v[136:139]
    v_add_f32 v24, v24, v100
    s_add_u32 m0, s60, 8192
    v_mfma_f32_16x16x32_bf16 v[140:143], a[144:147], a[140:143], v[140:143]
    s_waitcnt vmcnt(7)
    buffer_load_dwordx4 v12, s[12:15], s63 offen offset:0 nt lds
    s_waitcnt lgkmcnt(5)
    v_mfma_f32_16x16x32_bf16 v[156:159], a[148:151], a[140:143], v[156:159]
    ds_read_b64_tr_b16 a[160:161], v8 offset:49152
    v_add_f32 v25, v25, v108
    v_mfma_f32_16x16x32_bf16 v[152:155], a[148:151], a[136:139], v[152:155]
    ds_read_b64_tr_b16 a[162:163], v8 offset:57344
    v_add_f32 v26, v26, v116
    v_mfma_f32_16x16x32_bf16 v[148:151], a[148:151], a[132:135], v[148:151]
    v_mfma_f32_16x16x32_bf16 v[144:147], a[148:151], a[128:131], v[144:147]
    v_add_f32 v27, v27, v124
    s_waitcnt lgkmcnt(5)
    v_mfma_f32_16x16x32_bf16 v[160:163], a[152:155], a[128:131], v[160:163]
    ds_read_b64_tr_b16 a[164:165], v9 offset:49152
    v_add_f32 v24, v24, v101
    v_mfma_f32_16x16x32_bf16 v[164:167], a[152:155], a[132:135], v[164:167]
    ds_read_b64_tr_b16 a[166:167], v9 offset:57344
    v_mfma_f32_16x16x32_bf16 v[168:171], a[152:155], a[136:139], v[168:171]
    s_waitcnt vmcnt(7)
    buffer_load_dwordx4 v13, s[12:15], s63 offen offset:1024 nt lds
    v_mfma_f32_16x16x32_bf16 v[172:175], a[152:155], a[140:143], v[172:175]
    v_add_f32 v25, v25, v109
    v_add_f32 v26, v26, v117
    s_waitcnt lgkmcnt(4)
    v_mfma_f32_16x16x32_bf16 v[188:191], a[156:159], a[140:143], v[188:191]
    ds_read_b64_tr_b16 a[168:169], v10 offset:49152
    v_mfma_f32_16x16x32_bf16 v[184:187], a[156:159], a[136:139], v[184:187]
    ds_read_b64_tr_b16 a[170:171], v10 offset:57344
    v_add_f32 v27, v27, v125
    v_mfma_f32_16x16x32_bf16 v[180:183], a[156:159], a[132:135], v[180:183]
    v_add_f32 v24, v24, v102
    v_mfma_f32_16x16x32_bf16 v[176:179], a[156:159], a[128:131], v[176:179]
    s_waitcnt lgkmcnt(4)
    v_mfma_f32_16x16x32_bf16 v[192:195], a[160:163], a[128:131], v[192:195]
    ds_read_b64_tr_b16 a[172:173], v11 offset:49152
    v_add_f32 v25, v25, v110
    v_mfma_f32_16x16x32_bf16 v[196:199], a[160:163], a[132:135], v[196:199]
    ds_read_b64_tr_b16 a[174:175], v11 offset:57344
    v_add_f32 v26, v26, v118
    v_mfma_f32_16x16x32_bf16 v[200:203], a[160:163], a[136:139], v[200:203]
    s_waitcnt vmcnt(7)
    buffer_load_dwordx4 v14, s[12:15], s63 offen offset:2048 nt lds
    v_mfma_f32_16x16x32_bf16 v[204:207], a[160:163], a[140:143], v[204:207]
    v_add_f32 v27, v27, v126
    s_waitcnt lgkmcnt(4)
    v_mfma_f32_16x16x32_bf16 v[220:223], a[164:167], a[140:143], v[220:223]
    ds_read_b128 a[144:147], v0 offset:32768
    v_add_f32 v24, v24, v103
    v_mfma_f32_16x16x32_bf16 v[216:219], a[164:167], a[136:139], v[216:219]
    v_mfma_f32_16x16x32_bf16 v[212:215], a[164:167], a[132:135], v[212:215]
    v_add_f32 v25, v25, v111
    v_mfma_f32_16x16x32_bf16 v[208:211], a[164:167], a[128:131], v[208:211]
    v_add_f32 v26, v26, v119
    s_waitcnt lgkmcnt(3)
    v_mfma_f32_16x16x32_bf16 v[224:227], a[168:171], a[128:131], v[224:227]
    ds_read_b128 a[148:151], v0 offset:40960
    v_add_f32 v27, v27, v127
    v_mfma_f32_16x16x32_bf16 v[228:231], a[168:171], a[132:135], v[228:231]
    s_waitcnt vmcnt(7)
    buffer_load_dwordx4 v15, s[12:15], s63 offen offset:3072 nt lds
    s_add_u32 s63, s63, 24576
    v_mfma_f32_16x16x32_bf16 v[232:235], a[168:171], a[136:139], v[232:235]
    v_mfma_f32_16x16x32_bf16 v[236:239], a[168:171], a[140:143], v[236:239]
    s_waitcnt lgkmcnt(2)
    v_mfma_f32_16x16x32_bf16 v[252:255], a[172:175], a[140:143], v[252:255]
    ds_read_b128 a[152:155], v1 offset:32768
    v_mfma_f32_16x16x32_bf16 v[248:251], a[172:175], a[136:139], v[248:251]
    v_mfma_f32_16x16x32_bf16 v[244:247], a[172:175], a[132:135], v[244:247]
    v_cmp_ne_u32 vcc, 0, v28
    v_mfma_f32_16x16x32_bf16 v[240:243], a[172:175], a[128:131], v[240:243]
    s_cbranch_vccnz L_rare_p4_l1
L_rareback_p4_l1:
    s_waitcnt lgkmcnt(2)
    v_mfma_f32_16x16x32_bf16 v[96:99], a[144:147], a[0:3], v[32:35]
    s_waitcnt vmcnt(63)
    s_barrier
    ds_read_b128 a[156:159], v1 offset:40960
    v_mfma_f32_16x16x32_bf16 v[104:107], a[144:147], a[32:35], v[36:39]
    v_exp_f32 v64, v64
    s_add_u32 m0, s60, 98304
    v_mfma_f32_16x16x32_bf16 v[112:115], a[144:147], a[64:67], v[40:43]
    s_waitcnt vmcnt(7)
    buffer_load_dwordx4 v16, s[16:19], s64 offen offset:0 nt lds
    v_mfma_f32_16x16x32_bf16 v[120:123], a[144:147], a[96:99], v[44:47]
    v_exp_f32 v65, v65
    s_waitcnt lgkmcnt(2)
    v_mfma_f32_16x16x32_bf16 v[124:127], a[148:151], a[96:99], v[44:47]
    ds_read_b128 a[160:163], v2 offset:32768
    v_mfma_f32_16x16x32_bf16 v[116:119], a[148:151], a[64:67], v[40:43]
    v_exp_f32 v66, v66
    v_mfma_f32_16x16x32_bf16 v[108:111], a[148:151], a[32:35], v[36:39]
    v_exp_f32 v67, v67
    v_mfma_f32_16x16x32_bf16 v[100:103], a[148:151], a[0:3], v[32:35]
    v_exp_f32 v68, v68
    s_waitcnt lgkmcnt(2)
    v_mfma_f32_16x16x32_bf16 v[96:99], a[152:155], a[4:7], v[96:99]
    ds_read_b128 a[164:167], v2 offset:40960
    v_cvt_pk_bf16_f32 v48, v64, v65
    v_mfma_f32_16x16x32_bf16 v[104:107], a[152:155], a[36:39], v[104:107]
    v_exp_f32 v69, v69
    v_mfma_f32_16x16x32_bf16 v[112:115], a[152:155], a[68:71], v[112:115]
    s_waitcnt vmcnt(7)
    buffer_load_dwordx4 v17, s[16:19], s64 offen offset:1024 nt lds
    v_mfma_f32_16x16x32_bf16 v[120:123], a[152:155], a[100:103], v[120:123]
    v_exp_f32 v70, v70
    s_waitcnt lgkmcnt(2)
    v_mfma_f32_16x16x32_bf16 v[124:127], a[156:159], a[100:103], v[124:127]
    ds_read_b128 a[168:171], v3 offset:32768
    v_cvt_pk_bf16_f32 v49, v66, v67
    v_mfma_f32_16x16x32_bf16 v[116:119], a[156:159], a[68:71], v[116:119]
    v_exp_f32 v71, v71
    v_mfma_f32_16x16x32_bf16 v[108:111], a[156:159], a[36:39], v[108:111]
    v_exp_f32 v72, v72
    v_mfma_f32_16x16x32_bf16 v[100:103], a[156:159], a[4:7], v[100:103]
    v_exp_f32 v73, v73
    s_waitcnt lgkmcnt(2)
    v_mfma_f32_16x16x32_bf16 v[96:99], a[160:163], a[8:11], v[96:99]
    ds_read_b128 a[172:175], v3 offset:40960
    v_cvt_pk_bf16_f32 v50, v68, v69
    v_mfma_f32_16x16x32_bf16 v[104:107], a[160:163], a[40:43], v[104:107]
    s_waitcnt vmcnt(7)
    buffer_load_dwordx4 v18, s[16:19], s64 offen offset:2048 nt lds
    v_mfma_f32_16x16x32_bf16 v[112:115], a[160:163], a[72:75], v[112:115]
    v_exp_f32 v74, v74
    v_mfma_f32_16x16x32_bf16 v[120:123], a[160:163], a[104:107], v[120:123]
    v_exp_f32 v75, v75
    s_waitcnt lgkmcnt(2)
    v_mfma_f32_16x16x32_bf16 v[124:127], a[164:167], a[104:107], v[124:127]
    ds_read_b128 a[144:147], v0 offset:33024
    v_cvt_pk_bf16_f32 v51, v70, v71
    v_mfma_f32_16x16x32_bf16 v[116:119], a[164:167], a[72:75], v[116:119]
    ds_write_b128 v29, v[48:51] offset:0
    v_mfma_f32_16x16x32_bf16 v[108:111], a[164:167], a[40:43], v[108:111]
    v_exp_f32 v76, v76
    v_mfma_f32_16x16x32_bf16 v[100:103], a[164:167], a[8:11], v[100:103]
    v_exp_f32 v77, v77
    s_waitcnt lgkmcnt(3)
    v_mfma_f32_16x16x32_bf16 v[96:99], a[168:171], a[12:15], v[96:99]
    ds_read_b128 a[148:151], v0 offset:41216
    v_cvt_pk_bf16_f32 v52, v72, v73
    v_mfma_f32_16x16x32_bf16 v[104:107], a[168:171], a[44:47], v[104:107]
    s_waitcnt vmcnt(7)
    buffer_load_dwordx4 v19, s[16:19], s64 offen offset:3072 nt lds
    s_add_u32 s64, s64, 8192
    v_mfma_f32_16x16x32_bf16 v[112:115], a[168:171], a[76:79], v[112:115]
    v_exp_f32 v78, v78
    v_mfma_f32_16x16x32_bf16 v[120:123], a[168:171], a[108:111], v[120:123]
    v_exp_f32 v79, v79
    s_waitcnt lgkmcnt(3)
    v_mfma_f32_16x16x32_bf16 v[124:127], a[172:175], a[108:111], v[124:127]
    ds_read_b128 a[152:155], v1 offset:33024
    v_cvt_pk_bf16_f32 v53, v74, v75
    v_mfma_f32_16x16x32_bf16 v[116:119], a[172:175], a[76:79], v[116:119]
    v_exp_f32 v80, v80
    v_mfma_f32_16x16x32_bf16 v[108:111], a[172:175], a[44:47], v[108:111]
    v_exp_f32 v81, v81
    s_add_u32 m0, s60, 106496
    v_mfma_f32_16x16x32_bf16 v[100:103], a[172:175], a[12:15], v[100:103]
    s_waitcnt vmcnt(7)
    buffer_load_dwordx4 v16, s[16:19], s64 offen offset:0 nt lds
    s_waitcnt lgkmcnt(3)
    v_mfma_f32_16x16x32_bf16 v[96:99], a[144:147], a[16:19], v[96:99]
    ds_read_b128 a[156:159], v1 offset:41216
    v_cvt_pk_bf16_f32 v54, v76, v77
    v_mfma_f32_16x16x32_bf16 v[104:107], a[144:147], a[48:51], v[104:107]
    v_exp_f32 v82, v82
    v_mfma_f32_16x16x32_bf16 v[112:115], a[144:147], a[80:83], v[112:115]
    v_exp_f32 v83, v83
    v_mfma_f32_16x16x32_bf16 v[120:123], a[144:147], a[112:115], v[120:123]
    v_exp_f32 v84, v84
    s_waitcnt lgkmcnt(2)
    v_mfma_f32_16x16x32_bf16 v[124:127], a[148:151], a[112:115], v[124:127]
    ds_read_b128 a[160:163], v2 offset:33024
    v_cvt_pk_bf16_f32 v55, v78, v79
    v_mfma_f32_16x16x32_bf16 v[116:119], a[148:151], a[80:83], v[116:119]
    ds_write_b128 v29, v[52:55] offset:1024
    v_mfma_f32_16x16x32_bf16 v[108:111], a[148:151], a[48:51], v[108:111]
    s_waitcnt vmcnt(7)
    buffer_load_dwordx4 v17, s[16:19], s64 offen offset:1024 nt lds
    v_mfma_f32_16x16x32_bf16 v[100:103], a[148:151], a[16:19], v[100:103]
    v_cvt_pk_bf16_f32 v56, v80, v81
    v_cvt_pk_bf16_f32 v57, v82, v83
    s_waitcnt lgkmcnt(3)
    v_mfma_f32_16x16x32_bf16 v[96:99], a[152:155], a[20:23], v[96:99]
    ds_read_b128 a[164:167], v2 offset:41216
    v_mfma_f32_16x16x32_bf16 v[104:107], a[152:155], a[52:55], v[104:107]
    v_exp_f32 v85, v85
    v_mfma_f32_16x16x32_bf16 v[112:115], a[152:155], a[84:87], v[112:115]
    v_exp_f32 v86, v86
    v_mfma_f32_16x16x32_bf16 v[120:123], a[152:155], a[116:119], v[120:123]
    v_exp_f32 v87, v87
    s_waitcnt lgkmcnt(3)
    v_mfma_f32_16x16x32_bf16 v[124:127], a[156:159], a[116:119], v[124:127]
    ds_read_b128 a[168:171], v3 offset:33024
    v_cvt_pk_bf16_f32 v58, v84, v85
    v_mfma_f32_16x16x32_bf16 v[116:119], a[156:159], a[84:87], v[116:119]
    s_waitcnt vmcnt(7)
    buffer_load_dwordx4 v18, s[16:19], s64 offen offset:2048 nt lds
    v_mfma_f32_16x16x32_bf16 v[108:111], a[156:159], a[52:55], v[108:111]
    v_exp_f32 v88, v88
    v_mfma_f32_16x16x32_bf16 v[100:103], a[156:159], a[20:23], v[100:103]
    v_exp_f32 v89, v89
    s_waitcnt lgkmcnt(3)
    v_mfma_f32_16x16x32_bf16 v[96:99], a[160:163], a[24:27], v[96:99]
    ds_read_b128 a[172:175], v3 offset:41216
    v_cvt_pk_bf16_f32 v59, v86, v87
    v_mfma_f32_16x16x32_bf16 v[104:107], a[160:163], a[56:59], v[104:107]
    ds_write_b128 v29, v[56:59] offset:2048
    v_mfma_f32_16x16x32_bf16 v[112:115], a[160:163], a[88:91], v[112:115]
    v_exp_f32 v90, v90
    v_mfma_f32_16x16x32_bf16 v[120:123], a[160:163], a[120:123], v[120:123]
    v_exp_f32 v91, v91
    s_waitcnt lgkmcnt(3)
    v_mfma_f32_16x16x32_bf16 v[124:127], a[164:167], a[120:123], v[124:127]
    ds_read_b64_tr_b16 a[144:145], v4 offset:0
    v_cvt_pk_bf16_f32 v60, v88, v89
    v_mfma_f32_16x16x32_bf16 v[116:119], a[164:167], a[88:91], v[116:119]
    ds_read_b64_tr_b16 a[146:147], v4 offset:8192
    v_cvt_pk_bf16_f32 v61, v90, v91
    v_mfma_f32_16x16x32_bf16 v[108:111], a[164:167], a[56:59], v[108:111]
    s_waitcnt vmcnt(7)
    buffer_load_dwordx4 v19, s[16:19], s64 offen offset:3072 nt lds
    s_add_u32 s64, s64, 24576
    v_mfma_f32_16x16x32_bf16 v[100:103], a[164:167], a[24:27], v[100:103]
    v_exp_f32 v92, v92
    s_waitcnt lgkmcnt(4)
    v_mfma_f32_16x16x32_bf16 v[96:99], a[168:171], a[28:31], v[96:99]
    ds_read_b64_tr_b16 a[148:149], v5 offset:0
    v_mfma_f32_16x16x32_bf16 v[104:107], a[168:171], a[60:63], v[104:107]
    ds_read_b64_tr_b16 a[150:151], v5 offset:8192
    v_mfma_f32_16x16x32_bf16 v[112:115], a[168:171], a[92:95], v[112:115]
    v_exp_f32 v93, v93
    v_mfma_f32_16x16x32_bf16 v[120:123], a[168:171], a[124:127], v[120:123]
    v_exp_f32 v94, v94
    s_waitcnt lgkmcnt(5)
    v_mfma_f32_16x16x32_bf16 v[124:127], a[172:175], a[124:127], v[124:127]
    ds_read_b64_tr_b16 a[152:153], v6 offset:0
    v_cvt_pk_bf16_f32 v62, v92, v93
    v_mfma_f32_16x16x32_bf16 v[116:119], a[172:175], a[92:95], v[116:119]
    ds_read_b64_tr_b16 a[154:155], v6 offset:8192
    v_mfma_f32_16x16x32_bf16 v[108:111], a[172:175], a[60:63], v[108:111]
    v_exp_f32 v95, v95
    v_mfma_f32_16x16x32_bf16 v[100:103], a[172:175], a[28:31], v[100:103]
    v_cvt_pk_bf16_f32 v63, v94, v95
    s_waitcnt lgkmcnt(4)
    v_mfma_f32_16x16x32_bf16 v[128:131], a[144:147], v[48:51], v[128:131]
    ds_read_b64_tr_b16 a[156:157], v7 offset:0
    ds_write_b128 v29, v[60:63] offset:3072
    v_mfma_f32_16x16x32_bf16 v[132:135], a[144:147], v[52:55], v[132:135]
    ds_read_b64_tr_b16 a[158:159], v7 offset:8192
    v_mfma_f32_16x16x32_bf16 v[136:139], a[144:147], v[56:59], v[136:139]
    v_mfma_f32_16x16x32_bf16 v[140:143], a[144:147], v[60:63], v[140:143]
    v_max3_f32 v28, v96, v97, v98
    v_max3_f32 v28, v28, v99, v100
    s_waitcnt lgkmcnt(5)
    v_mfma_f32_16x16x32_bf16 v[156:159], a[148:151], v[60:63], v[156:159]
    ds_read_b64_tr_b16 a[160:161], v8 offset:0
    v_max3_f32 v28, v28, v101, v102
    v_mfma_f32_16x16x32_bf16 v[152:155], a[148:151], v[56:59], v[152:155]
    s_waitcnt lgkmcnt(2)
    s_barrier
    ds_read_b64_tr_b16 a[162:163], v8 offset:8192
    v_max3_f32 v28, v28, v103, v104
    v_mfma_f32_16x16x32_bf16 v[148:151], a[148:151], v[52:55], v[148:151]
    ds_read_b128 a[128:131], v30 offset:0
    v_max3_f32 v28, v28, v105, v106
    s_add_u32 m0, s60, 32768
    v_mfma_f32_16x16x32_bf16 v[144:147], a[148:151], v[48:51], v[144:147]
    s_waitcnt vmcnt(7)
    buffer_load_dwordx4 v12, s[12:15], s63 offen offset:0 nt lds
    v_mfma_f32_16x16x32_bf16 v[160:163], a[152:155], v[48:51], v[160:163]
    ds_read_b64_tr_b16 a[164:165], v9 offset:0
    v_max3_f32 v28, v28, v107, v108
    v_mfma_f32_16x16x32_bf16 v[164:167], a[152:155], v[52:55], v[164:167]
    ds_read_b64_tr_b16 a[166:167], v9 offset:8192
    ds_read_b128 a[132:135], v30 offset:1024
    v_mfma_f32_16x16x32_bf16 v[168:171], a[152:155], v[56:59], v[168:171]
    v_max3_f32 v28, v28, v109, v110
    v_max3_f32 v28, v28, v111, v112
    v_mfma_f32_16x16x32_bf16 v[172:175], a[152:155], v[60:63], v[172:175]
    v_max3_f32 v28, v28, v113, v114
    v_max3_f32 v28, v28, v115, v116
    s_waitcnt lgkmcnt(6)
    v_mfma_f32_16x16x32_bf16 v[188:191], a[156:159], v[60:63], v[188:191]
    ds_read_b64_tr_b16 a[168:169], v10 offset:0
    v_max3_f32 v28, v28, v117, v118
    v_mfma_f32_16x16x32_bf16 v[184:187], a[156:159], v[56:59], v[184:187]
    ds_read_b64_tr_b16 a[170:171], v10 offset:8192
    v_max3_f32 v28, v28, v119, v120
    v_mfma_f32_16x16x32_bf16 v[180:183], a[156:159], v[52:55], v[180:183]
    s_waitcnt vmcnt(7)
    buffer_load_dwordx4 v13, s[12:15], s63 offen offset:1024 nt lds
    v_mfma_f32_16x16x32_bf16 v[176:179], a[156:159], v[48:51], v[176:179]
    ds_read_b128 a[136:139], v30 offset:2048
    v_max3_f32 v28, v28, v121, v122
    s_waitcnt lgkmcnt(7)
    v_mfma_f32_16x16x32_bf16 v[192:195], a[160:163], v[48:51], v[192:195]
    ds_read_b64_tr_b16 a[172:173], v11 offset:0
    v_add_f32 v24, v24, v64
    v_mfma_f32_16x16x32_bf16 v[196:199], a[160:163], v[52:55], v[196:199]
    ds_read_b64_tr_b16 a[174:175], v11 offset:8192
    v_add_f32 v25, v25, v72
    v_mfma_f32_16x16x32_bf16 v[200:203], a[160:163], v[56:59], v[200:203]
    ds_read_b128 a[140:143], v30 offset:3072
    v_add_f32 v26, v26, v80
    v_mfma_f32_16x16x32_bf16 v[204:207], a[160:163], v[60:63], v[204:207]
    v_add_f32 v27, v27, v88
    v_add_f32 v24, v24, v65
    s_waitcnt lgkmcnt(7)
    v_mfma_f32_16x16x32_bf16 v[220:223], a[164:167], v[60:63], v[220:223]
    ds_read_b64_tr_b16 a[144:145], v4 offset:16384
    v_add_f32 v25, v25, v73
    v_mfma_f32_16x16x32_bf16 v[216:219], a[164:167], v[56:59], v[216:219]
    ds_read_b64_tr_b16 a[146:147], v4 offset:24576
    v_max3_f32 v28, v28, v123, v124
    v_mfma_f32_16x16x32_bf16 v[212:215], a[164:167], v[52:55], v[212:215]
    s_waitcnt vmcnt(7)
    buffer_load_dwordx4 v14, s[12:15], s63 offen offset:2048 nt lds
    v_mfma_f32_16x16x32_bf16 v[208:211], a[164:167], v[48:51], v[208:211]
    v_add_f32 v26, v26, v81
    v_max3_f32 v28, v28, v125, v126
    s_waitcnt lgkmcnt(6)
    v_mfma_f32_16x16x32_bf16 v[224:227], a[168:171], v[48:51], v[224:227]
    ds_read_b64_tr_b16 a[148:149], v5 offset:16384
    v_add_f32 v27, v27, v89
    v_mfma_f32_16x16x32_bf16 v[228:231], a[168:171], v[52:55], v[228:231]
    ds_read_b64_tr_b16 a[150:151], v5 offset:24576
    v_add_f32 v24, v24, v66
    v_mfma_f32_16x16x32_bf16 v[232:235], a[168:171], v[56:59], v[232:235]
    v_max_f32 v28, v28, v127
    v_add_f32 v25, v25, v74
    v_mfma_f32_16x16x32_bf16 v[236:239], a[168:171], v[60:63], v[236:239]
    v_add_f32 v26, v26, v82
    v_add_f32 v27, v27, v90
    s_waitcnt lgkmcnt(5)
    v_mfma_f32_16x16x32_bf16 v[252:255], a[172:175], v[60:63], v[252:255]
    ds_read_b64_tr_b16 a[152:153], v6 offset:16384
    v_add_f32 v24, v24, v67
    v_mfma_f32_16x16x32_bf16 v[248:251], a[172:175], v[56:59], v[248:251]
    ds_read_b64_tr_b16 a[154:155], v6 offset:24576
    v_mfma_f32_16x16x32_bf16 v[244:247], a[172:175], v[52:55], v[244:247]
    s_waitcnt vmcnt(7)
    buffer_load_dwordx4 v15, s[12:15], s63 offen offset:3072 nt lds
    s_add_u32 s63, s63, 8192
    v_mfma_f32_16x16x32_bf16 v[240:243], a[172:175], v[48:51], v[240:243]
    v_add_f32 v25, v25, v75
    v_add_f32 v26, v26, v83
    v_cmp_lt_f32 vcc, s66, v28
    s_cbranch_vccnz L_flag_p4_l0
L_flagback_p4_l0:
    s_waitcnt lgkmcnt(4)
    v_mfma_f32_16x16x32_bf16 v[128:131], a[144:147], a[128:131], v[128:131]
    s_waitcnt vmcnt(63)
    s_barrier
    ds_read_b32 v28, v31
    ds_read_b64_tr_b16 a[156:157], v7 offset:16384
    v_mfma_f32_16x16x32_bf16 v[132:135], a[144:147], a[132:135], v[132:135]
    ds_read_b64_tr_b16 a[158:159], v7 offset:24576
    v_add_f32 v27, v27, v91
    v_mfma_f32_16x16x32_bf16 v[136:139], a[144:147], a[136:139], v[136:139]
    v_add_f32 v24, v24, v68
    s_add_u32 m0, s60, 40960
    v_mfma_f32_16x16x32_bf16 v[140:143], a[144:147], a[140:143], v[140:143]
    s_waitcnt vmcnt(7)
    buffer_load_dwordx4 v12, s[12:15], s63 offen offset:0 nt lds
    s_waitcnt lgkmcnt(5)
    v_mfma_f32_16x16x32_bf16 v[156:159], a[148:151], a[140:143], v[156:159]
    ds_read_b64_tr_b16 a[160:161], v8 offset:16384
    v_add_f32 v25, v25, v76
    v_mfma_f32_16x16x32_bf16 v[152:155], a[148:151], a[136:139], v[152:155]
    ds_read_b64_tr_b16 a[162:163], v8 offset:24576
    v_add_f32 v26, v26, v84
    v_mfma_f32_16x16x32_bf16 v[148:151], a[148:151], a[132:135], v[148:151]
    v_mfma_f32_16x16x32_bf16 v[144:147], a[148:151], a[128:131], v[144:147]
    v_add_f32 v27, v27, v92
    s_waitcnt lgkmcnt(5)
    v_mfma_f32_16x16x32_bf16 v[160:163], a[152:155], a[128:131], v[160:163]
    ds_read_b64_tr_b16 a[164:165], v9 offset:16384
    v_add_f32 v24, v24, v69
    v_mfma_f32_16x16x32_bf16 v[164:167], a[152:155], a[132:135], v[164:167]
    ds_read_b64_tr_b16 a[166:167], v9 offset:24576
    v_mfma_f32_16x16x32_bf16 v[168:171], a[152:155], a[136:139], v[168:171]
    s_waitcnt vmcnt(7)
    buffer_load_dwordx4 v13, s[12:15], s63 offen offset:1024 nt lds
    v_mfma_f32_16x16x32_bf16 v[172:175], a[152:155], a[140:143], v[172:175]
    v_add_f32 v25, v25, v77
    v_add_f32 v26, v26, v85
    s_waitcnt lgkmcnt(4)
    v_mfma_f32_16x16x32_bf16 v[188:191], a[156:159], a[140:143], v[188:191]
    ds_read_b64_tr_b16 a[168:169], v10 offset:16384
    v_mfma_f32_16x16x32_bf16 v[184:187], a[156:159], a[136:139], v[184:187]
    ds_read_b64_tr_b16 a[170:171], v10 offset:24576
    v_add_f32 v27, v27, v93
    v_mfma_f32_16x16x32_bf16 v[180:183], a[156:159], a[132:135], v[180:183]
    v_add_f32 v24, v24, v70
    v_mfma_f32_16x16x32_bf16 v[176:179], a[156:159], a[128:131], v[176:179]
    s_waitcnt lgkmcnt(4)
    v_mfma_f32_16x16x32_bf16 v[192:195], a[160:163], a[128:131], v[192:195]
    ds_read_b64_tr_b16 a[172:173], v11 offset:16384
    v_add_f32 v25, v25, v78
    v_mfma_f32_16x16x32_bf16 v[196:199], a[160:163], a[132:135], v[196:199]
    ds_read_b64_tr_b16 a[174:175], v11 offset:24576
    v_add_f32 v26, v26, v86
    v_mfma_f32_16x16x32_bf16 v[200:203], a[160:163], a[136:139], v[200:203]
    s_waitcnt vmcnt(7)
    buffer_load_dwordx4 v14, s[12:15], s63 offen offset:2048 nt lds
    v_mfma_f32_16x16x32_bf16 v[204:207], a[160:163], a[140:143], v[204:207]
    v_add_f32 v27, v27, v94
    s_waitcnt lgkmcnt(4)
    v_mfma_f32_16x16x32_bf16 v[220:223], a[164:167], a[140:143], v[220:223]
    ds_read_b128 a[144:147], v0 offset:0
    v_add_f32 v24, v24, v71
    v_mfma_f32_16x16x32_bf16 v[216:219], a[164:167], a[136:139], v[216:219]
    v_mfma_f32_16x16x32_bf16 v[212:215], a[164:167], a[132:135], v[212:215]
    v_add_f32 v25, v25, v79
    v_mfma_f32_16x16x32_bf16 v[208:211], a[164:167], a[128:131], v[208:211]
    v_add_f32 v26, v26, v87
    s_waitcnt lgkmcnt(3)
    v_mfma_f32_16x16x32_bf16 v[224:227], a[168:171], a[128:131], v[224:227]
    ds_read_b128 a[148:151], v0 offset:8192
    v_add_f32 v27, v27, v95
    v_mfma_f32_16x16x32_bf16 v[228:231], a[168:171], a[132:135], v[228:231]
    s_waitcnt vmcnt(7)
    buffer_load_dwordx4 v15, s[12:15], s63 offen offset:3072 nt lds
    s_add_u32 s63, s63, 24576
    v_mfma_f32_16x16x32_bf16 v[232:235], a[168:171], a[136:139], v[232:235]
    v_mfma_f32_16x16x32_bf16 v[236:239], a[168:171], a[140:143], v[236:239]
    s_waitcnt lgkmcnt(2)
    v_mfma_f32_16x16x32_bf16 v[252:255], a[172:175], a[140:143], v[252:255]
    ds_read_b128 a[152:155], v1 offset:0
    v_mfma_f32_16x16x32_bf16 v[248:251], a[172:175], a[136:139], v[248:251]
    v_mfma_f32_16x16x32_bf16 v[244:247], a[172:175], a[132:135], v[244:247]
    v_cmp_ne_u32 vcc, 0, v28
    v_mfma_f32_16x16x32_bf16 v[240:243], a[172:175], a[128:131], v[240:243]
    s_cbranch_vccnz L_rare_p4_l0
L_rareback_p4_l0:
    s_waitcnt lgkmcnt(2)
    v_mfma_f32_16x16x32_bf16 v[64:67], a[144:147], a[0:3], v[32:35]
    s_waitcnt vmcnt(63)
    s_barrier
    ds_read_b128 a[156:159], v1 offset:8192
    v_mfma_f32_16x16x32_bf16 v[72:75], a[144:147], a[32:35], v[36:39]
    v_exp_f32 v96, v96
    s_add_u32 m0, s60, 65536
    v_mfma_f32_16x16x32_bf16 v[80:83], a[144:147], a[64:67], v[40:43]
    s_waitcnt vmcnt(7)
    buffer_load_dwordx4 v16, s[16:19], s64 offen offset:0 nt lds
    v_mfma_f32_16x16x32_bf16 v[88:91], a[144:147], a[96:99], v[44:47]
    v_exp_f32 v97, v97
    s_waitcnt lgkmcnt(2)
    v_mfma_f32_16x16x32_bf16 v[92:95], a[148:151], a[96:99], v[44:47]
    ds_read_b128 a[160:163], v2 offset:0
    v_mfma_f32_16x16x32_bf16 v[84:87], a[148:151], a[64:67], v[40:43]
    v_exp_f32 v98, v98
    v_mfma_f32_16x16x32_bf16 v[76:79], a[148:151], a[32:35], v[36:39]
    v_exp_f32 v99, v99
    v_mfma_f32_16x16x32_bf16 v[68:71], a[148:151], a[0:3], v[32:35]
    v_exp_f32 v100, v100
    s_waitcnt lgkmcnt(2)
    v_mfma_f32_16x16x32_bf16 v[64:67], a[152:155], a[4:7], v[64:67]
    ds_read_b128 a[164:167], v2 offset:8192
    v_cvt_pk_bf16_f32 v48, v96, v97
    v_mfma_f32_16x16x32_bf16 v[72:75], a[152:155], a[36:39], v[72:75]
    v_exp_f32 v101, v101
    v_mfma_f32_16x16x32_bf16 v[80:83], a[152:155], a[68:71], v[80:83]
    s_waitcnt vmcnt(7)
    buffer_load_dwordx4 v17, s[16:19], s64 offen offset:1024 nt lds
    v_mfma_f32_16x16x32_bf16 v[88:91], a[152:155], a[100:103], v[88:91]
    v_exp_f32 v102, v102
    s_waitcnt lgkmcnt(2)
    v_mfma_f32_16x16x32_bf16 v[92:95], a[156:159], a[100:103], v[92:95]
    ds_read_b128 a[168:171], v3 offset:0
    v_cvt_pk_bf16_f32 v49, v98, v99
    v_mfma_f32_16x16x32_bf16 v[84:87], a[156:159], a[68:71], v[84:87]
    v_exp_f32 v103, v103
    v_mfma_f32_16x16x32_bf16 v[76:79], a[156:159], a[36:39], v[76:79]
    v_exp_f32 v104, v104
    v_mfma_f32_16x16x32_bf16 v[68:71], a[156:159], a[4:7], v[68:71]
    v_exp_f32 v105, v105
    s_waitcnt lgkmcnt(2)
    v_mfma_f32_16x16x32_bf16 v[64:67], a[160:163], a[8:11], v[64:67]
    ds_read_b128 a[172:175], v3 offset:8192
    v_cvt_pk_bf16_f32 v50, v100, v101
    v_mfma_f32_16x16x32_bf16 v[72:75], a[160:163], a[40:43], v[72:75]
    s_waitcnt vmcnt(7)
    buffer_load_dwordx4 v18, s[16:19], s64 offen offset:2048 nt lds
    v_mfma_f32_16x16x32_bf16 v[80:83], a[160:163], a[72:75], v[80:83]
    v_exp_f32 v106, v106
    v_mfma_f32_16x16x32_bf16 v[88:91], a[160:163], a[104:107], v[88:91]
    v_exp_f32 v107, v107
    s_waitcnt lgkmcnt(2)
    v_mfma_f32_16x16x32_bf16 v[92:95], a[164:167], a[104:107], v[92:95]
    ds_read_b128 a[144:147], v0 offset:256
    v_cvt_pk_bf16_f32 v51, v102, v103
    v_mfma_f32_16x16x32_bf16 v[84:87], a[164:167], a[72:75], v[84:87]
    ds_write_b128 v29, v[48:51] offset:0
    v_mfma_f32_16x16x32_bf16 v[76:79], a[164:167], a[40:43], v[76:79]
    v_exp_f32 v108, v108
    v_mfma_f32_16x16x32_bf16 v[68:71], a[164:167], a[8:11], v[68:71]
    v_exp_f32 v109, v109
    s_waitcnt lgkmcnt(3)
    v_mfma_f32_16x16x32_bf16 v[64:67], a[168:171], a[12:15], v[64:67]
    ds_read_b128 a[148:151], v0 offset:8448
    v_cvt_pk_bf16_f32 v52, v104, v105
    v_mfma_f32_16x16x32_bf16 v[72:75], a[168:171], a[44:47], v[72:75]
    s_waitcnt vmcnt(7)
    buffer_load_dwordx4 v19, s[16:19], s64 offen offset:3072 nt lds
    s_add_u32 s64, s64, 8192
    v_mfma_f32_16x16x32_bf16 v[80:83], a[168:171], a[76:79], v[80:83]
    v_exp_f32 v110, v110
    v_mfma_f32_16x16x32_bf16 v[88:91], a[168:171], a[108:111], v[88:91]
    v_exp_f32 v111, v111
    s_waitcnt lgkmcnt(3)
    v_mfma_f32_16x16x32_bf16 v[92:95], a[172:175], a[108:111], v[92:95]
    ds_read_b128 a[152:155], v1 offset:256
    v_cvt_pk_bf16_f32 v53, v106, v107
    v_mfma_f32_16x16x32_bf16 v[84:87], a[172:175], a[76:79], v[84:87]
    v_exp_f32 v112, v112
    v_mfma_f32_16x16x32_bf16 v[76:79], a[172:175], a[44:47], v[76:79]
    v_exp_f32 v113, v113
    s_add_u32 m0, s60, 73728
    v_mfma_f32_16x16x32_bf16 v[68:71], a[172:175], a[12:15], v[68:71]
    s_waitcnt vmcnt(7)
    buffer_load_dwordx4 v16, s[16:19], s64 offen offset:0 nt lds
    s_waitcnt lgkmcnt(3)
    v_mfma_f32_16x16x32_bf16 v[64:67], a[144:147], a[16:19], v[64:67]
    ds_read_b128 a[156:159], v1 offset:8448
    v_cvt_pk_bf16_f32 v54, v108, v109
    v_mfma_f32_16x16x32_bf16 v[72:75], a[144:147], a[48:51], v[72:75]
    v_exp_f32 v114, v114
    v_mfma_f32_16x16x32_bf16 v[80:83], a[144:147], a[80:83], v[80:83]
    v_exp_f32 v115, v115
    v_mfma_f32_16x16x32_bf16 v[88:91], a[144:147], a[112:115], v[88:91]
    v_exp_f32 v116, v116
    s_waitcnt lgkmcnt(2)
    v_mfma_f32_16x16x32_bf16 v[92:95], a[148:151], a[112:115], v[92:95]
    ds_read_b128 a[160:163], v2 offset:256
    v_cvt_pk_bf16_f32 v55, v110, v111
    v_mfma_f32_16x16x32_bf16 v[84:87], a[148:151], a[80:83], v[84:87]
    ds_write_b128 v29, v[52:55] offset:1024
    v_mfma_f32_16x16x32_bf16 v[76:79], a[148:151], a[48:51], v[76:79]
    s_waitcnt vmcnt(7)
    buffer_load_dwordx4 v17, s[16:19], s64 offen offset:1024 nt lds
    v_mfma_f32_16x16x32_bf16 v[68:71], a[148:151], a[16:19], v[68:71]
    v_cvt_pk_bf16_f32 v56, v112, v113
    v_cvt_pk_bf16_f32 v57, v114, v115
    s_waitcnt lgkmcnt(3)
    v_mfma_f32_16x16x32_bf16 v[64:67], a[152:155], a[20:23], v[64:67]
    ds_read_b128 a[164:167], v2 offset:8448
    v_mfma_f32_16x16x32_bf16 v[72:75], a[152:155], a[52:55], v[72:75]
    v_exp_f32 v117, v117
    v_mfma_f32_16x16x32_bf16 v[80:83], a[152:155], a[84:87], v[80:83]
    v_exp_f32 v118, v118
    v_mfma_f32_16x16x32_bf16 v[88:91], a[152:155], a[116:119], v[88:91]
    v_exp_f32 v119, v119
    s_waitcnt lgkmcnt(3)
    v_mfma_f32_16x16x32_bf16 v[92:95], a[156:159], a[116:119], v[92:95]
    ds_read_b128 a[168:171], v3 offset:256
    v_cvt_pk_bf16_f32 v58, v116, v117
    v_mfma_f32_16x16x32_bf16 v[84:87], a[156:159], a[84:87], v[84:87]
    s_waitcnt vmcnt(7)
    buffer_load_dwordx4 v18, s[16:19], s64 offen offset:2048 nt lds
    v_mfma_f32_16x16x32_bf16 v[76:79], a[156:159], a[52:55], v[76:79]
    v_exp_f32 v120, v120
    v_mfma_f32_16x16x32_bf16 v[68:71], a[156:159], a[20:23], v[68:71]
    v_exp_f32 v121, v121
    s_waitcnt lgkmcnt(3)
    v_mfma_f32_16x16x32_bf16 v[64:67], a[160:163], a[24:27], v[64:67]
    ds_read_b128 a[172:175], v3 offset:8448
    v_cvt_pk_bf16_f32 v59, v118, v119
    v_mfma_f32_16x16x32_bf16 v[72:75], a[160:163], a[56:59], v[72:75]
    ds_write_b128 v29, v[56:59] offset:2048
    v_mfma_f32_16x16x32_bf16 v[80:83], a[160:163], a[88:91], v[80:83]
    v_exp_f32 v122, v122
    v_mfma_f32_16x16x32_bf16 v[88:91], a[160:163], a[120:123], v[88:91]
    v_exp_f32 v123, v123
    s_waitcnt lgkmcnt(3)
    v_mfma_f32_16x16x32_bf16 v[92:95], a[164:167], a[120:123], v[92:95]
    ds_read_b64_tr_b16 a[144:145], v4 offset:32768
    v_cvt_pk_bf16_f32 v60, v120, v121
    v_mfma_f32_16x16x32_bf16 v[84:87], a[164:167], a[88:91], v[84:87]
    ds_read_b64_tr_b16 a[146:147], v4 offset:40960
    v_cvt_pk_bf16_f32 v61, v122, v123
    v_mfma_f32_16x16x32_bf16 v[76:79], a[164:167], a[56:59], v[76:79]
    s_waitcnt vmcnt(7)
    buffer_load_dwordx4 v19, s[16:19], s64 offen offset:3072 nt lds
    s_add_u32 s64, s64, 24576
    v_mfma_f32_16x16x32_bf16 v[68:71], a[164:167], a[24:27], v[68:71]
    v_exp_f32 v124, v124
    s_waitcnt lgkmcnt(4)
    v_mfma_f32_16x16x32_bf16 v[64:67], a[168:171], a[28:31], v[64:67]
    ds_read_b64_tr_b16 a[148:149], v5 offset:32768
    v_mfma_f32_16x16x32_bf16 v[72:75], a[168:171], a[60:63], v[72:75]
    ds_read_b64_tr_b16 a[150:151], v5 offset:40960
    v_mfma_f32_16x16x32_bf16 v[80:83], a[168:171], a[92:95], v[80:83]
    v_exp_f32 v125, v125
    v_mfma_f32_16x16x32_bf16 v[88:91], a[168:171], a[124:127], v[88:91]
    v_exp_f32 v126, v126
    s_waitcnt lgkmcnt(5)
    v_mfma_f32_16x16x32_bf16 v[92:95], a[172:175], a[124:127], v[92:95]
    ds_read_b64_tr_b16 a[152:153], v6 offset:32768
    v_cvt_pk_bf16_f32 v62, v124, v125
    v_mfma_f32_16x16x32_bf16 v[84:87], a[172:175], a[92:95], v[84:87]
    ds_read_b64_tr_b16 a[154:155], v6 offset:40960
    v_mfma_f32_16x16x32_bf16 v[76:79], a[172:175], a[60:63], v[76:79]
    v_exp_f32 v127, v127
    v_mfma_f32_16x16x32_bf16 v[68:71], a[172:175], a[28:31], v[68:71]
    v_cvt_pk_bf16_f32 v63, v126, v127
    s_sub_u32 s65, s65, 1
    s_cmp_lg_u32 s65, 0
    s_cbranch_scc1 L_loop_p4
    v_accvgpr_read_b32 v21, a177
    v_accvgpr_read_b32 v12, a177
    v_add_u32 v13, 6144, v12
    v_add_u32 v14, 12288, v12
    v_add_u32 v15, 18432, v12
    s_waitcnt lgkmcnt(4)
    v_mfma_f32_16x16x32_bf16 v[128:131], a[144:147], v[48:51], v[128:131]
    ds_read_b64_tr_b16 a[156:157], v7 offset:32768
    ds_write_b128 v29, v[60:63] offset:3072
    v_mfma_f32_16x16x32_bf16 v[132:135], a[144:147], v[52:55], v[132:135]
    ds_read_b64_tr_b16 a[158:159], v7 offset:40960
    v_mfma_f32_16x16x32_bf16 v[136:139], a[144:147], v[56:59], v[136:139]
    v_mfma_f32_16x16x32_bf16 v[140:143], a[144:147], v[60:63], v[140:143]
    v_max3_f32 v28, v64, v65, v66
    v_max3_f32 v28, v28, v67, v68
    s_waitcnt lgkmcnt(5)
    v_mfma_f32_16x16x32_bf16 v[156:159], a[148:151], v[60:63], v[156:159]
    ds_read_b64_tr_b16 a[160:161], v8 offset:32768
    v_max3_f32 v28, v28, v69, v70
    v_mfma_f32_16x16x32_bf16 v[152:155], a[148:151], v[56:59], v[152:155]
    s_waitcnt lgkmcnt(2)
    s_barrier
    ds_read_b64_tr_b16 a[162:163], v8 offset:40960
    v_max3_f32 v28, v28, v71, v72
    v_mfma_f32_16x16x32_bf16 v[148:151], a[148:151], v[52:55], v[148:151]
    ds_read_b128 a[128:131], v30 offset:0
    v_max3_f32 v28, v28, v73, v74
    s_add_u32 m0, s61, 0
    s_mov_b32 s68, 0
    v_mfma_f32_16x16x32_bf16 v[144:147], a[148:151], v[48:51], v[144:147]
    buffer_load_dwordx4 v12, s[24:27], s68 offen offset:0  lds
    v_mfma_f32_16x16x32_bf16 v[160:163], a[152:155], v[48:51], v[160:163]
    ds_read_b64_tr_b16 a[164:165], v9 offset:32768
    v_max3_f32 v28, v28, v75, v76
    v_mfma_f32_16x16x32_bf16 v[164:167], a[152:155], v[52:55], v[164:167]
    ds_read_b64_tr_b16 a[166:167], v9 offset:40960
    ds_read_b128 a[132:135], v30 offset:1024
    v_mfma_f32_16x16x32_bf16 v[168:171], a[152:155], v[56:59], v[168:171]
    v_max3_f32 v28, v28, v77, v78
    v_max3_f32 v28, v28, v79, v80
    v_mfma_f32_16x16x32_bf16 v[172:175], a[152:155], v[60:63], v[172:175]
    v_max3_f32 v28, v28, v81, v82
    v_max3_f32 v28, v28, v83, v84
    s_waitcnt lgkmcnt(6)
    v_mfma_f32_16x16x32_bf16 v[188:191], a[156:159], v[60:63], v[188:191]
    ds_read_b64_tr_b16 a[168:169], v10 offset:32768
    v_max3_f32 v28, v28, v85, v86
    v_mfma_f32_16x16x32_bf16 v[184:187], a[156:159], v[56:59], v[184:187]
    ds_read_b64_tr_b16 a[170:171], v10 offset:40960
    v_max3_f32 v28, v28, v87, v88
    v_mfma_f32_16x16x32_bf16 v[180:183], a[156:159], v[52:55], v[180:183]
    buffer_load_dwordx4 v13, s[24:27], s68 offen offset:1024  lds
    v_mfma_f32_16x16x32_bf16 v[176:179], a[156:159], v[48:51], v[176:179]
    ds_read_b128 a[136:139], v30 offset:2048
    v_max3_f32 v28, v28, v89, v90
    s_waitcnt lgkmcnt(7)
    v_mfma_f32_16x16x32_bf16 v[192:195], a[160:163], v[48:51], v[192:195]
    ds_read_b64_tr_b16 a[172:173], v11 offset:32768
    v_add_f32 v24, v24, v96
    v_mfma_f32_16x16x32_bf16 v[196:199], a[160:163], v[52:55], v[196:199]
    ds_read_b64_tr_b16 a[174:175], v11 offset:40960
    v_add_f32 v25, v25, v104
    v_mfma_f32_16x16x32_bf16 v[200:203], a[160:163], v[56:59], v[200:203]
    ds_read_b128 a[140:143], v30 offset:3072
    v_add_f32 v26, v26, v112
    v_mfma_f32_16x16x32_bf16 v[204:207], a[160:163], v[60:63], v[204:207]
    v_add_f32 v27, v27, v120
    v_add_f32 v24, v24, v97
    s_waitcnt lgkmcnt(7)
    v_mfma_f32_16x16x32_bf16 v[220:223], a[164:167], v[60:63], v[220:223]
    ds_read_b64_tr_b16 a[144:145], v4 offset:49152
    v_add_f32 v25, v25, v105
    v_mfma_f32_16x16x32_bf16 v[216:219], a[164:167], v[56:59], v[216:219]
    ds_read_b64_tr_b16 a[146:147], v4 offset:57344
    v_max3_f32 v28, v28, v91, v92
    v_mfma_f32_16x16x32_bf16 v[212:215], a[164:167], v[52:55], v[212:215]
    buffer_load_dwordx4 v14, s[24:27], s68 offen offset:2048  lds
    v_mfma_f32_16x16x32_bf16 v[208:211], a[164:167], v[48:51], v[208:211]
    v_add_f32 v26, v26, v113
    v_max3_f32 v28, v28, v93, v94
    s_waitcnt lgkmcnt(6)
    v_mfma_f32_16x16x32_bf16 v[224:227], a[168:171], v[48:51], v[224:227]
    ds_read_b64_tr_b16 a[148:149], v5 offset:49152
    v_add_f32 v27, v27, v121
    v_mfma_f32_16x16x32_bf16 v[228:231], a[168:171], v[52:55], v[228:231]
    ds_read_b64_tr_b16 a[150:151], v5 offset:57344
    v_add_f32 v24, v24, v98
    v_mfma_f32_16x16x32_bf16 v[232:235], a[168:171], v[56:59], v[232:235]
    v_max_f32 v28, v28, v95
    v_add_f32 v25, v25, v106
    v_mfma_f32_16x16x32_bf16 v[236:239], a[168:171], v[60:63], v[236:239]
    v_add_f32 v26, v26, v114
    v_add_f32 v27, v27, v122
    s_waitcnt lgkmcnt(5)
    v_mfma_f32_16x16x32_bf16 v[252:255], a[172:175], v[60:63], v[252:255]
    ds_read_b64_tr_b16 a[152:153], v6 offset:49152
    v_add_f32 v24, v24, v99
    v_mfma_f32_16x16x32_bf16 v[248:251], a[172:175], v[56:59], v[248:251]
    ds_read_b64_tr_b16 a[154:155], v6 offset:57344
    v_mfma_f32_16x16x32_bf16 v[244:247], a[172:175], v[52:55], v[244:247]
    buffer_load_dwordx4 v15, s[24:27], s68 offen offset:3072  lds
    v_mfma_f32_16x16x32_bf16 v[240:243], a[172:175], v[48:51], v[240:243]
    v_add_f32 v25, v25, v107
    v_add_f32 v26, v26, v115
    v_cmp_lt_f32 vcc, s66, v28
    s_cbranch_vccnz L_flag_p4_t29
L_flagback_p4_t29:
    s_waitcnt lgkmcnt(4)
    v_mfma_f32_16x16x32_bf16 v[128:131], a[144:147], a[128:131], v[128:131]
    s_waitcnt vmcnt(63)
    s_barrier
    ds_read_b32 v28, v31
    ds_read_b64_tr_b16 a[156:157], v7 offset:49152
    v_mfma_f32_16x16x32_bf16 v[132:135], a[144:147], a[132:135], v[132:135]
    ds_read_b64_tr_b16 a[158:159], v7 offset:57344
    v_add_f32 v27, v27, v123
    v_mfma_f32_16x16x32_bf16 v[136:139], a[144:147], a[136:139], v[136:139]
    v_add_f32 v24, v24, v100
    s_add_u32 m0, s61, 4096
    s_mov_b32 s68, 28672
    v_mfma_f32_16x16x32_bf16 v[140:143], a[144:147], a[140:143], v[140:143]
    buffer_load_dwordx4 v12, s[24:27], s68 offen offset:0  lds
    s_waitcnt lgkmcnt(5)
    v_mfma_f32_16x16x32_bf16 v[156:159], a[148:151], a[140:143], v[156:159]
    ds_read_b64_tr_b16 a[160:161], v8 offset:49152
    v_add_f32 v25, v25, v108
    v_mfma_f32_16x16x32_bf16 v[152:155], a[148:151], a[136:139], v[152:155]
    ds_read_b64_tr_b16 a[162:163], v8 offset:57344
    v_add_f32 v26, v26, v116
    v_mfma_f32_16x16x32_bf16 v[148:151], a[148:151], a[132:135], v[148:151]
    s_mov_b32 s3, 640
    buffer_load_dwordx4 a[192:195], v21, s[24:27], s3 offen
    v_mfma_f32_16x16x32_bf16 v[144:147], a[148:151], a[128:131], v[144:147]
    v_add_f32 v27, v27, v124
    s_waitcnt lgkmcnt(5)
    v_mfma_f32_16x16x32_bf16 v[160:163], a[152:155], a[128:131], v[160:163]
    ds_read_b64_tr_b16 a[164:165], v9 offset:49152
    v_add_f32 v24, v24, v101
    v_mfma_f32_16x16x32_bf16 v[164:167], a[152:155], a[132:135], v[164:167]
    ds_read_b64_tr_b16 a[166:167], v9 offset:57344
    v_mfma_f32_16x16x32_bf16 v[168:171], a[152:155], a[136:139], v[168:171]
    buffer_load_dwordx4 v13, s[24:27], s68 offen offset:1024  lds
    v_mfma_f32_16x16x32_bf16 v[172:175], a[152:155], a[140:143], v[172:175]
    v_add_f32 v25, v25, v109
    v_add_f32 v26, v26, v117
    s_waitcnt lgkmcnt(4)
    v_mfma_f32_16x16x32_bf16 v[188:191], a[156:159], a[140:143], v[188:191]
    ds_read_b64_tr_b16 a[168:169], v10 offset:49152
    v_mfma_f32_16x16x32_bf16 v[184:187], a[156:159], a[136:139], v[184:187]
    ds_read_b64_tr_b16 a[170:171], v10 offset:57344
    v_add_f32 v27, v27, v125
    v_mfma_f32_16x16x32_bf16 v[180:183], a[156:159], a[132:135], v[180:183]
    s_mov_b32 s3, 7808
    buffer_load_dwordx4 a[196:199], v21, s[24:27], s3 offen
    v_mfma_f32_16x16x32_bf16 v[176:179], a[156:159], a[128:131], v[176:179]
    v_add_f32 v24, v24, v102
    s_waitcnt lgkmcnt(4)
    v_mfma_f32_16x16x32_bf16 v[192:195], a[160:163], a[128:131], v[192:195]
    ds_read_b64_tr_b16 a[172:173], v11 offset:49152
    v_add_f32 v25, v25, v110
    v_mfma_f32_16x16x32_bf16 v[196:199], a[160:163], a[132:135], v[196:199]
    ds_read_b64_tr_b16 a[174:175], v11 offset:57344
    v_add_f32 v26, v26, v118
    v_mfma_f32_16x16x32_bf16 v[200:203], a[160:163], a[136:139], v[200:203]
    buffer_load_dwordx4 v14, s[24:27], s68 offen offset:2048  lds
    v_mfma_f32_16x16x32_bf16 v[204:207], a[160:163], a[140:143], v[204:207]
    v_add_f32 v27, v27, v126
    s_waitcnt lgkmcnt(4)
    v_mfma_f32_16x16x32_bf16 v[220:223], a[164:167], a[140:143], v[220:223]
    ds_read_b128 a[144:147], v0 offset:32768
    v_add_f32 v24, v24, v103
    v_mfma_f32_16x16x32_bf16 v[216:219], a[164:167], a[136:139], v[216:219]
    v_mfma_f32_16x16x32_bf16 v[212:215], a[164:167], a[132:135], v[212:215]
    s_mov_b32 s3, 14976
    buffer_load_dwordx4 a[200:203], v21, s[24:27], s3 offen
    v_mfma_f32_16x16x32_bf16 v[208:211], a[164:167], a[128:131], v[208:211]
    v_add_f32 v25, v25, v111
    v_add_f32 v26, v26, v119
    s_waitcnt lgkmcnt(3)
    v_mfma_f32_16x16x32_bf16 v[224:227], a[168:171], a[128:131], v[224:227]
    ds_read_b128 a[148:151], v0 offset:40960
    v_add_f32 v27, v27, v127
    v_mfma_f32_16x16x32_bf16 v[228:231], a[168:171], a[132:135], v[228:231]
    buffer_load_dwordx4 v15, s[24:27], s68 offen offset:3072  lds
    v_mfma_f32_16x16x32_bf16 v[232:235], a[168:171], a[136:139], v[232:235]
    v_mfma_f32_16x16x32_bf16 v[236:239], a[168:171], a[140:143], v[236:239]
    s_waitcnt lgkmcnt(2)
    v_mfma_f32_16x16x32_bf16 v[252:255], a[172:175], a[140:143], v[252:255]
    ds_read_b128 a[152:155], v1 offset:32768
    v_mfma_f32_16x16x32_bf16 v[248:251], a[172:175], a[136:139], v[248:251]
    v_mfma_f32_16x16x32_bf16 v[244:247], a[172:175], a[132:135], v[244:247]
    v_cmp_ne_u32 vcc, 0, v28
    v_mfma_f32_16x16x32_bf16 v[240:243], a[172:175], a[128:131], v[240:243]
    s_mov_b32 s3, 22144
    buffer_load_dwordx4 a[204:207], v21, s[24:27], s3 offen
    s_cbranch_vccnz L_rare_p4_t29
L_rareback_p4_t29:
    s_waitcnt lgkmcnt(2)
    v_mfma_f32_16x16x32_bf16 v[96:99], a[144:147], a[0:3], v[32:35]
    s_waitcnt vmcnt(12)
    s_barrier
    ds_read_b128 a[156:159], v1 offset:40960
    v_mfma_f32_16x16x32_bf16 v[104:107], a[144:147], a[32:35], v[36:39]
    v_exp_f32 v64, v64
    s_add_u32 m0, s60, 98304
    v_mfma_f32_16x16x32_bf16 v[112:115], a[144:147], a[64:67], v[40:43]
    buffer_load_dwordx4 v16, s[16:19], s64 offen offset:0 nt lds
    v_mfma_f32_16x16x32_bf16 v[120:123], a[144:147], a[96:99], v[44:47]
    v_exp_f32 v65, v65
    s_waitcnt lgkmcnt(2)
    v_mfma_f32_16x16x32_bf16 v[124:127], a[148:151], a[96:99], v[44:47]
    ds_read_b128 a[160:163], v2 offset:32768
    v_mfma_f32_16x16x32_bf16 v[116:119], a[148:151], a[64:67], v[40:43]
    v_exp_f32 v66, v66
    v_mfma_f32_16x16x32_bf16 v[108:111], a[148:151], a[32:35], v[36:39]
    buffer_load_dwordx4 v17, s[16:19], s64 offen offset:1024 nt lds
    v_mfma_f32_16x16x32_bf16 v[100:103], a[148:151], a[0:3], v[32:35]
    v_exp_f32 v67, v67
    s_waitcnt lgkmcnt(2)
    v_mfma_f32_16x16x32_bf16 v[96:99], a[152:155], a[4:7], v[96:99]
    ds_read_b128 a[164:167], v2 offset:40960
    v_cvt_pk_bf16_f32 v48, v64, v65
    v_mfma_f32_16x16x32_bf16 v[104:107], a[152:155], a[36:39], v[104:107]
    buffer_load_dwordx4 v18, s[16:19], s64 offen offset:2048 nt lds
    v_mfma_f32_16x16x32_bf16 v[112:115], a[152:155], a[68:71], v[112:115]
    v_exp_f32 v68, v68
    v_mfma_f32_16x16x32_bf16 v[120:123], a[152:155], a[100:103], v[120:123]
    v_exp_f32 v69, v69
    s_waitcnt lgkmcnt(2)
    v_mfma_f32_16x16x32_bf16 v[124:127], a[156:159], a[100:103], v[124:127]
    ds_read_b128 a[168:171], v3 offset:32768
    v_cvt_pk_bf16_f32 v49, v66, v67
    v_mfma_f32_16x16x32_bf16 v[116:119], a[156:159], a[68:71], v[116:119]
    buffer_load_dwordx4 v19, s[16:19], s64 offen offset:3072 nt lds
    s_add_u32 s64, s64, 8192
    v_mfma_f32_16x16x32_bf16 v[108:111], a[156:159], a[36:39], v[108:111]
    v_exp_f32 v70, v70
    s_add_u32 m0, s60, 106496
    v_mfma_f32_16x16x32_bf16 v[100:103], a[156:159], a[4:7], v[100:103]
    buffer_load_dwordx4 v16, s[16:19], s64 offen offset:0 nt lds
    s_waitcnt lgkmcnt(2)
    v_mfma_f32_16x16x32_bf16 v[96:99], a[160:163], a[8:11], v[96:99]
    ds_read_b128 a[172:175], v3 offset:40960
    v_cvt_pk_bf16_f32 v50, v68, v69
    v_mfma_f32_16x16x32_bf16 v[104:107], a[160:163], a[40:43], v[104:107]
    v_exp_f32 v71, v71
    v_mfma_f32_16x16x32_bf16 v[112:115], a[160:163], a[72:75], v[112:115]
    v_exp_f32 v72, v72
    v_mfma_f32_16x16x32_bf16 v[120:123], a[160:163], a[104:107], v[120:123]
    buffer_load_dwordx4 v17, s[16:19], s64 offen offset:1024 nt lds
    s_waitcnt lgkmcnt(2)
    v_mfma_f32_16x16x32_bf16 v[124:127], a[164:167], a[104:107], v[124:127]
    ds_read_b128 a[144:147], v0 offset:33024
    v_cvt_pk_bf16_f32 v51, v70, v71
    v_mfma_f32_16x16x32_bf16 v[116:119], a[164:167], a[72:75], v[116:119]
    ds_write_b128 v29, v[48:51] offset:0
    v_exp_f32 v73, v73
    v_mfma_f32_16x16x32_bf16 v[108:111], a[164:167], a[40:43], v[108:111]
    v_exp_f32 v74, v74
    v_mfma_f32_16x16x32_bf16 v[100:103], a[164:167], a[8:11], v[100:103]
    buffer_load_dwordx4 v18, s[16:19], s64 offen offset:2048 nt lds
    s_waitcnt lgkmcnt(3)
    v_mfma_f32_16x16x32_bf16 v[96:99], a[168:171], a[12:15], v[96:99]
    ds_read_b128 a[148:151], v0 offset:41216
    v_cvt_pk_bf16_f32 v52, v72, v73
    v_mfma_f32_16x16x32_bf16 v[104:107], a[168:171], a[44:47], v[104:107]
    v_exp_f32 v75, v75
    v_mfma_f32_16x16x32_bf16 v[112:115], a[168:171], a[76:79], v[112:115]
    buffer_load_dwordx4 v19, s[16:19], s64 offen offset:3072 nt lds
    s_add_u32 s64, s64, 24576
    v_mfma_f32_16x16x32_bf16 v[120:123], a[168:171], a[108:111], v[120:123]
    v_exp_f32 v76, v76
    s_waitcnt lgkmcnt(3)
    v_mfma_f32_16x16x32_bf16 v[124:127], a[172:175], a[108:111], v[124:127]
    ds_read_b128 a[152:155], v1 offset:33024
    v_cvt_pk_bf16_f32 v53, v74, v75
    v_mfma_f32_16x16x32_bf16 v[116:119], a[172:175], a[76:79], v[116:119]
    v_exp_f32 v77, v77
    v_mfma_f32_16x16x32_bf16 v[108:111], a[172:175], a[44:47], v[108:111]
    v_exp_f32 v78, v78
    v_mfma_f32_16x16x32_bf16 v[100:103], a[172:175], a[12:15], v[100:103]
    v_exp_f32 v79, v79
    s_waitcnt lgkmcnt(3)
    v_mfma_f32_16x16x32_bf16 v[96:99], a[144:147], a[16:19], v[96:99]
    ds_read_b128 a[156:159], v1 offset:41216
    v_cvt_pk_bf16_f32 v54, v76, v77
    v_mfma_f32_16x16x32_bf16 v[104:107], a[144:147], a[48:51], v[104:107]
    v_exp_f32 v80, v80
    v_mfma_f32_16x16x32_bf16 v[112:115], a[144:147], a[80:83], v[112:115]
    v_exp_f32 v81, v81
    v_mfma_f32_16x16x32_bf16 v[120:123], a[144:147], a[112:115], v[120:123]
    v_exp_f32 v82, v82
    s_waitcnt lgkmcnt(2)
    v_mfma_f32_16x16x32_bf16 v[124:127], a[148:151], a[112:115], v[124:127]
    ds_read_b128 a[160:163], v2 offset:33024
    v_cvt_pk_bf16_f32 v55, v78, v79
    v_mfma_f32_16x16x32_bf16 v[116:119], a[148:151], a[80:83], v[116:119]
    ds_write_b128 v29, v[52:55] offset:1024
    v_mfma_f32_16x16x32_bf16 v[108:111], a[148:151], a[48:51], v[108:111]
    v_exp_f32 v83, v83
    v_mfma_f32_16x16x32_bf16 v[100:103], a[148:151], a[16:19], v[100:103]
    v_cvt_pk_bf16_f32 v56, v80, v81
    v_cvt_pk_bf16_f32 v57, v82, v83
    s_waitcnt lgkmcnt(3)
    v_mfma_f32_16x16x32_bf16 v[96:99], a[152:155], a[20:23], v[96:99]
    ds_read_b128 a[164:167], v2 offset:41216
    v_mfma_f32_16x16x32_bf16 v[104:107], a[152:155], a[52:55], v[104:107]
    v_exp_f32 v84, v84
    v_mfma_f32_16x16x32_bf16 v[112:115], a[152:155], a[84:87], v[112:115]
    v_exp_f32 v85, v85
    v_mfma_f32_16x16x32_bf16 v[120:123], a[152:155], a[116:119], v[120:123]
    v_exp_f32 v86, v86
    s_waitcnt lgkmcnt(3)
    v_mfma_f32_16x16x32_bf16 v[124:127], a[156:159], a[116:119], v[124:127]
    ds_read_b128 a[168:171], v3 offset:33024
    v_cvt_pk_bf16_f32 v58, v84, v85
    v_mfma_f32_16x16x32_bf16 v[116:119], a[156:159], a[84:87], v[116:119]
    v_exp_f32 v87, v87
    v_mfma_f32_16x16x32_bf16 v[108:111], a[156:159], a[52:55], v[108:111]
    v_exp_f32 v88, v88
    v_mfma_f32_16x16x32_bf16 v[100:103], a[156:159], a[20:23], v[100:103]
    v_exp_f32 v89, v89
    s_waitcnt lgkmcnt(3)
    v_mfma_f32_16x16x32_bf16 v[96:99], a[160:163], a[24:27], v[96:99]
    ds_read_b128 a[172:175], v3 offset:41216
    v_cvt_pk_bf16_f32 v59, v86, v87
    v_mfma_f32_16x16x32_bf16 v[104:107], a[160:163], a[56:59], v[104:107]
    ds_write_b128 v29, v[56:59] offset:2048
    v_mfma_f32_16x16x32_bf16 v[112:115], a[160:163], a[88:91], v[112:115]
    v_exp_f32 v90, v90
    v_mfma_f32_16x16x32_bf16 v[120:123], a[160:163], a[120:123], v[120:123]
    v_exp_f32 v91, v91
    s_waitcnt lgkmcnt(3)
    v_mfma_f32_16x16x32_bf16 v[124:127], a[164:167], a[120:123], v[124:127]
    ds_read_b64_tr_b16 a[144:145], v4 offset:0
    v_cvt_pk_bf16_f32 v60, v88, v89
    v_mfma_f32_16x16x32_bf16 v[116:119], a[164:167], a[88:91], v[116:119]
    ds_read_b64_tr_b16 a[146:147], v4 offset:8192
    v_cvt_pk_bf16_f32 v61, v90, v91
    v_mfma_f32_16x16x32_bf16 v[108:111], a[164:167], a[56:59], v[108:111]
    v_exp_f32 v92, v92
    v_mfma_f32_16x16x32_bf16 v[100:103], a[164:167], a[24:27], v[100:103]
    v_exp_f32 v93, v93
    s_waitcnt lgkmcnt(4)
    v_mfma_f32_16x16x32_bf16 v[96:99], a[168:171], a[28:31], v[96:99]
    ds_read_b64_tr_b16 a[148:149], v5 offset:0
    v_cvt_pk_bf16_f32 v62, v92, v93
    v_mfma_f32_16x16x32_bf16 v[104:107], a[168:171], a[60:63], v[104:107]
    ds_read_b64_tr_b16 a[150:151], v5 offset:8192
    v_mfma_f32_16x16x32_bf16 v[112:115], a[168:171], a[92:95], v[112:115]
    v_exp_f32 v94, v94
    v_mfma_f32_16x16x32_bf16 v[120:123], a[168:171], a[124:127], v[120:123]
    v_exp_f32 v95, v95
    s_waitcnt lgkmcnt(5)
    v_mfma_f32_16x16x32_bf16 v[124:127], a[172:175], a[124:127], v[124:127]
    ds_read_b64_tr_b16 a[152:153], v6 offset:0
    v_cvt_pk_bf16_f32 v63, v94, v95
    v_mfma_f32_16x16x32_bf16 v[116:119], a[172:175], a[92:95], v[116:119]
    ds_read_b64_tr_b16 a[154:155], v6 offset:8192
    v_mfma_f32_16x16x32_bf16 v[108:111], a[172:175], a[60:63], v[108:111]
    ds_write_b128 v29, v[60:63] offset:3072
    v_mfma_f32_16x16x32_bf16 v[100:103], a[172:175], a[28:31], v[100:103]
    v_accvgpr_read_b32 v28, a180
    buffer_load_dword a180, v28, s[24:27], 0 offen offset:384
    s_waitcnt lgkmcnt(5)
    v_mfma_f32_16x16x32_bf16 v[128:131], a[144:147], v[48:51], v[128:131]
    ds_read_b64_tr_b16 a[156:157], v7 offset:0
    v_mfma_f32_16x16x32_bf16 v[132:135], a[144:147], v[52:55], v[132:135]
    ds_read_b64_tr_b16 a[158:159], v7 offset:8192
    v_mfma_f32_16x16x32_bf16 v[136:139], a[144:147], v[56:59], v[136:139]
    v_mfma_f32_16x16x32_bf16 v[140:143], a[144:147], v[60:63], v[140:143]
    v_max3_f32 v28, v96, v97, v98
    v_max3_f32 v28, v28, v99, v100
    s_waitcnt lgkmcnt(5)
    v_mfma_f32_16x16x32_bf16 v[156:159], a[148:151], v[60:63], v[156:159]
    ds_read_b64_tr_b16 a[160:161], v8 offset:0
    v_max3_f32 v28, v28, v101, v102
    v_mfma_f32_16x16x32_bf16 v[152:155], a[148:151], v[56:59], v[152:155]
    s_waitcnt lgkmcnt(3)
    s_barrier
    ds_read_b64_tr_b16 a[162:163], v8 offset:8192
    v_max3_f32 v28, v28, v103, v104
    v_mfma_f32_16x16x32_bf16 v[148:151], a[148:151], v[52:55], v[148:151]
    ds_read_b128 a[128:131], v30 offset:0
    v_max3_f32 v28, v28, v105, v106
    s_add_u32 m0, s61, 32768
    s_mov_b32 s68, 128
    v_mfma_f32_16x16x32_bf16 v[144:147], a[148:151], v[48:51], v[144:147]
    buffer_load_dwordx4 v12, s[24:27], s68 offen offset:0  lds
    v_mfma_f32_16x16x32_bf16 v[160:163], a[152:155], v[48:51], v[160:163]
    ds_read_b64_tr_b16 a[164:165], v9 offset:0
    v_max3_f32 v28, v28, v107, v108
    v_mfma_f32_16x16x32_bf16 v[164:167], a[152:155], v[52:55], v[164:167]
    ds_read_b64_tr_b16 a[166:167], v9 offset:8192
    ds_read_b128 a[132:135], v30 offset:1024
    v_mfma_f32_16x16x32_bf16 v[168:171], a[152:155], v[56:59], v[168:171]
    v_max3_f32 v28, v28, v109, v110
    v_max3_f32 v28, v28, v111, v112
    v_mfma_f32_16x16x32_bf16 v[172:175], a[152:155], v[60:63], v[172:175]
    v_max3_f32 v28, v28, v113, v114
    v_max3_f32 v28, v28, v115, v116
    s_waitcnt lgkmcnt(6)
    v_mfma_f32_16x16x32_bf16 v[188:191], a[156:159], v[60:63], v[188:191]
    ds_read_b64_tr_b16 a[168:169], v10 offset:0
    v_max3_f32 v28, v28, v117, v118
    v_mfma_f32_16x16x32_bf16 v[184:187], a[156:159], v[56:59], v[184:187]
    ds_read_b64_tr_b16 a[170:171], v10 offset:8192
    v_max3_f32 v28, v28, v119, v120
    v_mfma_f32_16x16x32_bf16 v[180:183], a[156:159], v[52:55], v[180:183]
    buffer_load_dwordx4 v13, s[24:27], s68 offen offset:1024  lds
    v_mfma_f32_16x16x32_bf16 v[176:179], a[156:159], v[48:51], v[176:179]
    ds_read_b128 a[136:139], v30 offset:2048
    v_max3_f32 v28, v28, v121, v122
    s_waitcnt lgkmcnt(7)
    v_mfma_f32_16x16x32_bf16 v[192:195], a[160:163], v[48:51], v[192:195]
    ds_read_b64_tr_b16 a[172:173], v11 offset:0
    v_add_f32 v24, v24, v64
    v_mfma_f32_16x16x32_bf16 v[196:199], a[160:163], v[52:55], v[196:199]
    ds_read_b64_tr_b16 a[174:175], v11 offset:8192
    v_add_f32 v25, v25, v72
    v_mfma_f32_16x16x32_bf16 v[200:203], a[160:163], v[56:59], v[200:203]
    ds_read_b128 a[140:143], v30 offset:3072
    v_add_f32 v26, v26, v80
    v_mfma_f32_16x16x32_bf16 v[204:207], a[160:163], v[60:63], v[204:207]
    v_add_f32 v27, v27, v88
    v_add_f32 v24, v24, v65
    s_waitcnt lgkmcnt(7)
    v_mfma_f32_16x16x32_bf16 v[220:223], a[164:167], v[60:63], v[220:223]
    ds_read_b64_tr_b16 a[144:145], v4 offset:16384
    v_add_f32 v25, v25, v73
    v_mfma_f32_16x16x32_bf16 v[216:219], a[164:167], v[56:59], v[216:219]
    ds_read_b64_tr_b16 a[146:147], v4 offset:24576
    v_max3_f32 v28, v28, v123, v124
    v_mfma_f32_16x16x32_bf16 v[212:215], a[164:167], v[52:55], v[212:215]
    buffer_load_dwordx4 v14, s[24:27], s68 offen offset:2048  lds
    v_mfma_f32_16x16x32_bf16 v[208:211], a[164:167], v[48:51], v[208:211]
    v_add_f32 v26, v26, v81
    v_max3_f32 v28, v28, v125, v126
    s_waitcnt lgkmcnt(6)
    v_mfma_f32_16x16x32_bf16 v[224:227], a[168:171], v[48:51], v[224:227]
    ds_read_b64_tr_b16 a[148:149], v5 offset:16384
    v_add_f32 v27, v27, v89
    v_mfma_f32_16x16x32_bf16 v[228:231], a[168:171], v[52:55], v[228:231]
    ds_read_b64_tr_b16 a[150:151], v5 offset:24576
    v_add_f32 v24, v24, v66
    v_mfma_f32_16x16x32_bf16 v[232:235], a[168:171], v[56:59], v[232:235]
    v_max_f32 v28, v28, v127
    v_add_f32 v25, v25, v74
    v_mfma_f32_16x16x32_bf16 v[236:239], a[168:171], v[60:63], v[236:239]
    v_add_f32 v26, v26, v82
    v_add_f32 v27, v27, v90
    s_waitcnt lgkmcnt(5)
    v_mfma_f32_16x16x32_bf16 v[252:255], a[172:175], v[60:63], v[252:255]
    ds_read_b64_tr_b16 a[152:153], v6 offset:16384
    v_add_f32 v24, v24, v67
    v_mfma_f32_16x16x32_bf16 v[248:251], a[172:175], v[56:59], v[248:251]
    ds_read_b64_tr_b16 a[154:155], v6 offset:24576
    v_mfma_f32_16x16x32_bf16 v[244:247], a[172:175], v[52:55], v[244:247]
    buffer_load_dwordx4 v15, s[24:27], s68 offen offset:3072  lds
    v_mfma_f32_16x16x32_bf16 v[240:243], a[172:175], v[48:51], v[240:243]
    v_add_f32 v25, v25, v75
    v_add_f32 v26, v26, v83
    v_cmp_lt_f32 vcc, s66, v28
    s_cbranch_vccnz L_flag_p4_t30
L_flagback_p4_t30:
    s_waitcnt lgkmcnt(4)
    v_mfma_f32_16x16x32_bf16 v[128:131], a[144:147], a[128:131], v[128:131]
    s_waitcnt vmcnt(5)
    s_barrier
    ds_read_b32 v28, v31
    ds_read_b64_tr_b16 a[156:157], v7 offset:16384
    v_mfma_f32_16x16x32_bf16 v[132:135], a[144:147], a[132:135], v[132:135]
    ds_read_b64_tr_b16 a[158:159], v7 offset:24576
    v_add_f32 v27, v27, v91
    v_mfma_f32_16x16x32_bf16 v[136:139], a[144:147], a[136:139], v[136:139]
    v_add_f32 v24, v24, v68
    s_add_u32 m0, s61, 36864
    s_mov_b32 s68, 28800
    v_mfma_f32_16x16x32_bf16 v[140:143], a[144:147], a[140:143], v[140:143]
    buffer_load_dwordx4 v12, s[24:27], s68 offen offset:0  lds
    s_waitcnt lgkmcnt(5)
    v_mfma_f32_16x16x32_bf16 v[156:159], a[148:151], a[140:143], v[156:159]
    ds_read_b64_tr_b16 a[160:161], v8 offset:16384
    v_add_f32 v25, v25, v76
    v_mfma_f32_16x16x32_bf16 v[152:155], a[148:151], a[136:139], v[152:155]
    ds_read_b64_tr_b16 a[162:163], v8 offset:24576
    v_add_f32 v26, v26, v84
    v_mfma_f32_16x16x32_bf16 v[148:151], a[148:151], a[132:135], v[148:151]
    s_mov_b32 s3, 29312
    buffer_load_dwordx4 a[208:211], v21, s[24:27], s3 offen
    v_mfma_f32_16x16x32_bf16 v[144:147], a[148:151], a[128:131], v[144:147]
    v_add_f32 v27, v27, v92
    s_waitcnt lgkmcnt(5)
    v_mfma_f32_16x16x32_bf16 v[160:163], a[152:155], a[128:131], v[160:163]
    ds_read_b64_tr_b16 a[164:165], v9 offset:16384
    v_add_f32 v24, v24, v69
    v_mfma_f32_16x16x32_bf16 v[164:167], a[152:155], a[132:135], v[164:167]
    ds_read_b64_tr_b16 a[166:167], v9 offset:24576
    v_mfma_f32_16x16x32_bf16 v[168:171], a[152:155], a[136:139], v[168:171]
    buffer_load_dwordx4 v13, s[24:27], s68 offen offset:1024  lds
    v_mfma_f32_16x16x32_bf16 v[172:175], a[152:155], a[140:143], v[172:175]
    v_add_f32 v25, v25, v77
    v_add_f32 v26, v26, v85
    s_waitcnt lgkmcnt(4)
    v_mfma_f32_16x16x32_bf16 v[188:191], a[156:159], a[140:143], v[188:191]
    ds_read_b64_tr_b16 a[168:169], v10 offset:16384
    v_mfma_f32_16x16x32_bf16 v[184:187], a[156:159], a[136:139], v[184:187]
    ds_read_b64_tr_b16 a[170:171], v10 offset:24576
    v_add_f32 v27, v27, v93
    v_mfma_f32_16x16x32_bf16 v[180:183], a[156:159], a[132:135], v[180:183]
    s_mov_b32 s3, 36480
    buffer_load_dwordx4 a[212:215], v21, s[24:27], s3 offen
    v_mfma_f32_16x16x32_bf16 v[176:179], a[156:159], a[128:131], v[176:179]
    v_add_f32 v24, v24, v70
    s_waitcnt lgkmcnt(4)
    v_mfma_f32_16x16x32_bf16 v[192:195], a[160:163], a[128:131], v[192:195]
    ds_read_b64_tr_b16 a[172:173], v11 offset:16384
    v_add_f32 v25, v25, v78
    v_mfma_f32_16x16x32_bf16 v[196:199], a[160:163], a[132:135], v[196:199]
    ds_read_b64_tr_b16 a[174:175], v11 offset:24576
    v_add_f32 v26, v26, v86
    v_mfma_f32_16x16x32_bf16 v[200:203], a[160:163], a[136:139], v[200:203]
    buffer_load_dwordx4 v14, s[24:27], s68 offen offset:2048  lds
    v_mfma_f32_16x16x32_bf16 v[204:207], a[160:163], a[140:143], v[204:207]
    v_add_f32 v27, v27, v94
    s_waitcnt lgkmcnt(4)
    v_mfma_f32_16x16x32_bf16 v[220:223], a[164:167], a[140:143], v[220:223]
    ds_read_b64_tr_b16 a[144:145], v4 offset:32768
    v_add_f32 v24, v24, v71
    v_mfma_f32_16x16x32_bf16 v[216:219], a[164:167], a[136:139], v[216:219]
    ds_read_b64_tr_b16 a[146:147], v4 offset:40960
    v_mfma_f32_16x16x32_bf16 v[212:215], a[164:167], a[132:135], v[212:215]
    s_mov_b32 s3, 43648
    buffer_load_dwordx4 a[216:219], v21, s[24:27], s3 offen
    v_mfma_f32_16x16x32_bf16 v[208:211], a[164:167], a[128:131], v[208:211]
    v_add_f32 v25, v25, v79
    v_add_f32 v26, v26, v87
    s_waitcnt lgkmcnt(4)
    v_mfma_f32_16x16x32_bf16 v[224:227], a[168:171], a[128:131], v[224:227]
    ds_read_b64_tr_b16 a[148:149], v5 offset:32768
    v_add_f32 v27, v27, v95
    v_mfma_f32_16x16x32_bf16 v[228:231], a[168:171], a[132:135], v[228:231]
    ds_read_b64_tr_b16 a[150:151], v5 offset:40960
    v_mfma_f32_16x16x32_bf16 v[232:235], a[168:171], a[136:139], v[232:235]
    buffer_load_dwordx4 v15, s[24:27], s68 offen offset:3072  lds
    v_mfma_f32_16x16x32_bf16 v[236:239], a[168:171], a[140:143], v[236:239]
    s_waitcnt lgkmcnt(4)
    v_mfma_f32_16x16x32_bf16 v[252:255], a[172:175], a[140:143], v[252:255]
    ds_read_b64_tr_b16 a[152:153], v6 offset:32768
    v_mfma_f32_16x16x32_bf16 v[248:251], a[172:175], a[136:139], v[248:251]
    ds_read_b64_tr_b16 a[154:155], v6 offset:40960
    v_mfma_f32_16x16x32_bf16 v[244:247], a[172:175], a[132:135], v[244:247]
    v_cmp_ne_u32 vcc, 0, v28
    v_mfma_f32_16x16x32_bf16 v[240:243], a[172:175], a[128:131], v[240:243]
    s_mov_b32 s3, 50816
    buffer_load_dwordx4 a[220:223], v21, s[24:27], s3 offen
    s_cbranch_vccnz L_rare_p4_t30
L_rareback_p4_t30:
    v_exp_f32 v96, v96
    v_exp_f32 v97, v97
    v_exp_f32 v98, v98
    v_cvt_pk_bf16_f32 v48, v96, v97
    v_exp_f32 v99, v99
    v_exp_f32 v100, v100
    v_cvt_pk_bf16_f32 v49, v98, v99
    v_exp_f32 v101, v101
    v_exp_f32 v102, v102
    v_cvt_pk_bf16_f32 v50, v100, v101
    v_exp_f32 v103, v103
    v_exp_f32 v104, v104
    v_cvt_pk_bf16_f32 v51, v102, v103
    ds_write_b128 v29, v[48:51] offset:0
    v_exp_f32 v105, v105
    v_exp_f32 v106, v106
    v_cvt_pk_bf16_f32 v52, v104, v105
    v_exp_f32 v107, v107
    v_exp_f32 v108, v108
    v_cvt_pk_bf16_f32 v53, v106, v107
    v_exp_f32 v109, v109
    v_exp_f32 v110, v110
    v_cvt_pk_bf16_f32 v54, v108, v109
    v_exp_f32 v111, v111
    v_exp_f32 v112, v112
    v_cvt_pk_bf16_f32 v55, v110, v111
    ds_write_b128 v29, v[52:55] offset:1024
    v_exp_f32 v113, v113
    v_exp_f32 v114, v114
    v_cvt_pk_bf16_f32 v56, v112, v113
    v_exp_f32 v115, v115
    v_exp_f32 v116, v116
    v_cvt_pk_bf16_f32 v57, v114, v115
    v_exp_f32 v117, v117
    v_exp_f32 v118, v118
    v_cvt_pk_bf16_f32 v58, v116, v117
    v_exp_f32 v119, v119
    v_exp_f32 v120, v120
    v_cvt_pk_bf16_f32 v59, v118, v119
    ds_write_b128 v29, v[56:59] offset:2048
    v_exp_f32 v121, v121
    v_exp_f32 v122, v122
    v_cvt_pk_bf16_f32 v60, v120, v121
    v_exp_f32 v123, v123
    v_exp_f32 v124, v124
    v_cvt_pk_bf16_f32 v61, v122, v123
    v_exp_f32 v125, v125
    v_exp_f32 v126, v126
    v_cvt_pk_bf16_f32 v62, v124, v125
    v_exp_f32 v127, v127
    s_nop 0
    v_cvt_pk_bf16_f32 v63, v126, v127
    ds_write_b128 v29, v[60:63] offset:3072
    s_waitcnt lgkmcnt(8)
    v_mfma_f32_16x16x32_bf16 v[128:131], a[144:147], v[48:51], v[128:131]
    ds_read_b64_tr_b16 a[156:157], v7 offset:32768
    v_add_f32 v24, v24, v96
    v_mfma_f32_16x16x32_bf16 v[132:135], a[144:147], v[52:55], v[132:135]
    ds_read_b64_tr_b16 a[158:159], v7 offset:40960
    v_accvgpr_read_b32 v0, a176
    v_mfma_f32_16x16x32_bf16 v[136:139], a[144:147], v[56:59], v[136:139]
    v_xor_b32 v1, 32, v0
    v_add_f32 v25, v25, v104
    v_mfma_f32_16x16x32_bf16 v[140:143], a[144:147], v[60:63], v[140:143]
    v_add_f32 v26, v26, v112
    v_add_f32 v27, v27, v120
    s_waitcnt lgkmcnt(8)
    v_mfma_f32_16x16x32_bf16 v[156:159], a[148:151], v[60:63], v[156:159]
    ds_read_b64_tr_b16 a[160:161], v8 offset:32768
    v_add_f32 v24, v24, v97
    v_mfma_f32_16x16x32_bf16 v[152:155], a[148:151], v[56:59], v[152:155]
    s_waitcnt lgkmcnt(3)
    s_barrier
    ds_read_b64_tr_b16 a[162:163], v8 offset:40960
    v_add_u32 v2, 65536, v0
    v_mfma_f32_16x16x32_bf16 v[148:151], a[148:151], v[52:55], v[148:151]
    v_xor_b32 v3, 32, v2
    ds_read_b128 a[128:131], v30 offset:0
    v_mfma_f32_16x16x32_bf16 v[144:147], a[148:151], v[48:51], v[144:147]
    s_mov_b32 s3, 768
    buffer_load_dwordx4 a[224:227], v21, s[24:27], s3 offen
    v_mfma_f32_16x16x32_bf16 v[160:163], a[152:155], v[48:51], v[160:163]
    ds_read_b64_tr_b16 a[164:165], v9 offset:32768
    v_add_f32 v25, v25, v105
    v_mfma_f32_16x16x32_bf16 v[164:167], a[152:155], v[52:55], v[164:167]
    ds_read_b64_tr_b16 a[166:167], v9 offset:40960
    v_and_b32 v17, 0xffffefff, v29
    v_mfma_f32_16x16x32_bf16 v[168:171], a[152:155], v[56:59], v[168:171]
    v_and_b32 v18, 1023, v29
    v_add_f32 v26, v26, v113
    s_add_u32 m0, s61, 65536
    s_mov_b32 s68, 256
    v_mfma_f32_16x16x32_bf16 v[172:175], a[152:155], v[60:63], v[172:175]
    buffer_load_dwordx4 v12, s[24:27], s68 offen offset:0  lds
    s_waitcnt lgkmcnt(5)
    v_mfma_f32_16x16x32_bf16 v[188:191], a[156:159], v[60:63], v[188:191]
    ds_read_b64_tr_b16 a[168:169], v10 offset:32768
    ds_read_b128 a[132:135], v30 offset:1024
    v_mfma_f32_16x16x32_bf16 v[184:187], a[156:159], v[56:59], v[184:187]
    ds_read_b64_tr_b16 a[170:171], v10 offset:40960
    v_add_u32 v18, s61, v18
    v_mfma_f32_16x16x32_bf16 v[180:183], a[156:159], v[52:55], v[180:183]
    buffer_load_dwordx4 v13, s[24:27], s68 offen offset:1024  lds
    v_mfma_f32_16x16x32_bf16 v[176:179], a[156:159], v[48:51], v[176:179]
    v_add_f32 v27, v27, v121
    v_add_f32 v24, v24, v98
    s_waitcnt lgkmcnt(6)
    v_mfma_f32_16x16x32_bf16 v[192:195], a[160:163], v[48:51], v[192:195]
    ds_read_b64_tr_b16 a[172:173], v11 offset:32768
    v_add_f32 v25, v25, v106
    v_mfma_f32_16x16x32_bf16 v[196:199], a[160:163], v[52:55], v[196:199]
    ds_read_b64_tr_b16 a[174:175], v11 offset:40960
    v_add_f32 v26, v26, v114
    v_mfma_f32_16x16x32_bf16 v[200:203], a[160:163], v[56:59], v[200:203]
    ds_read_b128 a[136:139], v30 offset:2048
    v_add_f32 v27, v27, v122
    v_mfma_f32_16x16x32_bf16 v[204:207], a[160:163], v[60:63], v[204:207]
    v_add_f32 v24, v24, v99
    v_add_f32 v25, v25, v107
    s_waitcnt lgkmcnt(6)
    v_mfma_f32_16x16x32_bf16 v[220:223], a[164:167], v[60:63], v[220:223]
    ds_read_b64_tr_b16 a[144:145], v4 offset:49152
    ds_read_b128 a[140:143], v30 offset:3072
    v_mfma_f32_16x16x32_bf16 v[216:219], a[164:167], v[56:59], v[216:219]
    ds_read_b64_tr_b16 a[146:147], v4 offset:57344
    v_add_f32 v26, v26, v115
    v_mfma_f32_16x16x32_bf16 v[212:215], a[164:167], v[52:55], v[212:215]
    buffer_load_dwordx4 v14, s[24:27], s68 offen offset:2048  lds
    v_mfma_f32_16x16x32_bf16 v[208:211], a[164:167], v[48:51], v[208:211]
    v_add_f32 v27, v27, v123
    v_add_f32 v24, v24, v100
    s_waitcnt lgkmcnt(6)
    v_mfma_f32_16x16x32_bf16 v[224:227], a[168:171], v[48:51], v[224:227]
    ds_read_b64_tr_b16 a[148:149], v5 offset:49152
    v_add_f32 v25, v25, v108
    v_mfma_f32_16x16x32_bf16 v[228:231], a[168:171], v[52:55], v[228:231]
    ds_read_b64_tr_b16 a[150:151], v5 offset:57344
    v_add_f32 v26, v26, v116
    v_mfma_f32_16x16x32_bf16 v[232:235], a[168:171], v[56:59], v[232:235]
    v_add_f32 v27, v27, v124
    v_add_f32 v24, v24, v101
    v_mfma_f32_16x16x32_bf16 v[236:239], a[168:171], v[60:63], v[236:239]
    v_add_f32 v25, v25, v109
    v_add_f32 v26, v26, v117
    s_waitcnt lgkmcnt(6)
    v_mfma_f32_16x16x32_bf16 v[252:255], a[172:175], v[60:63], v[252:255]
    ds_read_b64_tr_b16 a[152:153], v6 offset:49152
    v_add_f32 v27, v27, v125
    v_mfma_f32_16x16x32_bf16 v[248:251], a[172:175], v[56:59], v[248:251]
    ds_read_b64_tr_b16 a[154:155], v6 offset:57344
    v_add_f32 v24, v24, v102
    v_mfma_f32_16x16x32_bf16 v[244:247], a[172:175], v[52:55], v[244:247]
    buffer_load_dwordx4 v15, s[24:27], s68 offen offset:3072  lds
    v_mfma_f32_16x16x32_bf16 v[240:243], a[172:175], v[48:51], v[240:243]
    s_mov_b32 s3, 7936
    buffer_load_dwordx4 a[228:231], v21, s[24:27], s3 offen
    s_waitcnt lgkmcnt(4)
    v_mfma_f32_16x16x32_bf16 v[128:131], a[144:147], a[128:131], v[128:131]
    s_waitcnt vmcnt(63)
    s_barrier
    ds_read_b64_tr_b16 a[156:157], v7 offset:49152
    v_add_f32 v25, v25, v110
    v_mfma_f32_16x16x32_bf16 v[132:135], a[144:147], a[132:135], v[132:135]
    ds_read_b64_tr_b16 a[158:159], v7 offset:57344
    v_add_f32 v26, v26, v118
    v_mfma_f32_16x16x32_bf16 v[136:139], a[144:147], a[136:139], v[136:139]
    v_add_f32 v27, v27, v126
    v_add_f32 v24, v24, v103
    s_add_u32 m0, s61, 69632
    s_mov_b32 s68, 28928
    v_mfma_f32_16x16x32_bf16 v[140:143], a[144:147], a[140:143], v[140:143]
    buffer_load_dwordx4 v12, s[24:27], s68 offen offset:0  lds
    s_waitcnt lgkmcnt(4)
    v_mfma_f32_16x16x32_bf16 v[156:159], a[148:151], a[140:143], v[156:159]
    ds_read_b64_tr_b16 a[160:161], v8 offset:49152
    v_add_f32 v25, v25, v111
    v_mfma_f32_16x16x32_bf16 v[152:155], a[148:151], a[136:139], v[152:155]
    ds_read_b64_tr_b16 a[162:163], v8 offset:57344
    v_add_f32 v26, v26, v119
    v_mfma_f32_16x16x32_bf16 v[148:151], a[148:151], a[132:135], v[148:151]
    s_mov_b32 s3, 15104
    buffer_load_dwordx4 a[232:235], v21, s[24:27], s3 offen
    v_mfma_f32_16x16x32_bf16 v[144:147], a[148:151], a[128:131], v[144:147]
    v_add_f32 v27, v27, v127
    s_waitcnt lgkmcnt(4)
    v_mfma_f32_16x16x32_bf16 v[160:163], a[152:155], a[128:131], v[160:163]
    ds_read_b64_tr_b16 a[164:165], v9 offset:49152
    v_mfma_f32_16x16x32_bf16 v[164:167], a[152:155], a[132:135], v[164:167]
    ds_read_b64_tr_b16 a[166:167], v9 offset:57344
    v_mfma_f32_16x16x32_bf16 v[168:171], a[152:155], a[136:139], v[168:171]
    buffer_load_dwordx4 v13, s[24:27], s68 offen offset:1024  lds
    v_mfma_f32_16x16x32_bf16 v[172:175], a[152:155], a[140:143], v[172:175]
    v_cvt_pk_bf16_f32 v128, v128, v129
    v_cvt_pk_bf16_f32 v129, v130, v131
    s_waitcnt lgkmcnt(4)
    v_mfma_f32_16x16x32_bf16 v[188:191], a[156:159], a[140:143], v[188:191]
    ds_read_b64_tr_b16 a[168:169], v10 offset:49152
    v_cvt_pk_bf16_f32 v130, v144, v145
    v_mfma_f32_16x16x32_bf16 v[184:187], a[156:159], a[136:139], v[184:187]
    ds_read_b64_tr_b16 a[170:171], v10 offset:57344
    v_cvt_pk_bf16_f32 v131, v146, v147
    v_mfma_f32_16x16x32_bf16 v[180:183], a[156:159], a[132:135], v[180:183]
    ds_write_b128 v29, v[128:131] offset:0
    v_mfma_f32_16x16x32_bf16 v[176:179], a[156:159], a[128:131], v[176:179]
    v_cvt_pk_bf16_f32 v132, v132, v133
    v_cvt_pk_bf16_f32 v133, v134, v135
    s_waitcnt lgkmcnt(5)
    v_mfma_f32_16x16x32_bf16 v[192:195], a[160:163], a[128:131], v[192:195]
    ds_read_b64_tr_b16 a[172:173], v11 offset:49152
    v_cvt_pk_bf16_f32 v134, v148, v149
    v_mfma_f32_16x16x32_bf16 v[196:199], a[160:163], a[132:135], v[196:199]
    ds_read_b64_tr_b16 a[174:175], v11 offset:57344
    v_cvt_pk_bf16_f32 v135, v150, v151
    ds_write_b128 v29, v[132:135] offset:1024
    v_mfma_f32_16x16x32_bf16 v[200:203], a[160:163], a[136:139], v[200:203]
    v_cvt_pk_bf16_f32 v136, v136, v137
    v_cvt_pk_bf16_f32 v137, v138, v139
    v_mfma_f32_16x16x32_bf16 v[204:207], a[160:163], a[140:143], v[204:207]
    v_cvt_pk_bf16_f32 v138, v152, v153
    v_cvt_pk_bf16_f32 v139, v154, v155
    s_waitcnt lgkmcnt(6)
    v_mfma_f32_16x16x32_bf16 v[220:223], a[164:167], a[140:143], v[220:223]
    ds_read_b64_tr_b16 a[144:145], v0 offset:0
    ds_write_b128 v29, v[136:139] offset:2048
    v_cvt_pk_bf16_f32 v140, v140, v141
    v_mfma_f32_16x16x32_bf16 v[216:219], a[164:167], a[136:139], v[216:219]
    ds_read_b64_tr_b16 a[146:147], v0 offset:2048
    v_cvt_pk_bf16_f32 v141, v142, v143
    v_cvt_pk_bf16_f32 v142, v156, v157
    v_mfma_f32_16x16x32_bf16 v[212:215], a[164:167], a[132:135], v[212:215]
    buffer_load_dwordx4 v14, s[24:27], s68 offen offset:2048  lds
    v_cvt_pk_bf16_f32 v143, v158, v159
    ds_write_b128 v29, v[140:143] offset:3072
    v_mfma_f32_16x16x32_bf16 v[208:211], a[164:167], a[128:131], v[208:211]
    v_cvt_pk_bf16_f32 v160, v160, v161
    v_cvt_pk_bf16_f32 v161, v162, v163
    s_waitcnt lgkmcnt(8)
    v_mfma_f32_16x16x32_bf16 v[224:227], a[168:171], a[128:131], v[224:227]
    s_waitcnt lgkmcnt(0)
    s_barrier
    ds_read_b64_tr_b16 a[148:149], v1 offset:0
    ds_read_b128 a[0:3], v17 offset:0
    v_cvt_pk_bf16_f32 v162, v176, v177
    v_mfma_f32_16x16x32_bf16 v[228:231], a[168:171], a[132:135], v[228:231]
    ds_read_b64_tr_b16 a[150:151], v1 offset:2048
    ds_read_b128 a[4:7], v17 offset:1024
    v_cvt_pk_bf16_f32 v163, v178, v179
    ds_write_b128 v29, v[160:163] offset:16384
    v_mfma_f32_16x16x32_bf16 v[232:235], a[168:171], a[136:139], v[232:235]
    v_cvt_pk_bf16_f32 v164, v164, v165
    ds_read_b128 a[8:11], v17 offset:2048
    v_cvt_pk_bf16_f32 v165, v166, v167
    v_mfma_f32_16x16x32_bf16 v[236:239], a[168:171], a[140:143], v[236:239]
    buffer_load_dwordx4 v15, s[24:27], s68 offen offset:3072  lds
    v_cvt_pk_bf16_f32 v166, v180, v181
    v_cvt_pk_bf16_f32 v167, v182, v183
    v_mfma_f32_16x16x32_bf16 v[252:255], a[172:175], a[140:143], v[252:255]
    ds_read_b64_tr_b16 a[152:153], v0 offset:16384
    ds_read_b128 a[12:15], v17 offset:3072
    ds_read_b128 a[64:67], v17 offset:4096
    ds_write_b128 v29, v[164:167] offset:17408
    v_mfma_f32_16x16x32_bf16 v[248:251], a[172:175], a[136:139], v[248:251]
    ds_read_b64_tr_b16 a[154:155], v0 offset:18432
    ds_read_b128 a[68:71], v17 offset:5120
    v_cvt_pk_bf16_f32 v168, v168, v169
    v_cvt_pk_bf16_f32 v169, v170, v171
    v_cvt_pk_bf16_f32 v170, v184, v185
    v_mfma_f32_16x16x32_bf16 v[244:247], a[172:175], a[132:135], v[244:247]
    ds_read_b128 a[72:75], v17 offset:6144
    ds_read_b128 a[76:79], v17 offset:7168
    v_cvt_pk_bf16_f32 v171, v186, v187
    ds_write_b128 v29, v[168:171] offset:18432
    v_mfma_f32_16x16x32_bf16 v[240:243], a[172:175], a[128:131], v[240:243]
    v_cvt_pk_bf16_f32 v172, v172, v173
    v_cvt_pk_bf16_f32 v173, v174, v175
    s_mov_b32 s3, 22272
    buffer_load_dwordx4 a[236:239], v21, s[24:27], s3 offen
    v_cvt_pk_bf16_f32 v174, v188, v189
    v_cvt_pk_bf16_f32 v175, v190, v191
    ds_write_b128 v29, v[172:175] offset:19456
    s_waitcnt lgkmcnt(14)
    v_mfma_f32_16x16x32_bf16 v[64:67], a[144:147], a[0:3], 0
    ds_read_b64_tr_b16 a[156:157], v1 offset:16384
    s_waitcnt lgkmcnt(13)
    v_mfma_f32_16x16x32_bf16 v[68:71], a[144:147], a[4:7], 0
    s_waitcnt lgkmcnt(3)
    s_waitcnt lgkmcnt(1)
    s_barrier
    ds_read_b64_tr_b16 a[158:159], v1 offset:18432
    ds_read_b128 a[16:19], v17 offset:16384
    v_mfma_f32_16x16x32_bf16 v[72:75], a[144:147], a[8:11], 0
    ds_read_b128 a[20:23], v17 offset:17408
    ds_read_b128 a[24:27], v17 offset:18432
    v_mfma_f32_16x16x32_bf16 v[76:79], a[144:147], a[12:15], 0
    v_cvt_pk_bf16_f32 v192, v192, v193
    ds_read_b128 a[28:31], v17 offset:19456
    v_mfma_f32_16x16x32_bf16 v[92:95], a[148:151], a[12:15], 0
    ds_read_b64_tr_b16 a[160:161], v0 offset:4096
    ds_read_b128 a[80:83], v17 offset:20480
    v_cvt_pk_bf16_f32 v193, v194, v195
    v_mfma_f32_16x16x32_bf16 v[88:91], a[148:151], a[8:11], 0
    ds_read_b64_tr_b16 a[162:163], v0 offset:6144
    ds_read_b128 a[84:87], v17 offset:21504
    v_cvt_pk_bf16_f32 v194, v208, v209
    v_mfma_f32_16x16x32_bf16 v[84:87], a[148:151], a[4:7], 0
    s_mov_b32 s3, 29440
    buffer_load_dwordx4 a[240:243], v21, s[24:27], s3 offen
    v_cvt_pk_bf16_f32 v195, v210, v211
    ds_write_b128 v29, v[192:195] offset:0
    v_mfma_f32_16x16x32_bf16 v[80:83], a[148:151], a[0:3], 0
    v_cvt_pk_bf16_f32 v196, v196, v197
    ds_read_b128 a[88:91], v17 offset:22528
    v_mfma_f32_16x16x32_bf16 v[64:67], a[152:155], a[64:67], v[64:67]
    ds_read_b64_tr_b16 a[164:165], v1 offset:4096
    ds_read_b128 a[92:95], v17 offset:23552
    v_cvt_pk_bf16_f32 v197, v198, v199
    v_cvt_pk_bf16_f32 v198, v212, v213
    v_mfma_f32_16x16x32_bf16 v[68:71], a[152:155], a[68:71], v[68:71]
    ds_read_b64_tr_b16 a[166:167], v1 offset:6144
    v_cvt_pk_bf16_f32 v199, v214, v215
    v_mfma_f32_16x16x32_bf16 v[72:75], a[152:155], a[72:75], v[72:75]
    ds_write_b128 v29, v[196:199] offset:1024
    v_cvt_pk_bf16_f32 v200, v200, v201
    v_mfma_f32_16x16x32_bf16 v[76:79], a[152:155], a[76:79], v[76:79]
    v_cvt_pk_bf16_f32 v201, v202, v203
    v_cvt_pk_bf16_f32 v202, v216, v217
    s_waitcnt lgkmcnt(14)
    v_mfma_f32_16x16x32_bf16 v[92:95], a[156:159], a[76:79], v[92:95]
    ds_read_b64_tr_b16 a[168:169], v0 offset:20480
    v_cvt_pk_bf16_f32 v203, v218, v219
    v_mfma_f32_16x16x32_bf16 v[88:91], a[156:159], a[72:75], v[88:91]
    ds_read_b64_tr_b16 a[170:171], v0 offset:22528
    ds_write_b128 v29, v[200:203] offset:2048
    v_mfma_f32_16x16x32_bf16 v[84:87], a[156:159], a[68:71], v[84:87]
    v_cvt_pk_bf16_f32 v204, v204, v205
    v_cvt_pk_bf16_f32 v205, v206, v207
    v_mfma_f32_16x16x32_bf16 v[80:83], a[156:159], a[64:67], v[80:83]
    s_mov_b32 s3, 36608
    buffer_load_dwordx4 a[244:247], v21, s[24:27], s3 offen
    v_cvt_pk_bf16_f32 v206, v220, v221
    s_waitcnt lgkmcnt(10)
    v_mfma_f32_16x16x32_bf16 v[64:67], a[160:163], a[16:19], v[64:67]
    ds_read_b64_tr_b16 a[172:173], v1 offset:20480
    v_cvt_pk_bf16_f32 v207, v222, v223
    ds_write_b128 v29, v[204:207] offset:3072
    v_mfma_f32_16x16x32_bf16 v[68:71], a[160:163], a[20:23], v[68:71]
    ds_read_b64_tr_b16 a[174:175], v1 offset:22528
    v_mfma_f32_16x16x32_bf16 v[72:75], a[160:163], a[24:27], v[72:75]
    s_waitcnt lgkmcnt(8)
    s_waitcnt lgkmcnt(1)
    s_barrier
    ds_read_b128 a[32:35], v17 offset:0
    ds_read_b128 a[36:39], v17 offset:1024
    v_mfma_f32_16x16x32_bf16 v[76:79], a[160:163], a[28:31], v[76:79]
    ds_read_b128 a[40:43], v17 offset:2048
    ds_read_b128 a[44:47], v17 offset:3072
    v_mfma_f32_16x16x32_bf16 v[92:95], a[164:167], a[28:31], v[92:95]
    ds_read_b64_tr_b16 a[144:145], v0 offset:8192
    ds_read_b128 a[96:99], v17 offset:4096
    v_cvt_pk_bf16_f32 v224, v224, v225
    v_mfma_f32_16x16x32_bf16 v[88:91], a[164:167], a[24:27], v[88:91]
    ds_read_b64_tr_b16 a[146:147], v0 offset:10240
    ds_read_b128 a[100:103], v17 offset:5120
    v_cvt_pk_bf16_f32 v225, v226, v227
    v_mfma_f32_16x16x32_bf16 v[84:87], a[164:167], a[20:23], v[84:87]
    v_cvt_pk_bf16_f32 v226, v240, v241
    ds_read_b128 a[104:107], v17 offset:6144
    v_cvt_pk_bf16_f32 v227, v242, v243
    v_mfma_f32_16x16x32_bf16 v[80:83], a[164:167], a[16:19], v[80:83]
    s_mov_b32 s3, 43776
    buffer_load_dwordx4 a[248:251], v21, s[24:27], s3 offen
    ds_write_b128 v29, v[224:227] offset:16384
    v_mfma_f32_16x16x32_bf16 v[64:67], a[168:171], a[80:83], v[64:67]
    ds_read_b64_tr_b16 a[148:149], v1 offset:8192
    ds_read_b128 a[108:111], v17 offset:7168
    v_cvt_pk_bf16_f32 v228, v228, v229
    v_cvt_pk_bf16_f32 v229, v230, v231
    v_mfma_f32_16x16x32_bf16 v[68:71], a[168:171], a[84:87], v[68:71]
    ds_read_b64_tr_b16 a[150:151], v1 offset:10240
    v_cvt_pk_bf16_f32 v230, v244, v245
    v_mfma_f32_16x16x32_bf16 v[72:75], a[168:171], a[88:91], v[72:75]
    v_cvt_pk_bf16_f32 v231, v246, v247
    ds_write_b128 v29, v[228:231] offset:17408
    v_mfma_f32_16x16x32_bf16 v[76:79], a[168:171], a[92:95], v[76:79]
    v_cvt_pk_bf16_f32 v232, v232, v233
    v_cvt_pk_bf16_f32 v233, v234, v235
    s_waitcnt lgkmcnt(14)
    v_mfma_f32_16x16x32_bf16 v[92:95], a[172:175], a[92:95], v[92:95]
    ds_read_b64_tr_b16 a[152:153], v0 offset:24576
    v_cvt_pk_bf16_f32 v234, v248, v249
    v_mfma_f32_16x16x32_bf16 v[88:91], a[172:175], a[88:91], v[88:91]
    ds_read_b64_tr_b16 a[154:155], v0 offset:26624
    v_cvt_pk_bf16_f32 v235, v250, v251
    ds_write_b128 v29, v[232:235] offset:18432
    v_mfma_f32_16x16x32_bf16 v[84:87], a[172:175], a[84:87], v[84:87]
    v_cvt_pk_bf16_f32 v236, v236, v237
    v_cvt_pk_bf16_f32 v237, v238, v239
    v_mfma_f32_16x16x32_bf16 v[80:83], a[172:175], a[80:83], v[80:83]
    v_cvt_pk_bf16_f32 v238, v252, v253
    v_cvt_pk_bf16_f32 v239, v254, v255
    s_waitcnt lgkmcnt(10)
    v_mfma_f32_16x16x32_bf16 v[64:67], a[144:147], a[32:35], v[64:67]
    ds_read_b64_tr_b16 a[156:157], v1 offset:24576
    ds_write_b128 v29, v[236:239] offset:19456
    v_mfma_f32_16x16x32_bf16 v[68:71], a[144:147], a[36:39], v[68:71]
    ds_read_b64_tr_b16 a[158:159], v1 offset:26624
    v_mfma_f32_16x16x32_bf16 v[72:75], a[144:147], a[40:43], v[72:75]
    s_waitcnt lgkmcnt(1)
    s_barrier
    s_mov_b32 s3, 50944
    buffer_load_dwordx4 a[252:255], v21, s[24:27], s3 offen
    v_mfma_f32_16x16x32_bf16 v[76:79], a[144:147], a[44:47], v[76:79]
    ds_read_b128 a[48:51], v17 offset:16384
    ds_read_b128 a[52:55], v17 offset:17408
    v_mov_b32 v36, v24
    v_mfma_f32_16x16x32_bf16 v[92:95], a[148:151], a[44:47], v[92:95]
    ds_read_b64_tr_b16 a[160:161], v0 offset:12288
    ds_read_b128 a[56:59], v17 offset:18432
    v_mov_b32 v37, v25
    v_mfma_f32_16x16x32_bf16 v[88:91], a[148:151], a[40:43], v[88:91]
    ds_read_b64_tr_b16 a[162:163], v0 offset:14336
    ds_read_b128 a[60:63], v17 offset:19456
    v_mov_b32 v38, v26
    v_mov_b32 v39, v27
    s_add_u32 m0, s61, 98304
    s_mov_b32 s68, 384
    v_mfma_f32_16x16x32_bf16 v[84:87], a[148:151], a[36:39], v[84:87]
    buffer_load_dwordx4 v12, s[24:27], s68 offen offset:0  lds
    v_permlane32_swap_b32 v36, v24
    v_permlane32_swap_b32 v37, v25
    v_mfma_f32_16x16x32_bf16 v[80:83], a[148:151], a[32:35], v[80:83]
    buffer_load_dwordx4 v13, s[24:27], s68 offen offset:1024  lds
    v_permlane32_swap_b32 v38, v26
    v_mfma_f32_16x16x32_bf16 v[64:67], a[152:155], a[96:99], v[64:67]
    ds_read_b64_tr_b16 a[164:165], v1 offset:12288
    ds_read_b128 a[112:115], v17 offset:20480
    v_permlane32_swap_b32 v39, v27
    v_add_f32 v24, v24, v36
    v_mfma_f32_16x16x32_bf16 v[68:71], a[152:155], a[100:103], v[68:71]
    ds_read_b64_tr_b16 a[166:167], v1 offset:14336
    ds_read_b128 a[116:119], v17 offset:21504
    v_add_f32 v25, v25, v37
    v_add_f32 v26, v26, v38
    v_mfma_f32_16x16x32_bf16 v[72:75], a[152:155], a[104:107], v[72:75]
    v_add_f32 v27, v27, v39
    ds_read_b128 a[120:123], v17 offset:22528
    v_mov_b32 v36, v24
    v_mfma_f32_16x16x32_bf16 v[76:79], a[152:155], a[108:111], v[76:79]
    buffer_load_dwordx4 v14, s[24:27], s68 offen offset:2048  lds
    v_mov_b32 v37, v25
    s_waitcnt lgkmcnt(11)
    v_mfma_f32_16x16x32_bf16 v[92:95], a[156:159], a[108:111], v[92:95]
    ds_read_b64_tr_b16 a[168:169], v0 offset:28672
    ds_read_b128 a[124:127], v17 offset:23552
    v_mov_b32 v38, v26
    v_mov_b32 v39, v27
    v_mfma_f32_16x16x32_bf16 v[88:91], a[156:159], a[104:107], v[88:91]
    ds_read_b64_tr_b16 a[170:171], v0 offset:30720
    v_permlane16_swap_b32 v36, v24
    v_permlane16_swap_b32 v37, v25
    v_mfma_f32_16x16x32_bf16 v[84:87], a[156:159], a[100:103], v[84:87]
    v_permlane16_swap_b32 v38, v26
    v_permlane16_swap_b32 v39, v27
    v_mfma_f32_16x16x32_bf16 v[80:83], a[156:159], a[96:99], v[80:83]
    buffer_load_dwordx4 v15, s[24:27], s68 offen offset:3072  lds
    v_add_f32 v24, v24, v36
    s_waitcnt lgkmcnt(9)
    v_mfma_f32_16x16x32_bf16 v[64:67], a[160:163], a[48:51], v[64:67]
    ds_read_b64_tr_b16 a[172:173], v1 offset:28672
    v_add_f32 v25, v25, v37
    v_add_f32 v26, v26, v38
    v_mfma_f32_16x16x32_bf16 v[68:71], a[160:163], a[52:55], v[68:71]
    ds_read_b64_tr_b16 a[174:175], v1 offset:30720
    v_add_f32 v27, v27, v39
    ds_write_b128 v22, v[24:27]
    s_add_u32 m0, s61, 102400
    s_mov_b32 s68, 29056
    v_mfma_f32_16x16x32_bf16 v[72:75], a[160:163], a[56:59], v[72:75]
    buffer_load_dwordx4 v12, s[24:27], s68 offen offset:0  lds
    s_waitcnt lgkmcnt(11)
    v_mfma_f32_16x16x32_bf16 v[76:79], a[160:163], a[60:63], v[76:79]
    s_waitcnt lgkmcnt(0)
    s_waitcnt vmcnt(22)
    s_barrier
    ds_read_b128 v[36:39], v23
    v_mfma_f32_16x16x32_bf16 v[92:95], a[164:167], a[60:63], v[92:95]
    ds_read_b64_tr_b16 a[144:145], v0 offset:32768
    v_mfma_f32_16x16x32_bf16 v[88:91], a[164:167], a[56:59], v[88:91]
    ds_read_b64_tr_b16 a[146:147], v0 offset:34816
    v_mfma_f32_16x16x32_bf16 v[84:87], a[164:167], a[52:55], v[84:87]
    buffer_load_dwordx4 v13, s[24:27], s68 offen offset:1024  lds
    v_mfma_f32_16x16x32_bf16 v[80:83], a[164:167], a[48:51], v[80:83]
    v_mfma_f32_16x16x32_bf16 v[64:67], a[168:171], a[112:115], v[64:67]
    ds_read_b64_tr_b16 a[148:149], v1 offset:32768
    v_mfma_f32_16x16x32_bf16 v[68:71], a[168:171], a[116:119], v[68:71]
    ds_read_b64_tr_b16 a[150:151], v1 offset:34816
    v_mfma_f32_16x16x32_bf16 v[72:75], a[168:171], a[120:123], v[72:75]
    buffer_load_dwordx4 v14, s[24:27], s68 offen offset:2048  lds
    v_mfma_f32_16x16x32_bf16 v[76:79], a[168:171], a[124:127], v[76:79]
    s_waitcnt lgkmcnt(4)
    v_add_f32 v24, v24, v36
    v_add_f32 v25, v25, v37
    v_mfma_f32_16x16x32_bf16 v[92:95], a[172:175], a[124:127], v[92:95]
    ds_read_b64_tr_b16 a[152:153], v0 offset:36864
    v_add_f32 v26, v26, v38
    v_mfma_f32_16x16x32_bf16 v[88:91], a[172:175], a[120:123], v[88:91]
    ds_read_b64_tr_b16 a[154:155], v0 offset:38912
    v_add_f32 v27, v27, v39
    v_mfma_f32_16x16x32_bf16 v[84:87], a[172:175], a[116:119], v[84:87]
    v_rcp_f32 v32, v24
    v_mfma_f32_16x16x32_bf16 v[80:83], a[172:175], a[112:115], v[80:83]
    buffer_load_dwordx4 v15, s[24:27], s68 offen offset:3072  lds
    v_rcp_f32 v33, v25
    v_rcp_f32 v34, v26
    v_rcp_f32 v35, v27
    s_waitcnt lgkmcnt(4)
    v_mfma_f32_16x16x32_bf16 v[96:99], a[144:147], a[0:3], 0
    s_barrier
    ds_read_b64_tr_b16 a[156:157], v1 offset:36864
    v_mfma_f32_16x16x32_bf16 v[100:103], a[144:147], a[4:7], 0
    ds_read_b64_tr_b16 a[158:159], v1 offset:38912
    s_add_u32 m0, s61, 0
    s_mov_b32 s68, 512
    v_mfma_f32_16x16x32_bf16 v[104:107], a[144:147], a[8:11], 0
    buffer_load_dwordx4 v12, s[24:27], s68 offen offset:0  lds
    v_mfma_f32_16x16x32_bf16 v[108:111], a[144:147], a[12:15], 0
    v_mul_f32 v64, v32, v64
    v_mul_f32 v65, v32, v65
    s_waitcnt lgkmcnt(4)
    v_mfma_f32_16x16x32_bf16 v[124:127], a[148:151], a[12:15], 0
    ds_read_b64_tr_b16 a[160:161], v0 offset:40960
    v_mul_f32 v66, v32, v66
    v_mfma_f32_16x16x32_bf16 v[120:123], a[148:151], a[8:11], 0
    ds_read_b64_tr_b16 a[162:163], v0 offset:43008
    v_mul_f32 v67, v32, v67
    v_mfma_f32_16x16x32_bf16 v[116:119], a[148:151], a[4:7], 0
    v_cvt_pk_bf16_f32 v128, v64, v65
    v_mfma_f32_16x16x32_bf16 v[112:115], a[148:151], a[0:3], 0
    buffer_load_dwordx4 v13, s[24:27], s68 offen offset:1024  lds
    s_waitcnt lgkmcnt(4)
    v_mfma_f32_16x16x32_bf16 v[96:99], a[152:155], a[16:19], v[96:99]
    ds_read_b64_tr_b16 a[164:165], v1 offset:40960
    v_cvt_pk_bf16_f32 v129, v66, v67
    v_mfma_f32_16x16x32_bf16 v[100:103], a[152:155], a[20:23], v[100:103]
    ds_read_b64_tr_b16 a[166:167], v1 offset:43008
    v_mul_f32 v80, v32, v80
    v_mfma_f32_16x16x32_bf16 v[104:107], a[152:155], a[24:27], v[104:107]
    v_mul_f32 v81, v32, v81
    v_mfma_f32_16x16x32_bf16 v[108:111], a[152:155], a[28:31], v[108:111]
    buffer_load_dwordx4 v14, s[24:27], s68 offen offset:2048  lds
    s_waitcnt lgkmcnt(4)
    v_mfma_f32_16x16x32_bf16 v[124:127], a[156:159], a[28:31], v[124:127]
    ds_read_b64_tr_b16 a[168:169], v0 offset:45056
    v_mul_f32 v82, v32, v82
    v_mfma_f32_16x16x32_bf16 v[120:123], a[156:159], a[24:27], v[120:123]
    ds_read_b64_tr_b16 a[170:171], v0 offset:47104
    v_mul_f32 v83, v32, v83
    v_mfma_f32_16x16x32_bf16 v[116:119], a[156:159], a[20:23], v[116:119]
    v_cvt_pk_bf16_f32 v130, v80, v81
    v_cvt_pk_bf16_f32 v131, v82, v83
    v_mfma_f32_16x16x32_bf16 v[112:115], a[156:159], a[16:19], v[112:115]
    buffer_load_dwordx4 v15, s[24:27], s68 offen offset:3072  lds
    s_waitcnt lgkmcnt(4)
    v_mfma_f32_16x16x32_bf16 v[96:99], a[160:163], a[32:35], v[96:99]
    ds_read_b64_tr_b16 a[172:173], v1 offset:45056
    v_mul_f32 v68, v33, v68
    v_mfma_f32_16x16x32_bf16 v[100:103], a[160:163], a[36:39], v[100:103]
    ds_read_b64_tr_b16 a[174:175], v1 offset:47104
    v_mul_f32 v69, v33, v69
    v_mfma_f32_16x16x32_bf16 v[104:107], a[160:163], a[40:43], v[104:107]
    v_mul_f32 v70, v33, v70
    v_mfma_f32_16x16x32_bf16 v[108:111], a[160:163], a[44:47], v[108:111]
    v_mul_f32 v71, v33, v71
    s_waitcnt lgkmcnt(4)
    v_mfma_f32_16x16x32_bf16 v[124:127], a[164:167], a[44:47], v[124:127]
    ds_read_b64_tr_b16 a[144:145], v0 offset:49152
    v_mfma_f32_16x16x32_bf16 v[120:123], a[164:167], a[40:43], v[120:123]
    ds_read_b64_tr_b16 a[146:147], v0 offset:51200
    v_cvt_pk_bf16_f32 v132, v68, v69
    s_add_u32 m0, s61, 4096
    s_mov_b32 s68, 29184
    v_mfma_f32_16x16x32_bf16 v[116:119], a[164:167], a[36:39], v[116:119]
    buffer_load_dwordx4 v12, s[24:27], s68 offen offset:0  lds
    v_mfma_f32_16x16x32_bf16 v[112:115], a[164:167], a[32:35], v[112:115]
    v_cvt_pk_bf16_f32 v133, v70, v71
    v_mul_f32 v84, v33, v84
    s_waitcnt lgkmcnt(4)
    v_mfma_f32_16x16x32_bf16 v[96:99], a[168:171], a[48:51], v[96:99]
    ds_read_b64_tr_b16 a[148:149], v1 offset:49152
    v_mul_f32 v85, v33, v85
    v_mfma_f32_16x16x32_bf16 v[100:103], a[168:171], a[52:55], v[100:103]
    ds_read_b64_tr_b16 a[150:151], v1 offset:51200
    v_mfma_f32_16x16x32_bf16 v[104:107], a[168:171], a[56:59], v[104:107]
    buffer_load_dwordx4 v13, s[24:27], s68 offen offset:1024  lds
    v_mfma_f32_16x16x32_bf16 v[108:111], a[168:171], a[60:63], v[108:111]
    v_mul_f32 v86, v33, v86
    v_mul_f32 v87, v33, v87
    s_waitcnt lgkmcnt(4)
    v_mfma_f32_16x16x32_bf16 v[124:127], a[172:175], a[60:63], v[124:127]
    ds_read_b64_tr_b16 a[152:153], v0 offset:53248
    v_cvt_pk_bf16_f32 v134, v84, v85
    v_mfma_f32_16x16x32_bf16 v[120:123], a[172:175], a[56:59], v[120:123]
    ds_read_b64_tr_b16 a[154:155], v0 offset:55296
    v_cvt_pk_bf16_f32 v135, v86, v87
    v_mfma_f32_16x16x32_bf16 v[116:119], a[172:175], a[52:55], v[116:119]
    buffer_load_dwordx4 v14, s[24:27], s68 offen offset:2048  lds
    v_mfma_f32_16x16x32_bf16 v[112:115], a[172:175], a[48:51], v[112:115]
    v_mul_f32 v72, v34, v72
    s_waitcnt lgkmcnt(4)
    v_mfma_f32_16x16x32_bf16 v[96:99], a[144:147], a[64:67], v[96:99]
    s_waitcnt vmcnt(20)
    s_barrier
    ds_read_b64_tr_b16 a[156:157], v1 offset:53248
    v_mul_f32 v73, v34, v73
    v_mfma_f32_16x16x32_bf16 v[100:103], a[144:147], a[68:71], v[100:103]
    ds_read_b64_tr_b16 a[158:159], v1 offset:55296
    v_mul_f32 v74, v34, v74
    v_mfma_f32_16x16x32_bf16 v[104:107], a[144:147], a[72:75], v[104:107]
    buffer_load_dwordx4 v15, s[24:27], s68 offen offset:3072  lds
    v_mfma_f32_16x16x32_bf16 v[108:111], a[144:147], a[76:79], v[108:111]
    v_mul_f32 v75, v34, v75
    s_waitcnt lgkmcnt(4)
    v_mfma_f32_16x16x32_bf16 v[124:127], a[148:151], a[76:79], v[124:127]
    ds_read_b64_tr_b16 a[160:161], v0 offset:57344
    v_cvt_pk_bf16_f32 v136, v72, v73
    v_mfma_f32_16x16x32_bf16 v[120:123], a[148:151], a[72:75], v[120:123]
    ds_read_b64_tr_b16 a[162:163], v0 offset:59392
    v_cvt_pk_bf16_f32 v137, v74, v75
    v_mfma_f32_16x16x32_bf16 v[116:119], a[148:151], a[68:71], v[116:119]
    v_mul_f32 v88, v34, v88
    v_mfma_f32_16x16x32_bf16 v[112:115], a[148:151], a[64:67], v[112:115]
    v_mul_f32 v89, v34, v89
    s_waitcnt lgkmcnt(4)
    v_mfma_f32_16x16x32_bf16 v[96:99], a[152:155], a[80:83], v[96:99]
    ds_read_b64_tr_b16 a[164:165], v1 offset:57344
    v_mfma_f32_16x16x32_bf16 v[100:103], a[152:155], a[84:87], v[100:103]
    ds_read_b64_tr_b16 a[166:167], v1 offset:59392
    v_mul_f32 v90, v34, v90
    v_mfma_f32_16x16x32_bf16 v[104:107], a[152:155], a[88:91], v[104:107]
    v_mul_f32 v91, v34, v91
    v_mfma_f32_16x16x32_bf16 v[108:111], a[152:155], a[92:95], v[108:111]
    v_cvt_pk_bf16_f32 v138, v88, v89
    s_waitcnt lgkmcnt(4)
    v_mfma_f32_16x16x32_bf16 v[124:127], a[156:159], a[92:95], v[124:127]
    ds_read_b64_tr_b16 a[168:169], v0 offset:61440
    v_cvt_pk_bf16_f32 v139, v90, v91
    v_mfma_f32_16x16x32_bf16 v[120:123], a[156:159], a[88:91], v[120:123]
    ds_read_b64_tr_b16 a[170:171], v0 offset:63488
    v_mfma_f32_16x16x32_bf16 v[116:119], a[156:159], a[84:87], v[116:119]
    v_mul_f32 v76, v35, v76
    v_mfma_f32_16x16x32_bf16 v[112:115], a[156:159], a[80:83], v[112:115]
    v_mul_f32 v77, v35, v77
    s_waitcnt lgkmcnt(4)
    v_mfma_f32_16x16x32_bf16 v[96:99], a[160:163], a[96:99], v[96:99]
    ds_read_b64_tr_b16 a[172:173], v1 offset:61440
    v_mul_f32 v78, v35, v78
    v_mfma_f32_16x16x32_bf16 v[100:103], a[160:163], a[100:103], v[100:103]
    ds_read_b64_tr_b16 a[174:175], v1 offset:63488
    v_mul_f32 v79, v35, v79
    v_mfma_f32_16x16x32_bf16 v[104:107], a[160:163], a[104:107], v[104:107]
    v_mfma_f32_16x16x32_bf16 v[108:111], a[160:163], a[108:111], v[108:111]
    v_cvt_pk_bf16_f32 v140, v76, v77
    s_waitcnt lgkmcnt(4)
    v_mfma_f32_16x16x32_bf16 v[124:127], a[164:167], a[108:111], v[124:127]
    ds_read_b64_tr_b16 a[144:145], v2 offset:0
    v_cvt_pk_bf16_f32 v141, v78, v79
    v_mfma_f32_16x16x32_bf16 v[120:123], a[164:167], a[104:107], v[120:123]
    ds_read_b64_tr_b16 a[146:147], v2 offset:2048
    v_mul_f32 v92, v35, v92
    v_mfma_f32_16x16x32_bf16 v[116:119], a[164:167], a[100:103], v[116:119]
    v_mul_f32 v93, v35, v93
    v_mfma_f32_16x16x32_bf16 v[112:115], a[164:167], a[96:99], v[112:115]
    s_waitcnt lgkmcnt(4)
    v_mfma_f32_16x16x32_bf16 v[96:99], a[168:171], a[112:115], v[96:99]
    ds_read_b64_tr_b16 a[148:149], v3 offset:0
    v_mul_f32 v94, v35, v94
    v_mfma_f32_16x16x32_bf16 v[100:103], a[168:171], a[116:119], v[100:103]
    ds_read_b64_tr_b16 a[150:151], v3 offset:2048
    v_mul_f32 v95, v35, v95
    v_mfma_f32_16x16x32_bf16 v[104:107], a[168:171], a[120:123], v[104:107]
    v_cvt_pk_bf16_f32 v142, v92, v93
    v_mfma_f32_16x16x32_bf16 v[108:111], a[168:171], a[124:127], v[108:111]
    v_cvt_pk_bf16_f32 v143, v94, v95
    s_waitcnt lgkmcnt(4)
    v_mfma_f32_16x16x32_bf16 v[124:127], a[172:175], a[124:127], v[124:127]
    ds_read_b64_tr_b16 a[152:153], v2 offset:4096
    v_mfma_f32_16x16x32_bf16 v[120:123], a[172:175], a[120:123], v[120:123]
    ds_read_b64_tr_b16 a[154:155], v2 offset:6144
    v_mfma_f32_16x16x32_bf16 v[116:119], a[172:175], a[116:119], v[116:119]
    v_mfma_f32_16x16x32_bf16 v[112:115], a[172:175], a[112:115], v[112:115]
    s_waitcnt lgkmcnt(4)
    v_mfma_f32_16x16x32_bf16 v[64:67], a[144:147], a[0:3], 0
    s_barrier
    ds_read_b64_tr_b16 a[156:157], v3 offset:4096
    v_mfma_f32_16x16x32_bf16 v[68:71], a[144:147], a[4:7], 0
    ds_read_b64_tr_b16 a[158:159], v3 offset:6144
    v_mfma_f32_16x16x32_bf16 v[72:75], a[144:147], a[8:11], 0
    ds_write_b128 v18, a[192:195] offset:32768
    v_mfma_f32_16x16x32_bf16 v[76:79], a[144:147], a[12:15], 0
    s_mov_b32 s69, 0
    buffer_store_dwordx4 v[128:131], v20, s[28:31], s69 offen sc1
    s_waitcnt lgkmcnt(5)
    v_mfma_f32_16x16x32_bf16 v[92:95], a[148:151], a[12:15], 0
    ds_read_b64_tr_b16 a[160:161], v2 offset:8192
    v_mul_f32 v96, v32, v96
    v_mfma_f32_16x16x32_bf16 v[88:91], a[148:151], a[8:11], 0
    ds_read_b64_tr_b16 a[162:163], v2 offset:10240
    v_mul_f32 v97, v32, v97
    v_mfma_f32_16x16x32_bf16 v[84:87], a[148:151], a[4:7], 0
    v_mul_f32 v98, v32, v98
    v_mul_f32 v99, v32, v99
    v_mfma_f32_16x16x32_bf16 v[80:83], a[148:151], a[0:3], 0
    v_cvt_pk_bf16_f32 v144, v96, v97
    v_cvt_pk_bf16_f32 v145, v98, v99
    s_waitcnt lgkmcnt(5)
    v_mfma_f32_16x16x32_bf16 v[64:67], a[152:155], a[16:19], v[64:67]
    ds_read_b64_tr_b16 a[164:165], v3 offset:8192
    v_mul_f32 v112, v32, v112
    v_mfma_f32_16x16x32_bf16 v[68:71], a[152:155], a[20:23], v[68:71]
    ds_read_b64_tr_b16 a[166:167], v3 offset:10240
    v_mul_f32 v113, v32, v113
    v_mfma_f32_16x16x32_bf16 v[72:75], a[152:155], a[24:27], v[72:75]
    ds_write_b128 v18, a[196:199] offset:33792
    v_mfma_f32_16x16x32_bf16 v[76:79], a[152:155], a[28:31], v[76:79]
    v_mul_f32 v114, v32, v114
    v_mul_f32 v115, v32, v115
    s_waitcnt lgkmcnt(6)
    v_mfma_f32_16x16x32_bf16 v[92:95], a[156:159], a[28:31], v[92:95]
    ds_read_b64_tr_b16 a[168:169], v2 offset:12288
    v_cvt_pk_bf16_f32 v146, v112, v113
    v_mfma_f32_16x16x32_bf16 v[88:91], a[156:159], a[24:27], v[88:91]
    ds_read_b64_tr_b16 a[170:171], v2 offset:14336
    v_cvt_pk_bf16_f32 v147, v114, v115
    v_mfma_f32_16x16x32_bf16 v[84:87], a[156:159], a[20:23], v[84:87]
    s_mov_b32 s69, 2048
    buffer_store_dwordx4 v[144:147], v20, s[28:31], s69 offen sc1
    v_mfma_f32_16x16x32_bf16 v[80:83], a[156:159], a[16:19], v[80:83]
    s_waitcnt lgkmcnt(5)
    v_mfma_f32_16x16x32_bf16 v[64:67], a[160:163], a[32:35], v[64:67]
    ds_read_b64_tr_b16 a[172:173], v3 offset:12288
    v_mul_f32 v100, v33, v100
    v_mfma_f32_16x16x32_bf16 v[68:71], a[160:163], a[36:39], v[68:71]
    ds_read_b64_tr_b16 a[174:175], v3 offset:14336
    v_mul_f32 v101, v33, v101
    v_mfma_f32_16x16x32_bf16 v[72:75], a[160:163], a[40:43], v[72:75]
    ds_write_b128 v18, a[200:203] offset:34816
    v_mfma_f32_16x16x32_bf16 v[76:79], a[160:163], a[44:47], v[76:79]
    v_mul_f32 v102, v33, v102
    v_mul_f32 v103, v33, v103
    s_waitcnt lgkmcnt(6)
    v_mfma_f32_16x16x32_bf16 v[92:95], a[164:167], a[44:47], v[92:95]
    ds_read_b64_tr_b16 a[144:145], v2 offset:16384
    v_cvt_pk_bf16_f32 v148, v100, v101
    v_mfma_f32_16x16x32_bf16 v[88:91], a[164:167], a[40:43], v[88:91]
    ds_read_b64_tr_b16 a[146:147], v2 offset:18432
    v_cvt_pk_bf16_f32 v149, v102, v103
    v_mfma_f32_16x16x32_bf16 v[84:87], a[164:167], a[36:39], v[84:87]
    s_mov_b32 s69, 14336
    buffer_store_dwordx4 v[132:135], v20, s[28:31], s69 offen
    v_mfma_f32_16x16x32_bf16 v[80:83], a[164:167], a[32:35], v[80:83]
    ds_write_b128 v18, a[204:207] offset:35840
    s_waitcnt lgkmcnt(6)
    v_mfma_f32_16x16x32_bf16 v[64:67], a[168:171], a[48:51], v[64:67]
    ds_read_b64_tr_b16 a[148:149], v3 offset:16384
    v_mul_f32 v116, v33, v116
    v_mfma_f32_16x16x32_bf16 v[68:71], a[168:171], a[52:55], v[68:71]
    ds_read_b64_tr_b16 a[150:151], v3 offset:18432
    v_mul_f32 v117, v33, v117
    v_mfma_f32_16x16x32_bf16 v[72:75], a[168:171], a[56:59], v[72:75]
    v_mul_f32 v118, v33, v118
    v_mul_f32 v119, v33, v119
    v_mfma_f32_16x16x32_bf16 v[76:79], a[168:171], a[60:63], v[76:79]
    v_cvt_pk_bf16_f32 v150, v116, v117
    s_waitcnt lgkmcnt(6)
    v_mfma_f32_16x16x32_bf16 v[92:95], a[172:175], a[60:63], v[92:95]
    ds_read_b64_tr_b16 a[152:153], v2 offset:20480
    v_cvt_pk_bf16_f32 v151, v118, v119
    v_mfma_f32_16x16x32_bf16 v[88:91], a[172:175], a[56:59], v[88:91]
    ds_read_b64_tr_b16 a[154:155], v2 offset:22528
    v_mfma_f32_16x16x32_bf16 v[84:87], a[172:175], a[52:55], v[84:87]
    ds_write_b128 v18, a[208:211] offset:36864
    v_mfma_f32_16x16x32_bf16 v[80:83], a[172:175], a[48:51], v[80:83]
    s_mov_b32 s69, 16384
    buffer_store_dwordx4 v[148:151], v20, s[28:31], s69 offen
    s_waitcnt lgkmcnt(6)
    v_mfma_f32_16x16x32_bf16 v[64:67], a[144:147], a[64:67], v[64:67]
    s_waitcnt vmcnt(12)
    s_barrier
    ds_read_b64_tr_b16 a[156:157], v3 offset:20480
    v_mul_f32 v104, v34, v104
    v_mfma_f32_16x16x32_bf16 v[68:71], a[144:147], a[68:71], v[68:71]
    ds_read_b64_tr_b16 a[158:159], v3 offset:22528
    v_mul_f32 v105, v34, v105
    v_mfma_f32_16x16x32_bf16 v[72:75], a[144:147], a[72:75], v[72:75]
    v_mul_f32 v106, v34, v106
    v_mul_f32 v107, v34, v107
    v_mfma_f32_16x16x32_bf16 v[76:79], a[144:147], a[76:79], v[76:79]
    ds_write_b128 v18, a[212:215] offset:37888
    s_waitcnt lgkmcnt(6)
    v_mfma_f32_16x16x32_bf16 v[92:95], a[148:151], a[76:79], v[92:95]
    ds_read_b64_tr_b16 a[160:161], v2 offset:24576
    v_cvt_pk_bf16_f32 v152, v104, v105
    v_mfma_f32_16x16x32_bf16 v[88:91], a[148:151], a[72:75], v[88:91]
    ds_read_b64_tr_b16 a[162:163], v2 offset:26624
    v_cvt_pk_bf16_f32 v153, v106, v107
    v_mfma_f32_16x16x32_bf16 v[84:87], a[148:151], a[68:71], v[84:87]
    v_mul_f32 v120, v34, v120
    v_mfma_f32_16x16x32_bf16 v[80:83], a[148:151], a[64:67], v[80:83]
    v_mul_f32 v121, v34, v121
    s_waitcnt lgkmcnt(6)
    v_mfma_f32_16x16x32_bf16 v[64:67], a[152:155], a[80:83], v[64:67]
    ds_read_b64_tr_b16 a[164:165], v3 offset:24576
    v_mul_f32 v122, v34, v122
    v_mfma_f32_16x16x32_bf16 v[68:71], a[152:155], a[84:87], v[68:71]
    ds_read_b64_tr_b16 a[166:167], v3 offset:26624
    v_mul_f32 v123, v34, v123
    v_mfma_f32_16x16x32_bf16 v[72:75], a[152:155], a[88:91], v[72:75]
    s_mov_b32 s69, 28672
    buffer_store_dwordx4 v[136:139], v20, s[28:31], s69 offen
    v_mfma_f32_16x16x32_bf16 v[76:79], a[152:155], a[92:95], v[76:79]
    ds_write_b128 v18, a[216:219] offset:38912
    s_waitcnt lgkmcnt(6)
    v_mfma_f32_16x16x32_bf16 v[92:95], a[156:159], a[92:95], v[92:95]
    ds_read_b64_tr_b16 a[168:169], v2 offset:28672
    v_cvt_pk_bf16_f32 v154, v120, v121
    v_mfma_f32_16x16x32_bf16 v[88:91], a[156:159], a[88:91], v[88:91]
    ds_read_b64_tr_b16 a[170:171], v2 offset:30720
    v_cvt_pk_bf16_f32 v155, v122, v123
    v_mfma_f32_16x16x32_bf16 v[84:87], a[156:159], a[84:87], v[84:87]
    s_mov_b32 s69, 30720
    buffer_store_dwordx4 v[152:155], v20, s[28:31], s69 offen
    v_mfma_f32_16x16x32_bf16 v[80:83], a[156:159], a[80:83], v[80:83]
    v_mul_f32 v108, v35, v108
    v_mul_f32 v109, v35, v109
    s_waitcnt lgkmcnt(5)
    v_mfma_f32_16x16x32_bf16 v[64:67], a[160:163], a[96:99], v[64:67]
    ds_read_b64_tr_b16 a[172:173], v3 offset:28672
    v_mul_f32 v110, v35, v110
    v_mfma_f32_16x16x32_bf16 v[68:71], a[160:163], a[100:103], v[68:71]
    ds_read_b64_tr_b16 a[174:175], v3 offset:30720
    v_mul_f32 v111, v35, v111
    v_mfma_f32_16x16x32_bf16 v[72:75], a[160:163], a[104:107], v[72:75]
    ds_write_b128 v18, a[220:223] offset:39936
    v_mfma_f32_16x16x32_bf16 v[76:79], a[160:163], a[108:111], v[76:79]
    v_cvt_pk_bf16_f32 v156, v108, v109
    v_cvt_pk_bf16_f32 v157, v110, v111
    s_waitcnt lgkmcnt(6)
    v_mfma_f32_16x16x32_bf16 v[92:95], a[164:167], a[108:111], v[92:95]
    ds_read_b64_tr_b16 a[144:145], v2 offset:32768
    v_mfma_f32_16x16x32_bf16 v[88:91], a[164:167], a[104:107], v[88:91]
    ds_read_b64_tr_b16 a[146:147], v2 offset:34816
    v_mul_f32 v124, v35, v124
    v_mfma_f32_16x16x32_bf16 v[84:87], a[164:167], a[100:103], v[84:87]
    v_mul_f32 v125, v35, v125
    v_mfma_f32_16x16x32_bf16 v[80:83], a[164:167], a[96:99], v[80:83]
    v_mul_f32 v126, v35, v126
    s_waitcnt lgkmcnt(5)
    v_mfma_f32_16x16x32_bf16 v[64:67], a[168:171], a[112:115], v[64:67]
    ds_read_b64_tr_b16 a[148:149], v3 offset:32768
    v_mul_f32 v127, v35, v127
    v_mfma_f32_16x16x32_bf16 v[68:71], a[168:171], a[116:119], v[68:71]
    ds_read_b64_tr_b16 a[150:151], v3 offset:34816
    v_cvt_pk_bf16_f32 v158, v124, v125
    v_mfma_f32_16x16x32_bf16 v[72:75], a[168:171], a[120:123], v[72:75]
    v_cvt_pk_bf16_f32 v159, v126, v127
    v_mfma_f32_16x16x32_bf16 v[76:79], a[168:171], a[124:127], v[76:79]
    s_mov_b32 s69, 45056
    buffer_store_dwordx4 v[156:159], v20, s[28:31], s69 offen
    s_waitcnt lgkmcnt(5)
    v_mfma_f32_16x16x32_bf16 v[92:95], a[172:175], a[124:127], v[92:95]
    ds_read_b64_tr_b16 a[152:153], v2 offset:36864
    v_mfma_f32_16x16x32_bf16 v[88:91], a[172:175], a[120:123], v[88:91]
    ds_read_b64_tr_b16 a[154:155], v2 offset:38912
    v_mfma_f32_16x16x32_bf16 v[84:87], a[172:175], a[116:119], v[84:87]
    s_mov_b32 s69, 43008
    buffer_store_dwordx4 v[140:143], v20, s[28:31], s69 offen
    v_mfma_f32_16x16x32_bf16 v[80:83], a[172:175], a[112:115], v[80:83]
    s_waitcnt lgkmcnt(4)
    v_mfma_f32_16x16x32_bf16 v[96:99], a[144:147], a[0:3], 0
    s_barrier
    ds_read_b64_tr_b16 a[156:157], v3 offset:36864
    v_mfma_f32_16x16x32_bf16 v[100:103], a[144:147], a[4:7], 0
    ds_read_b64_tr_b16 a[158:159], v3 offset:38912
    v_mfma_f32_16x16x32_bf16 v[104:107], a[144:147], a[8:11], 0
    v_add_u32 v18, 65536, v18
    v_mfma_f32_16x16x32_bf16 v[108:111], a[144:147], a[12:15], 0
    v_mul_f32 v64, v32, v64
    v_mul_f32 v65, v32, v65
    s_waitcnt lgkmcnt(4)
    v_mfma_f32_16x16x32_bf16 v[124:127], a[148:151], a[12:15], 0
    ds_read_b64_tr_b16 a[160:161], v2 offset:40960
    v_mul_f32 v66, v32, v66
    v_mfma_f32_16x16x32_bf16 v[120:123], a[148:151], a[8:11], 0
    ds_read_b64_tr_b16 a[162:163], v2 offset:43008
    v_mul_f32 v67, v32, v67
    v_mfma_f32_16x16x32_bf16 v[116:119], a[148:151], a[4:7], 0
    v_cvt_pk_bf16_f32 v160, v64, v65
    v_cvt_pk_bf16_f32 v161, v66, v67
    v_mfma_f32_16x16x32_bf16 v[112:115], a[148:151], a[0:3], 0
    v_mul_f32 v80, v32, v80
    s_waitcnt lgkmcnt(4)
    v_mfma_f32_16x16x32_bf16 v[96:99], a[152:155], a[16:19], v[96:99]
    ds_read_b64_tr_b16 a[164:165], v3 offset:40960
    v_mfma_f32_16x16x32_bf16 v[100:103], a[152:155], a[20:23], v[100:103]
    ds_read_b64_tr_b16 a[166:167], v3 offset:43008
    v_mul_f32 v81, v32, v81
    v_mfma_f32_16x16x32_bf16 v[104:107], a[152:155], a[24:27], v[104:107]
    ds_write_b128 v18, a[224:227] offset:0
    v_mfma_f32_16x16x32_bf16 v[108:111], a[152:155], a[28:31], v[108:111]
    v_mul_f32 v82, v32, v82
    v_mul_f32 v83, v32, v83
    s_waitcnt lgkmcnt(5)
    v_mfma_f32_16x16x32_bf16 v[124:127], a[156:159], a[28:31], v[124:127]
    ds_read_b64_tr_b16 a[168:169], v2 offset:45056
    v_cvt_pk_bf16_f32 v162, v80, v81
    v_mfma_f32_16x16x32_bf16 v[120:123], a[156:159], a[24:27], v[120:123]
    ds_read_b64_tr_b16 a[170:171], v2 offset:47104
    v_cvt_pk_bf16_f32 v163, v82, v83
    v_mfma_f32_16x16x32_bf16 v[116:119], a[156:159], a[20:23], v[116:119]
    ds_write_b128 v18, a[228:231] offset:1024
    v_mfma_f32_16x16x32_bf16 v[112:115], a[156:159], a[16:19], v[112:115]
    s_mov_b32 s69, 4096
    buffer_store_dwordx4 v[160:163], v20, s[28:31], s69 offen sc1
    s_waitcnt lgkmcnt(6)
    v_mfma_f32_16x16x32_bf16 v[96:99], a[160:163], a[32:35], v[96:99]
    ds_read_b64_tr_b16 a[172:173], v3 offset:45056
    v_mul_f32 v68, v33, v68
    v_mfma_f32_16x16x32_bf16 v[100:103], a[160:163], a[36:39], v[100:103]
    ds_read_b64_tr_b16 a[174:175], v3 offset:47104
    v_mul_f32 v69, v33, v69
    v_mfma_f32_16x16x32_bf16 v[104:107], a[160:163], a[40:43], v[104:107]
    v_mul_f32 v70, v33, v70
    v_mfma_f32_16x16x32_bf16 v[108:111], a[160:163], a[44:47], v[108:111]
    v_mul_f32 v71, v33, v71
    s_waitcnt lgkmcnt(6)
    v_mfma_f32_16x16x32_bf16 v[124:127], a[164:167], a[44:47], v[124:127]
    ds_read_b64_tr_b16 a[144:145], v2 offset:49152
    v_cvt_pk_bf16_f32 v164, v68, v69
    v_mfma_f32_16x16x32_bf16 v[120:123], a[164:167], a[40:43], v[120:123]
    ds_read_b64_tr_b16 a[146:147], v2 offset:51200
    v_cvt_pk_bf16_f32 v165, v70, v71
    v_mfma_f32_16x16x32_bf16 v[116:119], a[164:167], a[36:39], v[116:119]
    ds_write_b128 v18, a[232:235] offset:2048
    v_mfma_f32_16x16x32_bf16 v[112:115], a[164:167], a[32:35], v[112:115]
    v_mul_f32 v84, v33, v84
    s_waitcnt lgkmcnt(6)
    v_mfma_f32_16x16x32_bf16 v[96:99], a[168:171], a[48:51], v[96:99]
    ds_read_b64_tr_b16 a[148:149], v3 offset:49152
    v_mul_f32 v85, v33, v85
    v_mfma_f32_16x16x32_bf16 v[100:103], a[168:171], a[52:55], v[100:103]
    ds_read_b64_tr_b16 a[150:151], v3 offset:51200
    v_mul_f32 v86, v33, v86
    v_mfma_f32_16x16x32_bf16 v[104:107], a[168:171], a[56:59], v[104:107]
    ds_write_b128 v18, a[236:239] offset:3072
    v_mfma_f32_16x16x32_bf16 v[108:111], a[168:171], a[60:63], v[108:111]
    v_mul_f32 v87, v33, v87
    v_cvt_pk_bf16_f32 v166, v84, v85
    s_waitcnt lgkmcnt(6)
    v_mfma_f32_16x16x32_bf16 v[124:127], a[172:175], a[60:63], v[124:127]
    ds_read_b64_tr_b16 a[152:153], v2 offset:53248
    v_cvt_pk_bf16_f32 v167, v86, v87
    v_mfma_f32_16x16x32_bf16 v[120:123], a[172:175], a[56:59], v[120:123]
    ds_read_b64_tr_b16 a[154:155], v2 offset:55296
    v_mfma_f32_16x16x32_bf16 v[116:119], a[172:175], a[52:55], v[116:119]
    s_mov_b32 s69, 18432
    buffer_store_dwordx4 v[164:167], v20, s[28:31], s69 offen
    v_mfma_f32_16x16x32_bf16 v[112:115], a[172:175], a[48:51], v[112:115]
    ds_write_b128 v18, a[240:243] offset:4096
    s_waitcnt lgkmcnt(7)
    v_mfma_f32_16x16x32_bf16 v[96:99], a[144:147], a[64:67], v[96:99]
    s_waitcnt vmcnt(10)
    s_barrier
    ds_read_b64_tr_b16 a[156:157], v3 offset:53248
    v_mul_f32 v72, v34, v72
    v_mfma_f32_16x16x32_bf16 v[100:103], a[144:147], a[68:71], v[100:103]
    ds_read_b64_tr_b16 a[158:159], v3 offset:55296
    v_mul_f32 v73, v34, v73
    v_mfma_f32_16x16x32_bf16 v[104:107], a[144:147], a[72:75], v[104:107]
    v_mul_f32 v74, v34, v74
    v_mul_f32 v75, v34, v75
    v_mfma_f32_16x16x32_bf16 v[108:111], a[144:147], a[76:79], v[108:111]
    v_cvt_pk_bf16_f32 v168, v72, v73
    s_waitcnt lgkmcnt(6)
    v_mfma_f32_16x16x32_bf16 v[124:127], a[148:151], a[76:79], v[124:127]
    ds_read_b64_tr_b16 a[160:161], v2 offset:57344
    v_cvt_pk_bf16_f32 v169, v74, v75
    v_mfma_f32_16x16x32_bf16 v[120:123], a[148:151], a[72:75], v[120:123]
    ds_read_b64_tr_b16 a[162:163], v2 offset:59392
    v_mfma_f32_16x16x32_bf16 v[116:119], a[148:151], a[68:71], v[116:119]
    ds_write_b128 v18, a[244:247] offset:5120
    v_mfma_f32_16x16x32_bf16 v[112:115], a[148:151], a[64:67], v[112:115]
    v_mul_f32 v88, v34, v88
    v_mul_f32 v89, v34, v89
    s_waitcnt lgkmcnt(6)
    v_mfma_f32_16x16x32_bf16 v[96:99], a[152:155], a[80:83], v[96:99]
    ds_read_b64_tr_b16 a[164:165], v3 offset:57344
    v_mul_f32 v90, v34, v90
    v_mfma_f32_16x16x32_bf16 v[100:103], a[152:155], a[84:87], v[100:103]
    ds_read_b64_tr_b16 a[166:167], v3 offset:59392
    v_mul_f32 v91, v34, v91
    v_mfma_f32_16x16x32_bf16 v[104:107], a[152:155], a[88:91], v[104:107]
    v_cvt_pk_bf16_f32 v170, v88, v89
    v_mfma_f32_16x16x32_bf16 v[108:111], a[152:155], a[92:95], v[108:111]
    ds_write_b128 v18, a[248:251] offset:6144
    s_waitcnt lgkmcnt(6)
    v_mfma_f32_16x16x32_bf16 v[124:127], a[156:159], a[92:95], v[124:127]
    ds_read_b64_tr_b16 a[168:169], v2 offset:61440
    v_cvt_pk_bf16_f32 v171, v90, v91
    v_mfma_f32_16x16x32_bf16 v[120:123], a[156:159], a[88:91], v[120:123]
    ds_read_b64_tr_b16 a[170:171], v2 offset:63488
    v_mfma_f32_16x16x32_bf16 v[116:119], a[156:159], a[84:87], v[116:119]
    s_mov_b32 s69, 32768
    buffer_store_dwordx4 v[168:171], v20, s[28:31], s69 offen
    v_mfma_f32_16x16x32_bf16 v[112:115], a[156:159], a[80:83], v[112:115]
    v_mul_f32 v76, v35, v76
    v_mul_f32 v77, v35, v77
    s_waitcnt lgkmcnt(6)
    v_mfma_f32_16x16x32_bf16 v[96:99], a[160:163], a[96:99], v[96:99]
    ds_read_b64_tr_b16 a[172:173], v3 offset:61440
    v_mul_f32 v78, v35, v78
    v_mfma_f32_16x16x32_bf16 v[100:103], a[160:163], a[100:103], v[100:103]
    ds_read_b64_tr_b16 a[174:175], v3 offset:63488
    v_mul_f32 v79, v35, v79
    v_mfma_f32_16x16x32_bf16 v[104:107], a[160:163], a[104:107], v[104:107]
    ds_write_b128 v18, a[252:255] offset:7168
    v_mfma_f32_16x16x32_bf16 v[108:111], a[160:163], a[108:111], v[108:111]
    v_cvt_pk_bf16_f32 v172, v76, v77
    v_cvt_pk_bf16_f32 v173, v78, v79
    s_waitcnt lgkmcnt(6)
    v_mfma_f32_16x16x32_bf16 v[124:127], a[164:167], a[108:111], v[124:127]
    ds_read_b64_tr_b16 a[144:145], v0 offset:0
    v_mfma_f32_16x16x32_bf16 v[120:123], a[164:167], a[104:107], v[120:123]
    ds_read_b64_tr_b16 a[146:147], v0 offset:2048
    v_mul_f32 v92, v35, v92
    v_mfma_f32_16x16x32_bf16 v[116:119], a[164:167], a[100:103], v[116:119]
    v_mul_f32 v93, v35, v93
    v_mfma_f32_16x16x32_bf16 v[112:115], a[164:167], a[96:99], v[112:115]
    v_mul_f32 v94, v35, v94
    s_waitcnt lgkmcnt(5)
    v_mfma_f32_16x16x32_bf16 v[96:99], a[168:171], a[112:115], v[96:99]
    ds_read_b64_tr_b16 a[148:149], v1 offset:0
    v_mul_f32 v95, v35, v95
    v_mfma_f32_16x16x32_bf16 v[100:103], a[168:171], a[116:119], v[100:103]
    ds_read_b64_tr_b16 a[150:151], v1 offset:2048
    v_cvt_pk_bf16_f32 v174, v92, v93
    v_mfma_f32_16x16x32_bf16 v[104:107], a[168:171], a[120:123], v[104:107]
    v_cvt_pk_bf16_f32 v175, v94, v95
    v_mfma_f32_16x16x32_bf16 v[108:111], a[168:171], a[124:127], v[108:111]
    s_mov_b32 s69, 47104
    buffer_store_dwordx4 v[172:175], v20, s[28:31], s69 offen
    s_waitcnt lgkmcnt(5)
    v_mfma_f32_16x16x32_bf16 v[124:127], a[172:175], a[124:127], v[124:127]
    ds_read_b64_tr_b16 a[152:153], v0 offset:4096
    v_mfma_f32_16x16x32_bf16 v[120:123], a[172:175], a[120:123], v[120:123]
    ds_read_b64_tr_b16 a[154:155], v0 offset:6144
    v_mfma_f32_16x16x32_bf16 v[116:119], a[172:175], a[116:119], v[116:119]
    v_mfma_f32_16x16x32_bf16 v[112:115], a[172:175], a[112:115], v[112:115]
    s_waitcnt lgkmcnt(4)
    v_mfma_f32_16x16x32_bf16 v[64:67], a[144:147], a[0:3], 0
    ds_read_b64_tr_b16 a[156:157], v1 offset:4096
    v_mfma_f32_16x16x32_bf16 v[68:71], a[144:147], a[4:7], 0
    ds_read_b64_tr_b16 a[158:159], v1 offset:6144
    v_mfma_f32_16x16x32_bf16 v[72:75], a[144:147], a[8:11], 0
    v_mfma_f32_16x16x32_bf16 v[76:79], a[144:147], a[12:15], 0
    v_mul_f32 v96, v32, v96
    v_mul_f32 v97, v32, v97
    s_waitcnt lgkmcnt(4)
    v_mfma_f32_16x16x32_bf16 v[92:95], a[148:151], a[12:15], 0
    ds_read_b64_tr_b16 a[160:161], v0 offset:8192
    v_mul_f32 v98, v32, v98
    v_mfma_f32_16x16x32_bf16 v[88:91], a[148:151], a[8:11], 0
    ds_read_b64_tr_b16 a[162:163], v0 offset:10240
    v_mul_f32 v99, v32, v99
    v_mfma_f32_16x16x32_bf16 v[84:87], a[148:151], a[4:7], 0
    v_cvt_pk_bf16_f32 v176, v96, v97
    v_cvt_pk_bf16_f32 v177, v98, v99
    v_mfma_f32_16x16x32_bf16 v[80:83], a[148:151], a[0:3], 0
    v_mul_f32 v112, v32, v112
    s_waitcnt lgkmcnt(4)
    v_mfma_f32_16x16x32_bf16 v[64:67], a[152:155], a[16:19], v[64:67]
    ds_read_b64_tr_b16 a[164:165], v1 offset:8192
    v_mfma_f32_16x16x32_bf16 v[68:71], a[152:155], a[20:23], v[68:71]
    ds_read_b64_tr_b16 a[166:167], v1 offset:10240
    v_mul_f32 v113, v32, v113
    v_mfma_f32_16x16x32_bf16 v[72:75], a[152:155], a[24:27], v[72:75]
    v_mul_f32 v114, v32, v114
    v_mfma_f32_16x16x32_bf16 v[76:79], a[152:155], a[28:31], v[76:79]
    v_mul_f32 v115, v32, v115
    s_waitcnt lgkmcnt(4)
    v_mfma_f32_16x16x32_bf16 v[92:95], a[156:159], a[28:31], v[92:95]
    ds_read_b64_tr_b16 a[168:169], v0 offset:12288
    v_cvt_pk_bf16_f32 v178, v112, v113
    v_mfma_f32_16x16x32_bf16 v[88:91], a[156:159], a[24:27], v[88:91]
    ds_read_b64_tr_b16 a[170:171], v0 offset:14336
    v_cvt_pk_bf16_f32 v179, v114, v115
    v_mfma_f32_16x16x32_bf16 v[84:87], a[156:159], a[20:23], v[84:87]
    s_mov_b32 s69, 6144
    buffer_store_dwordx4 v[176:179], v20, s[28:31], s69 offen sc1
    v_mfma_f32_16x16x32_bf16 v[80:83], a[156:159], a[16:19], v[80:83]
    s_waitcnt lgkmcnt(4)
    v_mfma_f32_16x16x32_bf16 v[64:67], a[160:163], a[32:35], v[64:67]
    ds_read_b64_tr_b16 a[172:173], v1 offset:12288
    v_mul_f32 v100, v33, v100
    v_mfma_f32_16x16x32_bf16 v[68:71], a[160:163], a[36:39], v[68:71]
    ds_read_b64_tr_b16 a[174:175], v1 offset:14336
    v_mul_f32 v101, v33, v101
    v_mfma_f32_16x16x32_bf16 v[72:75], a[160:163], a[40:43], v[72:75]
    v_mul_f32 v102, v33, v102
    v_mfma_f32_16x16x32_bf16 v[76:79], a[160:163], a[44:47], v[76:79]
    v_mul_f32 v103, v33, v103
    s_waitcnt lgkmcnt(4)
    v_mfma_f32_16x16x32_bf16 v[92:95], a[164:167], a[44:47], v[92:95]
    ds_read_b64_tr_b16 a[144:145], v0 offset:16384
    v_cvt_pk_bf16_f32 v180, v100, v101
    v_mfma_f32_16x16x32_bf16 v[88:91], a[164:167], a[40:43], v[88:91]
    ds_read_b64_tr_b16 a[146:147], v0 offset:18432
    v_cvt_pk_bf16_f32 v181, v102, v103
    v_mfma_f32_16x16x32_bf16 v[84:87], a[164:167], a[36:39], v[84:87]
    v_mul_f32 v116, v33, v116
    v_mfma_f32_16x16x32_bf16 v[80:83], a[164:167], a[32:35], v[80:83]
    s_waitcnt lgkmcnt(4)
    v_mfma_f32_16x16x32_bf16 v[64:67], a[168:171], a[48:51], v[64:67]
    ds_read_b64_tr_b16 a[148:149], v1 offset:16384
    v_mul_f32 v117, v33, v117
    v_mfma_f32_16x16x32_bf16 v[68:71], a[168:171], a[52:55], v[68:71]
    ds_read_b64_tr_b16 a[150:151], v1 offset:18432
    v_mul_f32 v118, v33, v118
    v_mfma_f32_16x16x32_bf16 v[72:75], a[168:171], a[56:59], v[72:75]
    v_mul_f32 v119, v33, v119
    v_mfma_f32_16x16x32_bf16 v[76:79], a[168:171], a[60:63], v[76:79]
    v_cvt_pk_bf16_f32 v182, v116, v117
    s_waitcnt lgkmcnt(4)
    v_mfma_f32_16x16x32_bf16 v[92:95], a[172:175], a[60:63], v[92:95]
    ds_read_b64_tr_b16 a[152:153], v0 offset:20480
    v_cvt_pk_bf16_f32 v183, v118, v119
    v_mfma_f32_16x16x32_bf16 v[88:91], a[172:175], a[56:59], v[88:91]
    ds_read_b64_tr_b16 a[154:155], v0 offset:22528
    v_mfma_f32_16x16x32_bf16 v[84:87], a[172:175], a[52:55], v[84:87]
    s_mov_b32 s69, 20480
    buffer_store_dwordx4 v[180:183], v20, s[28:31], s69 offen
    v_mfma_f32_16x16x32_bf16 v[80:83], a[172:175], a[48:51], v[80:83]
    v_mul_f32 v104, v34, v104
    s_waitcnt lgkmcnt(4)
    v_mfma_f32_16x16x32_bf16 v[64:67], a[144:147], a[64:67], v[64:67]
    s_barrier
    ds_read_b64_tr_b16 a[156:157], v1 offset:20480
    v_mul_f32 v105, v34, v105
    v_mfma_f32_16x16x32_bf16 v[68:71], a[144:147], a[68:71], v[68:71]
    ds_read_b64_tr_b16 a[158:159], v1 offset:22528
    v_mul_f32 v106, v34, v106
    v_mfma_f32_16x16x32_bf16 v[72:75], a[144:147], a[72:75], v[72:75]
    v_mul_f32 v107, v34, v107
    v_mfma_f32_16x16x32_bf16 v[76:79], a[144:147], a[76:79], v[76:79]
    v_cvt_pk_bf16_f32 v184, v104, v105
    s_waitcnt lgkmcnt(4)
    v_mfma_f32_16x16x32_bf16 v[92:95], a[148:151], a[76:79], v[92:95]
    ds_read_b64_tr_b16 a[160:161], v0 offset:24576
    v_cvt_pk_bf16_f32 v185, v106, v107
    v_mfma_f32_16x16x32_bf16 v[88:91], a[148:151], a[72:75], v[88:91]
    ds_read_b64_tr_b16 a[162:163], v0 offset:26624
    v_mfma_f32_16x16x32_bf16 v[84:87], a[148:151], a[68:71], v[84:87]
    v_mul_f32 v120, v34, v120
    v_mfma_f32_16x16x32_bf16 v[80:83], a[148:151], a[64:67], v[80:83]
    v_mul_f32 v121, v34, v121
    s_waitcnt lgkmcnt(4)
    v_mfma_f32_16x16x32_bf16 v[64:67], a[152:155], a[80:83], v[64:67]
    ds_read_b64_tr_b16 a[164:165], v1 offset:24576
    v_mul_f32 v122, v34, v122
    v_mfma_f32_16x16x32_bf16 v[68:71], a[152:155], a[84:87], v[68:71]
    ds_read_b64_tr_b16 a[166:167], v1 offset:26624
    v_mul_f32 v123, v34, v123
    v_mfma_f32_16x16x32_bf16 v[72:75], a[152:155], a[88:91], v[72:75]
    v_cvt_pk_bf16_f32 v186, v120, v121
    v_mfma_f32_16x16x32_bf16 v[76:79], a[152:155], a[92:95], v[76:79]
    v_cvt_pk_bf16_f32 v187, v122, v123
    s_waitcnt lgkmcnt(4)
    v_mfma_f32_16x16x32_bf16 v[92:95], a[156:159], a[92:95], v[92:95]
    ds_read_b64_tr_b16 a[168:169], v0 offset:28672
    v_mfma_f32_16x16x32_bf16 v[88:91], a[156:159], a[88:91], v[88:91]
    ds_read_b64_tr_b16 a[170:171], v0 offset:30720
    v_mfma_f32_16x16x32_bf16 v[84:87], a[156:159], a[84:87], v[84:87]
    s_mov_b32 s69, 34816
    buffer_store_dwordx4 v[184:187], v20, s[28:31], s69 offen
    v_mfma_f32_16x16x32_bf16 v[80:83], a[156:159], a[80:83], v[80:83]
    v_mul_f32 v108, v35, v108
    v_mul_f32 v109, v35, v109
    s_waitcnt lgkmcnt(4)
    v_mfma_f32_16x16x32_bf16 v[64:67], a[160:163], a[96:99], v[64:67]
    ds_read_b64_tr_b16 a[172:173], v1 offset:28672
    v_mul_f32 v110, v35, v110
    v_mfma_f32_16x16x32_bf16 v[68:71], a[160:163], a[100:103], v[68:71]
    ds_read_b64_tr_b16 a[174:175], v1 offset:30720
    v_mul_f32 v111, v35, v111
    v_mfma_f32_16x16x32_bf16 v[72:75], a[160:163], a[104:107], v[72:75]
    v_cvt_pk_bf16_f32 v188, v108, v109
    v_mfma_f32_16x16x32_bf16 v[76:79], a[160:163], a[108:111], v[76:79]
    v_cvt_pk_bf16_f32 v189, v110, v111
    s_waitcnt lgkmcnt(4)
    v_mfma_f32_16x16x32_bf16 v[92:95], a[164:167], a[108:111], v[92:95]
    ds_read_b64_tr_b16 a[144:145], v0 offset:32768
    v_mfma_f32_16x16x32_bf16 v[88:91], a[164:167], a[104:107], v[88:91]
    ds_read_b64_tr_b16 a[146:147], v0 offset:34816
    v_mul_f32 v124, v35, v124
    v_mfma_f32_16x16x32_bf16 v[84:87], a[164:167], a[100:103], v[84:87]
    v_mul_f32 v125, v35, v125
    v_mfma_f32_16x16x32_bf16 v[80:83], a[164:167], a[96:99], v[80:83]
    v_mul_f32 v126, v35, v126
    s_waitcnt lgkmcnt(4)
    v_mfma_f32_16x16x32_bf16 v[64:67], a[168:171], a[112:115], v[64:67]
    ds_read_b64_tr_b16 a[148:149], v1 offset:32768
    v_mul_f32 v127, v35, v127
    v_mfma_f32_16x16x32_bf16 v[68:71], a[168:171], a[116:119], v[68:71]
    ds_read_b64_tr_b16 a[150:151], v1 offset:34816
    v_cvt_pk_bf16_f32 v190, v124, v125
    v_mfma_f32_16x16x32_bf16 v[72:75], a[168:171], a[120:123], v[72:75]
    v_cvt_pk_bf16_f32 v191, v126, v127
    v_mfma_f32_16x16x32_bf16 v[76:79], a[168:171], a[124:127], v[76:79]
    s_mov_b32 s69, 49152
    buffer_store_dwordx4 v[188:191], v20, s[28:31], s69 offen
    s_waitcnt lgkmcnt(4)
    v_mfma_f32_16x16x32_bf16 v[92:95], a[172:175], a[124:127], v[92:95]
    ds_read_b64_tr_b16 a[152:153], v0 offset:36864
    v_mfma_f32_16x16x32_bf16 v[88:91], a[172:175], a[120:123], v[88:91]
    ds_read_b64_tr_b16 a[154:155], v0 offset:38912
    v_mfma_f32_16x16x32_bf16 v[84:87], a[172:175], a[116:119], v[84:87]
    v_mfma_f32_16x16x32_bf16 v[80:83], a[172:175], a[112:115], v[80:83]
    s_waitcnt lgkmcnt(4)
    v_mfma_f32_16x16x32_bf16 v[96:99], a[144:147], a[0:3], 0
    ds_read_b64_tr_b16 a[156:157], v1 offset:36864
    v_mfma_f32_16x16x32_bf16 v[100:103], a[144:147], a[4:7], 0
    ds_read_b64_tr_b16 a[158:159], v1 offset:38912
    v_mfma_f32_16x16x32_bf16 v[104:107], a[144:147], a[8:11], 0
    v_mfma_f32_16x16x32_bf16 v[108:111], a[144:147], a[12:15], 0
    v_mul_f32 v64, v32, v64
    v_mul_f32 v65, v32, v65
    s_waitcnt lgkmcnt(4)
    v_mfma_f32_16x16x32_bf16 v[124:127], a[148:151], a[12:15], 0
    ds_read_b64_tr_b16 a[160:161], v0 offset:40960
    v_mul_f32 v66, v32, v66
    v_mfma_f32_16x16x32_bf16 v[120:123], a[148:151], a[8:11], 0
    ds_read_b64_tr_b16 a[162:163], v0 offset:43008
    v_mul_f32 v67, v32, v67
    v_mfma_f32_16x16x32_bf16 v[116:119], a[148:151], a[4:7], 0
    v_cvt_pk_bf16_f32 v192, v64, v65
    v_cvt_pk_bf16_f32 v193, v66, v67
    v_mfma_f32_16x16x32_bf16 v[112:115], a[148:151], a[0:3], 0
    v_mul_f32 v80, v32, v80
    s_waitcnt lgkmcnt(4)
    v_mfma_f32_16x16x32_bf16 v[96:99], a[152:155], a[16:19], v[96:99]
    ds_read_b64_tr_b16 a[164:165], v1 offset:40960
    v_mfma_f32_16x16x32_bf16 v[100:103], a[152:155], a[20:23], v[100:103]
    ds_read_b64_tr_b16 a[166:167], v1 offset:43008
    v_mul_f32 v81, v32, v81
    v_mfma_f32_16x16x32_bf16 v[104:107], a[152:155], a[24:27], v[104:107]
    v_mul_f32 v82, v32, v82
    v_mfma_f32_16x16x32_bf16 v[108:111], a[152:155], a[28:31], v[108:111]
    v_mul_f32 v83, v32, v83
    s_waitcnt lgkmcnt(4)
    v_mfma_f32_16x16x32_bf16 v[124:127], a[156:159], a[28:31], v[124:127]
    ds_read_b64_tr_b16 a[168:169], v0 offset:45056
    v_cvt_pk_bf16_f32 v194, v80, v81
    v_mfma_f32_16x16x32_bf16 v[120:123], a[156:159], a[24:27], v[120:123]
    ds_read_b64_tr_b16 a[170:171], v0 offset:47104
    v_cvt_pk_bf16_f32 v195, v82, v83
    v_mfma_f32_16x16x32_bf16 v[116:119], a[156:159], a[20:23], v[116:119]
    s_mov_b32 s69, 8192
    buffer_store_dwordx4 v[192:195], v20, s[28:31], s69 offen sc1
    v_mfma_f32_16x16x32_bf16 v[112:115], a[156:159], a[16:19], v[112:115]
    s_waitcnt lgkmcnt(4)
    v_mfma_f32_16x16x32_bf16 v[96:99], a[160:163], a[32:35], v[96:99]
    ds_read_b64_tr_b16 a[172:173], v1 offset:45056
    v_mul_f32 v68, v33, v68
    v_mfma_f32_16x16x32_bf16 v[100:103], a[160:163], a[36:39], v[100:103]
    ds_read_b64_tr_b16 a[174:175], v1 offset:47104
    v_mul_f32 v69, v33, v69
    v_mfma_f32_16x16x32_bf16 v[104:107], a[160:163], a[40:43], v[104:107]
    v_mul_f32 v70, v33, v70
    v_mfma_f32_16x16x32_bf16 v[108:111], a[160:163], a[44:47], v[108:111]
    v_mul_f32 v71, v33, v71
    s_waitcnt lgkmcnt(4)
    v_mfma_f32_16x16x32_bf16 v[124:127], a[164:167], a[44:47], v[124:127]
    ds_read_b64_tr_b16 a[144:145], v0 offset:49152
    v_cvt_pk_bf16_f32 v196, v68, v69
    v_mfma_f32_16x16x32_bf16 v[120:123], a[164:167], a[40:43], v[120:123]
    ds_read_b64_tr_b16 a[146:147], v0 offset:51200
    v_cvt_pk_bf16_f32 v197, v70, v71
    v_mfma_f32_16x16x32_bf16 v[116:119], a[164:167], a[36:39], v[116:119]
    v_mul_f32 v84, v33, v84
    v_mfma_f32_16x16x32_bf16 v[112:115], a[164:167], a[32:35], v[112:115]
    s_waitcnt lgkmcnt(4)
    v_mfma_f32_16x16x32_bf16 v[96:99], a[168:171], a[48:51], v[96:99]
    ds_read_b64_tr_b16 a[148:149], v1 offset:49152
    v_mul_f32 v85, v33, v85
    v_mfma_f32_16x16x32_bf16 v[100:103], a[168:171], a[52:55], v[100:103]
    ds_read_b64_tr_b16 a[150:151], v1 offset:51200
    v_mul_f32 v86, v33, v86
    v_mfma_f32_16x16x32_bf16 v[104:107], a[168:171], a[56:59], v[104:107]
    v_mul_f32 v87, v33, v87
    v_mfma_f32_16x16x32_bf16 v[108:111], a[168:171], a[60:63], v[108:111]
    v_cvt_pk_bf16_f32 v198, v84, v85
    s_waitcnt lgkmcnt(4)
    v_mfma_f32_16x16x32_bf16 v[124:127], a[172:175], a[60:63], v[124:127]
    ds_read_b64_tr_b16 a[152:153], v0 offset:53248
    v_cvt_pk_bf16_f32 v199, v86, v87
    v_mfma_f32_16x16x32_bf16 v[120:123], a[172:175], a[56:59], v[120:123]
    ds_read_b64_tr_b16 a[154:155], v0 offset:55296
    v_mfma_f32_16x16x32_bf16 v[116:119], a[172:175], a[52:55], v[116:119]
    s_mov_b32 s69, 22528
    buffer_store_dwordx4 v[196:199], v20, s[28:31], s69 offen
    v_mfma_f32_16x16x32_bf16 v[112:115], a[172:175], a[48:51], v[112:115]
    v_mul_f32 v72, v34, v72
    s_waitcnt lgkmcnt(4)
    v_mfma_f32_16x16x32_bf16 v[96:99], a[144:147], a[64:67], v[96:99]
    s_barrier
    ds_read_b64_tr_b16 a[156:157], v1 offset:53248
    v_mul_f32 v73, v34, v73
    v_mfma_f32_16x16x32_bf16 v[100:103], a[144:147], a[68:71], v[100:103]
    ds_read_b64_tr_b16 a[158:159], v1 offset:55296
    v_mul_f32 v74, v34, v74
    v_mfma_f32_16x16x32_bf16 v[104:107], a[144:147], a[72:75], v[104:107]
    v_mul_f32 v75, v34, v75
    v_mfma_f32_16x16x32_bf16 v[108:111], a[144:147], a[76:79], v[108:111]
    v_cvt_pk_bf16_f32 v200, v72, v73
    s_waitcnt lgkmcnt(4)
    v_mfma_f32_16x16x32_bf16 v[124:127], a[148:151], a[76:79], v[124:127]
    ds_read_b64_tr_b16 a[160:161], v0 offset:57344
    v_cvt_pk_bf16_f32 v201, v74, v75
    v_mfma_f32_16x16x32_bf16 v[120:123], a[148:151], a[72:75], v[120:123]
    ds_read_b64_tr_b16 a[162:163], v0 offset:59392
    v_mfma_f32_16x16x32_bf16 v[116:119], a[148:151], a[68:71], v[116:119]
    v_mul_f32 v88, v34, v88
    v_mfma_f32_16x16x32_bf16 v[112:115], a[148:151], a[64:67], v[112:115]
    v_mul_f32 v89, v34, v89
    s_waitcnt lgkmcnt(4)
    v_mfma_f32_16x16x32_bf16 v[96:99], a[152:155], a[80:83], v[96:99]
    ds_read_b64_tr_b16 a[164:165], v1 offset:57344
    v_mul_f32 v90, v34, v90
    v_mfma_f32_16x16x32_bf16 v[100:103], a[152:155], a[84:87], v[100:103]
    ds_read_b64_tr_b16 a[166:167], v1 offset:59392
    v_mul_f32 v91, v34, v91
    v_mfma_f32_16x16x32_bf16 v[104:107], a[152:155], a[88:91], v[104:107]
    v_cvt_pk_bf16_f32 v202, v88, v89
    v_mfma_f32_16x16x32_bf16 v[108:111], a[152:155], a[92:95], v[108:111]
    v_cvt_pk_bf16_f32 v203, v90, v91
    s_waitcnt lgkmcnt(4)
    v_mfma_f32_16x16x32_bf16 v[124:127], a[156:159], a[92:95], v[124:127]
    ds_read_b64_tr_b16 a[168:169], v0 offset:61440
    v_mfma_f32_16x16x32_bf16 v[120:123], a[156:159], a[88:91], v[120:123]
    ds_read_b64_tr_b16 a[170:171], v0 offset:63488
    v_mfma_f32_16x16x32_bf16 v[116:119], a[156:159], a[84:87], v[116:119]
    s_mov_b32 s69, 36864
    buffer_store_dwordx4 v[200:203], v20, s[28:31], s69 offen
    v_mfma_f32_16x16x32_bf16 v[112:115], a[156:159], a[80:83], v[112:115]
    v_mul_f32 v76, v35, v76
    v_mul_f32 v77, v35, v77
    s_waitcnt lgkmcnt(4)
    v_mfma_f32_16x16x32_bf16 v[96:99], a[160:163], a[96:99], v[96:99]
    ds_read_b64_tr_b16 a[172:173], v1 offset:61440
    v_mul_f32 v78, v35, v78
    v_mfma_f32_16x16x32_bf16 v[100:103], a[160:163], a[100:103], v[100:103]
    ds_read_b64_tr_b16 a[174:175], v1 offset:63488
    v_mul_f32 v79, v35, v79
    v_mfma_f32_16x16x32_bf16 v[104:107], a[160:163], a[104:107], v[104:107]
    v_cvt_pk_bf16_f32 v204, v76, v77
    v_mfma_f32_16x16x32_bf16 v[108:111], a[160:163], a[108:111], v[108:111]
    v_cvt_pk_bf16_f32 v205, v78, v79
    s_waitcnt lgkmcnt(4)
    v_mfma_f32_16x16x32_bf16 v[124:127], a[164:167], a[108:111], v[124:127]
    ds_read_b64_tr_b16 a[144:145], v2 offset:0
    v_mfma_f32_16x16x32_bf16 v[120:123], a[164:167], a[104:107], v[120:123]
    ds_read_b64_tr_b16 a[146:147], v2 offset:2048
    v_mul_f32 v92, v35, v92
    v_mfma_f32_16x16x32_bf16 v[116:119], a[164:167], a[100:103], v[116:119]
    v_mul_f32 v93, v35, v93
    v_mfma_f32_16x16x32_bf16 v[112:115], a[164:167], a[96:99], v[112:115]
    v_mul_f32 v94, v35, v94
    s_waitcnt lgkmcnt(4)
    v_mfma_f32_16x16x32_bf16 v[96:99], a[168:171], a[112:115], v[96:99]
    ds_read_b64_tr_b16 a[148:149], v3 offset:0
    v_mul_f32 v95, v35, v95
    v_mfma_f32_16x16x32_bf16 v[100:103], a[168:171], a[116:119], v[100:103]
    ds_read_b64_tr_b16 a[150:151], v3 offset:2048
    v_cvt_pk_bf16_f32 v206, v92, v93
    v_mfma_f32_16x16x32_bf16 v[104:107], a[168:171], a[120:123], v[104:107]
    v_cvt_pk_bf16_f32 v207, v94, v95
    v_mfma_f32_16x16x32_bf16 v[108:111], a[168:171], a[124:127], v[108:111]
    s_mov_b32 s69, 51200
    buffer_store_dwordx4 v[204:207], v20, s[28:31], s69 offen
    s_waitcnt lgkmcnt(4)
    v_mfma_f32_16x16x32_bf16 v[124:127], a[172:175], a[124:127], v[124:127]
    ds_read_b64_tr_b16 a[152:153], v2 offset:4096
    v_mfma_f32_16x16x32_bf16 v[120:123], a[172:175], a[120:123], v[120:123]
    ds_read_b64_tr_b16 a[154:155], v2 offset:6144
    v_mfma_f32_16x16x32_bf16 v[116:119], a[172:175], a[116:119], v[116:119]
    v_mfma_f32_16x16x32_bf16 v[112:115], a[172:175], a[112:115], v[112:115]
    s_waitcnt lgkmcnt(4)
    v_mfma_f32_16x16x32_bf16 v[64:67], a[144:147], a[0:3], 0
    ds_read_b64_tr_b16 a[156:157], v3 offset:4096
    v_mfma_f32_16x16x32_bf16 v[68:71], a[144:147], a[4:7], 0
    ds_read_b64_tr_b16 a[158:159], v3 offset:6144
    v_mfma_f32_16x16x32_bf16 v[72:75], a[144:147], a[8:11], 0
    v_mfma_f32_16x16x32_bf16 v[76:79], a[144:147], a[12:15], 0
    v_mul_f32 v96, v32, v96
    v_mul_f32 v97, v32, v97
    s_waitcnt lgkmcnt(4)
    v_mfma_f32_16x16x32_bf16 v[92:95], a[148:151], a[12:15], 0
    ds_read_b64_tr_b16 a[160:161], v2 offset:8192
    v_mul_f32 v98, v32, v98
    v_mfma_f32_16x16x32_bf16 v[88:91], a[148:151], a[8:11], 0
    ds_read_b64_tr_b16 a[162:163], v2 offset:10240
    v_mul_f32 v99, v32, v99
    v_mfma_f32_16x16x32_bf16 v[84:87], a[148:151], a[4:7], 0
    v_cvt_pk_bf16_f32 v208, v96, v97
    v_cvt_pk_bf16_f32 v209, v98, v99
    v_mfma_f32_16x16x32_bf16 v[80:83], a[148:151], a[0:3], 0
    v_mul_f32 v112, v32, v112
    s_waitcnt lgkmcnt(4)
    v_mfma_f32_16x16x32_bf16 v[64:67], a[152:155], a[16:19], v[64:67]
    ds_read_b64_tr_b16 a[164:165], v3 offset:8192
    v_mfma_f32_16x16x32_bf16 v[68:71], a[152:155], a[20:23], v[68:71]
    ds_read_b64_tr_b16 a[166:167], v3 offset:10240
    v_mul_f32 v113, v32, v113
    v_mfma_f32_16x16x32_bf16 v[72:75], a[152:155], a[24:27], v[72:75]
    v_mul_f32 v114, v32, v114
    v_mfma_f32_16x16x32_bf16 v[76:79], a[152:155], a[28:31], v[76:79]
    v_mul_f32 v115, v32, v115
    s_waitcnt lgkmcnt(4)
    v_mfma_f32_16x16x32_bf16 v[92:95], a[156:159], a[28:31], v[92:95]
    ds_read_b64_tr_b16 a[168:169], v2 offset:12288
    v_cvt_pk_bf16_f32 v210, v112, v113
    v_mfma_f32_16x16x32_bf16 v[88:91], a[156:159], a[24:27], v[88:91]
    ds_read_b64_tr_b16 a[170:171], v2 offset:14336
    v_cvt_pk_bf16_f32 v211, v114, v115
    v_mfma_f32_16x16x32_bf16 v[84:87], a[156:159], a[20:23], v[84:87]
    s_mov_b32 s69, 10240
    buffer_store_dwordx4 v[208:211], v20, s[28:31], s69 offen sc1
    v_mfma_f32_16x16x32_bf16 v[80:83], a[156:159], a[16:19], v[80:83]
    s_waitcnt lgkmcnt(4)
    v_mfma_f32_16x16x32_bf16 v[64:67], a[160:163], a[32:35], v[64:67]
    ds_read_b64_tr_b16 a[172:173], v3 offset:12288
    v_mul_f32 v100, v33, v100
    v_mfma_f32_16x16x32_bf16 v[68:71], a[160:163], a[36:39], v[68:71]
    ds_read_b64_tr_b16 a[174:175], v3 offset:14336
    v_mul_f32 v101, v33, v101
    v_mfma_f32_16x16x32_bf16 v[72:75], a[160:163], a[40:43], v[72:75]
    v_mul_f32 v102, v33, v102
    v_mfma_f32_16x16x32_bf16 v[76:79], a[160:163], a[44:47], v[76:79]
    v_mul_f32 v103, v33, v103
    s_waitcnt lgkmcnt(4)
    v_mfma_f32_16x16x32_bf16 v[92:95], a[164:167], a[44:47], v[92:95]
    ds_read_b64_tr_b16 a[144:145], v2 offset:16384
    v_cvt_pk_bf16_f32 v212, v100, v101
    v_mfma_f32_16x16x32_bf16 v[88:91], a[164:167], a[40:43], v[88:91]
    ds_read_b64_tr_b16 a[146:147], v2 offset:18432
    v_cvt_pk_bf16_f32 v213, v102, v103
    v_mfma_f32_16x16x32_bf16 v[84:87], a[164:167], a[36:39], v[84:87]
    v_mul_f32 v116, v33, v116
    v_mfma_f32_16x16x32_bf16 v[80:83], a[164:167], a[32:35], v[80:83]
    s_waitcnt lgkmcnt(4)
    v_mfma_f32_16x16x32_bf16 v[64:67], a[168:171], a[48:51], v[64:67]
    ds_read_b64_tr_b16 a[148:149], v3 offset:16384
    v_mul_f32 v117, v33, v117
    v_mfma_f32_16x16x32_bf16 v[68:71], a[168:171], a[52:55], v[68:71]
    ds_read_b64_tr_b16 a[150:151], v3 offset:18432
    v_mul_f32 v118, v33, v118
    v_mfma_f32_16x16x32_bf16 v[72:75], a[168:171], a[56:59], v[72:75]
    v_mul_f32 v119, v33, v119
    v_mfma_f32_16x16x32_bf16 v[76:79], a[168:171], a[60:63], v[76:79]
    v_cvt_pk_bf16_f32 v214, v116, v117
    s_waitcnt lgkmcnt(4)
    v_mfma_f32_16x16x32_bf16 v[92:95], a[172:175], a[60:63], v[92:95]
    ds_read_b64_tr_b16 a[152:153], v2 offset:20480
    v_cvt_pk_bf16_f32 v215, v118, v119
    v_mfma_f32_16x16x32_bf16 v[88:91], a[172:175], a[56:59], v[88:91]
    ds_read_b64_tr_b16 a[154:155], v2 offset:22528
    v_mfma_f32_16x16x32_bf16 v[84:87], a[172:175], a[52:55], v[84:87]
    s_mov_b32 s69, 24576
    buffer_store_dwordx4 v[212:215], v20, s[28:31], s69 offen
    v_mfma_f32_16x16x32_bf16 v[80:83], a[172:175], a[48:51], v[80:83]
    v_mul_f32 v104, v34, v104
    s_waitcnt lgkmcnt(4)
    v_mfma_f32_16x16x32_bf16 v[64:67], a[144:147], a[64:67], v[64:67]
    ds_read_b64_tr_b16 a[156:157], v3 offset:20480
    v_mul_f32 v105, v34, v105
    v_mfma_f32_16x16x32_bf16 v[68:71], a[144:147], a[68:71], v[68:71]
    ds_read_b64_tr_b16 a[158:159], v3 offset:22528
    v_mul_f32 v106, v34, v106
    v_mfma_f32_16x16x32_bf16 v[72:75], a[144:147], a[72:75], v[72:75]
    v_mul_f32 v107, v34, v107
    v_mfma_f32_16x16x32_bf16 v[76:79], a[144:147], a[76:79], v[76:79]
    v_cvt_pk_bf16_f32 v216, v104, v105
    s_waitcnt lgkmcnt(4)
    v_mfma_f32_16x16x32_bf16 v[92:95], a[148:151], a[76:79], v[92:95]
    ds_read_b64_tr_b16 a[160:161], v2 offset:24576
    v_cvt_pk_bf16_f32 v217, v106, v107
    v_mfma_f32_16x16x32_bf16 v[88:91], a[148:151], a[72:75], v[88:91]
    ds_read_b64_tr_b16 a[162:163], v2 offset:26624
    v_mfma_f32_16x16x32_bf16 v[84:87], a[148:151], a[68:71], v[84:87]
    v_mul_f32 v120, v34, v120
    v_mfma_f32_16x16x32_bf16 v[80:83], a[148:151], a[64:67], v[80:83]
    v_mul_f32 v121, v34, v121
    s_waitcnt lgkmcnt(4)
    v_mfma_f32_16x16x32_bf16 v[64:67], a[152:155], a[80:83], v[64:67]
    ds_read_b64_tr_b16 a[164:165], v3 offset:24576
    v_mul_f32 v122, v34, v122
    v_mfma_f32_16x16x32_bf16 v[68:71], a[152:155], a[84:87], v[68:71]
    ds_read_b64_tr_b16 a[166:167], v3 offset:26624
    v_mul_f32 v123, v34, v123
    v_mfma_f32_16x16x32_bf16 v[72:75], a[152:155], a[88:91], v[72:75]
    v_cvt_pk_bf16_f32 v218, v120, v121
    v_mfma_f32_16x16x32_bf16 v[76:79], a[152:155], a[92:95], v[76:79]
    v_cvt_pk_bf16_f32 v219, v122, v123
    s_waitcnt lgkmcnt(4)
    v_mfma_f32_16x16x32_bf16 v[92:95], a[156:159], a[92:95], v[92:95]
    ds_read_b64_tr_b16 a[168:169], v2 offset:28672
    v_mfma_f32_16x16x32_bf16 v[88:91], a[156:159], a[88:91], v[88:91]
    ds_read_b64_tr_b16 a[170:171], v2 offset:30720
    v_mfma_f32_16x16x32_bf16 v[84:87], a[156:159], a[84:87], v[84:87]
    s_mov_b32 s69, 38912
    buffer_store_dwordx4 v[216:219], v20, s[28:31], s69 offen
    v_mfma_f32_16x16x32_bf16 v[80:83], a[156:159], a[80:83], v[80:83]
    v_mul_f32 v108, v35, v108
    v_mul_f32 v109, v35, v109
    s_waitcnt lgkmcnt(4)
    v_mfma_f32_16x16x32_bf16 v[64:67], a[160:163], a[96:99], v[64:67]
    ds_read_b64_tr_b16 a[172:173], v3 offset:28672
    v_mul_f32 v110, v35, v110
    v_mfma_f32_16x16x32_bf16 v[68:71], a[160:163], a[100:103], v[68:71]
    ds_read_b64_tr_b16 a[174:175], v3 offset:30720
    v_mul_f32 v111, v35, v111
    v_mfma_f32_16x16x32_bf16 v[72:75], a[160:163], a[104:107], v[72:75]
    v_cvt_pk_bf16_f32 v220, v108, v109
    v_mfma_f32_16x16x32_bf16 v[76:79], a[160:163], a[108:111], v[76:79]
    v_cvt_pk_bf16_f32 v221, v110, v111
    s_waitcnt lgkmcnt(4)
    v_mfma_f32_16x16x32_bf16 v[92:95], a[164:167], a[108:111], v[92:95]
    v_mfma_f32_16x16x32_bf16 v[88:91], a[164:167], a[104:107], v[88:91]
    v_mul_f32 v124, v35, v124
    v_mfma_f32_16x16x32_bf16 v[84:87], a[164:167], a[100:103], v[84:87]
    v_mul_f32 v125, v35, v125
    v_mfma_f32_16x16x32_bf16 v[80:83], a[164:167], a[96:99], v[80:83]
    v_mul_f32 v126, v35, v126
    s_waitcnt lgkmcnt(2)
    v_mfma_f32_16x16x32_bf16 v[64:67], a[168:171], a[112:115], v[64:67]
    v_mul_f32 v127, v35, v127
    v_mfma_f32_16x16x32_bf16 v[68:71], a[168:171], a[116:119], v[68:71]
    v_cvt_pk_bf16_f32 v222, v124, v125
    v_mfma_f32_16x16x32_bf16 v[72:75], a[168:171], a[120:123], v[72:75]
    v_cvt_pk_bf16_f32 v223, v126, v127
    v_mfma_f32_16x16x32_bf16 v[76:79], a[168:171], a[124:127], v[76:79]
    s_mov_b32 s69, 53248
    buffer_store_dwordx4 v[220:223], v20, s[28:31], s69 offen
    s_waitcnt lgkmcnt(0)
    v_mfma_f32_16x16x32_bf16 v[92:95], a[172:175], a[124:127], v[92:95]
    v_mfma_f32_16x16x32_bf16 v[88:91], a[172:175], a[120:123], v[88:91]
    v_mfma_f32_16x16x32_bf16 v[84:87], a[172:175], a[116:119], v[84:87]
    v_mfma_f32_16x16x32_bf16 v[80:83], a[172:175], a[112:115], v[80:83]
    v_mul_f32 v64, v32, v64
    v_mul_f32 v65, v32, v65
    v_mul_f32 v66, v32, v66
    v_mul_f32 v67, v32, v67
    v_cvt_pk_bf16_f32 v224, v64, v65
    v_cvt_pk_bf16_f32 v225, v66, v67
    s_nop 1
    v_mul_f32 v80, v32, v80
    v_mul_f32 v81, v32, v81
    v_mul_f32 v82, v32, v82
    v_mul_f32 v83, v32, v83
    v_cvt_pk_bf16_f32 v226, v80, v81
    v_cvt_pk_bf16_f32 v227, v82, v83
    s_mov_b32 s69, 12288
    buffer_store_dwordx4 v[224:227], v20, s[28:31], s69 offen sc1
    v_mul_f32 v68, v33, v68
    v_mul_f32 v69, v33, v69
    v_mul_f32 v70, v33, v70
    v_mul_f32 v71, v33, v71
    v_cvt_pk_bf16_f32 v228, v68, v69
    v_cvt_pk_bf16_f32 v229, v70, v71
    v_mul_f32 v84, v33, v84
    v_mul_f32 v85, v33, v85
    v_mul_f32 v86, v33, v86
    v_mul_f32 v87, v33, v87
    v_cvt_pk_bf16_f32 v230, v84, v85
    v_cvt_pk_bf16_f32 v231, v86, v87
    s_mov_b32 s69, 26624
    buffer_store_dwordx4 v[228:231], v20, s[28:31], s69 offen
    v_mul_f32 v72, v34, v72
    v_mul_f32 v73, v34, v73
    v_mul_f32 v74, v34, v74
    v_mul_f32 v75, v34, v75
    v_cvt_pk_bf16_f32 v232, v72, v73
    v_cvt_pk_bf16_f32 v233, v74, v75
    v_mul_f32 v88, v34, v88
    v_mul_f32 v89, v34, v89
    v_mul_f32 v90, v34, v90
    v_mul_f32 v91, v34, v91
    v_cvt_pk_bf16_f32 v234, v88, v89
    v_cvt_pk_bf16_f32 v235, v90, v91
    s_mov_b32 s69, 40960
    buffer_store_dwordx4 v[232:235], v20, s[28:31], s69 offen
    v_mul_f32 v76, v35, v76
    v_mul_f32 v77, v35, v77
    v_mul_f32 v78, v35, v78
    v_mul_f32 v79, v35, v79
    v_cvt_pk_bf16_f32 v236, v76, v77
    v_cvt_pk_bf16_f32 v237, v78, v79
    v_mul_f32 v92, v35, v92
    v_mul_f32 v93, v35, v93
    v_mul_f32 v94, v35, v94
    v_mul_f32 v95, v35, v95
    v_cvt_pk_bf16_f32 v238, v92, v93
    v_cvt_pk_bf16_f32 v239, v94, v95
    s_mov_b32 s69, 55296
    buffer_store_dwordx4 v[236:239], v20, s[28:31], s69 offen
    s_waitcnt vmcnt(0)
    s_branch L_fin
L_flag_p4_t0:
    s_mov_b64 exec, vcc
    ds_write_b32 v31, v28
    s_mov_b64 exec, -1
    s_waitcnt lgkmcnt(0)
    s_branch L_flagback_p4_t0
L_rare_p4_t0:
    s_call_b64 s[70:71], L_rescale1_p4
    s_branch L_rareback_p4_t0
L_flag_p4_l1:
    s_mov_b64 exec, vcc
    ds_write_b32 v31, v28
    s_mov_b64 exec, -1
    s_waitcnt lgkmcnt(0)
    s_branch L_flagback_p4_l1
L_rare_p4_l1:
    s_call_b64 s[70:71], L_rescale0_p4
    s_branch L_rareback_p4_l1
L_flag_p4_l0:
    s_mov_b64 exec, vcc
    ds_write_b32 v31, v28
    s_mov_b64 exec, -1
    s_waitcnt lgkmcnt(0)
    s_branch L_flagback_p4_l0
L_rare_p4_l0:
    s_call_b64 s[70:71], L_rescale1_p4
    s_branch L_rareback_p4_l0
L_flag_p4_t29:
    s_mov_b64 exec, vcc
    ds_write_b32 v31, v28
    s_mov_b64 exec, -1
    s_waitcnt lgkmcnt(0)
    s_branch L_flagback_p4_t29
L_rare_p4_t29:
    s_call_b64 s[70:71], L_rescale0_p4
    s_branch L_rareback_p4_t29
L_flag_p4_t30:
    s_mov_b64 exec, vcc
    ds_write_b32 v31, v28
    s_mov_b64 exec, -1
    s_waitcnt lgkmcnt(0)
    s_branch L_flagback_p4_t30
L_rare_p4_t30:
    s_call_b64 s[70:71], L_rescale1_p4
    s_branch L_rareback_p4_t30
L_rescale0_p4:
    s_nop 7
    s_waitcnt lgkmcnt(0)
    s_barrier
    v_max3_f32 v48, v64, v65, v66
    v_max3_f32 v49, v72, v73, v74
    v_max3_f32 v50, v80, v81, v82
    v_max3_f32 v51, v88, v89, v90
    v_max3_f32 v48, v48, v67, v68
    v_max3_f32 v49, v49, v75, v76
    v_max3_f32 v50, v50, v83, v84
    v_max3_f32 v51, v51, v91, v92
    v_max3_f32 v48, v48, v69, v70
    v_max3_f32 v49, v49, v77, v78
    v_max3_f32 v50, v50, v85, v86
    v_max3_f32 v51, v51, v93, v94
    v_max_f32 v48, v48, v71
    v_max_f32 v49, v49, v79
    v_max_f32 v50, v50, v87
    v_max_f32 v51, v51, v95
    v_mov_b32 v52, v48
    v_mov_b32 v53, v49
    v_mov_b32 v54, v50
    v_mov_b32 v55, v51
    v_permlane32_swap_b32 v52, v48
    v_permlane32_swap_b32 v53, v49
    v_permlane32_swap_b32 v54, v50
    v_permlane32_swap_b32 v55, v51
    v_max_f32 v48, v48, v52
    v_max_f32 v49, v49, v53
    v_max_f32 v50, v50, v54
    v_max_f32 v51, v51, v55
    v_mov_b32 v52, v48
    v_mov_b32 v53, v49
    v_mov_b32 v54, v50
    v_mov_b32 v55, v51
    v_permlane16_swap_b32 v52, v48
    v_permlane16_swap_b32 v53, v49
    v_permlane16_swap_b32 v54, v50
    v_permlane16_swap_b32 v55, v51
    v_max_f32 v48, v48, v52
    v_max_f32 v49, v49, v53
    v_max_f32 v50, v50, v54
    v_max_f32 v51, v51, v55
    v_mov_b32 v56, 0
    ds_write_b128 v22, v[48:51]
    ds_write_b32 v31, v56
    s_waitcnt lgkmcnt(0)
    s_barrier
    ds_read_b128 v[52:55], v23
    s_waitcnt lgkmcnt(0)
    v_max3_f32 v48, 0, v48, v52
    v_sub_f32 v56, 0, v48
    v_exp_f32 v56, v56
    v_max3_f32 v49, 0, v49, v53
    v_sub_f32 v57, 0, v49
    v_exp_f32 v57, v57
    v_max3_f32 v50, 0, v50, v54
    v_sub_f32 v58, 0, v50
    v_exp_f32 v58, v58
    v_max3_f32 v51, 0, v51, v55
    v_sub_f32 v59, 0, v51
    v_exp_f32 v59, v59
    s_nop 0
    v_mul_f32 v24, v56, v24
    v_mul_f32 v128, v56, v128
    v_mul_f32 v129, v56, v129
    v_mul_f32 v130, v56, v130
    v_mul_f32 v131, v56, v131
    v_mul_f32 v144, v56, v144
    v_mul_f32 v145, v56, v145
    v_mul_f32 v146, v56, v146
    v_mul_f32 v147, v56, v147
    v_mul_f32 v160, v56, v160
    v_mul_f32 v161, v56, v161
    v_mul_f32 v162, v56, v162
    v_mul_f32 v163, v56, v163
    v_mul_f32 v176, v56, v176
    v_mul_f32 v177, v56, v177
    v_mul_f32 v178, v56, v178
    v_mul_f32 v179, v56, v179
    v_mul_f32 v192, v56, v192
    v_mul_f32 v193, v56, v193
    v_mul_f32 v194, v56, v194
    v_mul_f32 v195, v56, v195
    v_mul_f32 v208, v56, v208
    v_mul_f32 v209, v56, v209
    v_mul_f32 v210, v56, v210
    v_mul_f32 v211, v56, v211
    v_mul_f32 v224, v56, v224
    v_mul_f32 v225, v56, v225
    v_mul_f32 v226, v56, v226
    v_mul_f32 v227, v56, v227
    v_mul_f32 v240, v56, v240
    v_mul_f32 v241, v56, v241
    v_mul_f32 v242, v56, v242
    v_mul_f32 v243, v56, v243
    v_mul_f32 v25, v57, v25
    v_mul_f32 v132, v57, v132
    v_mul_f32 v133, v57, v133
    v_mul_f32 v134, v57, v134
    v_mul_f32 v135, v57, v135
    v_mul_f32 v148, v57, v148
    v_mul_f32 v149, v57, v149
    v_mul_f32 v150, v57, v150
    v_mul_f32 v151, v57, v151
    v_mul_f32 v164, v57, v164
    v_mul_f32 v165, v57, v165
    v_mul_f32 v166, v57, v166
    v_mul_f32 v167, v57, v167
    v_mul_f32 v180, v57, v180
    v_mul_f32 v181, v57, v181
    v_mul_f32 v182, v57, v182
    v_mul_f32 v183, v57, v183
    v_mul_f32 v196, v57, v196
    v_mul_f32 v197, v57, v197
    v_mul_f32 v198, v57, v198
    v_mul_f32 v199, v57, v199
    v_mul_f32 v212, v57, v212
    v_mul_f32 v213, v57, v213
    v_mul_f32 v214, v57, v214
    v_mul_f32 v215, v57, v215
    v_mul_f32 v228, v57, v228
    v_mul_f32 v229, v57, v229
    v_mul_f32 v230, v57, v230
    v_mul_f32 v231, v57, v231
    v_mul_f32 v244, v57, v244
    v_mul_f32 v245, v57, v245
    v_mul_f32 v246, v57, v246
    v_mul_f32 v247, v57, v247
    v_mul_f32 v26, v58, v26
    v_mul_f32 v136, v58, v136
    v_mul_f32 v137, v58, v137
    v_mul_f32 v138, v58, v138
    v_mul_f32 v139, v58, v139
    v_mul_f32 v152, v58, v152
    v_mul_f32 v153, v58, v153
    v_mul_f32 v154, v58, v154
    v_mul_f32 v155, v58, v155
    v_mul_f32 v168, v58, v168
    v_mul_f32 v169, v58, v169
    v_mul_f32 v170, v58, v170
    v_mul_f32 v171, v58, v171
    v_mul_f32 v184, v58, v184
    v_mul_f32 v185, v58, v185
    v_mul_f32 v186, v58, v186
    v_mul_f32 v187, v58, v187
    v_mul_f32 v200, v58, v200
    v_mul_f32 v201, v58, v201
    v_mul_f32 v202, v58, v202
    v_mul_f32 v203, v58, v203
    v_mul_f32 v216, v58, v216
    v_mul_f32 v217, v58, v217
    v_mul_f32 v218, v58, v218
    v_mul_f32 v219, v58, v219
    v_mul_f32 v232, v58, v232
    v_mul_f32 v233, v58, v233
    v_mul_f32 v234, v58, v234
    v_mul_f32 v235, v58, v235
    v_mul_f32 v248, v58, v248
    v_mul_f32 v249, v58, v249
    v_mul_f32 v250, v58, v250
    v_mul_f32 v251, v58, v251
    v_mul_f32 v27, v59, v27
    v_mul_f32 v140, v59, v140
    v_mul_f32 v141, v59, v141
    v_mul_f32 v142, v59, v142
    v_mul_f32 v143, v59, v143
    v_mul_f32 v156, v59, v156
    v_mul_f32 v157, v59, v157
    v_mul_f32 v158, v59, v158
    v_mul_f32 v159, v59, v159
    v_mul_f32 v172, v59, v172
    v_mul_f32 v173, v59, v173
    v_mul_f32 v174, v59, v174
    v_mul_f32 v175, v59, v175
    v_mul_f32 v188, v59, v188
    v_mul_f32 v189, v59, v189
    v_mul_f32 v190, v59, v190
    v_mul_f32 v191, v59, v191
    v_mul_f32 v204, v59, v204
    v_mul_f32 v205, v59, v205
    v_mul_f32 v206, v59, v206
    v_mul_f32 v207, v59, v207
    v_mul_f32 v220, v59, v220
    v_mul_f32 v221, v59, v221
    v_mul_f32 v222, v59, v222
    v_mul_f32 v223, v59, v223
    v_mul_f32 v236, v59, v236
    v_mul_f32 v237, v59, v237
    v_mul_f32 v238, v59, v238
    v_mul_f32 v239, v59, v239
    v_mul_f32 v252, v59, v252
    v_mul_f32 v253, v59, v253
    v_mul_f32 v254, v59, v254
    v_mul_f32 v255, v59, v255
    v_sub_f32 v64, v64, v48
    v_sub_f32 v65, v65, v48
    v_sub_f32 v66, v66, v48
    v_sub_f32 v67, v67, v48
    v_sub_f32 v68, v68, v48
    v_sub_f32 v69, v69, v48
    v_sub_f32 v70, v70, v48
    v_sub_f32 v71, v71, v48
    v_sub_f32 v32, v32, v48
    v_sub_f32 v33, v33, v48
    v_sub_f32 v34, v34, v48
    v_sub_f32 v35, v35, v48
    v_sub_f32 v72, v72, v49
    v_sub_f32 v73, v73, v49
    v_sub_f32 v74, v74, v49
    v_sub_f32 v75, v75, v49
    v_sub_f32 v76, v76, v49
    v_sub_f32 v77, v77, v49
    v_sub_f32 v78, v78, v49
    v_sub_f32 v79, v79, v49
    v_sub_f32 v36, v36, v49
    v_sub_f32 v37, v37, v49
    v_sub_f32 v38, v38, v49
    v_sub_f32 v39, v39, v49
    v_sub_f32 v80, v80, v50
    v_sub_f32 v81, v81, v50
    v_sub_f32 v82, v82, v50
    v_sub_f32 v83, v83, v50
    v_sub_f32 v84, v84, v50
    v_sub_f32 v85, v85, v50
    v_sub_f32 v86, v86, v50
    v_sub_f32 v87, v87, v50
    v_sub_f32 v40, v40, v50
    v_sub_f32 v41, v41, v50
    v_sub_f32 v42, v42, v50
    v_sub_f32 v43, v43, v50
    v_sub_f32 v88, v88, v51
    v_sub_f32 v89, v89, v51
    v_sub_f32 v90, v90, v51
    v_sub_f32 v91, v91, v51
    v_sub_f32 v92, v92, v51
    v_sub_f32 v93, v93, v51
    v_sub_f32 v94, v94, v51
    v_sub_f32 v95, v95, v51
    v_sub_f32 v44, v44, v51
    v_sub_f32 v45, v45, v51
    v_sub_f32 v46, v46, v51
    v_sub_f32 v47, v47, v51
    s_nop 3
    s_setpc_b64 s[70:71]
L_rescale1_p4:
    s_nop 7
    s_waitcnt lgkmcnt(0)
    s_barrier
    v_max3_f32 v48, v96, v97, v98
    v_max3_f32 v49, v104, v105, v106
    v_max3_f32 v50, v112, v113, v114
    v_max3_f32 v51, v120, v121, v122
    v_max3_f32 v48, v48, v99, v100
    v_max3_f32 v49, v49, v107, v108
    v_max3_f32 v50, v50, v115, v116
    v_max3_f32 v51, v51, v123, v124
    v_max3_f32 v48, v48, v101, v102
    v_max3_f32 v49, v49, v109, v110
    v_max3_f32 v50, v50, v117, v118
    v_max3_f32 v51, v51, v125, v126
    v_max_f32 v48, v48, v103
    v_max_f32 v49, v49, v111
    v_max_f32 v50, v50, v119
    v_max_f32 v51, v51, v127
    v_mov_b32 v52, v48
    v_mov_b32 v53, v49
    v_mov_b32 v54, v50
    v_mov_b32 v55, v51
    v_permlane32_swap_b32 v52, v48
    v_permlane32_swap_b32 v53, v49
    v_permlane32_swap_b32 v54, v50
    v_permlane32_swap_b32 v55, v51
    v_max_f32 v48, v48, v52
    v_max_f32 v49, v49, v53
    v_max_f32 v50, v50, v54
    v_max_f32 v51, v51, v55
    v_mov_b32 v52, v48
    v_mov_b32 v53, v49
    v_mov_b32 v54, v50
    v_mov_b32 v55, v51
    v_permlane16_swap_b32 v52, v48
    v_permlane16_swap_b32 v53, v49
    v_permlane16_swap_b32 v54, v50
    v_permlane16_swap_b32 v55, v51
    v_max_f32 v48, v48, v52
    v_max_f32 v49, v49, v53
    v_max_f32 v50, v50, v54
    v_max_f32 v51, v51, v55
    v_mov_b32 v56, 0
    ds_write_b128 v22, v[48:51]
    ds_write_b32 v31, v56
    s_waitcnt lgkmcnt(0)
    s_barrier
    ds_read_b128 v[52:55], v23
    s_waitcnt lgkmcnt(0)
    v_max3_f32 v48, 0, v48, v52
    v_sub_f32 v56, 0, v48
    v_exp_f32 v56, v56
    v_max3_f32 v49, 0, v49, v53
    v_sub_f32 v57, 0, v49
    v_exp_f32 v57, v57
    v_max3_f32 v50, 0, v50, v54
    v_sub_f32 v58, 0, v50
    v_exp_f32 v58, v58
    v_max3_f32 v51, 0, v51, v55
    v_sub_f32 v59, 0, v51
    v_exp_f32 v59, v59
    s_nop 0
    v_mul_f32 v24, v56, v24
    v_mul_f32 v128, v56, v128
    v_mul_f32 v129, v56, v129
    v_mul_f32 v130, v56, v130
    v_mul_f32 v131, v56, v131
    v_mul_f32 v144, v56, v144
    v_mul_f32 v145, v56, v145
    v_mul_f32 v146, v56, v146
    v_mul_f32 v147, v56, v147
    v_mul_f32 v160, v56, v160
    v_mul_f32 v161, v56, v161
    v_mul_f32 v162, v56, v162
    v_mul_f32 v163, v56, v163
    v_mul_f32 v176, v56, v176
    v_mul_f32 v177, v56, v177
    v_mul_f32 v178, v56, v178
    v_mul_f32 v179, v56, v179
    v_mul_f32 v192, v56, v192
    v_mul_f32 v193, v56, v193
    v_mul_f32 v194, v56, v194
    v_mul_f32 v195, v56, v195
    v_mul_f32 v208, v56, v208
    v_mul_f32 v209, v56, v209
    v_mul_f32 v210, v56, v210
    v_mul_f32 v211, v56, v211
    v_mul_f32 v224, v56, v224
    v_mul_f32 v225, v56, v225
    v_mul_f32 v226, v56, v226
    v_mul_f32 v227, v56, v227
    v_mul_f32 v240, v56, v240
    v_mul_f32 v241, v56, v241
    v_mul_f32 v242, v56, v242
    v_mul_f32 v243, v56, v243
    v_mul_f32 v25, v57, v25
    v_mul_f32 v132, v57, v132
    v_mul_f32 v133, v57, v133
    v_mul_f32 v134, v57, v134
    v_mul_f32 v135, v57, v135
    v_mul_f32 v148, v57, v148
    v_mul_f32 v149, v57, v149
    v_mul_f32 v150, v57, v150
    v_mul_f32 v151, v57, v151
    v_mul_f32 v164, v57, v164
    v_mul_f32 v165, v57, v165
    v_mul_f32 v166, v57, v166
    v_mul_f32 v167, v57, v167
    v_mul_f32 v180, v57, v180
    v_mul_f32 v181, v57, v181
    v_mul_f32 v182, v57, v182
    v_mul_f32 v183, v57, v183
    v_mul_f32 v196, v57, v196
    v_mul_f32 v197, v57, v197
    v_mul_f32 v198, v57, v198
    v_mul_f32 v199, v57, v199
    v_mul_f32 v212, v57, v212
    v_mul_f32 v213, v57, v213
    v_mul_f32 v214, v57, v214
    v_mul_f32 v215, v57, v215
    v_mul_f32 v228, v57, v228
    v_mul_f32 v229, v57, v229
    v_mul_f32 v230, v57, v230
    v_mul_f32 v231, v57, v231
    v_mul_f32 v244, v57, v244
    v_mul_f32 v245, v57, v245
    v_mul_f32 v246, v57, v246
    v_mul_f32 v247, v57, v247
    v_mul_f32 v26, v58, v26
    v_mul_f32 v136, v58, v136
    v_mul_f32 v137, v58, v137
    v_mul_f32 v138, v58, v138
    v_mul_f32 v139, v58, v139
    v_mul_f32 v152, v58, v152
    v_mul_f32 v153, v58, v153
    v_mul_f32 v154, v58, v154
    v_mul_f32 v155, v58, v155
    v_mul_f32 v168, v58, v168
    v_mul_f32 v169, v58, v169
    v_mul_f32 v170, v58, v170
    v_mul_f32 v171, v58, v171
    v_mul_f32 v184, v58, v184
    v_mul_f32 v185, v58, v185
    v_mul_f32 v186, v58, v186
    v_mul_f32 v187, v58, v187
    v_mul_f32 v200, v58, v200
    v_mul_f32 v201, v58, v201
    v_mul_f32 v202, v58, v202
    v_mul_f32 v203, v58, v203
    v_mul_f32 v216, v58, v216
    v_mul_f32 v217, v58, v217
    v_mul_f32 v218, v58, v218
    v_mul_f32 v219, v58, v219
    v_mul_f32 v232, v58, v232
    v_mul_f32 v233, v58, v233
    v_mul_f32 v234, v58, v234
    v_mul_f32 v235, v58, v235
    v_mul_f32 v248, v58, v248
    v_mul_f32 v249, v58, v249
    v_mul_f32 v250, v58, v250
    v_mul_f32 v251, v58, v251
    v_mul_f32 v27, v59, v27
    v_mul_f32 v140, v59, v140
    v_mul_f32 v141, v59, v141
    v_mul_f32 v142, v59, v142
    v_mul_f32 v143, v59, v143
    v_mul_f32 v156, v59, v156
    v_mul_f32 v157, v59, v157
    v_mul_f32 v158, v59, v158
    v_mul_f32 v159, v59, v159
    v_mul_f32 v172, v59, v172
    v_mul_f32 v173, v59, v173
    v_mul_f32 v174, v59, v174
    v_mul_f32 v175, v59, v175
    v_mul_f32 v188, v59, v188
    v_mul_f32 v189, v59, v189
    v_mul_f32 v190, v59, v190
    v_mul_f32 v191, v59, v191
    v_mul_f32 v204, v59, v204
    v_mul_f32 v205, v59, v205
    v_mul_f32 v206, v59, v206
    v_mul_f32 v207, v59, v207
    v_mul_f32 v220, v59, v220
    v_mul_f32 v221, v59, v221
    v_mul_f32 v222, v59, v222
    v_mul_f32 v223, v59, v223
    v_mul_f32 v236, v59, v236
    v_mul_f32 v237, v59, v237
    v_mul_f32 v238, v59, v238
    v_mul_f32 v239, v59, v239
    v_mul_f32 v252, v59, v252
    v_mul_f32 v253, v59, v253
    v_mul_f32 v254, v59, v254
    v_mul_f32 v255, v59, v255
    v_sub_f32 v96, v96, v48
    v_sub_f32 v97, v97, v48
    v_sub_f32 v98, v98, v48
    v_sub_f32 v99, v99, v48
    v_sub_f32 v100, v100, v48
    v_sub_f32 v101, v101, v48
    v_sub_f32 v102, v102, v48
    v_sub_f32 v103, v103, v48
    v_sub_f32 v32, v32, v48
    v_sub_f32 v33, v33, v48
    v_sub_f32 v34, v34, v48
    v_sub_f32 v35, v35, v48
    v_sub_f32 v104, v104, v49
    v_sub_f32 v105, v105, v49
    v_sub_f32 v106, v106, v49
    v_sub_f32 v107, v107, v49
    v_sub_f32 v108, v108, v49
    v_sub_f32 v109, v109, v49
    v_sub_f32 v110, v110, v49
    v_sub_f32 v111, v111, v49
    v_sub_f32 v36, v36, v49
    v_sub_f32 v37, v37, v49
    v_sub_f32 v38, v38, v49
    v_sub_f32 v39, v39, v49
    v_sub_f32 v112, v112, v50
    v_sub_f32 v113, v113, v50
    v_sub_f32 v114, v114, v50
    v_sub_f32 v115, v115, v50
    v_sub_f32 v116, v116, v50
    v_sub_f32 v117, v117, v50
    v_sub_f32 v118, v118, v50
    v_sub_f32 v119, v119, v50
    v_sub_f32 v40, v40, v50
    v_sub_f32 v41, v41, v50
    v_sub_f32 v42, v42, v50
    v_sub_f32 v43, v43, v50
    v_sub_f32 v120, v120, v51
    v_sub_f32 v121, v121, v51
    v_sub_f32 v122, v122, v51
    v_sub_f32 v123, v123, v51
    v_sub_f32 v124, v124, v51
    v_sub_f32 v125, v125, v51
    v_sub_f32 v126, v126, v51
    v_sub_f32 v127, v127, v51
    v_sub_f32 v44, v44, v51
    v_sub_f32 v45, v45, v51
    v_sub_f32 v46, v46, v51
    v_sub_f32 v47, v47, v51
    s_nop 3
    s_setpc_b64 s[70:71]
L_path3:
    s_waitcnt vmcnt(17)
    s_barrier
    ds_read_b128 a[192:195], v64 offset:0
    ds_read_b128 a[196:199], v64 offset:2048
    ds_read_b128 a[200:203], v64 offset:4096
    ds_read_b64_tr_b16 a[144:145], v100 offset:32768
    ds_read_b64_tr_b16 a[146:147], v100 offset:34816
    ds_read_b64_tr_b16 a[148:149], v100 offset:32776
    ds_read_b64_tr_b16 a[150:151], v100 offset:34824
    ds_read_b64_tr_b16 a[152:153], v101 offset:32768
    ds_read_b64_tr_b16 a[154:155], v101 offset:34816
    s_waitcnt lgkmcnt(4)
    v_mfma_f32_16x16x32_bf16 v[128:131], a[144:147], a[192:195], 0
    s_waitcnt vmcnt(13)
    s_barrier
    ds_read_b64_tr_b16 a[156:157], v101 offset:32776
    v_mfma_f32_16x16x32_bf16 v[132:135], a[144:147], a[196:199], 0
    ds_read_b64_tr_b16 a[158:159], v101 offset:34824
    s_add_u32 m0, s59, 65536
    s_mov_b32 s68, 1048576
    v_mfma_f32_16x16x32_bf16 v[136:139], a[144:147], a[200:203], 0
    buffer_load_dwordx4 v104, s[20:23], s68 offen offset:0  lds
    s_waitcnt lgkmcnt(4)
    v_mfma_f32_16x16x32_bf16 v[152:155], a[148:151], a[200:203], 0
    ds_read_b64_tr_b16 a[160:161], v102 offset:32768
    ds_read_b128 a[208:211], v65 offset:0
    v_mfma_f32_16x16x32_bf16 v[148:151], a[148:151], a[196:199], 0
    ds_read_b64_tr_b16 a[162:163], v102 offset:34816
    v_mfma_f32_16x16x32_bf16 v[144:147], a[148:151], a[192:195], 0
    buffer_load_dwordx4 v105, s[20:23], s68 offen offset:1024  lds
    s_waitcnt lgkmcnt(5)
    v_mfma_f32_16x16x32_bf16 v[160:163], a[152:155], a[192:195], 0
    ds_read_b64_tr_b16 a[164:165], v102 offset:32776
    ds_read_b128 a[212:215], v65 offset:2048
    v_mfma_f32_16x16x32_bf16 v[164:167], a[152:155], a[196:199], 0
    ds_read_b64_tr_b16 a[166:167], v102 offset:34824
    v_mfma_f32_16x16x32_bf16 v[168:171], a[152:155], a[200:203], 0
    buffer_load_dwordx4 v106, s[20:23], s68 offen offset:2048  lds
    s_waitcnt lgkmcnt(6)
    v_mfma_f32_16x16x32_bf16 v[184:187], a[156:159], a[200:203], 0
    ds_read_b64_tr_b16 a[168:169], v103 offset:32768
    v_mfma_f32_16x16x32_bf16 v[180:183], a[156:159], a[196:199], 0
    ds_read_b64_tr_b16 a[170:171], v103 offset:34816
    ds_read_b128 a[216:219], v65 offset:4096
    v_mfma_f32_16x16x32_bf16 v[176:179], a[156:159], a[192:195], 0
    buffer_load_dwordx4 v107, s[20:23], s68 offen offset:3072  lds
    s_waitcnt lgkmcnt(6)
    v_mfma_f32_16x16x32_bf16 v[192:195], a[160:163], a[192:195], 0
    ds_read_b64_tr_b16 a[172:173], v103 offset:32776
    v_mfma_f32_16x16x32_bf16 v[196:199], a[160:163], a[196:199], 0
    ds_read_b64_tr_b16 a[174:175], v103 offset:34824
    s_add_u32 m0, s59, 81920
    s_mov_b32 s68, 1310720
    v_mfma_f32_16x16x32_bf16 v[200:203], a[160:163], a[200:203], 0
    buffer_load_dwordx4 v104, s[20:23], s68 offen offset:0  lds
    s_waitcnt lgkmcnt(5)
    v_mfma_f32_16x16x32_bf16 v[216:219], a[164:167], a[200:203], 0
    ds_read_b64_tr_b16 a[144:145], v100 offset:49152
    v_mfma_f32_16x16x32_bf16 v[212:215], a[164:167], a[196:199], 0
    ds_read_b64_tr_b16 a[146:147], v100 offset:51200
    v_mfma_f32_16x16x32_bf16 v[208:211], a[164:167], a[192:195], 0
    buffer_load_dwordx4 v105, s[20:23], s68 offen offset:1024  lds
    s_waitcnt lgkmcnt(5)
    v_mfma_f32_16x16x32_bf16 v[224:227], a[168:171], a[192:195], 0
    ds_read_b64_tr_b16 a[148:149], v100 offset:49160
    v_mfma_f32_16x16x32_bf16 v[228:231], a[168:171], a[196:199], 0
    ds_read_b64_tr_b16 a[150:151], v100 offset:51208
    v_mfma_f32_16x16x32_bf16 v[232:235], a[168:171], a[200:203], 0
    buffer_load_dwordx4 v106, s[20:23], s68 offen offset:2048  lds
    s_waitcnt lgkmcnt(4)
    v_mfma_f32_16x16x32_bf16 v[248:251], a[172:175], a[200:203], 0
    ds_read_b64_tr_b16 a[152:153], v101 offset:49152
    v_mfma_f32_16x16x32_bf16 v[244:247], a[172:175], a[196:199], 0
    ds_read_b64_tr_b16 a[154:155], v101 offset:51200
    v_mfma_f32_16x16x32_bf16 v[240:243], a[172:175], a[192:195], 0
    buffer_load_dwordx4 v107, s[20:23], s68 offen offset:3072  lds
    s_waitcnt lgkmcnt(4)
    v_mfma_f32_16x16x32_bf16 v[128:131], a[144:147], a[208:211], v[128:131]
    s_waitcnt vmcnt(13)
    s_waitcnt vmcnt(63)
    s_barrier
    ds_read_b64_tr_b16 a[156:157], v101 offset:49160
    v_mfma_f32_16x16x32_bf16 v[132:135], a[144:147], a[212:215], v[132:135]
    ds_read_b64_tr_b16 a[158:159], v101 offset:51208
    s_add_u32 m0, s59, 131072
    s_mov_b32 s68, 256
    v_mfma_f32_16x16x32_bf16 v[136:139], a[144:147], a[216:219], v[136:139]
    buffer_load_dwordx4 v108, s[8:11], s68 offen offset:0  lds
    s_waitcnt lgkmcnt(4)
    v_mfma_f32_16x16x32_bf16 v[152:155], a[148:151], a[216:219], v[152:155]
    ds_read_b64_tr_b16 a[160:161], v102 offset:49152
    ds_read_b128 a[192:195], v64 offset:16384
    v_mfma_f32_16x16x32_bf16 v[148:151], a[148:151], a[212:215], v[148:151]
    ds_read_b64_tr_b16 a[162:163], v102 offset:51200
    v_mfma_f32_16x16x32_bf16 v[144:147], a[148:151], a[208:211], v[144:147]
    buffer_load_dwordx4 v109, s[8:11], s68 offen offset:1024  lds
    s_waitcnt lgkmcnt(5)
    v_mfma_f32_16x16x32_bf16 v[160:163], a[152:155], a[208:211], v[160:163]
    ds_read_b64_tr_b16 a[164:165], v102 offset:49160
    ds_read_b128 a[196:199], v64 offset:18432
    v_mfma_f32_16x16x32_bf16 v[164:167], a[152:155], a[212:215], v[164:167]
    ds_read_b64_tr_b16 a[166:167], v102 offset:51208
    v_mfma_f32_16x16x32_bf16 v[168:171], a[152:155], a[216:219], v[168:171]
    buffer_load_dwordx4 v110, s[8:11], s68 offen offset:2048  lds
    s_waitcnt lgkmcnt(6)
    v_mfma_f32_16x16x32_bf16 v[184:187], a[156:159], a[216:219], v[184:187]
    ds_read_b64_tr_b16 a[168:169], v103 offset:49152
    v_mfma_f32_16x16x32_bf16 v[180:183], a[156:159], a[212:215], v[180:183]
    ds_read_b64_tr_b16 a[170:171], v103 offset:51200
    ds_read_b128 a[200:203], v64 offset:20480
    v_mfma_f32_16x16x32_bf16 v[176:179], a[156:159], a[208:211], v[176:179]
    buffer_load_dwordx4 v111, s[8:11], s68 offen offset:3072  lds
    s_waitcnt lgkmcnt(6)
    v_mfma_f32_16x16x32_bf16 v[192:195], a[160:163], a[208:211], v[192:195]
    ds_read_b64_tr_b16 a[172:173], v103 offset:49160
    v_mfma_f32_16x16x32_bf16 v[196:199], a[160:163], a[212:215], v[196:199]
    ds_read_b64_tr_b16 a[174:175], v103 offset:51208
    s_add_u32 m0, s59, 98304
    s_mov_b32 s68, 1572864
    v_mfma_f32_16x16x32_bf16 v[200:203], a[160:163], a[216:219], v[200:203]
    buffer_load_dwordx4 v104, s[20:23], s68 offen offset:0  lds
    s_waitcnt lgkmcnt(5)
    v_mfma_f32_16x16x32_bf16 v[216:219], a[164:167], a[216:219], v[216:219]
    ds_read_b64_tr_b16 a[144:145], v96 offset:32768
    v_mfma_f32_16x16x32_bf16 v[212:215], a[164:167], a[212:215], v[212:215]
    ds_read_b64_tr_b16 a[146:147], v96 offset:34816
    v_mfma_f32_16x16x32_bf16 v[208:211], a[164:167], a[208:211], v[208:211]
    buffer_load_dwordx4 v105, s[20:23], s68 offen offset:1024  lds
    s_waitcnt lgkmcnt(5)
    v_mfma_f32_16x16x32_bf16 v[224:227], a[168:171], a[208:211], v[224:227]
    ds_read_b64_tr_b16 a[148:149], v96 offset:32776
    v_mfma_f32_16x16x32_bf16 v[228:231], a[168:171], a[212:215], v[228:231]
    ds_read_b64_tr_b16 a[150:151], v96 offset:34824
    v_mfma_f32_16x16x32_bf16 v[232:235], a[168:171], a[216:219], v[232:235]
    buffer_load_dwordx4 v106, s[20:23], s68 offen offset:2048  lds
    s_waitcnt lgkmcnt(4)
    v_mfma_f32_16x16x32_bf16 v[248:251], a[172:175], a[216:219], v[248:251]
    ds_read_b64_tr_b16 a[152:153], v97 offset:32768
    v_mfma_f32_16x16x32_bf16 v[244:247], a[172:175], a[212:215], v[244:247]
    ds_read_b64_tr_b16 a[154:155], v97 offset:34816
    v_mfma_f32_16x16x32_bf16 v[240:243], a[172:175], a[208:211], v[240:243]
    buffer_load_dwordx4 v107, s[20:23], s68 offen offset:3072  lds
    s_waitcnt lgkmcnt(4)
    v_mfma_f32_16x16x32_bf16 v[128:131], a[144:147], a[192:195], v[128:131]
    s_waitcnt vmcnt(17)
    s_barrier
    ds_read_b64_tr_b16 a[156:157], v97 offset:32776
    v_mfma_f32_16x16x32_bf16 v[132:135], a[144:147], a[196:199], v[132:135]
    ds_read_b64_tr_b16 a[158:159], v97 offset:34824
    s_add_u32 m0, s59, 114688
    s_mov_b32 s68, 1835008
    v_mfma_f32_16x16x32_bf16 v[136:139], a[144:147], a[200:203], v[136:139]
    buffer_load_dwordx4 v104, s[20:23], s68 offen offset:0  lds
    s_waitcnt lgkmcnt(4)
    v_mfma_f32_16x16x32_bf16 v[152:155], a[148:151], a[200:203], v[152:155]
    ds_read_b64_tr_b16 a[160:161], v98 offset:32768
    ds_read_b128 a[208:211], v65 offset:16384
    v_mfma_f32_16x16x32_bf16 v[148:151], a[148:151], a[196:199], v[148:151]
    ds_read_b64_tr_b16 a[162:163], v98 offset:34816
    v_mfma_f32_16x16x32_bf16 v[144:147], a[148:151], a[192:195], v[144:147]
    ds_read_b128 a[212:215], v65 offset:18432
    s_waitcnt lgkmcnt(6)
    v_mfma_f32_16x16x32_bf16 v[160:163], a[152:155], a[192:195], v[160:163]
    ds_read_b64_tr_b16 a[164:165], v98 offset:32776
    v_mfma_f32_16x16x32_bf16 v[164:167], a[152:155], a[196:199], v[164:167]
    ds_read_b64_tr_b16 a[166:167], v98 offset:34824
    v_mfma_f32_16x16x32_bf16 v[168:171], a[152:155], a[200:203], v[168:171]
    s_waitcnt lgkmcnt(6)
    v_mfma_f32_16x16x32_bf16 v[184:187], a[156:159], a[200:203], v[184:187]
    ds_read_b64_tr_b16 a[168:169], v99 offset:32768
    v_mfma_f32_16x16x32_bf16 v[180:183], a[156:159], a[196:199], v[180:183]
    ds_read_b64_tr_b16 a[170:171], v99 offset:34816
    ds_read_b128 a[216:219], v65 offset:20480
    v_mfma_f32_16x16x32_bf16 v[176:179], a[156:159], a[192:195], v[176:179]
    buffer_load_dwordx4 v105, s[20:23], s68 offen offset:1024  lds
    s_waitcnt lgkmcnt(6)
    v_mfma_f32_16x16x32_bf16 v[192:195], a[160:163], a[192:195], v[192:195]
    ds_read_b64_tr_b16 a[172:173], v99 offset:32776
    v_mfma_f32_16x16x32_bf16 v[196:199], a[160:163], a[196:199], v[196:199]
    ds_read_b64_tr_b16 a[174:175], v99 offset:34824
    v_mfma_f32_16x16x32_bf16 v[200:203], a[160:163], a[200:203], v[200:203]
    s_waitcnt lgkmcnt(5)
    v_mfma_f32_16x16x32_bf16 v[216:219], a[164:167], a[200:203], v[216:219]
    ds_read_b64_tr_b16 a[144:145], v96 offset:49152
    v_mfma_f32_16x16x32_bf16 v[212:215], a[164:167], a[196:199], v[212:215]
    ds_read_b64_tr_b16 a[146:147], v96 offset:51200
    v_mfma_f32_16x16x32_bf16 v[208:211], a[164:167], a[192:195], v[208:211]
    buffer_load_dwordx4 v106, s[20:23], s68 offen offset:2048  lds
    s_waitcnt lgkmcnt(5)
    v_mfma_f32_16x16x32_bf16 v[224:227], a[168:171], a[192:195], v[224:227]
    ds_read_b64_tr_b16 a[148:149], v96 offset:49160
    v_mfma_f32_16x16x32_bf16 v[228:231], a[168:171], a[196:199], v[228:231]
    ds_read_b64_tr_b16 a[150:151], v96 offset:51208
    v_mfma_f32_16x16x32_bf16 v[232:235], a[168:171], a[200:203], v[232:235]
    s_waitcnt lgkmcnt(4)
    v_mfma_f32_16x16x32_bf16 v[248:251], a[172:175], a[200:203], v[248:251]
    ds_read_b64_tr_b16 a[152:153], v97 offset:49152
    v_mfma_f32_16x16x32_bf16 v[244:247], a[172:175], a[196:199], v[244:247]
    ds_read_b64_tr_b16 a[154:155], v97 offset:51200
    v_mfma_f32_16x16x32_bf16 v[240:243], a[172:175], a[192:195], v[240:243]
    buffer_load_dwordx4 v107, s[20:23], s68 offen offset:3072  lds
    s_waitcnt lgkmcnt(4)
    v_mfma_f32_16x16x32_bf16 v[128:131], a[144:147], a[208:211], v[128:131]
    s_waitcnt vmcnt(16)
    s_waitcnt vmcnt(8)
    s_barrier
    ds_read_b64_tr_b16 a[156:157], v97 offset:49160
    v_mfma_f32_16x16x32_bf16 v[132:135], a[144:147], a[212:215], v[132:135]
    ds_read_b64_tr_b16 a[158:159], v97 offset:51208
    s_add_u32 m0, s59, 147456
    s_mov_b32 s68, 384
    v_mfma_f32_16x16x32_bf16 v[136:139], a[144:147], a[216:219], v[136:139]
    buffer_load_dwordx4 v108, s[8:11], s68 offen offset:0  lds
    s_waitcnt lgkmcnt(4)
    v_mfma_f32_16x16x32_bf16 v[152:155], a[148:151], a[216:219], v[152:155]
    ds_read_b64_tr_b16 a[160:161], v98 offset:49152
    ds_read_b128 a[192:195], v64 offset:0
    v_mfma_f32_16x16x32_bf16 v[148:151], a[148:151], a[212:215], v[148:151]
    ds_read_b64_tr_b16 a[162:163], v98 offset:51200
    v_mfma_f32_16x16x32_bf16 v[144:147], a[148:151], a[208:211], v[144:147]
    buffer_load_dwordx4 v109, s[8:11], s68 offen offset:1024  lds
    s_waitcnt lgkmcnt(5)
    v_mfma_f32_16x16x32_bf16 v[160:163], a[152:155], a[208:211], v[160:163]
    ds_read_b64_tr_b16 a[164:165], v98 offset:49160
    ds_read_b128 a[196:199], v64 offset:2048
    v_mfma_f32_16x16x32_bf16 v[164:167], a[152:155], a[212:215], v[164:167]
    ds_read_b64_tr_b16 a[166:167], v98 offset:51208
    v_mfma_f32_16x16x32_bf16 v[168:171], a[152:155], a[216:219], v[168:171]
    buffer_load_dwordx4 v110, s[8:11], s68 offen offset:2048  lds
    s_waitcnt lgkmcnt(6)
    v_mfma_f32_16x16x32_bf16 v[184:187], a[156:159], a[216:219], v[184:187]
    ds_read_b64_tr_b16 a[168:169], v99 offset:49152
    v_mfma_f32_16x16x32_bf16 v[180:183], a[156:159], a[212:215], v[180:183]
    ds_read_b64_tr_b16 a[170:171], v99 offset:51200
    ds_read_b128 a[200:203], v64 offset:4096
    v_mfma_f32_16x16x32_bf16 v[176:179], a[156:159], a[208:211], v[176:179]
    buffer_load_dwordx4 v111, s[8:11], s68 offen offset:3072  lds
    s_waitcnt lgkmcnt(6)
    v_mfma_f32_16x16x32_bf16 v[192:195], a[160:163], a[208:211], v[192:195]
    ds_read_b64_tr_b16 a[172:173], v99 offset:49160
    v_mfma_f32_16x16x32_bf16 v[196:199], a[160:163], a[212:215], v[196:199]
    ds_read_b64_tr_b16 a[174:175], v99 offset:51208
    s_add_u32 m0, s59, 32768
    s_mov_b32 s68, 2097152
    v_mfma_f32_16x16x32_bf16 v[200:203], a[160:163], a[216:219], v[200:203]
    buffer_load_dwordx4 v104, s[20:23], s68 offen offset:0  lds
    s_waitcnt lgkmcnt(5)
    v_mfma_f32_16x16x32_bf16 v[216:219], a[164:167], a[216:219], v[216:219]
    ds_read_b64_tr_b16 a[144:145], v100 offset:0
    v_mfma_f32_16x16x32_bf16 v[212:215], a[164:167], a[212:215], v[212:215]
    ds_read_b64_tr_b16 a[146:147], v100 offset:2048
    v_mfma_f32_16x16x32_bf16 v[208:211], a[164:167], a[208:211], v[208:211]
    buffer_load_dwordx4 v105, s[20:23], s68 offen offset:1024  lds
    s_waitcnt lgkmcnt(5)
    v_mfma_f32_16x16x32_bf16 v[224:227], a[168:171], a[208:211], v[224:227]
    ds_read_b64_tr_b16 a[148:149], v100 offset:8
    v_mfma_f32_16x16x32_bf16 v[228:231], a[168:171], a[212:215], v[228:231]
    ds_read_b64_tr_b16 a[150:151], v100 offset:2056
    v_mfma_f32_16x16x32_bf16 v[232:235], a[168:171], a[216:219], v[232:235]
    buffer_load_dwordx4 v106, s[20:23], s68 offen offset:2048  lds
    s_waitcnt lgkmcnt(4)
    v_mfma_f32_16x16x32_bf16 v[248:251], a[172:175], a[216:219], v[248:251]
    ds_read_b64_tr_b16 a[152:153], v101 offset:0
    v_mfma_f32_16x16x32_bf16 v[244:247], a[172:175], a[212:215], v[244:247]
    ds_read_b64_tr_b16 a[154:155], v101 offset:2048
    v_mfma_f32_16x16x32_bf16 v[240:243], a[172:175], a[208:211], v[240:243]
    buffer_load_dwordx4 v107, s[20:23], s68 offen offset:3072  lds
    s_waitcnt lgkmcnt(4)
    v_mfma_f32_16x16x32_bf16 v[128:131], a[144:147], a[192:195], v[128:131]
    s_waitcnt vmcnt(63)
    s_barrier
    ds_read_b64_tr_b16 a[156:157], v101 offset:8
    v_mfma_f32_16x16x32_bf16 v[132:135], a[144:147], a[196:199], v[132:135]
    ds_read_b64_tr_b16 a[158:159], v101 offset:2056
    s_add_u32 m0, s59, 49152
    s_mov_b32 s68, 2359296
    v_mfma_f32_16x16x32_bf16 v[136:139], a[144:147], a[200:203], v[136:139]
    buffer_load_dwordx4 v104, s[20:23], s68 offen offset:0  lds
    s_waitcnt lgkmcnt(4)
    v_mfma_f32_16x16x32_bf16 v[152:155], a[148:151], a[200:203], v[152:155]
    ds_read_b64_tr_b16 a[160:161], v102 offset:0
    ds_read_b128 a[208:211], v65 offset:0
    v_mfma_f32_16x16x32_bf16 v[148:151], a[148:151], a[196:199], v[148:151]
    ds_read_b64_tr_b16 a[162:163], v102 offset:2048
    v_mfma_f32_16x16x32_bf16 v[144:147], a[148:151], a[192:195], v[144:147]
    ds_read_b128 a[212:215], v65 offset:2048
    s_waitcnt lgkmcnt(6)
    v_mfma_f32_16x16x32_bf16 v[160:163], a[152:155], a[192:195], v[160:163]
    ds_read_b64_tr_b16 a[164:165], v102 offset:8
    v_mfma_f32_16x16x32_bf16 v[164:167], a[152:155], a[196:199], v[164:167]
    ds_read_b64_tr_b16 a[166:167], v102 offset:2056
    v_mfma_f32_16x16x32_bf16 v[168:171], a[152:155], a[200:203], v[168:171]
    s_waitcnt lgkmcnt(6)
    v_mfma_f32_16x16x32_bf16 v[184:187], a[156:159], a[200:203], v[184:187]
    ds_read_b64_tr_b16 a[168:169], v103 offset:0
    v_mfma_f32_16x16x32_bf16 v[180:183], a[156:159], a[196:199], v[180:183]
    ds_read_b64_tr_b16 a[170:171], v103 offset:2048
    ds_read_b128 a[216:219], v65 offset:4096
    v_mfma_f32_16x16x32_bf16 v[176:179], a[156:159], a[192:195], v[176:179]
    buffer_load_dwordx4 v105, s[20:23], s68 offen offset:1024  lds
    s_waitcnt lgkmcnt(6)
    v_mfma_f32_16x16x32_bf16 v[192:195], a[160:163], a[192:195], v[192:195]
    ds_read_b64_tr_b16 a[172:173], v103 offset:8
    v_mfma_f32_16x16x32_bf16 v[196:199], a[160:163], a[196:199], v[196:199]
    ds_read_b64_tr_b16 a[174:175], v103 offset:2056
    v_mfma_f32_16x16x32_bf16 v[200:203], a[160:163], a[200:203], v[200:203]
    s_waitcnt lgkmcnt(5)
    v_mfma_f32_16x16x32_bf16 v[216:219], a[164:167], a[200:203], v[216:219]
    ds_read_b64_tr_b16 a[144:145], v100 offset:16384
    v_mfma_f32_16x16x32_bf16 v[212:215], a[164:167], a[196:199], v[212:215]
    ds_read_b64_tr_b16 a[146:147], v100 offset:18432
    v_mfma_f32_16x16x32_bf16 v[208:211], a[164:167], a[192:195], v[208:211]
    buffer_load_dwordx4 v106, s[20:23], s68 offen offset:2048  lds
    s_waitcnt lgkmcnt(5)
    v_mfma_f32_16x16x32_bf16 v[224:227], a[168:171], a[192:195], v[224:227]
    ds_read_b64_tr_b16 a[148:149], v100 offset:16392
    v_mfma_f32_16x16x32_bf16 v[228:231], a[168:171], a[196:199], v[228:231]
    ds_read_b64_tr_b16 a[150:151], v100 offset:18440
    v_mfma_f32_16x16x32_bf16 v[232:235], a[168:171], a[200:203], v[232:235]
    s_waitcnt lgkmcnt(4)
    v_mfma_f32_16x16x32_bf16 v[248:251], a[172:175], a[200:203], v[248:251]
    ds_read_b64_tr_b16 a[152:153], v101 offset:16384
    v_mfma_f32_16x16x32_bf16 v[244:247], a[172:175], a[196:199], v[244:247]
    ds_read_b64_tr_b16 a[154:155], v101 offset:18432
    v_mfma_f32_16x16x32_bf16 v[240:243], a[172:175], a[192:195], v[240:243]
    buffer_load_dwordx4 v107, s[20:23], s68 offen offset:3072  lds
    s_waitcnt lgkmcnt(4)
    v_mfma_f32_16x16x32_bf16 v[128:131], a[144:147], a[208:211], v[128:131]
    s_waitcnt vmcnt(16)
    s_waitcnt vmcnt(8)
    s_barrier
    ds_read_b64_tr_b16 a[156:157], v101 offset:16392
    v_mfma_f32_16x16x32_bf16 v[132:135], a[144:147], a[212:215], v[132:135]
    ds_read_b64_tr_b16 a[158:159], v101 offset:18440
    s_add_u32 m0, s59, 131072
    s_mov_b32 s68, 512
    v_mfma_f32_16x16x32_bf16 v[136:139], a[144:147], a[216:219], v[136:139]
    buffer_load_dwordx4 v108, s[8:11], s68 offen offset:0  lds
    s_waitcnt lgkmcnt(4)
    v_mfma_f32_16x16x32_bf16 v[152:155], a[148:151], a[216:219], v[152:155]
    ds_read_b64_tr_b16 a[160:161], v102 offset:16384
    ds_read_b128 a[192:195], v64 offset:16384
    v_mfma_f32_16x16x32_bf16 v[148:151], a[148:151], a[212:215], v[148:151]
    ds_read_b64_tr_b16 a[162:163], v102 offset:18432
    v_mfma_f32_16x16x32_bf16 v[144:147], a[148:151], a[208:211], v[144:147]
    buffer_load_dwordx4 v109, s[8:11], s68 offen offset:1024  lds
    s_waitcnt lgkmcnt(5)
    v_mfma_f32_16x16x32_bf16 v[160:163], a[152:155], a[208:211], v[160:163]
    ds_read_b64_tr_b16 a[164:165], v102 offset:16392
    ds_read_b128 a[196:199], v64 offset:18432
    v_mfma_f32_16x16x32_bf16 v[164:167], a[152:155], a[212:215], v[164:167]
    ds_read_b64_tr_b16 a[166:167], v102 offset:18440
    v_mfma_f32_16x16x32_bf16 v[168:171], a[152:155], a[216:219], v[168:171]
    buffer_load_dwordx4 v110, s[8:11], s68 offen offset:2048  lds
    s_waitcnt lgkmcnt(6)
    v_mfma_f32_16x16x32_bf16 v[184:187], a[156:159], a[216:219], v[184:187]
    ds_read_b64_tr_b16 a[168:169], v103 offset:16384
    v_mfma_f32_16x16x32_bf16 v[180:183], a[156:159], a[212:215], v[180:183]
    ds_read_b64_tr_b16 a[170:171], v103 offset:18432
    ds_read_b128 a[200:203], v64 offset:20480
    v_mfma_f32_16x16x32_bf16 v[176:179], a[156:159], a[208:211], v[176:179]
    buffer_load_dwordx4 v111, s[8:11], s68 offen offset:3072  lds
    s_waitcnt lgkmcnt(6)
    v_mfma_f32_16x16x32_bf16 v[192:195], a[160:163], a[208:211], v[192:195]
    ds_read_b64_tr_b16 a[172:173], v103 offset:16392
    v_mfma_f32_16x16x32_bf16 v[196:199], a[160:163], a[212:215], v[196:199]
    ds_read_b64_tr_b16 a[174:175], v103 offset:18440
    s_add_u32 m0, s59, 65536
    s_mov_b32 s68, 2621440
    v_mfma_f32_16x16x32_bf16 v[200:203], a[160:163], a[216:219], v[200:203]
    buffer_load_dwordx4 v104, s[20:23], s68 offen offset:0  lds
    s_waitcnt lgkmcnt(5)
    v_mfma_f32_16x16x32_bf16 v[216:219], a[164:167], a[216:219], v[216:219]
    ds_read_b64_tr_b16 a[144:145], v100 offset:32768
    v_mfma_f32_16x16x32_bf16 v[212:215], a[164:167], a[212:215], v[212:215]
    ds_read_b64_tr_b16 a[146:147], v100 offset:34816
    v_mfma_f32_16x16x32_bf16 v[208:211], a[164:167], a[208:211], v[208:211]
    buffer_load_dwordx4 v105, s[20:23], s68 offen offset:1024  lds
    s_waitcnt lgkmcnt(5)
    v_mfma_f32_16x16x32_bf16 v[224:227], a[168:171], a[208:211], v[224:227]
    ds_read_b64_tr_b16 a[148:149], v100 offset:32776
    v_mfma_f32_16x16x32_bf16 v[228:231], a[168:171], a[212:215], v[228:231]
    ds_read_b64_tr_b16 a[150:151], v100 offset:34824
    v_mfma_f32_16x16x32_bf16 v[232:235], a[168:171], a[216:219], v[232:235]
    buffer_load_dwordx4 v106, s[20:23], s68 offen offset:2048  lds
    s_waitcnt lgkmcnt(4)
    v_mfma_f32_16x16x32_bf16 v[248:251], a[172:175], a[216:219], v[248:251]
    ds_read_b64_tr_b16 a[152:153], v101 offset:32768
    v_mfma_f32_16x16x32_bf16 v[244:247], a[172:175], a[212:215], v[244:247]
    ds_read_b64_tr_b16 a[154:155], v101 offset:34816
    v_mfma_f32_16x16x32_bf16 v[240:243], a[172:175], a[208:211], v[240:243]
    buffer_load_dwordx4 v107, s[20:23], s68 offen offset:3072  lds
    s_waitcnt lgkmcnt(4)
    v_mfma_f32_16x16x32_bf16 v[128:131], a[144:147], a[192:195], v[128:131]
    s_waitcnt vmcnt(63)
    s_barrier
    ds_read_b64_tr_b16 a[156:157], v101 offset:32776
    v_mfma_f32_16x16x32_bf16 v[132:135], a[144:147], a[196:199], v[132:135]
    ds_read_b64_tr_b16 a[158:159], v101 offset:34824
    s_add_u32 m0, s59, 81920
    s_mov_b32 s68, 2883584
    v_mfma_f32_16x16x32_bf16 v[136:139], a[144:147], a[200:203], v[136:139]
    buffer_load_dwordx4 v104, s[20:23], s68 offen offset:0  lds
    s_waitcnt lgkmcnt(4)
    v_mfma_f32_16x16x32_bf16 v[152:155], a[148:151], a[200:203], v[152:155]
    ds_read_b64_tr_b16 a[160:161], v102 offset:32768
    ds_read_b128 a[208:211], v65 offset:16384
    v_mfma_f32_16x16x32_bf16 v[148:151], a[148:151], a[196:199], v[148:151]
    ds_read_b64_tr_b16 a[162:163], v102 offset:34816
    v_mfma_f32_16x16x32_bf16 v[144:147], a[148:151], a[192:195], v[144:147]
    buffer_load_dwordx4 v105, s[20:23], s68 offen offset:1024  lds
    s_waitcnt lgkmcnt(5)
    v_mfma_f32_16x16x32_bf16 v[160:163], a[152:155], a[192:195], v[160:163]
    ds_read_b64_tr_b16 a[164:165], v102 offset:32776
    ds_read_b128 a[212:215], v65 offset:18432
    v_mfma_f32_16x16x32_bf16 v[164:167], a[152:155], a[196:199], v[164:167]
    ds_read_b64_tr_b16 a[166:167], v102 offset:34824
    v_mfma_f32_16x16x32_bf16 v[168:171], a[152:155], a[200:203], v[168:171]
    buffer_load_dwordx4 v106, s[20:23], s68 offen offset:2048  lds
    s_waitcnt lgkmcnt(6)
    v_mfma_f32_16x16x32_bf16 v[184:187], a[156:159], a[200:203], v[184:187]
    ds_read_b64_tr_b16 a[168:169], v103 offset:32768
    v_mfma_f32_16x16x32_bf16 v[180:183], a[156:159], a[196:199], v[180:183]
    ds_read_b64_tr_b16 a[170:171], v103 offset:34816
    ds_read_b128 a[216:219], v65 offset:20480
    v_mfma_f32_16x16x32_bf16 v[176:179], a[156:159], a[192:195], v[176:179]
    buffer_load_dwordx4 v107, s[20:23], s68 offen offset:3072  lds
    s_waitcnt lgkmcnt(6)
    v_mfma_f32_16x16x32_bf16 v[192:195], a[160:163], a[192:195], v[192:195]
    ds_read_b64_tr_b16 a[172:173], v103 offset:32776
    v_mfma_f32_16x16x32_bf16 v[196:199], a[160:163], a[196:199], v[196:199]
    ds_read_b64_tr_b16 a[174:175], v103 offset:34824
    s_add_u32 m0, s60, 0
    v_mfma_f32_16x16x32_bf16 v[200:203], a[160:163], a[200:203], v[200:203]
    buffer_load_dwordx4 v12, s[12:15], s63 offen offset:0 nt lds
    s_waitcnt lgkmcnt(5)
    v_mfma_f32_16x16x32_bf16 v[216:219], a[164:167], a[200:203], v[216:219]
    ds_read_b64_tr_b16 a[144:145], v100 offset:49152
    v_mfma_f32_16x16x32_bf16 v[212:215], a[164:167], a[196:199], v[212:215]
    ds_read_b64_tr_b16 a[146:147], v100 offset:51200
    v_mfma_f32_16x16x32_bf16 v[208:211], a[164:167], a[192:195], v[208:211]
    buffer_load_dwordx4 v13, s[12:15], s63 offen offset:1024 nt lds
    s_waitcnt lgkmcnt(5)
    v_mfma_f32_16x16x32_bf16 v[224:227], a[168:171], a[192:195], v[224:227]
    ds_read_b64_tr_b16 a[148:149], v100 offset:49160
    v_mfma_f32_16x16x32_bf16 v[228:231], a[168:171], a[196:199], v[228:231]
    ds_read_b64_tr_b16 a[150:151], v100 offset:51208
    v_mfma_f32_16x16x32_bf16 v[232:235], a[168:171], a[200:203], v[232:235]
    buffer_load_dwordx4 v14, s[12:15], s63 offen offset:2048 nt lds
    s_waitcnt lgkmcnt(4)
    v_mfma_f32_16x16x32_bf16 v[248:251], a[172:175], a[200:203], v[248:251]
    ds_read_b64_tr_b16 a[152:153], v101 offset:49152
    v_mfma_f32_16x16x32_bf16 v[244:247], a[172:175], a[196:199], v[244:247]
    ds_read_b64_tr_b16 a[154:155], v101 offset:51200
    v_mfma_f32_16x16x32_bf16 v[240:243], a[172:175], a[192:195], v[240:243]
    buffer_load_dwordx4 v15, s[12:15], s63 offen offset:3072 nt lds
    s_add_u32 s63, s63, 8192
    s_waitcnt lgkmcnt(4)
    v_mfma_f32_16x16x32_bf16 v[128:131], a[144:147], a[208:211], v[128:131]
    s_waitcnt vmcnt(20)
    s_waitcnt vmcnt(12)
    s_barrier
    ds_read_b64_tr_b16 a[156:157], v101 offset:49160
    v_mfma_f32_16x16x32_bf16 v[132:135], a[144:147], a[212:215], v[132:135]
    ds_read_b64_tr_b16 a[158:159], v101 offset:51208
    s_add_u32 m0, s59, 147456
    s_mov_b32 s68, 640
    v_mfma_f32_16x16x32_bf16 v[136:139], a[144:147], a[216:219], v[136:139]
    buffer_load_dwordx4 v108, s[8:11], s68 offen offset:0  lds
    s_waitcnt lgkmcnt(4)
    v_mfma_f32_16x16x32_bf16 v[152:155], a[148:151], a[216:219], v[152:155]
    ds_read_b64_tr_b16 a[160:161], v102 offset:49152
    ds_read_b128 a[192:195], v64 offset:0
    v_mfma_f32_16x16x32_bf16 v[148:151], a[148:151], a[212:215], v[148:151]
    ds_read_b64_tr_b16 a[162:163], v102 offset:51200
    v_mfma_f32_16x16x32_bf16 v[144:147], a[148:151], a[208:211], v[144:147]
    buffer_load_dwordx4 v109, s[8:11], s68 offen offset:1024  lds
    s_waitcnt lgkmcnt(5)
    v_mfma_f32_16x16x32_bf16 v[160:163], a[152:155], a[208:211], v[160:163]
    ds_read_b64_tr_b16 a[164:165], v102 offset:49160
    ds_read_b128 a[196:199], v64 offset:2048
    v_mfma_f32_16x16x32_bf16 v[164:167], a[152:155], a[212:215], v[164:167]
    ds_read_b64_tr_b16 a[166:167], v102 offset:51208
    v_mfma_f32_16x16x32_bf16 v[168:171], a[152:155], a[216:219], v[168:171]
    buffer_load_dwordx4 v110, s[8:11], s68 offen offset:2048  lds
    s_waitcnt lgkmcnt(6)
    v_mfma_f32_16x16x32_bf16 v[184:187], a[156:159], a[216:219], v[184:187]
    ds_read_b64_tr_b16 a[168:169], v103 offset:49152
    v_mfma_f32_16x16x32_bf16 v[180:183], a[156:159], a[212:215], v[180:183]
    ds_read_b64_tr_b16 a[170:171], v103 offset:51200
    ds_read_b128 a[200:203], v64 offset:4096
    v_mfma_f32_16x16x32_bf16 v[176:179], a[156:159], a[208:211], v[176:179]
    buffer_load_dwordx4 v111, s[8:11], s68 offen offset:3072  lds
    s_waitcnt lgkmcnt(6)
    v_mfma_f32_16x16x32_bf16 v[192:195], a[160:163], a[208:211], v[192:195]
    ds_read_b64_tr_b16 a[172:173], v103 offset:49160
    v_mfma_f32_16x16x32_bf16 v[196:199], a[160:163], a[212:215], v[196:199]
    ds_read_b64_tr_b16 a[174:175], v103 offset:51208
    s_add_u32 m0, s59, 98304
    s_mov_b32 s68, 3145728
    v_mfma_f32_16x16x32_bf16 v[200:203], a[160:163], a[216:219], v[200:203]
    buffer_load_dwordx4 v104, s[20:23], s68 offen offset:0  lds
    s_waitcnt lgkmcnt(5)
    v_mfma_f32_16x16x32_bf16 v[216:219], a[164:167], a[216:219], v[216:219]
    ds_read_b64_tr_b16 a[144:145], v96 offset:32768
    v_mfma_f32_16x16x32_bf16 v[212:215], a[164:167], a[212:215], v[212:215]
    ds_read_b64_tr_b16 a[146:147], v96 offset:34816
    v_mfma_f32_16x16x32_bf16 v[208:211], a[164:167], a[208:211], v[208:211]
    buffer_load_dwordx4 v105, s[20:23], s68 offen offset:1024  lds
    s_waitcnt lgkmcnt(5)
    v_mfma_f32_16x16x32_bf16 v[224:227], a[168:171], a[208:211], v[224:227]
    ds_read_b64_tr_b16 a[148:149], v96 offset:32776
    v_mfma_f32_16x16x32_bf16 v[228:231], a[168:171], a[212:215], v[228:231]
    ds_read_b64_tr_b16 a[150:151], v96 offset:34824
    v_mfma_f32_16x16x32_bf16 v[232:235], a[168:171], a[216:219], v[232:235]
    buffer_load_dwordx4 v106, s[20:23], s68 offen offset:2048  lds
    s_waitcnt lgkmcnt(4)
    v_mfma_f32_16x16x32_bf16 v[248:251], a[172:175], a[216:219], v[248:251]
    ds_read_b64_tr_b16 a[152:153], v97 offset:32768
    v_mfma_f32_16x16x32_bf16 v[244:247], a[172:175], a[212:215], v[244:247]
    ds_read_b64_tr_b16 a[154:155], v97 offset:34816
    v_mfma_f32_16x16x32_bf16 v[240:243], a[172:175], a[208:211], v[240:243]
    buffer_load_dwordx4 v107, s[20:23], s68 offen offset:3072  lds
    s_waitcnt lgkmcnt(4)
    v_mfma_f32_16x16x32_bf16 v[128:131], a[144:147], a[192:195], v[128:131]
    s_waitcnt vmcnt(63)
    s_barrier
    ds_read_b64_tr_b16 a[156:157], v97 offset:32776
    v_mfma_f32_16x16x32_bf16 v[132:135], a[144:147], a[196:199], v[132:135]
    ds_read_b64_tr_b16 a[158:159], v97 offset:34824
    s_add_u32 m0, s59, 114688
    s_mov_b32 s68, 3407872
    v_mfma_f32_16x16x32_bf16 v[136:139], a[144:147], a[200:203], v[136:139]
    buffer_load_dwordx4 v104, s[20:23], s68 offen offset:0  lds
    s_waitcnt lgkmcnt(4)
    v_mfma_f32_16x16x32_bf16 v[152:155], a[148:151], a[200:203], v[152:155]
    ds_read_b64_tr_b16 a[160:161], v98 offset:32768
    ds_read_b128 a[208:211], v65 offset:0
    v_mfma_f32_16x16x32_bf16 v[148:151], a[148:151], a[196:199], v[148:151]
    ds_read_b64_tr_b16 a[162:163], v98 offset:34816
    v_mfma_f32_16x16x32_bf16 v[144:147], a[148:151], a[192:195], v[144:147]
    buffer_load_dwordx4 v105, s[20:23], s68 offen offset:1024  lds
    s_waitcnt lgkmcnt(5)
    v_mfma_f32_16x16x32_bf16 v[160:163], a[152:155], a[192:195], v[160:163]
    ds_read_b64_tr_b16 a[164:165], v98 offset:32776
    ds_read_b128 a[212:215], v65 offset:2048
    v_mfma_f32_16x16x32_bf16 v[164:167], a[152:155], a[196:199], v[164:167]
    ds_read_b64_tr_b16 a[166:167], v98 offset:34824
    v_mfma_f32_16x16x32_bf16 v[168:171], a[152:155], a[200:203], v[168:171]
    buffer_load_dwordx4 v106, s[20:23], s68 offen offset:2048  lds
    s_waitcnt lgkmcnt(6)
    v_mfma_f32_16x16x32_bf16 v[184:187], a[156:159], a[200:203], v[184:187]
    ds_read_b64_tr_b16 a[168:169], v99 offset:32768
    v_mfma_f32_16x16x32_bf16 v[180:183], a[156:159], a[196:199], v[180:183]
    ds_read_b64_tr_b16 a[170:171], v99 offset:34816
    ds_read_b128 a[216:219], v65 offset:4096
    v_mfma_f32_16x16x32_bf16 v[176:179], a[156:159], a[192:195], v[176:179]
    buffer_load_dwordx4 v107, s[20:23], s68 offen offset:3072  lds
    s_waitcnt lgkmcnt(6)
    v_mfma_f32_16x16x32_bf16 v[192:195], a[160:163], a[192:195], v[192:195]
    ds_read_b64_tr_b16 a[172:173], v99 offset:32776
    v_mfma_f32_16x16x32_bf16 v[196:199], a[160:163], a[196:199], v[196:199]
    ds_read_b64_tr_b16 a[174:175], v99 offset:34824
    s_add_u32 m0, s60, 8192
    v_mfma_f32_16x16x32_bf16 v[200:203], a[160:163], a[200:203], v[200:203]
    buffer_load_dwordx4 v12, s[12:15], s63 offen offset:0 nt lds
    s_waitcnt lgkmcnt(5)
    v_mfma_f32_16x16x32_bf16 v[216:219], a[164:167], a[200:203], v[216:219]
    ds_read_b64_tr_b16 a[144:145], v96 offset:49152
    v_mfma_f32_16x16x32_bf16 v[212:215], a[164:167], a[196:199], v[212:215]
    ds_read_b64_tr_b16 a[146:147], v96 offset:51200
    v_mfma_f32_16x16x32_bf16 v[208:211], a[164:167], a[192:195], v[208:211]
    buffer_load_dwordx4 v13, s[12:15], s63 offen offset:1024 nt lds
    s_waitcnt lgkmcnt(5)
    v_mfma_f32_16x16x32_bf16 v[224:227], a[168:171], a[192:195], v[224:227]
    ds_read_b64_tr_b16 a[148:149], v96 offset:49160
    v_mfma_f32_16x16x32_bf16 v[228:231], a[168:171], a[196:199], v[228:231]
    ds_read_b64_tr_b16 a[150:151], v96 offset:51208
    v_mfma_f32_16x16x32_bf16 v[232:235], a[168:171], a[200:203], v[232:235]
    buffer_load_dwordx4 v14, s[12:15], s63 offen offset:2048 nt lds
    s_waitcnt lgkmcnt(4)
    v_mfma_f32_16x16x32_bf16 v[248:251], a[172:175], a[200:203], v[248:251]
    ds_read_b64_tr_b16 a[152:153], v97 offset:49152
    v_mfma_f32_16x16x32_bf16 v[244:247], a[172:175], a[196:199], v[244:247]
    ds_read_b64_tr_b16 a[154:155], v97 offset:51200
    v_mfma_f32_16x16x32_bf16 v[240:243], a[172:175], a[192:195], v[240:243]
    buffer_load_dwordx4 v15, s[12:15], s63 offen offset:3072 nt lds
    s_add_u32 s63, s63, 24576
    s_waitcnt lgkmcnt(4)
    v_mfma_f32_16x16x32_bf16 v[128:131], a[144:147], a[208:211], v[128:131]
    s_waitcnt vmcnt(24)
    s_waitcnt vmcnt(12)
    s_barrier
    ds_read_b64_tr_b16 a[156:157], v97 offset:49160
    v_mfma_f32_16x16x32_bf16 v[132:135], a[144:147], a[212:215], v[132:135]
    ds_read_b64_tr_b16 a[158:159], v97 offset:51208
    s_add_u32 m0, s59, 131072
    s_mov_b32 s68, 768
    v_mfma_f32_16x16x32_bf16 v[136:139], a[144:147], a[216:219], v[136:139]
    buffer_load_dwordx4 v108, s[8:11], s68 offen offset:0  lds
    s_waitcnt lgkmcnt(4)
    v_mfma_f32_16x16x32_bf16 v[152:155], a[148:151], a[216:219], v[152:155]
    ds_read_b64_tr_b16 a[160:161], v98 offset:49152
    ds_read_b128 a[192:195], v64 offset:16384
    v_mfma_f32_16x16x32_bf16 v[148:151], a[148:151], a[212:215], v[148:151]
    ds_read_b64_tr_b16 a[162:163], v98 offset:51200
    v_mfma_f32_16x16x32_bf16 v[144:147], a[148:151], a[208:211], v[144:147]
    ds_read_b128 a[196:199], v64 offset:18432
    s_waitcnt lgkmcnt(6)
    v_mfma_f32_16x16x32_bf16 v[160:163], a[152:155], a[208:211], v[160:163]
    ds_read_b64_tr_b16 a[164:165], v98 offset:49160
    v_mfma_f32_16x16x32_bf16 v[164:167], a[152:155], a[212:215], v[164:167]
    ds_read_b64_tr_b16 a[166:167], v98 offset:51208
    v_mfma_f32_16x16x32_bf16 v[168:171], a[152:155], a[216:219], v[168:171]
    s_waitcnt lgkmcnt(6)
    v_mfma_f32_16x16x32_bf16 v[184:187], a[156:159], a[216:219], v[184:187]
    ds_read_b64_tr_b16 a[168:169], v99 offset:49152
    v_mfma_f32_16x16x32_bf16 v[180:183], a[156:159], a[212:215], v[180:183]
    ds_read_b64_tr_b16 a[170:171], v99 offset:51200
    ds_read_b128 a[200:203], v64 offset:20480
    v_mfma_f32_16x16x32_bf16 v[176:179], a[156:159], a[208:211], v[176:179]
    buffer_load_dwordx4 v109, s[8:11], s68 offen offset:1024  lds
    s_waitcnt lgkmcnt(6)
    v_mfma_f32_16x16x32_bf16 v[192:195], a[160:163], a[208:211], v[192:195]
    ds_read_b64_tr_b16 a[172:173], v99 offset:49160
    v_mfma_f32_16x16x32_bf16 v[196:199], a[160:163], a[212:215], v[196:199]
    ds_read_b64_tr_b16 a[174:175], v99 offset:51208
    v_mfma_f32_16x16x32_bf16 v[200:203], a[160:163], a[216:219], v[200:203]
    s_waitcnt lgkmcnt(5)
    v_mfma_f32_16x16x32_bf16 v[216:219], a[164:167], a[216:219], v[216:219]
    ds_read_b64_tr_b16 a[144:145], v100 offset:0
    v_mfma_f32_16x16x32_bf16 v[212:215], a[164:167], a[212:215], v[212:215]
    ds_read_b64_tr_b16 a[146:147], v100 offset:2048
    v_mfma_f32_16x16x32_bf16 v[208:211], a[164:167], a[208:211], v[208:211]
    buffer_load_dwordx4 v110, s[8:11], s68 offen offset:2048  lds
    s_waitcnt lgkmcnt(5)
    v_mfma_f32_16x16x32_bf16 v[224:227], a[168:171], a[208:211], v[224:227]
    ds_read_b64_tr_b16 a[148:149], v100 offset:8
    v_mfma_f32_16x16x32_bf16 v[228:231], a[168:171], a[212:215], v[228:231]
    ds_read_b64_tr_b16 a[150:151], v100 offset:2056
    v_mfma_f32_16x16x32_bf16 v[232:235], a[168:171], a[216:219], v[232:235]
    s_waitcnt lgkmcnt(4)
    v_mfma_f32_16x16x32_bf16 v[248:251], a[172:175], a[216:219], v[248:251]
    ds_read_b64_tr_b16 a[152:153], v101 offset:0
    v_mfma_f32_16x16x32_bf16 v[244:247], a[172:175], a[212:215], v[244:247]
    ds_read_b64_tr_b16 a[154:155], v101 offset:2048
    v_mfma_f32_16x16x32_bf16 v[240:243], a[172:175], a[208:211], v[240:243]
    buffer_load_dwordx4 v111, s[8:11], s68 offen offset:3072  lds
    s_waitcnt lgkmcnt(4)
    v_mfma_f32_16x16x32_bf16 v[128:131], a[144:147], a[192:195], v[128:131]
    s_waitcnt vmcnt(63)
    s_barrier
    ds_read_b64_tr_b16 a[156:157], v101 offset:8
    v_mfma_f32_16x16x32_bf16 v[132:135], a[144:147], a[196:199], v[132:135]
    ds_read_b64_tr_b16 a[158:159], v101 offset:2056
    s_add_u32 m0, s60, 32768
    v_mfma_f32_16x16x32_bf16 v[136:139], a[144:147], a[200:203], v[136:139]
    buffer_load_dwordx4 v12, s[12:15], s63 offen offset:0 nt lds
    s_waitcnt lgkmcnt(4)
    v_mfma_f32_16x16x32_bf16 v[152:155], a[148:151], a[200:203], v[152:155]
    ds_read_b64_tr_b16 a[160:161], v102 offset:0
    ds_read_b128 a[208:211], v65 offset:16384
    v_mfma_f32_16x16x32_bf16 v[148:151], a[148:151], a[196:199], v[148:151]
    ds_read_b64_tr_b16 a[162:163], v102 offset:2048
    v_mfma_f32_16x16x32_bf16 v[144:147], a[148:151], a[192:195], v[144:147]
    buffer_load_dwordx4 v13, s[12:15], s63 offen offset:1024 nt lds
    s_waitcnt lgkmcnt(5)
    v_mfma_f32_16x16x32_bf16 v[160:163], a[152:155], a[192:195], v[160:163]
    ds_read_b64_tr_b16 a[164:165], v102 offset:8
    ds_read_b128 a[212:215], v65 offset:18432
    v_mfma_f32_16x16x32_bf16 v[164:167], a[152:155], a[196:199], v[164:167]
    ds_read_b64_tr_b16 a[166:167], v102 offset:2056
    v_mfma_f32_16x16x32_bf16 v[168:171], a[152:155], a[200:203], v[168:171]
    buffer_load_dwordx4 v14, s[12:15], s63 offen offset:2048 nt lds
    s_waitcnt lgkmcnt(6)
    v_mfma_f32_16x16x32_bf16 v[184:187], a[156:159], a[200:203], v[184:187]
    ds_read_b64_tr_b16 a[168:169], v103 offset:0
    v_mfma_f32_16x16x32_bf16 v[180:183], a[156:159], a[196:199], v[180:183]
    ds_read_b64_tr_b16 a[170:171], v103 offset:2048
    ds_read_b128 a[216:219], v65 offset:20480
    v_mfma_f32_16x16x32_bf16 v[176:179], a[156:159], a[192:195], v[176:179]
    buffer_load_dwordx4 v15, s[12:15], s63 offen offset:3072 nt lds
    s_add_u32 s63, s63, 8192
    s_waitcnt lgkmcnt(6)
    v_mfma_f32_16x16x32_bf16 v[192:195], a[160:163], a[192:195], v[192:195]
    ds_read_b64_tr_b16 a[172:173], v103 offset:8
    v_mfma_f32_16x16x32_bf16 v[196:199], a[160:163], a[196:199], v[196:199]
    ds_read_b64_tr_b16 a[174:175], v103 offset:2056
    s_add_u32 m0, s60, 40960
    v_mfma_f32_16x16x32_bf16 v[200:203], a[160:163], a[200:203], v[200:203]
    buffer_load_dwordx4 v12, s[12:15], s63 offen offset:0 nt lds
    s_waitcnt lgkmcnt(5)
    v_mfma_f32_16x16x32_bf16 v[216:219], a[164:167], a[200:203], v[216:219]
    ds_read_b64_tr_b16 a[144:145], v100 offset:16384
    v_mfma_f32_16x16x32_bf16 v[212:215], a[164:167], a[196:199], v[212:215]
    ds_read_b64_tr_b16 a[146:147], v100 offset:18432
    v_mfma_f32_16x16x32_bf16 v[208:211], a[164:167], a[192:195], v[208:211]
    buffer_load_dwordx4 v13, s[12:15], s63 offen offset:1024 nt lds
    s_waitcnt lgkmcnt(5)
    v_mfma_f32_16x16x32_bf16 v[224:227], a[168:171], a[192:195], v[224:227]
    ds_read_b64_tr_b16 a[148:149], v100 offset:16392
    v_mfma_f32_16x16x32_bf16 v[228:231], a[168:171], a[196:199], v[228:231]
    ds_read_b64_tr_b16 a[150:151], v100 offset:18440
    v_mfma_f32_16x16x32_bf16 v[232:235], a[168:171], a[200:203], v[232:235]
    buffer_load_dwordx4 v14, s[12:15], s63 offen offset:2048 nt lds
    s_waitcnt lgkmcnt(4)
    v_mfma_f32_16x16x32_bf16 v[248:251], a[172:175], a[200:203], v[248:251]
    ds_read_b64_tr_b16 a[152:153], v101 offset:16384
    v_mfma_f32_16x16x32_bf16 v[244:247], a[172:175], a[196:199], v[244:247]
    ds_read_b64_tr_b16 a[154:155], v101 offset:18432
    v_mfma_f32_16x16x32_bf16 v[240:243], a[172:175], a[192:195], v[240:243]
    buffer_load_dwordx4 v15, s[12:15], s63 offen offset:3072 nt lds
    s_add_u32 s63, s63, 24576
    s_waitcnt lgkmcnt(4)
    v_mfma_f32_16x16x32_bf16 v[128:131], a[144:147], a[208:211], v[128:131]
    s_waitcnt vmcnt(20)
    s_waitcnt vmcnt(8)
    s_barrier
    ds_read_b64_tr_b16 a[156:157], v101 offset:16392
    v_mfma_f32_16x16x32_bf16 v[132:135], a[144:147], a[212:215], v[132:135]
    ds_read_b64_tr_b16 a[158:159], v101 offset:18440
    v_mfma_f32_16x16x32_bf16 v[136:139], a[144:147], a[216:219], v[136:139]
    ds_read_b128 a[192:195], v64 offset:0
    s_waitcnt lgkmcnt(5)
    v_mfma_f32_16x16x32_bf16 v[152:155], a[148:151], a[216:219], v[152:155]
    ds_read_b64_tr_b16 a[160:161], v102 offset:16384
    v_mfma_f32_16x16x32_bf16 v[148:151], a[148:151], a[212:215], v[148:151]
    ds_read_b64_tr_b16 a[162:163], v102 offset:18432
    v_mfma_f32_16x16x32_bf16 v[144:147], a[148:151], a[208:211], v[144:147]
    ds_read_b128 a[196:199], v64 offset:2048
    s_waitcnt lgkmcnt(6)
    v_mfma_f32_16x16x32_bf16 v[160:163], a[152:155], a[208:211], v[160:163]
    ds_read_b64_tr_b16 a[164:165], v102 offset:16392
    v_mfma_f32_16x16x32_bf16 v[164:167], a[152:155], a[212:215], v[164:167]
    ds_read_b64_tr_b16 a[166:167], v102 offset:18440
    v_mfma_f32_16x16x32_bf16 v[168:171], a[152:155], a[216:219], v[168:171]
    s_waitcnt lgkmcnt(6)
    v_mfma_f32_16x16x32_bf16 v[184:187], a[156:159], a[216:219], v[184:187]
    ds_read_b64_tr_b16 a[168:169], v103 offset:16384
    v_mfma_f32_16x16x32_bf16 v[180:183], a[156:159], a[212:215], v[180:183]
    ds_read_b64_tr_b16 a[170:171], v103 offset:18432
    ds_read_b128 a[200:203], v64 offset:4096
    v_mfma_f32_16x16x32_bf16 v[176:179], a[156:159], a[208:211], v[176:179]
    s_waitcnt lgkmcnt(6)
    v_mfma_f32_16x16x32_bf16 v[192:195], a[160:163], a[208:211], v[192:195]
    ds_read_b64_tr_b16 a[172:173], v103 offset:16392
    v_mfma_f32_16x16x32_bf16 v[196:199], a[160:163], a[212:215], v[196:199]
    ds_read_b64_tr_b16 a[174:175], v103 offset:18440
    v_mfma_f32_16x16x32_bf16 v[200:203], a[160:163], a[216:219], v[200:203]
    s_waitcnt lgkmcnt(5)
    v_mfma_f32_16x16x32_bf16 v[216:219], a[164:167], a[216:219], v[216:219]
    ds_read_b64_tr_b16 a[144:145], v100 offset:32768
    v_mfma_f32_16x16x32_bf16 v[212:215], a[164:167], a[212:215], v[212:215]
    ds_read_b64_tr_b16 a[146:147], v100 offset:34816
    v_mfma_f32_16x16x32_bf16 v[208:211], a[164:167], a[208:211], v[208:211]
    s_waitcnt lgkmcnt(5)
    v_mfma_f32_16x16x32_bf16 v[224:227], a[168:171], a[208:211], v[224:227]
    ds_read_b64_tr_b16 a[148:149], v100 offset:32776
    v_mfma_f32_16x16x32_bf16 v[228:231], a[168:171], a[212:215], v[228:231]
    ds_read_b64_tr_b16 a[150:151], v100 offset:34824
    v_mfma_f32_16x16x32_bf16 v[232:235], a[168:171], a[216:219], v[232:235]
    s_waitcnt lgkmcnt(4)
    v_mfma_f32_16x16x32_bf16 v[248:251], a[172:175], a[216:219], v[248:251]
    ds_read_b64_tr_b16 a[152:153], v101 offset:32768
    v_mfma_f32_16x16x32_bf16 v[244:247], a[172:175], a[212:215], v[244:247]
    ds_read_b64_tr_b16 a[154:155], v101 offset:34816
    v_mfma_f32_16x16x32_bf16 v[240:243], a[172:175], a[208:211], v[240:243]
    s_waitcnt lgkmcnt(4)
    v_mfma_f32_16x16x32_bf16 v[128:131], a[144:147], a[192:195], v[128:131]
    s_waitcnt vmcnt(63)
    s_barrier
    ds_read_b64_tr_b16 a[156:157], v101 offset:32776
    v_mfma_f32_16x16x32_bf16 v[132:135], a[144:147], a[196:199], v[132:135]
    ds_read_b64_tr_b16 a[158:159], v101 offset:34824
    s_add_u32 m0, s60, 65536
    v_mfma_f32_16x16x32_bf16 v[136:139], a[144:147], a[200:203], v[136:139]
    buffer_load_dwordx4 v16, s[16:19], s64 offen offset:0 nt lds
    s_waitcnt lgkmcnt(4)
    v_mfma_f32_16x16x32_bf16 v[152:155], a[148:151], a[200:203], v[152:155]
    ds_read_b64_tr_b16 a[160:161], v102 offset:32768
    ds_read_b128 a[208:211], v65 offset:0
    v_mfma_f32_16x16x32_bf16 v[148:151], a[148:151], a[196:199], v[148:151]
    ds_read_b64_tr_b16 a[162:163], v102 offset:34816
    v_mfma_f32_16x16x32_bf16 v[144:147], a[148:151], a[192:195], v[144:147]
    buffer_load_dwordx4 v17, s[16:19], s64 offen offset:1024 nt lds
    s_waitcnt lgkmcnt(5)
    v_mfma_f32_16x16x32_bf16 v[160:163], a[152:155], a[192:195], v[160:163]
    ds_read_b64_tr_b16 a[164:165], v102 offset:32776
    ds_read_b128 a[212:215], v65 offset:2048
    v_mfma_f32_16x16x32_bf16 v[164:167], a[152:155], a[196:199], v[164:167]
    ds_read_b64_tr_b16 a[166:167], v102 offset:34824
    v_mfma_f32_16x16x32_bf16 v[168:171], a[152:155], a[200:203], v[168:171]
    buffer_load_dwordx4 v18, s[16:19], s64 offen offset:2048 nt lds
    s_waitcnt lgkmcnt(6)
    v_mfma_f32_16x16x32_bf16 v[184:187], a[156:159], a[200:203], v[184:187]
    ds_read_b64_tr_b16 a[168:169], v103 offset:32768
    v_mfma_f32_16x16x32_bf16 v[180:183], a[156:159], a[196:199], v[180:183]
    ds_read_b64_tr_b16 a[170:171], v103 offset:34816
    ds_read_b128 a[216:219], v65 offset:4096
    v_mfma_f32_16x16x32_bf16 v[176:179], a[156:159], a[192:195], v[176:179]
    buffer_load_dwordx4 v19, s[16:19], s64 offen offset:3072 nt lds
    s_add_u32 s64, s64, 8192
    s_waitcnt lgkmcnt(6)
    v_mfma_f32_16x16x32_bf16 v[192:195], a[160:163], a[192:195], v[192:195]
    ds_read_b64_tr_b16 a[172:173], v103 offset:32776
    v_mfma_f32_16x16x32_bf16 v[196:199], a[160:163], a[196:199], v[196:199]
    ds_read_b64_tr_b16 a[174:175], v103 offset:34824
    s_add_u32 m0, s60, 73728
    v_mfma_f32_16x16x32_bf16 v[200:203], a[160:163], a[200:203], v[200:203]
    buffer_load_dwordx4 v16, s[16:19], s64 offen offset:0 nt lds
    s_waitcnt lgkmcnt(5)
    v_mfma_f32_16x16x32_bf16 v[216:219], a[164:167], a[200:203], v[216:219]
    ds_read_b64_tr_b16 a[144:145], v100 offset:49152
    v_mfma_f32_16x16x32_bf16 v[212:215], a[164:167], a[196:199], v[212:215]
    ds_read_b64_tr_b16 a[146:147], v100 offset:51200
    v_mfma_f32_16x16x32_bf16 v[208:211], a[164:167], a[192:195], v[208:211]
    buffer_load_dwordx4 v17, s[16:19], s64 offen offset:1024 nt lds
    s_waitcnt lgkmcnt(5)
    v_mfma_f32_16x16x32_bf16 v[224:227], a[168:171], a[192:195], v[224:227]
    ds_read_b64_tr_b16 a[148:149], v100 offset:49160
    v_mfma_f32_16x16x32_bf16 v[228:231], a[168:171], a[196:199], v[228:231]
    ds_read_b64_tr_b16 a[150:151], v100 offset:51208
    v_mfma_f32_16x16x32_bf16 v[232:235], a[168:171], a[200:203], v[232:235]
    buffer_load_dwordx4 v18, s[16:19], s64 offen offset:2048 nt lds
    s_waitcnt lgkmcnt(4)
    v_mfma_f32_16x16x32_bf16 v[248:251], a[172:175], a[200:203], v[248:251]
    ds_read_b64_tr_b16 a[152:153], v101 offset:49152
    v_mfma_f32_16x16x32_bf16 v[244:247], a[172:175], a[196:199], v[244:247]
    ds_read_b64_tr_b16 a[154:155], v101 offset:51200
    v_mfma_f32_16x16x32_bf16 v[240:243], a[172:175], a[192:195], v[240:243]
    buffer_load_dwordx4 v19, s[16:19], s64 offen offset:3072 nt lds
    s_add_u32 s64, s64, 24576
    s_waitcnt lgkmcnt(4)
    v_mfma_f32_16x16x32_bf16 v[128:131], a[144:147], a[208:211], v[128:131]
    s_waitcnt vmcnt(63)
    s_barrier
    ds_read_b64_tr_b16 a[156:157], v101 offset:49160
    v_mfma_f32_16x16x32_bf16 v[132:135], a[144:147], a[212:215], v[132:135]
    ds_read_b64_tr_b16 a[158:159], v101 offset:51208
    v_mfma_f32_16x16x32_bf16 v[136:139], a[144:147], a[216:219], v[136:139]
    s_waitcnt lgkmcnt(4)
    v_mfma_f32_16x16x32_bf16 v[152:155], a[148:151], a[216:219], v[152:155]
    ds_read_b64_tr_b16 a[160:161], v102 offset:49152
    v_mfma_f32_16x16x32_bf16 v[148:151], a[148:151], a[212:215], v[148:151]
    ds_read_b64_tr_b16 a[162:163], v102 offset:51200
    v_mfma_f32_16x16x32_bf16 v[144:147], a[148:151], a[208:211], v[144:147]
    s_waitcnt lgkmcnt(4)
    v_mfma_f32_16x16x32_bf16 v[160:163], a[152:155], a[208:211], v[160:163]
    ds_read_b64_tr_b16 a[164:165], v102 offset:49160
    v_mfma_f32_16x16x32_bf16 v[164:167], a[152:155], a[212:215], v[164:167]
    ds_read_b64_tr_b16 a[166:167], v102 offset:51208
    v_mfma_f32_16x16x32_bf16 v[168:171], a[152:155], a[216:219], v[168:171]
    s_waitcnt lgkmcnt(4)
    v_mfma_f32_16x16x32_bf16 v[184:187], a[156:159], a[216:219], v[184:187]
    ds_read_b64_tr_b16 a[168:169], v103 offset:49152
    v_mul_f32 v128, s67, v128
    v_mfma_f32_16x16x32_bf16 v[180:183], a[156:159], a[212:215], v[180:183]
    ds_read_b64_tr_b16 a[170:171], v103 offset:51200
    v_mul_f32 v129, s67, v129
    v_mfma_f32_16x16x32_bf16 v[176:179], a[156:159], a[208:211], v[176:179]
    v_mul_f32 v130, s67, v130
    v_mul_f32 v131, s67, v131
    s_waitcnt lgkmcnt(4)
    v_mfma_f32_16x16x32_bf16 v[192:195], a[160:163], a[208:211], v[192:195]
    ds_read_b64_tr_b16 a[172:173], v103 offset:49160
    v_mul_f32 v144, s67, v144
    v_mfma_f32_16x16x32_bf16 v[196:199], a[160:163], a[212:215], v[196:199]
    ds_read_b64_tr_b16 a[174:175], v103 offset:51208
    v_mul_f32 v145, s67, v145
    v_mfma_f32_16x16x32_bf16 v[200:203], a[160:163], a[216:219], v[200:203]
    v_mul_f32 v146, s67, v146
    v_mul_f32 v147, s67, v147
    s_waitcnt lgkmcnt(4)
    v_mfma_f32_16x16x32_bf16 v[216:219], a[164:167], a[216:219], v[216:219]
    ds_read_b128 a[144:147], v0 offset:0
    v_cvt_pk_bf16_f32 v128, v128, v129
    v_mfma_f32_16x16x32_bf16 v[212:215], a[164:167], a[212:215], v[212:215]
    v_cvt_pk_bf16_f32 v129, v130, v131
    v_cvt_pk_bf16_f32 v130, v144, v145
    v_mfma_f32_16x16x32_bf16 v[208:211], a[164:167], a[208:211], v[208:211]
    v_cvt_pk_bf16_f32 v131, v146, v147
    s_waitcnt lgkmcnt(3)
    v_mfma_f32_16x16x32_bf16 v[224:227], a[168:171], a[208:211], v[224:227]
    ds_read_b128 a[148:151], v0 offset:8192
    v_mfma_f32_16x16x32_bf16 v[228:231], a[168:171], a[212:215], v[228:231]
    ds_write_b128 v29, v[128:131] offset:0
    v_mfma_f32_16x16x32_bf16 v[232:235], a[168:171], a[216:219], v[232:235]
    ds_read_b128 a[0:3], v29 offset:0
    v_mul_f32 v132, s67, v132
    s_waitcnt lgkmcnt(4)
    v_mfma_f32_16x16x32_bf16 v[248:251], a[172:175], a[216:219], v[248:251]
    ds_read_b128 a[152:155], v1 offset:0
    v_mul_f32 v133, s67, v133
    v_mfma_f32_16x16x32_bf16 v[244:247], a[172:175], a[212:215], v[244:247]
    v_mul_f32 v134, s67, v134
    v_mul_f32 v135, s67, v135
    v_mfma_f32_16x16x32_bf16 v[240:243], a[172:175], a[208:211], v[240:243]
    v_mul_f32 v148, s67, v148
    v_mul_f32 v149, s67, v149
    v_mul_f32 v150, s67, v150
    v_mul_f32 v151, s67, v151
    v_cvt_pk_bf16_f32 v132, v132, v133
    v_cvt_pk_bf16_f32 v133, v134, v135
    v_cvt_pk_bf16_f32 v134, v148, v149
    v_cvt_pk_bf16_f32 v135, v150, v151
    ds_write_b128 v29, v[132:135] offset:1024
    ds_read_b128 a[32:35], v29 offset:1024
    v_mul_f32 v136, s67, v136
    v_mul_f32 v137, s67, v137
    v_mul_f32 v138, s67, v138
    v_mul_f32 v139, s67, v139
    v_mul_f32 v152, s67, v152
    v_mul_f32 v153, s67, v153
    v_mul_f32 v154, s67, v154
    v_mul_f32 v155, s67, v155
    v_cvt_pk_bf16_f32 v136, v136, v137
    v_cvt_pk_bf16_f32 v137, v138, v139
    v_cvt_pk_bf16_f32 v138, v152, v153
    v_cvt_pk_bf16_f32 v139, v154, v155
    ds_write_b128 v29, v[136:139] offset:2048
    ds_read_b128 a[64:67], v29 offset:2048
    v_pk_mul_f32 v[160:161], v[160:161], s[70:71]
    v_pk_mul_f32 v[162:163], v[162:163], s[70:71]
    v_pk_mul_f32 v[176:177], v[176:177], s[70:71]
    v_pk_mul_f32 v[178:179], v[178:179], s[70:71]
    v_cvt_pk_bf16_f32 v160, v160, v161
    v_cvt_pk_bf16_f32 v161, v162, v163
    v_cvt_pk_bf16_f32 v162, v176, v177
    v_cvt_pk_bf16_f32 v163, v178, v179
    ds_write_b128 v29, v[160:163] offset:16384
    ds_read_b128 a[4:7], v29 offset:16384
    v_pk_mul_f32 v[164:165], v[164:165], s[70:71]
    v_pk_mul_f32 v[166:167], v[166:167], s[70:71]
    v_pk_mul_f32 v[180:181], v[180:181], s[70:71]
    v_pk_mul_f32 v[182:183], v[182:183], s[70:71]
    v_cvt_pk_bf16_f32 v164, v164, v165
    v_cvt_pk_bf16_f32 v165, v166, v167
    v_cvt_pk_bf16_f32 v166, v180, v181
    v_cvt_pk_bf16_f32 v167, v182, v183
    ds_write_b128 v29, v[164:167] offset:17408
    ds_read_b128 a[36:39], v29 offset:17408
    v_pk_mul_f32 v[168:169], v[168:169], s[70:71]
    v_pk_mul_f32 v[170:171], v[170:171], s[70:71]
    v_pk_mul_f32 v[184:185], v[184:185], s[70:71]
    v_pk_mul_f32 v[186:187], v[186:187], s[70:71]
    v_cvt_pk_bf16_f32 v168, v168, v169
    v_cvt_pk_bf16_f32 v169, v170, v171
    v_cvt_pk_bf16_f32 v170, v184, v185
    v_cvt_pk_bf16_f32 v171, v186, v187
    ds_write_b128 v29, v[168:171] offset:18432
    ds_read_b128 a[68:71], v29 offset:18432
    s_waitcnt lgkmcnt(7)
    s_barrier
    ds_read_b128 a[16:19], v30 offset:0
    ds_read_b128 a[48:51], v30 offset:1024
    ds_read_b128 a[80:83], v30 offset:2048
    v_mfma_f32_16x16x32_bf16 v[64:67], a[144:147], a[0:3], v[32:35]
    ds_read_b128 a[156:159], v1 offset:8192
    v_mul_f32 v192, s67, v192
    v_mul_f32 v193, s67, v193
    v_mul_f32 v194, s67, v194
    v_mul_f32 v195, s67, v195
    v_mul_f32 v208, s67, v208
    v_mul_f32 v209, s67, v209
    v_mul_f32 v210, s67, v210
    v_mul_f32 v211, s67, v211
    v_mfma_f32_16x16x32_bf16 v[72:75], a[144:147], a[32:35], v[36:39]
    v_cvt_pk_bf16_f32 v192, v192, v193
    v_cvt_pk_bf16_f32 v193, v194, v195
    v_cvt_pk_bf16_f32 v194, v208, v209
    v_cvt_pk_bf16_f32 v195, v210, v211
    v_mul_f32 v196, s67, v196
    v_mul_f32 v197, s67, v197
    v_mul_f32 v198, s67, v198
    s_waitcnt lgkmcnt(10)
    v_mfma_f32_16x16x32_bf16 v[80:83], a[144:147], a[64:67], v[40:43]
    v_mul_f32 v199, s67, v199
    v_mul_f32 v212, s67, v212
    v_mul_f32 v213, s67, v213
    v_mul_f32 v214, s67, v214
    v_mul_f32 v215, s67, v215
    v_cvt_pk_bf16_f32 v196, v196, v197
    v_cvt_pk_bf16_f32 v197, v198, v199
    v_mfma_f32_16x16x32_bf16 v[84:87], a[148:151], a[64:67], v[40:43]
    ds_read_b128 a[160:163], v2 offset:0
    v_cvt_pk_bf16_f32 v198, v212, v213
    v_cvt_pk_bf16_f32 v199, v214, v215
    v_mul_f32 v200, s67, v200
    v_mul_f32 v201, s67, v201
    v_mul_f32 v202, s67, v202
    v_mul_f32 v203, s67, v203
    v_mul_f32 v216, s67, v216
    v_mfma_f32_16x16x32_bf16 v[76:79], a[148:151], a[32:35], v[36:39]
    v_mul_f32 v217, s67, v217
    v_mul_f32 v218, s67, v218
    v_mul_f32 v219, s67, v219
    v_cvt_pk_bf16_f32 v200, v200, v201
    v_cvt_pk_bf16_f32 v201, v202, v203
    v_cvt_pk_bf16_f32 v202, v216, v217
    v_cvt_pk_bf16_f32 v203, v218, v219
    v_mfma_f32_16x16x32_bf16 v[68:71], a[148:151], a[0:3], v[32:35]
    s_waitcnt lgkmcnt(2)
    s_barrier
    ds_read_b128 a[20:23], v30 offset:16384
    ds_read_b128 a[52:55], v30 offset:17408
    ds_read_b128 a[84:87], v30 offset:18432
    v_mfma_f32_16x16x32_bf16 v[64:67], a[152:155], a[4:7], v[64:67]
    ds_read_b128 a[164:167], v2 offset:8192
    ds_write_b128 v29, v[192:195] offset:0
    ds_read_b128 a[8:11], v29 offset:0
    v_mul_f32 v224, s67, v224
    v_mul_f32 v225, s67, v225
    v_mul_f32 v226, s67, v226
    v_mul_f32 v227, s67, v227
    v_mul_f32 v240, s67, v240
    v_mul_f32 v241, s67, v241
    v_mul_f32 v242, s67, v242
    v_mfma_f32_16x16x32_bf16 v[72:75], a[152:155], a[36:39], v[72:75]
    v_mul_f32 v243, s67, v243
    v_cvt_pk_bf16_f32 v224, v224, v225
    v_cvt_pk_bf16_f32 v225, v226, v227
    v_cvt_pk_bf16_f32 v226, v240, v241
    v_cvt_pk_bf16_f32 v227, v242, v243
    ds_write_b128 v29, v[196:199] offset:1024
    ds_read_b128 a[40:43], v29 offset:1024
    v_mul_f32 v228, s67, v228
    v_mfma_f32_16x16x32_bf16 v[80:83], a[152:155], a[68:71], v[80:83]
    v_mul_f32 v229, s67, v229
    v_mul_f32 v230, s67, v230
    v_mul_f32 v231, s67, v231
    v_mul_f32 v244, s67, v244
    v_mul_f32 v245, s67, v245
    v_mul_f32 v246, s67, v246
    v_mul_f32 v247, s67, v247
    v_cvt_pk_bf16_f32 v228, v228, v229
    v_cvt_pk_bf16_f32 v229, v230, v231
    s_waitcnt lgkmcnt(9)
    v_mfma_f32_16x16x32_bf16 v[84:87], a[156:159], a[68:71], v[84:87]
    ds_read_b128 a[168:171], v3 offset:0
    v_cvt_pk_bf16_f32 v230, v244, v245
    v_cvt_pk_bf16_f32 v231, v246, v247
    ds_write_b128 v29, v[200:203] offset:2048
    ds_read_b128 a[72:75], v29 offset:2048
    v_mul_f32 v232, s67, v232
    v_mul_f32 v233, s67, v233
    v_mul_f32 v234, s67, v234
    v_mul_f32 v235, s67, v235
    v_mfma_f32_16x16x32_bf16 v[76:79], a[156:159], a[36:39], v[76:79]
    v_mul_f32 v248, s67, v248
    v_mul_f32 v249, s67, v249
    v_mul_f32 v250, s67, v250
    v_mul_f32 v251, s67, v251
    v_cvt_pk_bf16_f32 v232, v232, v233
    v_cvt_pk_bf16_f32 v233, v234, v235
    v_cvt_pk_bf16_f32 v234, v248, v249
    v_cvt_pk_bf16_f32 v235, v250, v251
    v_mfma_f32_16x16x32_bf16 v[68:71], a[156:159], a[4:7], v[68:71]
    s_waitcnt lgkmcnt(8)
    s_waitcnt lgkmcnt(1)
    s_barrier
    ds_read_b128 a[24:27], v30 offset:0
    ds_read_b128 a[56:59], v30 offset:1024
    ds_read_b128 a[88:91], v30 offset:2048
    v_mfma_f32_16x16x32_bf16 v[64:67], a[160:163], a[8:11], v[64:67]
    ds_read_b128 a[172:175], v3 offset:8192
    ds_write_b128 v29, v[224:227] offset:16384
    ds_read_b128 a[12:15], v29 offset:16384
    v_mfma_f32_16x16x32_bf16 v[72:75], a[160:163], a[40:43], v[72:75]
    ds_write_b128 v29, v[228:231] offset:17408
    s_waitcnt lgkmcnt(7)
    v_mfma_f32_16x16x32_bf16 v[80:83], a[160:163], a[72:75], v[80:83]
    ds_read_b128 a[44:47], v29 offset:17408
    ds_write_b128 v29, v[232:235] offset:18432
    v_mfma_f32_16x16x32_bf16 v[84:87], a[164:167], a[72:75], v[84:87]
    ds_read_b128 a[144:147], v0 offset:256
    ds_read_b128 a[76:79], v29 offset:18432
    v_mfma_f32_16x16x32_bf16 v[76:79], a[164:167], a[40:43], v[76:79]
    v_mfma_f32_16x16x32_bf16 v[68:71], a[164:167], a[8:11], v[68:71]
    s_waitcnt lgkmcnt(5)
    v_mfma_f32_16x16x32_bf16 v[64:67], a[168:171], a[12:15], v[64:67]
    ds_read_b128 a[148:151], v0 offset:8448
    s_waitcnt lgkmcnt(4)
    v_mfma_f32_16x16x32_bf16 v[72:75], a[168:171], a[44:47], v[72:75]
    s_waitcnt lgkmcnt(3)
    s_waitcnt vmcnt(8)
    s_barrier
    ds_read_b128 a[28:31], v30 offset:16384
    ds_read_b128 a[60:63], v30 offset:17408
    ds_read_b128 a[92:95], v30 offset:18432
    s_waitcnt lgkmcnt(4)
    v_mfma_f32_16x16x32_bf16 v[80:83], a[168:171], a[76:79], v[80:83]
    v_mfma_f32_16x16x32_bf16 v[84:87], a[172:175], a[76:79], v[84:87]
    ds_read_b128 a[152:155], v1 offset:256
    s_add_u32 m0, s60, 98304
    v_mfma_f32_16x16x32_bf16 v[76:79], a[172:175], a[44:47], v[76:79]
    buffer_load_dwordx4 v16, s[16:19], s64 offen offset:0 nt lds
    v_mfma_f32_16x16x32_bf16 v[68:71], a[172:175], a[12:15], v[68:71]
    v_mfma_f32_16x16x32_bf16 v[64:67], a[144:147], a[16:19], v[64:67]
    ds_read_b128 a[156:159], v1 offset:8448
    v_mfma_f32_16x16x32_bf16 v[72:75], a[144:147], a[48:51], v[72:75]
    buffer_load_dwordx4 v17, s[16:19], s64 offen offset:1024 nt lds
    v_mfma_f32_16x16x32_bf16 v[80:83], a[144:147], a[80:83], v[80:83]
    s_waitcnt lgkmcnt(5)
    v_mfma_f32_16x16x32_bf16 v[84:87], a[148:151], a[80:83], v[84:87]
    ds_read_b128 a[160:163], v2 offset:256
    v_mfma_f32_16x16x32_bf16 v[76:79], a[148:151], a[48:51], v[76:79]
    buffer_load_dwordx4 v18, s[16:19], s64 offen offset:2048 nt lds
    v_mfma_f32_16x16x32_bf16 v[68:71], a[148:151], a[16:19], v[68:71]
    s_waitcnt lgkmcnt(2)
    v_mfma_f32_16x16x32_bf16 v[64:67], a[152:155], a[20:23], v[64:67]
    ds_read_b128 a[164:167], v2 offset:8448
    v_mfma_f32_16x16x32_bf16 v[72:75], a[152:155], a[52:55], v[72:75]
    v_mfma_f32_16x16x32_bf16 v[80:83], a[152:155], a[84:87], v[80:83]
    buffer_load_dwordx4 v19, s[16:19], s64 offen offset:3072 nt lds
    s_add_u32 s64, s64, 8192
    s_waitcnt lgkmcnt(2)
    v_mfma_f32_16x16x32_bf16 v[84:87], a[156:159], a[84:87], v[84:87]
    ds_read_b128 a[168:171], v3 offset:256
    v_mfma_f32_16x16x32_bf16 v[76:79], a[156:159], a[52:55], v[76:79]
    s_add_u32 m0, s60, 106496
    v_mfma_f32_16x16x32_bf16 v[68:71], a[156:159], a[20:23], v[68:71]
    buffer_load_dwordx4 v16, s[16:19], s64 offen offset:0 nt lds
    s_waitcnt lgkmcnt(2)
    v_mfma_f32_16x16x32_bf16 v[64:67], a[160:163], a[24:27], v[64:67]
    ds_read_b128 a[172:175], v3 offset:8448
    v_mfma_f32_16x16x32_bf16 v[72:75], a[160:163], a[56:59], v[72:75]
    v_mfma_f32_16x16x32_bf16 v[80:83], a[160:163], a[88:91], v[80:83]
    s_waitcnt lgkmcnt(2)
    v_mfma_f32_16x16x32_bf16 v[84:87], a[164:167], a[88:91], v[84:87]
    ds_read_b128 a[144:147], v0 offset:32768
    v_mfma_f32_16x16x32_bf16 v[76:79], a[164:167], a[56:59], v[76:79]
    buffer_load_dwordx4 v17, s[16:19], s64 offen offset:1024 nt lds
    v_mfma_f32_16x16x32_bf16 v[68:71], a[164:167], a[24:27], v[68:71]
    s_waitcnt lgkmcnt(2)
    v_mfma_f32_16x16x32_bf16 v[64:67], a[168:171], a[28:31], v[64:67]
    ds_read_b128 a[148:151], v0 offset:40960
    v_mfma_f32_16x16x32_bf16 v[72:75], a[168:171], a[60:63], v[72:75]
    buffer_load_dwordx4 v18, s[16:19], s64 offen offset:2048 nt lds
    v_mfma_f32_16x16x32_bf16 v[80:83], a[168:171], a[92:95], v[80:83]
    s_waitcnt lgkmcnt(2)
    v_mfma_f32_16x16x32_bf16 v[84:87], a[172:175], a[92:95], v[84:87]
    ds_read_b128 a[152:155], v1 offset:32768
    v_mfma_f32_16x16x32_bf16 v[76:79], a[172:175], a[60:63], v[76:79]
    buffer_load_dwordx4 v19, s[16:19], s64 offen offset:3072 nt lds
    s_add_u32 s64, s64, 24576
    v_mfma_f32_16x16x32_bf16 v[68:71], a[172:175], a[28:31], v[68:71]
    v_max3_f32 v48, v64, v65, v66
    v_max3_f32 v49, v72, v73, v74
    v_max3_f32 v50, v80, v81, v82
    s_nop 4
    v_max3_f32 v48, v48, v67, v68
    v_max3_f32 v49, v49, v75, v76
    v_max3_f32 v50, v50, v83, v84
    v_max3_f32 v48, v48, v69, v70
    v_max3_f32 v49, v49, v77, v78
    v_max3_f32 v50, v50, v85, v86
    v_max_f32 v48, v48, v71
    v_max_f32 v49, v49, v79
    v_max_f32 v50, v50, v87
    v_mov_b32 v52, v48
    v_mov_b32 v53, v49
    v_mov_b32 v54, v50
    v_permlane32_swap_b32 v52, v48
    v_permlane32_swap_b32 v53, v49
    v_permlane32_swap_b32 v54, v50
    v_max_f32 v48, v48, v52
    v_max_f32 v49, v49, v53
    v_max_f32 v50, v50, v54
    v_mov_b32 v52, v48
    v_mov_b32 v53, v49
    v_mov_b32 v54, v50
    v_permlane16_swap_b32 v52, v48
    v_permlane16_swap_b32 v53, v49
    v_permlane16_swap_b32 v54, v50
    v_max_f32 v48, v48, v52
    v_max_f32 v49, v49, v53
    v_max_f32 v50, v50, v54
    v_mov_b32 v21, 0
    ds_write_b128 v22, v[48:51]
    ds_write_b32 v31, v21
    s_waitcnt lgkmcnt(0)
    s_barrier
    ds_read_b128 v[52:55], v23
    s_waitcnt lgkmcnt(0)
    v_max_f32 v48, v48, v52
    v_max_f32 v49, v49, v53
    v_max_f32 v50, v50, v54
    v_sub_f32 v32, 0, v48
    v_sub_f32 v33, 0, v48
    v_sub_f32 v34, 0, v48
    v_sub_f32 v35, 0, v48
    v_sub_f32 v36, 0, v49
    v_sub_f32 v37, 0, v49
    v_sub_f32 v38, 0, v49
    v_sub_f32 v39, 0, v49
    v_sub_f32 v40, 0, v50
    v_sub_f32 v41, 0, v50
    v_sub_f32 v42, 0, v50
    v_sub_f32 v43, 0, v50
    v_sub_f32 v64, v64, v48
    v_sub_f32 v65, v65, v48
    v_sub_f32 v66, v66, v48
    v_sub_f32 v67, v67, v48
    v_sub_f32 v68, v68, v48
    v_sub_f32 v69, v69, v48
    v_sub_f32 v70, v70, v48
    v_sub_f32 v71, v71, v48
    v_sub_f32 v72, v72, v49
    v_sub_f32 v73, v73, v49
    v_sub_f32 v74, v74, v49
    v_sub_f32 v75, v75, v49
    v_sub_f32 v76, v76, v49
    v_sub_f32 v77, v77, v49
    v_sub_f32 v78, v78, v49
    v_sub_f32 v79, v79, v49
    v_sub_f32 v80, v80, v50
    v_sub_f32 v81, v81, v50
    v_sub_f32 v82, v82, v50
    v_sub_f32 v83, v83, v50
    v_sub_f32 v84, v84, v50
    v_sub_f32 v85, v85, v50
    v_sub_f32 v86, v86, v50
    v_sub_f32 v87, v87, v50
    v_mfma_f32_16x16x32_bf16 v[96:99], a[144:147], a[0:3], v[32:35]
    s_waitcnt vmcnt(8)
    s_barrier
    ds_read_b128 a[156:159], v1 offset:40960
    v_mfma_f32_16x16x32_bf16 v[104:107], a[144:147], a[32:35], v[36:39]
    v_exp_f32 v64, v64
    s_add_u32 m0, s60, 0
    v_mfma_f32_16x16x32_bf16 v[112:115], a[144:147], a[64:67], v[40:43]
    s_waitcnt vmcnt(7)
    buffer_load_dwordx4 v12, s[12:15], s63 offen offset:0 nt lds
    v_mfma_f32_16x16x32_bf16 v[116:119], a[148:151], a[64:67], v[40:43]
    ds_read_b128 a[160:163], v2 offset:32768
    v_mfma_f32_16x16x32_bf16 v[108:111], a[148:151], a[32:35], v[36:39]
    v_exp_f32 v65, v65
    v_mfma_f32_16x16x32_bf16 v[100:103], a[148:151], a[0:3], v[32:35]
    v_exp_f32 v66, v66
    v_mfma_f32_16x16x32_bf16 v[96:99], a[152:155], a[4:7], v[96:99]
    ds_read_b128 a[164:167], v2 offset:40960
    v_cvt_pk_bf16_f32 v48, v64, v65
    v_mfma_f32_16x16x32_bf16 v[104:107], a[152:155], a[36:39], v[104:107]
    v_exp_f32 v67, v67
    v_mfma_f32_16x16x32_bf16 v[112:115], a[152:155], a[68:71], v[112:115]
    s_waitcnt vmcnt(7)
    buffer_load_dwordx4 v13, s[12:15], s63 offen offset:1024 nt lds
    s_waitcnt lgkmcnt(2)
    v_mfma_f32_16x16x32_bf16 v[116:119], a[156:159], a[68:71], v[116:119]
    ds_read_b128 a[168:171], v3 offset:32768
    v_cvt_pk_bf16_f32 v49, v66, v67
    v_mfma_f32_16x16x32_bf16 v[108:111], a[156:159], a[36:39], v[108:111]
    v_exp_f32 v68, v68
    v_mfma_f32_16x16x32_bf16 v[100:103], a[156:159], a[4:7], v[100:103]
    v_exp_f32 v69, v69
    s_waitcnt lgkmcnt(2)
    v_mfma_f32_16x16x32_bf16 v[96:99], a[160:163], a[8:11], v[96:99]
    ds_read_b128 a[172:175], v3 offset:40960
    v_cvt_pk_bf16_f32 v50, v68, v69
    v_mfma_f32_16x16x32_bf16 v[104:107], a[160:163], a[40:43], v[104:107]
    s_waitcnt vmcnt(7)
    buffer_load_dwordx4 v14, s[12:15], s63 offen offset:2048 nt lds
    v_mfma_f32_16x16x32_bf16 v[112:115], a[160:163], a[72:75], v[112:115]
    v_exp_f32 v70, v70
    s_waitcnt lgkmcnt(2)
    v_mfma_f32_16x16x32_bf16 v[116:119], a[164:167], a[72:75], v[116:119]
    ds_read_b128 a[144:147], v0 offset:33024
    v_mfma_f32_16x16x32_bf16 v[108:111], a[164:167], a[40:43], v[108:111]
    v_exp_f32 v71, v71
    v_mfma_f32_16x16x32_bf16 v[100:103], a[164:167], a[8:11], v[100:103]
    v_exp_f32 v72, v72
    s_waitcnt lgkmcnt(2)
    v_mfma_f32_16x16x32_bf16 v[96:99], a[168:171], a[12:15], v[96:99]
    ds_read_b128 a[148:151], v0 offset:41216
    v_cvt_pk_bf16_f32 v51, v70, v71
    v_mfma_f32_16x16x32_bf16 v[104:107], a[168:171], a[44:47], v[104:107]
    ds_write_b128 v29, v[48:51] offset:0
    v_mfma_f32_16x16x32_bf16 v[112:115], a[168:171], a[76:79], v[112:115]
    s_waitcnt vmcnt(7)
    buffer_load_dwordx4 v15, s[12:15], s63 offen offset:3072 nt lds
    s_add_u32 s63, s63, 8192
    s_waitcnt lgkmcnt(3)
    v_mfma_f32_16x16x32_bf16 v[116:119], a[172:175], a[76:79], v[116:119]
    ds_read_b128 a[152:155], v1 offset:33024
    v_exp_f32 v73, v73
    v_mfma_f32_16x16x32_bf16 v[108:111], a[172:175], a[44:47], v[108:111]
    v_exp_f32 v74, v74
    v_mfma_f32_16x16x32_bf16 v[100:103], a[172:175], a[12:15], v[100:103]
    v_exp_f32 v75, v75
    s_waitcnt lgkmcnt(3)
    v_mfma_f32_16x16x32_bf16 v[96:99], a[144:147], a[16:19], v[96:99]
    ds_read_b128 a[156:159], v1 offset:41216
    v_cvt_pk_bf16_f32 v52, v72, v73
    s_add_u32 m0, s60, 8192
    v_mfma_f32_16x16x32_bf16 v[104:107], a[144:147], a[48:51], v[104:107]
    s_waitcnt vmcnt(7)
    buffer_load_dwordx4 v12, s[12:15], s63 offen offset:0 nt lds
    v_mfma_f32_16x16x32_bf16 v[112:115], a[144:147], a[80:83], v[112:115]
    v_exp_f32 v76, v76
    s_waitcnt lgkmcnt(3)
    v_mfma_f32_16x16x32_bf16 v[116:119], a[148:151], a[80:83], v[116:119]
    ds_read_b128 a[160:163], v2 offset:33024
    v_cvt_pk_bf16_f32 v53, v74, v75
    v_mfma_f32_16x16x32_bf16 v[108:111], a[148:151], a[48:51], v[108:111]
    v_exp_f32 v77, v77
    v_mfma_f32_16x16x32_bf16 v[100:103], a[148:151], a[16:19], v[100:103]
    v_exp_f32 v78, v78
    s_waitcnt lgkmcnt(2)
    v_mfma_f32_16x16x32_bf16 v[96:99], a[152:155], a[20:23], v[96:99]
    ds_read_b128 a[164:167], v2 offset:41216
    v_cvt_pk_bf16_f32 v54, v76, v77
    v_mfma_f32_16x16x32_bf16 v[104:107], a[152:155], a[52:55], v[104:107]
    s_waitcnt vmcnt(7)
    buffer_load_dwordx4 v13, s[12:15], s63 offen offset:1024 nt lds
    v_mfma_f32_16x16x32_bf16 v[112:115], a[152:155], a[84:87], v[112:115]
    v_exp_f32 v79, v79
    s_waitcnt lgkmcnt(2)
    v_mfma_f32_16x16x32_bf16 v[116:119], a[156:159], a[84:87], v[116:119]
    ds_read_b128 a[168:171], v3 offset:33024
    v_cvt_pk_bf16_f32 v55, v78, v79
    v_mfma_f32_16x16x32_bf16 v[108:111], a[156:159], a[52:55], v[108:111]
    ds_write_b128 v29, v[52:55] offset:1024
    v_exp_f32 v80, v80
    v_mfma_f32_16x16x32_bf16 v[100:103], a[156:159], a[20:23], v[100:103]
    v_exp_f32 v81, v81
    s_waitcnt lgkmcnt(3)
    v_mfma_f32_16x16x32_bf16 v[96:99], a[160:163], a[24:27], v[96:99]
    ds_read_b128 a[172:175], v3 offset:41216
    v_cvt_pk_bf16_f32 v56, v80, v81
    v_mfma_f32_16x16x32_bf16 v[104:107], a[160:163], a[56:59], v[104:107]
    s_waitcnt vmcnt(7)
    buffer_load_dwordx4 v14, s[12:15], s63 offen offset:2048 nt lds
    v_exp_f32 v82, v82
    v_mfma_f32_16x16x32_bf16 v[112:115], a[160:163], a[88:91], v[112:115]
    v_exp_f32 v83, v83
    s_waitcnt lgkmcnt(3)
    v_mfma_f32_16x16x32_bf16 v[116:119], a[164:167], a[88:91], v[116:119]
    ds_read_b64_tr_b16 a[144:145], v4 offset:0
    v_cvt_pk_bf16_f32 v57, v82, v83
    v_mfma_f32_16x16x32_bf16 v[108:111], a[164:167], a[56:59], v[108:111]
    ds_read_b64_tr_b16 a[146:147], v4 offset:8192
    v_mfma_f32_16x16x32_bf16 v[100:103], a[164:167], a[24:27], v[100:103]
    v_exp_f32 v84, v84
    s_waitcnt lgkmcnt(4)
    v_mfma_f32_16x16x32_bf16 v[96:99], a[168:171], a[28:31], v[96:99]
    ds_read_b64_tr_b16 a[148:149], v5 offset:0
    v_mfma_f32_16x16x32_bf16 v[104:107], a[168:171], a[60:63], v[104:107]
    ds_read_b64_tr_b16 a[150:151], v5 offset:8192
    v_exp_f32 v85, v85
    v_mfma_f32_16x16x32_bf16 v[112:115], a[168:171], a[92:95], v[112:115]
    s_waitcnt vmcnt(7)
    buffer_load_dwordx4 v15, s[12:15], s63 offen offset:3072 nt lds
    s_add_u32 s63, s63, 24576
    s_waitcnt lgkmcnt(4)
    v_mfma_f32_16x16x32_bf16 v[116:119], a[172:175], a[92:95], v[116:119]
    ds_read_b64_tr_b16 a[152:153], v6 offset:0
    v_cvt_pk_bf16_f32 v58, v84, v85
    v_exp_f32 v86, v86
    v_mfma_f32_16x16x32_bf16 v[108:111], a[172:175], a[60:63], v[108:111]
    ds_read_b64_tr_b16 a[154:155], v6 offset:8192
    v_exp_f32 v87, v87
    v_mfma_f32_16x16x32_bf16 v[100:103], a[172:175], a[28:31], v[100:103]
    v_cvt_pk_bf16_f32 v59, v86, v87
    s_waitcnt lgkmcnt(4)
    v_mfma_f32_16x16x32_bf16 v[128:131], a[144:147], v[48:51], 0
    ds_read_b64_tr_b16 a[156:157], v7 offset:0
    ds_write_b128 v29, v[56:59] offset:2048
    v_mfma_f32_16x16x32_bf16 v[132:135], a[144:147], v[52:55], 0
    ds_read_b64_tr_b16 a[158:159], v7 offset:8192
    v_mfma_f32_16x16x32_bf16 v[136:139], a[144:147], v[56:59], 0
    s_waitcnt lgkmcnt(5)
    v_mfma_f32_16x16x32_bf16 v[152:155], a[148:151], v[56:59], 0
    ds_read_b64_tr_b16 a[160:161], v8 offset:0
    v_max3_f32 v28, v96, v97, v98
    v_mfma_f32_16x16x32_bf16 v[148:151], a[148:151], v[52:55], 0
    ds_read_b64_tr_b16 a[162:163], v8 offset:8192
    v_max3_f32 v28, v28, v99, v100
    v_mfma_f32_16x16x32_bf16 v[144:147], a[148:151], v[48:51], 0
    s_waitcnt lgkmcnt(3)
    s_barrier
    v_max3_f32 v28, v28, v101, v102
    v_max3_f32 v28, v28, v103, v104
    v_mfma_f32_16x16x32_bf16 v[160:163], a[152:155], v[48:51], 0
    ds_read_b64_tr_b16 a[164:165], v9 offset:0
    ds_read_b128 a[128:131], v30 offset:0
    v_mfma_f32_16x16x32_bf16 v[164:167], a[152:155], v[52:55], 0
    ds_read_b64_tr_b16 a[166:167], v9 offset:8192
    v_max3_f32 v28, v28, v105, v106
    s_add_u32 m0, s60, 32768
    v_mfma_f32_16x16x32_bf16 v[168:171], a[152:155], v[56:59], 0
    s_waitcnt vmcnt(7)
    buffer_load_dwordx4 v12, s[12:15], s63 offen offset:0 nt lds
    s_waitcnt lgkmcnt(5)
    v_mfma_f32_16x16x32_bf16 v[184:187], a[156:159], v[56:59], 0
    ds_read_b64_tr_b16 a[168:169], v10 offset:0
    ds_read_b128 a[132:135], v30 offset:1024
    v_mfma_f32_16x16x32_bf16 v[180:183], a[156:159], v[52:55], 0
    ds_read_b64_tr_b16 a[170:171], v10 offset:8192
    v_max3_f32 v28, v28, v107, v108
    v_mfma_f32_16x16x32_bf16 v[176:179], a[156:159], v[48:51], 0
    v_max3_f32 v28, v28, v109, v110
    v_max3_f32 v28, v28, v111, v112
    s_waitcnt lgkmcnt(6)
    v_mfma_f32_16x16x32_bf16 v[192:195], a[160:163], v[48:51], 0
    ds_read_b64_tr_b16 a[172:173], v11 offset:0
    v_add_f32 v24, v24, v64
    v_mfma_f32_16x16x32_bf16 v[196:199], a[160:163], v[52:55], 0
    ds_read_b64_tr_b16 a[174:175], v11 offset:8192
    ds_read_b128 a[136:139], v30 offset:2048
    v_mfma_f32_16x16x32_bf16 v[200:203], a[160:163], v[56:59], 0
    s_waitcnt vmcnt(7)
    buffer_load_dwordx4 v13, s[12:15], s63 offen offset:1024 nt lds
    s_waitcnt lgkmcnt(6)
    v_mfma_f32_16x16x32_bf16 v[216:219], a[164:167], v[56:59], 0
    ds_read_b64_tr_b16 a[144:145], v4 offset:16384
    v_add_f32 v25, v25, v72
    v_mfma_f32_16x16x32_bf16 v[212:215], a[164:167], v[52:55], 0
    ds_read_b64_tr_b16 a[146:147], v4 offset:24576
    v_add_f32 v26, v26, v80
    v_mfma_f32_16x16x32_bf16 v[208:211], a[164:167], v[48:51], 0
    s_waitcnt vmcnt(7)
    buffer_load_dwordx4 v14, s[12:15], s63 offen offset:2048 nt lds
    s_waitcnt lgkmcnt(5)
    v_mfma_f32_16x16x32_bf16 v[224:227], a[168:171], v[48:51], 0
    ds_read_b64_tr_b16 a[148:149], v5 offset:16384
    v_max3_f32 v28, v28, v113, v114
    v_mfma_f32_16x16x32_bf16 v[228:231], a[168:171], v[52:55], 0
    ds_read_b64_tr_b16 a[150:151], v5 offset:24576
    v_add_f32 v24, v24, v65
    v_max3_f32 v28, v28, v115, v116
    v_mfma_f32_16x16x32_bf16 v[232:235], a[168:171], v[56:59], 0
    v_add_f32 v25, v25, v73
    v_max3_f32 v28, v28, v117, v118
    s_waitcnt lgkmcnt(5)
    v_mfma_f32_16x16x32_bf16 v[248:251], a[172:175], v[56:59], 0
    ds_read_b64_tr_b16 a[152:153], v6 offset:16384
    v_add_f32 v26, v26, v81
    v_mfma_f32_16x16x32_bf16 v[244:247], a[172:175], v[52:55], 0
    ds_read_b64_tr_b16 a[154:155], v6 offset:24576
    v_max_f32 v28, v28, v119
    v_mfma_f32_16x16x32_bf16 v[240:243], a[172:175], v[48:51], 0
    s_waitcnt vmcnt(7)
    buffer_load_dwordx4 v15, s[12:15], s63 offen offset:3072 nt lds
    s_add_u32 s63, s63, 8192
    v_cmp_lt_f32 vcc, s66, v28
    s_cbranch_vccnz L_flag_p3_t0
L_flagback_p3_t0:
    s_waitcnt lgkmcnt(4)
    v_mfma_f32_16x16x32_bf16 v[128:131], a[144:147], a[128:131], v[128:131]
    s_waitcnt vmcnt(4)
    s_barrier
    ds_read_b32 v28, v31
    ds_read_b64_tr_b16 a[156:157], v7 offset:16384
    v_mfma_f32_16x16x32_bf16 v[132:135], a[144:147], a[132:135], v[132:135]
    ds_read_b64_tr_b16 a[158:159], v7 offset:24576
    v_add_f32 v24, v24, v66
    v_mfma_f32_16x16x32_bf16 v[136:139], a[144:147], a[136:139], v[136:139]
    v_add_f32 v25, v25, v74
    v_add_f32 v26, v26, v82
    s_waitcnt lgkmcnt(5)
    v_mfma_f32_16x16x32_bf16 v[152:155], a[148:151], a[136:139], v[152:155]
    ds_read_b64_tr_b16 a[160:161], v8 offset:16384
    v_add_f32 v24, v24, v67
    v_mfma_f32_16x16x32_bf16 v[148:151], a[148:151], a[132:135], v[148:151]
    ds_read_b64_tr_b16 a[162:163], v8 offset:24576
    v_add_f32 v25, v25, v75
    s_add_u32 m0, s60, 40960
    v_mfma_f32_16x16x32_bf16 v[144:147], a[148:151], a[128:131], v[144:147]
    s_waitcnt vmcnt(7)
    buffer_load_dwordx4 v12, s[12:15], s63 offen offset:0 nt lds
    s_waitcnt lgkmcnt(5)
    v_mfma_f32_16x16x32_bf16 v[160:163], a[152:155], a[128:131], v[160:163]
    ds_read_b64_tr_b16 a[164:165], v9 offset:16384
    v_add_f32 v26, v26, v83
    v_mfma_f32_16x16x32_bf16 v[164:167], a[152:155], a[132:135], v[164:167]
    ds_read_b64_tr_b16 a[166:167], v9 offset:24576
    v_add_f32 v24, v24, v68
    v_mfma_f32_16x16x32_bf16 v[168:171], a[152:155], a[136:139], v[168:171]
    s_waitcnt vmcnt(7)
    buffer_load_dwordx4 v13, s[12:15], s63 offen offset:1024 nt lds
    s_waitcnt lgkmcnt(4)
    v_mfma_f32_16x16x32_bf16 v[184:187], a[156:159], a[136:139], v[184:187]
    ds_read_b64_tr_b16 a[168:169], v10 offset:16384
    v_add_f32 v25, v25, v76
    v_mfma_f32_16x16x32_bf16 v[180:183], a[156:159], a[132:135], v[180:183]
    ds_read_b64_tr_b16 a[170:171], v10 offset:24576
    v_add_f32 v26, v26, v84
    v_mfma_f32_16x16x32_bf16 v[176:179], a[156:159], a[128:131], v[176:179]
    v_add_f32 v24, v24, v69
    v_add_f32 v25, v25, v77
    s_waitcnt lgkmcnt(4)
    v_mfma_f32_16x16x32_bf16 v[192:195], a[160:163], a[128:131], v[192:195]
    ds_read_b64_tr_b16 a[172:173], v11 offset:16384
    v_add_f32 v26, v26, v85
    v_mfma_f32_16x16x32_bf16 v[196:199], a[160:163], a[132:135], v[196:199]
    ds_read_b64_tr_b16 a[174:175], v11 offset:24576
    v_add_f32 v24, v24, v70
    v_mfma_f32_16x16x32_bf16 v[200:203], a[160:163], a[136:139], v[200:203]
    s_waitcnt vmcnt(7)
    buffer_load_dwordx4 v14, s[12:15], s63 offen offset:2048 nt lds
    s_waitcnt lgkmcnt(4)
    v_mfma_f32_16x16x32_bf16 v[216:219], a[164:167], a[136:139], v[216:219]
    ds_read_b128 a[144:147], v0 offset:0
    v_add_f32 v25, v25, v78
    v_mfma_f32_16x16x32_bf16 v[212:215], a[164:167], a[132:135], v[212:215]
    v_add_f32 v26, v26, v86
    v_add_f32 v24, v24, v71
    v_mfma_f32_16x16x32_bf16 v[208:211], a[164:167], a[128:131], v[208:211]
    v_add_f32 v25, v25, v79
    v_add_f32 v26, v26, v87
    s_waitcnt lgkmcnt(3)
    v_mfma_f32_16x16x32_bf16 v[224:227], a[168:171], a[128:131], v[224:227]
    ds_read_b128 a[148:151], v0 offset:8192
    v_mfma_f32_16x16x32_bf16 v[228:231], a[168:171], a[132:135], v[228:231]
    s_waitcnt vmcnt(7)
    buffer_load_dwordx4 v15, s[12:15], s63 offen offset:3072 nt lds
    s_add_u32 s63, s63, 24576
    v_mfma_f32_16x16x32_bf16 v[232:235], a[168:171], a[136:139], v[232:235]
    s_waitcnt lgkmcnt(2)
    v_mfma_f32_16x16x32_bf16 v[248:251], a[172:175], a[136:139], v[248:251]
    ds_read_b128 a[152:155], v1 offset:0
    v_mfma_f32_16x16x32_bf16 v[244:247], a[172:175], a[132:135], v[244:247]
    v_cmp_ne_u32 vcc, 0, v28
    v_mfma_f32_16x16x32_bf16 v[240:243], a[172:175], a[128:131], v[240:243]
    s_cbranch_vccnz L_rare_p3_t0
L_rareback_p3_t0:
    s_waitcnt lgkmcnt(2)
    v_mfma_f32_16x16x32_bf16 v[64:67], a[144:147], a[0:3], v[32:35]
    s_waitcnt vmcnt(63)
    s_barrier
    ds_read_b128 a[156:159], v1 offset:8192
    v_mfma_f32_16x16x32_bf16 v[72:75], a[144:147], a[32:35], v[36:39]
    v_exp_f32 v96, v96
    s_add_u32 m0, s60, 65536
    v_mfma_f32_16x16x32_bf16 v[80:83], a[144:147], a[64:67], v[40:43]
    s_waitcnt vmcnt(7)
    buffer_load_dwordx4 v16, s[16:19], s64 offen offset:0 nt lds
    s_waitcnt lgkmcnt(2)
    v_mfma_f32_16x16x32_bf16 v[84:87], a[148:151], a[64:67], v[40:43]
    ds_read_b128 a[160:163], v2 offset:0
    v_mfma_f32_16x16x32_bf16 v[76:79], a[148:151], a[32:35], v[36:39]
    v_exp_f32 v97, v97
    v_mfma_f32_16x16x32_bf16 v[68:71], a[148:151], a[0:3], v[32:35]
    v_exp_f32 v98, v98
    s_waitcnt lgkmcnt(2)
    v_mfma_f32_16x16x32_bf16 v[64:67], a[152:155], a[4:7], v[64:67]
    ds_read_b128 a[164:167], v2 offset:8192
    v_cvt_pk_bf16_f32 v48, v96, v97
    v_mfma_f32_16x16x32_bf16 v[72:75], a[152:155], a[36:39], v[72:75]
    v_exp_f32 v99, v99
    v_mfma_f32_16x16x32_bf16 v[80:83], a[152:155], a[68:71], v[80:83]
    s_waitcnt vmcnt(7)
    buffer_load_dwordx4 v17, s[16:19], s64 offen offset:1024 nt lds
    s_waitcnt lgkmcnt(2)
    v_mfma_f32_16x16x32_bf16 v[84:87], a[156:159], a[68:71], v[84:87]
    ds_read_b128 a[168:171], v3 offset:0
    v_cvt_pk_bf16_f32 v49, v98, v99
    v_mfma_f32_16x16x32_bf16 v[76:79], a[156:159], a[36:39], v[76:79]
    v_exp_f32 v100, v100
    v_mfma_f32_16x16x32_bf16 v[68:71], a[156:159], a[4:7], v[68:71]
    v_exp_f32 v101, v101
    s_waitcnt lgkmcnt(2)
    v_mfma_f32_16x16x32_bf16 v[64:67], a[160:163], a[8:11], v[64:67]
    ds_read_b128 a[172:175], v3 offset:8192
    v_cvt_pk_bf16_f32 v50, v100, v101
    v_mfma_f32_16x16x32_bf16 v[72:75], a[160:163], a[40:43], v[72:75]
    s_waitcnt vmcnt(7)
    buffer_load_dwordx4 v18, s[16:19], s64 offen offset:2048 nt lds
    v_mfma_f32_16x16x32_bf16 v[80:83], a[160:163], a[72:75], v[80:83]
    v_exp_f32 v102, v102
    s_waitcnt lgkmcnt(2)
    v_mfma_f32_16x16x32_bf16 v[84:87], a[164:167], a[72:75], v[84:87]
    ds_read_b128 a[144:147], v0 offset:256
    v_mfma_f32_16x16x32_bf16 v[76:79], a[164:167], a[40:43], v[76:79]
    v_exp_f32 v103, v103
    v_mfma_f32_16x16x32_bf16 v[68:71], a[164:167], a[8:11], v[68:71]
    v_exp_f32 v104, v104
    s_waitcnt lgkmcnt(2)
    v_mfma_f32_16x16x32_bf16 v[64:67], a[168:171], a[12:15], v[64:67]
    ds_read_b128 a[148:151], v0 offset:8448
    v_cvt_pk_bf16_f32 v51, v102, v103
    v_mfma_f32_16x16x32_bf16 v[72:75], a[168:171], a[44:47], v[72:75]
    ds_write_b128 v29, v[48:51] offset:0
    v_mfma_f32_16x16x32_bf16 v[80:83], a[168:171], a[76:79], v[80:83]
    s_waitcnt vmcnt(7)
    buffer_load_dwordx4 v19, s[16:19], s64 offen offset:3072 nt lds
    s_add_u32 s64, s64, 8192
    s_waitcnt lgkmcnt(3)
    v_mfma_f32_16x16x32_bf16 v[84:87], a[172:175], a[76:79], v[84:87]
    ds_read_b128 a[152:155], v1 offset:256
    v_exp_f32 v105, v105
    v_mfma_f32_16x16x32_bf16 v[76:79], a[172:175], a[44:47], v[76:79]
    v_exp_f32 v106, v106
    v_mfma_f32_16x16x32_bf16 v[68:71], a[172:175], a[12:15], v[68:71]
    v_exp_f32 v107, v107
    s_waitcnt lgkmcnt(3)
    v_mfma_f32_16x16x32_bf16 v[64:67], a[144:147], a[16:19], v[64:67]
    ds_read_b128 a[156:159], v1 offset:8448
    v_cvt_pk_bf16_f32 v52, v104, v105
    s_add_u32 m0, s60, 73728
    v_mfma_f32_16x16x32_bf16 v[72:75], a[144:147], a[48:51], v[72:75]
    s_waitcnt vmcnt(7)
    buffer_load_dwordx4 v16, s[16:19], s64 offen offset:0 nt lds
    v_mfma_f32_16x16x32_bf16 v[80:83], a[144:147], a[80:83], v[80:83]
    v_exp_f32 v108, v108
    s_waitcnt lgkmcnt(3)
    v_mfma_f32_16x16x32_bf16 v[84:87], a[148:151], a[80:83], v[84:87]
    ds_read_b128 a[160:163], v2 offset:256
    v_cvt_pk_bf16_f32 v53, v106, v107
    v_mfma_f32_16x16x32_bf16 v[76:79], a[148:151], a[48:51], v[76:79]
    v_exp_f32 v109, v109
    v_mfma_f32_16x16x32_bf16 v[68:71], a[148:151], a[16:19], v[68:71]
    v_exp_f32 v110, v110
    s_waitcnt lgkmcnt(2)
    v_mfma_f32_16x16x32_bf16 v[64:67], a[152:155], a[20:23], v[64:67]
    ds_read_b128 a[164:167], v2 offset:8448
    v_cvt_pk_bf16_f32 v54, v108, v109
    v_mfma_f32_16x16x32_bf16 v[72:75], a[152:155], a[52:55], v[72:75]
    s_waitcnt vmcnt(7)
    buffer_load_dwordx4 v17, s[16:19], s64 offen offset:1024 nt lds
    v_mfma_f32_16x16x32_bf16 v[80:83], a[152:155], a[84:87], v[80:83]
    v_exp_f32 v111, v111
    s_waitcnt lgkmcnt(2)
    v_mfma_f32_16x16x32_bf16 v[84:87], a[156:159], a[84:87], v[84:87]
    ds_read_b128 a[168:171], v3 offset:256
    v_cvt_pk_bf16_f32 v55, v110, v111
    v_mfma_f32_16x16x32_bf16 v[76:79], a[156:159], a[52:55], v[76:79]
    ds_write_b128 v29, v[52:55] offset:1024
    v_exp_f32 v112, v112
    v_mfma_f32_16x16x32_bf16 v[68:71], a[156:159], a[20:23], v[68:71]
    v_exp_f32 v113, v113
    s_waitcnt lgkmcnt(3)
    v_mfma_f32_16x16x32_bf16 v[64:67], a[160:163], a[24:27], v[64:67]
    ds_read_b128 a[172:175], v3 offset:8448
    v_cvt_pk_bf16_f32 v56, v112, v113
    v_mfma_f32_16x16x32_bf16 v[72:75], a[160:163], a[56:59], v[72:75]
    s_waitcnt vmcnt(7)
    buffer_load_dwordx4 v18, s[16:19], s64 offen offset:2048 nt lds
    v_exp_f32 v114, v114
    v_mfma_f32_16x16x32_bf16 v[80:83], a[160:163], a[88:91], v[80:83]
    v_exp_f32 v115, v115
    s_waitcnt lgkmcnt(3)
    v_mfma_f32_16x16x32_bf16 v[84:87], a[164:167], a[88:91], v[84:87]
    ds_read_b64_tr_b16 a[144:145], v4 offset:32768
    v_cvt_pk_bf16_f32 v57, v114, v115
    v_mfma_f32_16x16x32_bf16 v[76:79], a[164:167], a[56:59], v[76:79]
    ds_read_b64_tr_b16 a[146:147], v4 offset:40960
    v_mfma_f32_16x16x32_bf16 v[68:71], a[164:167], a[24:27], v[68:71]
    v_exp_f32 v116, v116
    s_waitcnt lgkmcnt(4)
    v_mfma_f32_16x16x32_bf16 v[64:67], a[168:171], a[28:31], v[64:67]
    ds_read_b64_tr_b16 a[148:149], v5 offset:32768
    v_mfma_f32_16x16x32_bf16 v[72:75], a[168:171], a[60:63], v[72:75]
    ds_read_b64_tr_b16 a[150:151], v5 offset:40960
    v_exp_f32 v117, v117
    v_mfma_f32_16x16x32_bf16 v[80:83], a[168:171], a[92:95], v[80:83]
    s_waitcnt vmcnt(7)
    buffer_load_dwordx4 v19, s[16:19], s64 offen offset:3072 nt lds
    s_add_u32 s64, s64, 24576
    s_waitcnt lgkmcnt(4)
    v_mfma_f32_16x16x32_bf16 v[84:87], a[172:175], a[92:95], v[84:87]
    ds_read_b64_tr_b16 a[152:153], v6 offset:32768
    v_cvt_pk_bf16_f32 v58, v116, v117
    v_exp_f32 v118, v118
    v_mfma_f32_16x16x32_bf16 v[76:79], a[172:175], a[60:63], v[76:79]
    ds_read_b64_tr_b16 a[154:155], v6 offset:40960
    v_exp_f32 v119, v119
    v_mfma_f32_16x16x32_bf16 v[68:71], a[172:175], a[28:31], v[68:71]
    v_cvt_pk_bf16_f32 v59, v118, v119
    s_mov_b32 s65, 14
L_loop_p3:
    s_waitcnt lgkmcnt(4)
    v_mfma_f32_16x16x32_bf16 v[128:131], a[144:147], v[48:51], v[128:131]
    ds_read_b64_tr_b16 a[156:157], v7 offset:32768
    ds_write_b128 v29, v[56:59] offset:2048
    v_mfma_f32_16x16x32_bf16 v[132:135], a[144:147], v[52:55], v[132:135]
    ds_read_b64_tr_b16 a[158:159], v7 offset:40960
    v_mfma_f32_16x16x32_bf16 v[136:139], a[144:147], v[56:59], v[136:139]
    s_waitcnt lgkmcnt(5)
    v_mfma_f32_16x16x32_bf16 v[152:155], a[148:151], v[56:59], v[152:155]
    ds_read_b64_tr_b16 a[160:161], v8 offset:32768
    v_max3_f32 v28, v64, v65, v66
    v_mfma_f32_16x16x32_bf16 v[148:151], a[148:151], v[52:55], v[148:151]
    ds_read_b64_tr_b16 a[162:163], v8 offset:40960
    v_max3_f32 v28, v28, v67, v68
    v_mfma_f32_16x16x32_bf16 v[144:147], a[148:151], v[48:51], v[144:147]
    s_waitcnt lgkmcnt(3)
    s_barrier
    v_max3_f32 v28, v28, v69, v70
    v_max3_f32 v28, v28, v71, v72
    v_mfma_f32_16x16x32_bf16 v[160:163], a[152:155], v[48:51], v[160:163]
    ds_read_b64_tr_b16 a[164:165], v9 offset:32768
    ds_read_b128 a[128:131], v30 offset:0
    v_mfma_f32_16x16x32_bf16 v[164:167], a[152:155], v[52:55], v[164:167]
    ds_read_b64_tr_b16 a[166:167], v9 offset:40960
    v_max3_f32 v28, v28, v73, v74
    s_add_u32 m0, s60, 0
    v_mfma_f32_16x16x32_bf16 v[168:171], a[152:155], v[56:59], v[168:171]
    s_waitcnt vmcnt(7)
    buffer_load_dwordx4 v12, s[12:15], s63 offen offset:0 nt lds
    s_waitcnt lgkmcnt(5)
    v_mfma_f32_16x16x32_bf16 v[184:187], a[156:159], v[56:59], v[184:187]
    ds_read_b64_tr_b16 a[168:169], v10 offset:32768
    ds_read_b128 a[132:135], v30 offset:1024
    v_mfma_f32_16x16x32_bf16 v[180:183], a[156:159], v[52:55], v[180:183]
    ds_read_b64_tr_b16 a[170:171], v10 offset:40960
    v_max3_f32 v28, v28, v75, v76
    v_mfma_f32_16x16x32_bf16 v[176:179], a[156:159], v[48:51], v[176:179]
    v_max3_f32 v28, v28, v77, v78
    v_max3_f32 v28, v28, v79, v80
    s_waitcnt lgkmcnt(6)
    v_mfma_f32_16x16x32_bf16 v[192:195], a[160:163], v[48:51], v[192:195]
    ds_read_b64_tr_b16 a[172:173], v11 offset:32768
    v_add_f32 v24, v24, v96
    v_mfma_f32_16x16x32_bf16 v[196:199], a[160:163], v[52:55], v[196:199]
    ds_read_b64_tr_b16 a[174:175], v11 offset:40960
    ds_read_b128 a[136:139], v30 offset:2048
    v_mfma_f32_16x16x32_bf16 v[200:203], a[160:163], v[56:59], v[200:203]
    s_waitcnt vmcnt(7)
    buffer_load_dwordx4 v13, s[12:15], s63 offen offset:1024 nt lds
    s_waitcnt lgkmcnt(6)
    v_mfma_f32_16x16x32_bf16 v[216:219], a[164:167], v[56:59], v[216:219]
    ds_read_b64_tr_b16 a[144:145], v4 offset:49152
    v_add_f32 v25, v25, v104
    v_mfma_f32_16x16x32_bf16 v[212:215], a[164:167], v[52:55], v[212:215]
    ds_read_b64_tr_b16 a[146:147], v4 offset:57344
    v_add_f32 v26, v26, v112
    v_mfma_f32_16x16x32_bf16 v[208:211], a[164:167], v[48:51], v[208:211]
    s_waitcnt vmcnt(7)
    buffer_load_dwordx4 v14, s[12:15], s63 offen offset:2048 nt lds
    s_waitcnt lgkmcnt(5)
    v_mfma_f32_16x16x32_bf16 v[224:227], a[168:171], v[48:51], v[224:227]
    ds_read_b64_tr_b16 a[148:149], v5 offset:49152
    v_max3_f32 v28, v28, v81, v82
    v_mfma_f32_16x16x32_bf16 v[228:231], a[168:171], v[52:55], v[228:231]
    ds_read_b64_tr_b16 a[150:151], v5 offset:57344
    v_add_f32 v24, v24, v97
    v_max3_f32 v28, v28, v83, v84
    v_mfma_f32_16x16x32_bf16 v[232:235], a[168:171], v[56:59], v[232:235]
    v_add_f32 v25, v25, v105
    v_max3_f32 v28, v28, v85, v86
    s_waitcnt lgkmcnt(5)
    v_mfma_f32_16x16x32_bf16 v[248:251], a[172:175], v[56:59], v[248:251]
    ds_read_b64_tr_b16 a[152:153], v6 offset:49152
    v_add_f32 v26, v26, v113
    v_mfma_f32_16x16x32_bf16 v[244:247], a[172:175], v[52:55], v[244:247]
    ds_read_b64_tr_b16 a[154:155], v6 offset:57344
    v_max_f32 v28, v28, v87
    v_mfma_f32_16x16x32_bf16 v[240:243], a[172:175], v[48:51], v[240:243]
    s_waitcnt vmcnt(7)
    buffer_load_dwordx4 v15, s[12:15], s63 offen offset:3072 nt lds
    s_add_u32 s63, s63, 8192
    v_cmp_lt_f32 vcc, s66, v28
    s_cbranch_vccnz L_flag_p3_l1
L_flagback_p3_l1:
    s_waitcnt lgkmcnt(4)
    v_mfma_f32_16x16x32_bf16 v[128:131], a[144:147], a[128:131], v[128:131]
    s_waitcnt vmcnt(63)
    s_barrier
    ds_read_b32 v28, v31
    ds_read_b64_tr_b16 a[156:157], v7 offset:49152
    v_mfma_f32_16x16x32_bf16 v[132:135], a[144:147], a[132:135], v[132:135]
    ds_read_b64_tr_b16 a[158:159], v7 offset:57344
    v_add_f32 v24, v24, v98
    v_mfma_f32_16x16x32_bf16 v[136:139], a[144:147], a[136:139], v[136:139]
    v_add_f32 v25, v25, v106
    v_add_f32 v26, v26, v114
    s_waitcnt lgkmcnt(5)
    v_mfma_f32_16x16x32_bf16 v[152:155], a[148:151], a[136:139], v[152:155]
    ds_read_b64_tr_b16 a[160:161], v8 offset:49152
    v_add_f32 v24, v24, v99
    v_mfma_f32_16x16x32_bf16 v[148:151], a[148:151], a[132:135], v[148:151]
    ds_read_b64_tr_b16 a[162:163], v8 offset:57344
    v_add_f32 v25, v25, v107
    s_add_u32 m0, s60, 8192
    v_mfma_f32_16x16x32_bf16 v[144:147], a[148:151], a[128:131], v[144:147]
    s_waitcnt vmcnt(7)
    buffer_load_dwordx4 v12, s[12:15], s63 offen offset:0 nt lds
    s_waitcnt lgkmcnt(5)
    v_mfma_f32_16x16x32_bf16 v[160:163], a[152:155], a[128:131], v[160:163]
    ds_read_b64_tr_b16 a[164:165], v9 offset:49152
    v_add_f32 v26, v26, v115
    v_mfma_f32_16x16x32_bf16 v[164:167], a[152:155], a[132:135], v[164:167]
    ds_read_b64_tr_b16 a[166:167], v9 offset:57344
    v_add_f32 v24, v24, v100
    v_mfma_f32_16x16x32_bf16 v[168:171], a[152:155], a[136:139], v[168:171]
    s_waitcnt vmcnt(7)
    buffer_load_dwordx4 v13, s[12:15], s63 offen offset:1024 nt lds
    s_waitcnt lgkmcnt(4)
    v_mfma_f32_16x16x32_bf16 v[184:187], a[156:159], a[136:139], v[184:187]
    ds_read_b64_tr_b16 a[168:169], v10 offset:49152
    v_add_f32 v25, v25, v108
    v_mfma_f32_16x16x32_bf16 v[180:183], a[156:159], a[132:135], v[180:183]
    ds_read_b64_tr_b16 a[170:171], v10 offset:57344
    v_add_f32 v26, v26, v116
    v_mfma_f32_16x16x32_bf16 v[176:179], a[156:159], a[128:131], v[176:179]
    v_add_f32 v24, v24, v101
    v_add_f32 v25, v25, v109
    s_waitcnt lgkmcnt(4)
    v_mfma_f32_16x16x32_bf16 v[192:195], a[160:163], a[128:131], v[192:195]
    ds_read_b64_tr_b16 a[172:173], v11 offset:49152
    v_add_f32 v26, v26, v117
    v_mfma_f32_16x16x32_bf16 v[196:199], a[160:163], a[132:135], v[196:199]
    ds_read_b64_tr_b16 a[174:175], v11 offset:57344
    v_add_f32 v24, v24, v102
    v_mfma_f32_16x16x32_bf16 v[200:203], a[160:163], a[136:139], v[200:203]
    s_waitcnt vmcnt(7)
    buffer_load_dwordx4 v14, s[12:15], s63 offen offset:2048 nt lds
    s_waitcnt lgkmcnt(4)
    v_mfma_f32_16x16x32_bf16 v[216:219], a[164:167], a[136:139], v[216:219]
    ds_read_b128 a[144:147], v0 offset:32768
    v_add_f32 v25, v25, v110
    v_mfma_f32_16x16x32_bf16 v[212:215], a[164:167], a[132:135], v[212:215]
    v_add_f32 v26, v26, v118
    v_add_f32 v24, v24, v103
    v_mfma_f32_16x16x32_bf16 v[208:211], a[164:167], a[128:131], v[208:211]
    v_add_f32 v25, v25, v111
    v_add_f32 v26, v26, v119
    s_waitcnt lgkmcnt(3)
    v_mfma_f32_16x16x32_bf16 v[224:227], a[168:171], a[128:131], v[224:227]
    ds_read_b128 a[148:151], v0 offset:40960
    v_mfma_f32_16x16x32_bf16 v[228:231], a[168:171], a[132:135], v[228:231]
    s_waitcnt vmcnt(7)
    buffer_load_dwordx4 v15, s[12:15], s63 offen offset:3072 nt lds
    s_add_u32 s63, s63, 24576
    v_mfma_f32_16x16x32_bf16 v[232:235], a[168:171], a[136:139], v[232:235]
    s_waitcnt lgkmcnt(2)
    v_mfma_f32_16x16x32_bf16 v[248:251], a[172:175], a[136:139], v[248:251]
    ds_read_b128 a[152:155], v1 offset:32768
    v_mfma_f32_16x16x32_bf16 v[244:247], a[172:175], a[132:135], v[244:247]
    v_cmp_ne_u32 vcc, 0, v28
    v_mfma_f32_16x16x32_bf16 v[240:243], a[172:175], a[128:131], v[240:243]
    s_cbranch_vccnz L_rare_p3_l1
L_rareback_p3_l1:
    s_waitcnt lgkmcnt(2)
    v_mfma_f32_16x16x32_bf16 v[96:99], a[144:147], a[0:3], v[32:35]
    s_waitcnt vmcnt(63)
    s_barrier
    ds_read_b128 a[156:159], v1 offset:40960
    v_mfma_f32_16x16x32_bf16 v[104:107], a[144:147], a[32:35], v[36:39]
    v_exp_f32 v64, v64
    s_add_u32 m0, s60, 98304
    v_mfma_f32_16x16x32_bf16 v[112:115], a[144:147], a[64:67], v[40:43]
    s_waitcnt vmcnt(7)
    buffer_load_dwordx4 v16, s[16:19], s64 offen offset:0 nt lds
    s_waitcnt lgkmcnt(2)
    v_mfma_f32_16x16x32_bf16 v[116:119], a[148:151], a[64:67], v[40:43]
    ds_read_b128 a[160:163], v2 offset:32768
    v_mfma_f32_16x16x32_bf16 v[108:111], a[148:151], a[32:35], v[36:39]
    v_exp_f32 v65, v65
    v_mfma_f32_16x16x32_bf16 v[100:103], a[148:151], a[0:3], v[32:35]
    v_exp_f32 v66, v66
    s_waitcnt lgkmcnt(2)
    v_mfma_f32_16x16x32_bf16 v[96:99], a[152:155], a[4:7], v[96:99]
    ds_read_b128 a[164:167], v2 offset:40960
    v_cvt_pk_bf16_f32 v48, v64, v65
    v_mfma_f32_16x16x32_bf16 v[104:107], a[152:155], a[36:39], v[104:107]
    v_exp_f32 v67, v67
    v_mfma_f32_16x16x32_bf16 v[112:115], a[152:155], a[68:71], v[112:115]
    s_waitcnt vmcnt(7)
    buffer_load_dwordx4 v17, s[16:19], s64 offen offset:1024 nt lds
    s_waitcnt lgkmcnt(2)
    v_mfma_f32_16x16x32_bf16 v[116:119], a[156:159], a[68:71], v[116:119]
    ds_read_b128 a[168:171], v3 offset:32768
    v_cvt_pk_bf16_f32 v49, v66, v67
    v_mfma_f32_16x16x32_bf16 v[108:111], a[156:159], a[36:39], v[108:111]
    v_exp_f32 v68, v68
    v_mfma_f32_16x16x32_bf16 v[100:103], a[156:159], a[4:7], v[100:103]
    v_exp_f32 v69, v69
    s_waitcnt lgkmcnt(2)
    v_mfma_f32_16x16x32_bf16 v[96:99], a[160:163], a[8:11], v[96:99]
    ds_read_b128 a[172:175], v3 offset:40960
    v_cvt_pk_bf16_f32 v50, v68, v69
    v_mfma_f32_16x16x32_bf16 v[104:107], a[160:163], a[40:43], v[104:107]
    s_waitcnt vmcnt(7)
    buffer_load_dwordx4 v18, s[16:19], s64 offen offset:2048 nt lds
    v_mfma_f32_16x16x32_bf16 v[112:115], a[160:163], a[72:75], v[112:115]
    v_exp_f32 v70, v70
    s_waitcnt lgkmcnt(2)
    v_mfma_f32_16x16x32_bf16 v[116:119], a[164:167], a[72:75], v[116:119]
    ds_read_b128 a[144:147], v0 offset:33024
    v_mfma_f32_16x16x32_bf16 v[108:111], a[164:167], a[40:43], v[108:111]
    v_exp_f32 v71, v71
    v_mfma_f32_16x16x32_bf16 v[100:103], a[164:167], a[8:11], v[100:103]
    v_exp_f32 v72, v72
    s_waitcnt lgkmcnt(2)
    v_mfma_f32_16x16x32_bf16 v[96:99], a[168:171], a[12:15], v[96:99]
    ds_read_b128 a[148:151], v0 offset:41216
    v_cvt_pk_bf16_f32 v51, v70, v71
    v_mfma_f32_16x16x32_bf16 v[104:107], a[168:171], a[44:47], v[104:107]
    ds_write_b128 v29, v[48:51] offset:0
    v_mfma_f32_16x16x32_bf16 v[112:115], a[168:171], a[76:79], v[112:115]
    s_waitcnt vmcnt(7)
    buffer_load_dwordx4 v19, s[16:19], s64 offen offset:3072 nt lds
    s_add_u32 s64, s64, 8192
    s_waitcnt lgkmcnt(3)
    v_mfma_f32_16x16x32_bf16 v[116:119], a[172:175], a[76:79], v[116:119]
    ds_read_b128 a[152:155], v1 offset:33024
    v_exp_f32 v73, v73
    v_mfma_f32_16x16x32_bf16 v[108:111], a[172:175], a[44:47], v[108:111]
    v_exp_f32 v74, v74
    v_mfma_f32_16x16x32_bf16 v[100:103], a[172:175], a[12:15], v[100:103]
    v_exp_f32 v75, v75
    s_waitcnt lgkmcnt(3)
    v_mfma_f32_16x16x32_bf16 v[96:99], a[144:147], a[16:19], v[96:99]
    ds_read_b128 a[156:159], v1 offset:41216
    v_cvt_pk_bf16_f32 v52, v72, v73
    s_add_u32 m0, s60, 106496
    v_mfma_f32_16x16x32_bf16 v[104:107], a[144:147], a[48:51], v[104:107]
    s_waitcnt vmcnt(7)
    buffer_load_dwordx4 v16, s[16:19], s64 offen offset:0 nt lds
    v_mfma_f32_16x16x32_bf16 v[112:115], a[144:147], a[80:83], v[112:115]
    v_exp_f32 v76, v76
    s_waitcnt lgkmcnt(3)
    v_mfma_f32_16x16x32_bf16 v[116:119], a[148:151], a[80:83], v[116:119]
    ds_read_b128 a[160:163], v2 offset:33024
    v_cvt_pk_bf16_f32 v53, v74, v75
    v_mfma_f32_16x16x32_bf16 v[108:111], a[148:151], a[48:51], v[108:111]
    v_exp_f32 v77, v77
    v_mfma_f32_16x16x32_bf16 v[100:103], a[148:151], a[16:19], v[100:103]
    v_exp_f32 v78, v78
    s_waitcnt lgkmcnt(2)
    v_mfma_f32_16x16x32_bf16 v[96:99], a[152:155], a[20:23], v[96:99]
    ds_read_b128 a[164:167], v2 offset:41216
    v_cvt_pk_bf16_f32 v54, v76, v77
    v_mfma_f32_16x16x32_bf16 v[104:107], a[152:155], a[52:55], v[104:107]
    s_waitcnt vmcnt(7)
    buffer_load_dwordx4 v17, s[16:19], s64 offen offset:1024 nt lds
    v_mfma_f32_16x16x32_bf16 v[112:115], a[152:155], a[84:87], v[112:115]
    v_exp_f32 v79, v79
    s_waitcnt lgkmcnt(2)
    v_mfma_f32_16x16x32_bf16 v[116:119], a[156:159], a[84:87], v[116:119]
    ds_read_b128 a[168:171], v3 offset:33024
    v_cvt_pk_bf16_f32 v55, v78, v79
    v_mfma_f32_16x16x32_bf16 v[108:111], a[156:159], a[52:55], v[108:111]
    ds_write_b128 v29, v[52:55] offset:1024
    v_exp_f32 v80, v80
    v_mfma_f32_16x16x32_bf16 v[100:103], a[156:159], a[20:23], v[100:103]
    v_exp_f32 v81, v81
    s_waitcnt lgkmcnt(3)
    v_mfma_f32_16x16x32_bf16 v[96:99], a[160:163], a[24:27], v[96:99]
    ds_read_b128 a[172:175], v3 offset:41216
    v_cvt_pk_bf16_f32 v56, v80, v81
    v_mfma_f32_16x16x32_bf16 v[104:107], a[160:163], a[56:59], v[104:107]
    s_waitcnt vmcnt(7)
    buffer_load_dwordx4 v18, s[16:19], s64 offen offset:2048 nt lds
    v_exp_f32 v82, v82
    v_mfma_f32_16x16x32_bf16 v[112:115], a[160:163], a[88:91], v[112:115]
    v_exp_f32 v83, v83
    s_waitcnt lgkmcnt(3)
    v_mfma_f32_16x16x32_bf16 v[116:119], a[164:167], a[88:91], v[116:119]
    ds_read_b64_tr_b16 a[144:145], v4 offset:0
    v_cvt_pk_bf16_f32 v57, v82, v83
    v_mfma_f32_16x16x32_bf16 v[108:111], a[164:167], a[56:59], v[108:111]
    ds_read_b64_tr_b16 a[146:147], v4 offset:8192
    v_mfma_f32_16x16x32_bf16 v[100:103], a[164:167], a[24:27], v[100:103]
    v_exp_f32 v84, v84
    s_waitcnt lgkmcnt(4)
    v_mfma_f32_16x16x32_bf16 v[96:99], a[168:171], a[28:31], v[96:99]
    ds_read_b64_tr_b16 a[148:149], v5 offset:0
    v_mfma_f32_16x16x32_bf16 v[104:107], a[168:171], a[60:63], v[104:107]
    ds_read_b64_tr_b16 a[150:151], v5 offset:8192
    v_exp_f32 v85, v85
    v_mfma_f32_16x16x32_bf16 v[112:115], a[168:171], a[92:95], v[112:115]
    s_waitcnt vmcnt(7)
    buffer_load_dwordx4 v19, s[16:19], s64 offen offset:3072 nt lds
    s_add_u32 s64, s64, 24576
    s_waitcnt lgkmcnt(4)
    v_mfma_f32_16x16x32_bf16 v[116:119], a[172:175], a[92:95], v[116:119]
    ds_read_b64_tr_b16 a[152:153], v6 offset:0
    v_cvt_pk_bf16_f32 v58, v84, v85
    v_exp_f32 v86, v86
    v_mfma_f32_16x16x32_bf16 v[108:111], a[172:175], a[60:63], v[108:111]
    ds_read_b64_tr_b16 a[154:155], v6 offset:8192
    v_exp_f32 v87, v87
    v_mfma_f32_16x16x32_bf16 v[100:103], a[172:175], a[28:31], v[100:103]
    v_cvt_pk_bf16_f32 v59, v86, v87
    s_waitcnt lgkmcnt(4)
    v_mfma_f32_16x16x32_bf16 v[128:131], a[144:147], v[48:51], v[128:131]
    ds_read_b64_tr_b16 a[156:157], v7 offset:0
    ds_write_b128 v29, v[56:59] offset:2048
    v_mfma_f32_16x16x32_bf16 v[132:135], a[144:147], v[52:55], v[132:135]
    ds_read_b64_tr_b16 a[158:159], v7 offset:8192
    v_mfma_f32_16x16x32_bf16 v[136:139], a[144:147], v[56:59], v[136:139]
    s_waitcnt lgkmcnt(5)
    v_mfma_f32_16x16x32_bf16 v[152:155], a[148:151], v[56:59], v[152:155]
    ds_read_b64_tr_b16 a[160:161], v8 offset:0
    v_max3_f32 v28, v96, v97, v98
    v_mfma_f32_16x16x32_bf16 v[148:151], a[148:151], v[52:55], v[148:151]
    ds_read_b64_tr_b16 a[162:163], v8 offset:8192
    v_max3_f32 v28, v28, v99, v100
    v_mfma_f32_16x16x32_bf16 v[144:147], a[148:151], v[48:51], v[144:147]
    s_waitcnt lgkmcnt(3)
    s_barrier
    v_max3_f32 v28, v28, v101, v102
    v_max3_f32 v28, v28, v103, v104
    v_mfma_f32_16x16x32_bf16 v[160:163], a[152:155], v[48:51], v[160:163]
    ds_read_b64_tr_b16 a[164:165], v9 offset:0
    ds_read_b128 a[128:131], v30 offset:0
    v_mfma_f32_16x16x32_bf16 v[164:167], a[152:155], v[52:55], v[164:167]
    ds_read_b64_tr_b16 a[166:167], v9 offset:8192
    v_max3_f32 v28, v28, v105, v106
    s_add_u32 m0, s60, 32768
    v_mfma_f32_16x16x32_bf16 v[168:171], a[152:155], v[56:59], v[168:171]
    s_waitcnt vmcnt(7)
    buffer_load_dwordx4 v12, s[12:15], s63 offen offset:0 nt lds
    s_waitcnt lgkmcnt(5)
    v_mfma_f32_16x16x32_bf16 v[184:187], a[156:159], v[56:59], v[184:187]
    ds_read_b64_tr_b16 a[168:169], v10 offset:0
    ds_read_b128 a[132:135], v30 offset:1024
    v_mfma_f32_16x16x32_bf16 v[180:183], a[156:159], v[52:55], v[180:183]
    ds_read_b64_tr_b16 a[170:171], v10 offset:8192
    v_max3_f32 v28, v28, v107, v108
    v_mfma_f32_16x16x32_bf16 v[176:179], a[156:159], v[48:51], v[176:179]
    v_max3_f32 v28, v28, v109, v110
    v_max3_f32 v28, v28, v111, v112
    s_waitcnt lgkmcnt(6)
    v_mfma_f32_16x16x32_bf16 v[192:195], a[160:163], v[48:51], v[192:195]
    ds_read_b64_tr_b16 a[172:173], v11 offset:0
    v_add_f32 v24, v24, v64
    v_mfma_f32_16x16x32_bf16 v[196:199], a[160:163], v[52:55], v[196:199]
    ds_read_b64_tr_b16 a[174:175], v11 offset:8192
    ds_read_b128 a[136:139], v30 offset:2048
    v_mfma_f32_16x16x32_bf16 v[200:203], a[160:163], v[56:59], v[200:203]
    s_waitcnt vmcnt(7)
    buffer_load_dwordx4 v13, s[12:15], s63 offen offset:1024 nt lds
    s_waitcnt lgkmcnt(6)
    v_mfma_f32_16x16x32_bf16 v[216:219], a[164:167], v[56:59], v[216:219]
    ds_read_b64_tr_b16 a[144:145], v4 offset:16384
    v_add_f32 v25, v25, v72
    v_mfma_f32_16x16x32_bf16 v[212:215], a[164:167], v[52:55], v[212:215]
    ds_read_b64_tr_b16 a[146:147], v4 offset:24576
    v_add_f32 v26, v26, v80
    v_mfma_f32_16x16x32_bf16 v[208:211], a[164:167], v[48:51], v[208:211]
    s_waitcnt vmcnt(7)
    buffer_load_dwordx4 v14, s[12:15], s63 offen offset:2048 nt lds
    s_waitcnt lgkmcnt(5)
    v_mfma_f32_16x16x32_bf16 v[224:227], a[168:171], v[48:51], v[224:227]
    ds_read_b64_tr_b16 a[148:149], v5 offset:16384
    v_max3_f32 v28, v28, v113, v114
    v_mfma_f32_16x16x32_bf16 v[228:231], a[168:171], v[52:55], v[228:231]
    ds_read_b64_tr_b16 a[150:151], v5 offset:24576
    v_add_f32 v24, v24, v65
    v_max3_f32 v28, v28, v115, v116
    v_mfma_f32_16x16x32_bf16 v[232:235], a[168:171], v[56:59], v[232:235]
    v_add_f32 v25, v25, v73
    v_max3_f32 v28, v28, v117, v118
    s_waitcnt lgkmcnt(5)
    v_mfma_f32_16x16x32_bf16 v[248:251], a[172:175], v[56:59], v[248:251]
    ds_read_b64_tr_b16 a[152:153], v6 offset:16384
    v_add_f32 v26, v26, v81
    v_mfma_f32_16x16x32_bf16 v[244:247], a[172:175], v[52:55], v[244:247]
    ds_read_b64_tr_b16 a[154:155], v6 offset:24576
    v_max_f32 v28, v28, v119
    v_mfma_f32_16x16x32_bf16 v[240:243], a[172:175], v[48:51], v[240:243]
    s_waitcnt vmcnt(7)
    buffer_load_dwordx4 v15, s[12:15], s63 offen offset:3072 nt lds
    s_add_u32 s63, s63, 8192
    v_cmp_lt_f32 vcc, s66, v28
    s_cbranch_vccnz L_flag_p3_l0
L_flagback_p3_l0:
    s_waitcnt lgkmcnt(4)
    v_mfma_f32_16x16x32_bf16 v[128:131], a[144:147], a[128:131], v[128:131]
    s_waitcnt vmcnt(63)
    s_barrier
    ds_read_b32 v28, v31
    ds_read_b64_tr_b16 a[156:157], v7 offset:16384
    v_mfma_f32_16x16x32_bf16 v[132:135], a[144:147], a[132:135], v[132:135]
    ds_read_b64_tr_b16 a[158:159], v7 offset:24576
    v_add_f32 v24, v24, v66
    v_mfma_f32_16x16x32_bf16 v[136:139], a[144:147], a[136:139], v[136:139]
    v_add_f32 v25, v25, v74
    v_add_f32 v26, v26, v82
    s_waitcnt lgkmcnt(5)
    v_mfma_f32_16x16x32_bf16 v[152:155], a[148:151], a[136:139], v[152:155]
    ds_read_b64_tr_b16 a[160:161], v8 offset:16384
    v_add_f32 v24, v24, v67
    v_mfma_f32_16x16x32_bf16 v[148:151], a[148:151], a[132:135], v[148:151]
    ds_read_b64_tr_b16 a[162:163], v8 offset:24576
    v_add_f32 v25, v25, v75
    s_add_u32 m0, s60, 40960
    v_mfma_f32_16x16x32_bf16 v[144:147], a[148:151], a[128:131], v[144:147]
    s_waitcnt vmcnt(7)
    buffer_load_dwordx4 v12, s[12:15], s63 offen offset:0 nt lds
    s_waitcnt lgkmcnt(5)
    v_mfma_f32_16x16x32_bf16 v[160:163], a[152:155], a[128:131], v[160:163]
    ds_read_b64_tr_b16 a[164:165], v9 offset:16384
    v_add_f32 v26, v26, v83
    v_mfma_f32_16x16x32_bf16 v[164:167], a[152:155], a[132:135], v[164:167]
    ds_read_b64_tr_b16 a[166:167], v9 offset:24576
    v_add_f32 v24, v24, v68
    v_mfma_f32_16x16x32_bf16 v[168:171], a[152:155], a[136:139], v[168:171]
    s_waitcnt vmcnt(7)
    buffer_load_dwordx4 v13, s[12:15], s63 offen offset:1024 nt lds
    s_waitcnt lgkmcnt(4)
    v_mfma_f32_16x16x32_bf16 v[184:187], a[156:159], a[136:139], v[184:187]
    ds_read_b64_tr_b16 a[168:169], v10 offset:16384
    v_add_f32 v25, v25, v76
    v_mfma_f32_16x16x32_bf16 v[180:183], a[156:159], a[132:135], v[180:183]
    ds_read_b64_tr_b16 a[170:171], v10 offset:24576
    v_add_f32 v26, v26, v84
    v_mfma_f32_16x16x32_bf16 v[176:179], a[156:159], a[128:131], v[176:179]
    v_add_f32 v24, v24, v69
    v_add_f32 v25, v25, v77
    s_waitcnt lgkmcnt(4)
    v_mfma_f32_16x16x32_bf16 v[192:195], a[160:163], a[128:131], v[192:195]
    ds_read_b64_tr_b16 a[172:173], v11 offset:16384
    v_add_f32 v26, v26, v85
    v_mfma_f32_16x16x32_bf16 v[196:199], a[160:163], a[132:135], v[196:199]
    ds_read_b64_tr_b16 a[174:175], v11 offset:24576
    v_add_f32 v24, v24, v70
    v_mfma_f32_16x16x32_bf16 v[200:203], a[160:163], a[136:139], v[200:203]
    s_waitcnt vmcnt(7)
    buffer_load_dwordx4 v14, s[12:15], s63 offen offset:2048 nt lds
    s_waitcnt lgkmcnt(4)
    v_mfma_f32_16x16x32_bf16 v[216:219], a[164:167], a[136:139], v[216:219]
    ds_read_b128 a[144:147], v0 offset:0
    v_add_f32 v25, v25, v78
    v_mfma_f32_16x16x32_bf16 v[212:215], a[164:167], a[132:135], v[212:215]
    v_add_f32 v26, v26, v86
    v_add_f32 v24, v24, v71
    v_mfma_f32_16x16x32_bf16 v[208:211], a[164:167], a[128:131], v[208:211]
    v_add_f32 v25, v25, v79
    v_add_f32 v26, v26, v87
    s_waitcnt lgkmcnt(3)
    v_mfma_f32_16x16x32_bf16 v[224:227], a[168:171], a[128:131], v[224:227]
    ds_read_b128 a[148:151], v0 offset:8192
    v_mfma_f32_16x16x32_bf16 v[228:231], a[168:171], a[132:135], v[228:231]
    s_waitcnt vmcnt(7)
    buffer_load_dwordx4 v15, s[12:15], s63 offen offset:3072 nt lds
    s_add_u32 s63, s63, 24576
    v_mfma_f32_16x16x32_bf16 v[232:235], a[168:171], a[136:139], v[232:235]
    s_waitcnt lgkmcnt(2)
    v_mfma_f32_16x16x32_bf16 v[248:251], a[172:175], a[136:139], v[248:251]
    ds_read_b128 a[152:155], v1 offset:0
    v_mfma_f32_16x16x32_bf16 v[244:247], a[172:175], a[132:135], v[244:247]
    v_cmp_ne_u32 vcc, 0, v28
    v_mfma_f32_16x16x32_bf16 v[240:243], a[172:175], a[128:131], v[240:243]
    s_cbranch_vccnz L_rare_p3_l0
L_rareback_p3_l0:
    s_waitcnt lgkmcnt(2)
    v_mfma_f32_16x16x32_bf16 v[64:67], a[144:147], a[0:3], v[32:35]
    s_waitcnt vmcnt(63)
    s_barrier
    ds_read_b128 a[156:159], v1 offset:8192
    v_mfma_f32_16x16x32_bf16 v[72:75], a[144:147], a[32:35], v[36:39]
    v_exp_f32 v96, v96
    s_add_u32 m0, s60, 65536
    v_mfma_f32_16x16x32_bf16 v[80:83], a[144:147], a[64:67], v[40:43]
    s_waitcnt vmcnt(7)
    buffer_load_dwordx4 v16, s[16:19], s64 offen offset:0 nt lds
    s_waitcnt lgkmcnt(2)
    v_mfma_f32_16x16x32_bf16 v[84:87], a[148:151], a[64:67], v[40:43]
    ds_read_b128 a[160:163], v2 offset:0
    v_mfma_f32_16x16x32_bf16 v[76:79], a[148:151], a[32:35], v[36:39]
    v_exp_f32 v97, v97
    v_mfma_f32_16x16x32_bf16 v[68:71], a[148:151], a[0:3], v[32:35]
    v_exp_f32 v98, v98
    s_waitcnt lgkmcnt(2)
    v_mfma_f32_16x16x32_bf16 v[64:67], a[152:155], a[4:7], v[64:67]
    ds_read_b128 a[164:167], v2 offset:8192
    v_cvt_pk_bf16_f32 v48, v96, v97
    v_mfma_f32_16x16x32_bf16 v[72:75], a[152:155], a[36:39], v[72:75]
    v_exp_f32 v99, v99
    v_mfma_f32_16x16x32_bf16 v[80:83], a[152:155], a[68:71], v[80:83]
    s_waitcnt vmcnt(7)
    buffer_load_dwordx4 v17, s[16:19], s64 offen offset:1024 nt lds
    s_waitcnt lgkmcnt(2)
    v_mfma_f32_16x16x32_bf16 v[84:87], a[156:159], a[68:71], v[84:87]
    ds_read_b128 a[168:171], v3 offset:0
    v_cvt_pk_bf16_f32 v49, v98, v99
    v_mfma_f32_16x16x32_bf16 v[76:79], a[156:159], a[36:39], v[76:79]
    v_exp_f32 v100, v100
    v_mfma_f32_16x16x32_bf16 v[68:71], a[156:159], a[4:7], v[68:71]
    v_exp_f32 v101, v101
    s_waitcnt lgkmcnt(2)
    v_mfma_f32_16x16x32_bf16 v[64:67], a[160:163], a[8:11], v[64:67]
    ds_read_b128 a[172:175], v3 offset:8192
    v_cvt_pk_bf16_f32 v50, v100, v101
    v_mfma_f32_16x16x32_bf16 v[72:75], a[160:163], a[40:43], v[72:75]
    s_waitcnt vmcnt(7)
    buffer_load_dwordx4 v18, s[16:19], s64 offen offset:2048 nt lds
    v_mfma_f32_16x16x32_bf16 v[80:83], a[160:163], a[72:75], v[80:83]
    v_exp_f32 v102, v102
    s_waitcnt lgkmcnt(2)
    v_mfma_f32_16x16x32_bf16 v[84:87], a[164:167], a[72:75], v[84:87]
    ds_read_b128 a[144:147], v0 offset:256
    v_mfma_f32_16x16x32_bf16 v[76:79], a[164:167], a[40:43], v[76:79]
    v_exp_f32 v103, v103
    v_mfma_f32_16x16x32_bf16 v[68:71], a[164:167], a[8:11], v[68:71]
    v_exp_f32 v104, v104
    s_waitcnt lgkmcnt(2)
    v_mfma_f32_16x16x32_bf16 v[64:67], a[168:171], a[12:15], v[64:67]
    ds_read_b128 a[148:151], v0 offset:8448
    v_cvt_pk_bf16_f32 v51, v102, v103
    v_mfma_f32_16x16x32_bf16 v[72:75], a[168:171], a[44:47], v[72:75]
    ds_write_b128 v29, v[48:51] offset:0
    v_mfma_f32_16x16x32_bf16 v[80:83], a[168:171], a[76:79], v[80:83]
    s_waitcnt vmcnt(7)
    buffer_load_dwordx4 v19, s[16:19], s64 offen offset:3072 nt lds
    s_add_u32 s64, s64, 8192
    s_waitcnt lgkmcnt(3)
    v_mfma_f32_16x16x32_bf16 v[84:87], a[172:175], a[76:79], v[84:87]
    ds_read_b128 a[152:155], v1 offset:256
    v_exp_f32 v105, v105
    v_mfma_f32_16x16x32_bf16 v[76:79], a[172:175], a[44:47], v[76:79]
    v_exp_f32 v106, v106
    v_mfma_f32_16x16x32_bf16 v[68:71], a[172:175], a[12:15], v[68:71]
    v_exp_f32 v107, v107
    s_waitcnt lgkmcnt(3)
    v_mfma_f32_16x16x32_bf16 v[64:67], a[144:147], a[16:19], v[64:67]
    ds_read_b128 a[156:159], v1 offset:8448
    v_cvt_pk_bf16_f32 v52, v104, v105
    s_add_u32 m0, s60, 73728
    v_mfma_f32_16x16x32_bf16 v[72:75], a[144:147], a[48:51], v[72:75]
    s_waitcnt vmcnt(7)
    buffer_load_dwordx4 v16, s[16:19], s64 offen offset:0 nt lds
    v_mfma_f32_16x16x32_bf16 v[80:83], a[144:147], a[80:83], v[80:83]
    v_exp_f32 v108, v108
    s_waitcnt lgkmcnt(3)
    v_mfma_f32_16x16x32_bf16 v[84:87], a[148:151], a[80:83], v[84:87]
    ds_read_b128 a[160:163], v2 offset:256
    v_cvt_pk_bf16_f32 v53, v106, v107
    v_mfma_f32_16x16x32_bf16 v[76:79], a[148:151], a[48:51], v[76:79]
    v_exp_f32 v109, v109
    v_mfma_f32_16x16x32_bf16 v[68:71], a[148:151], a[16:19], v[68:71]
    v_exp_f32 v110, v110
    s_waitcnt lgkmcnt(2)
    v_mfma_f32_16x16x32_bf16 v[64:67], a[152:155], a[20:23], v[64:67]
    ds_read_b128 a[164:167], v2 offset:8448
    v_cvt_pk_bf16_f32 v54, v108, v109
    v_mfma_f32_16x16x32_bf16 v[72:75], a[152:155], a[52:55], v[72:75]
    s_waitcnt vmcnt(7)
    buffer_load_dwordx4 v17, s[16:19], s64 offen offset:1024 nt lds
    v_mfma_f32_16x16x32_bf16 v[80:83], a[152:155], a[84:87], v[80:83]
    v_exp_f32 v111, v111
    s_waitcnt lgkmcnt(2)
    v_mfma_f32_16x16x32_bf16 v[84:87], a[156:159], a[84:87], v[84:87]
    ds_read_b128 a[168:171], v3 offset:256
    v_cvt_pk_bf16_f32 v55, v110, v111
    v_mfma_f32_16x16x32_bf16 v[76:79], a[156:159], a[52:55], v[76:79]
    ds_write_b128 v29, v[52:55] offset:1024
    v_exp_f32 v112, v112
    v_mfma_f32_16x16x32_bf16 v[68:71], a[156:159], a[20:23], v[68:71]
    v_exp_f32 v113, v113
    s_waitcnt lgkmcnt(3)
    v_mfma_f32_16x16x32_bf16 v[64:67], a[160:163], a[24:27], v[64:67]
    ds_read_b128 a[172:175], v3 offset:8448
    v_cvt_pk_bf16_f32 v56, v112, v113
    v_mfma_f32_16x16x32_bf16 v[72:75], a[160:163], a[56:59], v[72:75]
    s_waitcnt vmcnt(7)
    buffer_load_dwordx4 v18, s[16:19], s64 offen offset:2048 nt lds
    v_exp_f32 v114, v114
    v_mfma_f32_16x16x32_bf16 v[80:83], a[160:163], a[88:91], v[80:83]
    v_exp_f32 v115, v115
    s_waitcnt lgkmcnt(3)
    v_mfma_f32_16x16x32_bf16 v[84:87], a[164:167], a[88:91], v[84:87]
    ds_read_b64_tr_b16 a[144:145], v4 offset:32768
    v_cvt_pk_bf16_f32 v57, v114, v115
    v_mfma_f32_16x16x32_bf16 v[76:79], a[164:167], a[56:59], v[76:79]
    ds_read_b64_tr_b16 a[146:147], v4 offset:40960
    v_mfma_f32_16x16x32_bf16 v[68:71], a[164:167], a[24:27], v[68:71]
    v_exp_f32 v116, v116
    s_waitcnt lgkmcnt(4)
    v_mfma_f32_16x16x32_bf16 v[64:67], a[168:171], a[28:31], v[64:67]
    ds_read_b64_tr_b16 a[148:149], v5 offset:32768
    v_mfma_f32_16x16x32_bf16 v[72:75], a[168:171], a[60:63], v[72:75]
    ds_read_b64_tr_b16 a[150:151], v5 offset:40960
    v_exp_f32 v117, v117
    v_mfma_f32_16x16x32_bf16 v[80:83], a[168:171], a[92:95], v[80:83]
    s_waitcnt vmcnt(7)
    buffer_load_dwordx4 v19, s[16:19], s64 offen offset:3072 nt lds
    s_add_u32 s64, s64, 24576
    s_waitcnt lgkmcnt(4)
    v_mfma_f32_16x16x32_bf16 v[84:87], a[172:175], a[92:95], v[84:87]
    ds_read_b64_tr_b16 a[152:153], v6 offset:32768
    v_cvt_pk_bf16_f32 v58, v116, v117
    v_exp_f32 v118, v118
    v_mfma_f32_16x16x32_bf16 v[76:79], a[172:175], a[60:63], v[76:79]
    ds_read_b64_tr_b16 a[154:155], v6 offset:40960
    v_exp_f32 v119, v119
    v_mfma_f32_16x16x32_bf16 v[68:71], a[172:175], a[28:31], v[68:71]
    v_cvt_pk_bf16_f32 v59, v118, v119
    s_sub_u32 s65, s65, 1
    s_cmp_lg_u32 s65, 0
    s_cbranch_scc1 L_loop_p3
    v_accvgpr_read_b32 v21, a177
    v_accvgpr_read_b32 v12, a177
    v_add_u32 v13, 6144, v12
    v_add_u32 v14, 12288, v12
    v_add_u32 v15, 18432, v12
    s_waitcnt lgkmcnt(4)
    v_mfma_f32_16x16x32_bf16 v[128:131], a[144:147], v[48:51], v[128:131]
    ds_read_b64_tr_b16 a[156:157], v7 offset:32768
    ds_write_b128 v29, v[56:59] offset:2048
    v_mfma_f32_16x16x32_bf16 v[132:135], a[144:147], v[52:55], v[132:135]
    ds_read_b64_tr_b16 a[158:159], v7 offset:40960
    v_mfma_f32_16x16x32_bf16 v[136:139], a[144:147], v[56:59], v[136:139]
    s_waitcnt lgkmcnt(5)
    v_mfma_f32_16x16x32_bf16 v[152:155], a[148:151], v[56:59], v[152:155]
    ds_read_b64_tr_b16 a[160:161], v8 offset:32768
    v_max3_f32 v28, v64, v65, v66
    v_mfma_f32_16x16x32_bf16 v[148:151], a[148:151], v[52:55], v[148:151]
    ds_read_b64_tr_b16 a[162:163], v8 offset:40960
    v_max3_f32 v28, v28, v67, v68
    v_mfma_f32_16x16x32_bf16 v[144:147], a[148:151], v[48:51], v[144:147]
    s_waitcnt lgkmcnt(3)
    s_barrier
    v_max3_f32 v28, v28, v69, v70
    v_max3_f32 v28, v28, v71, v72
    v_mfma_f32_16x16x32_bf16 v[160:163], a[152:155], v[48:51], v[160:163]
    ds_read_b64_tr_b16 a[164:165], v9 offset:32768
    ds_read_b128 a[128:131], v30 offset:0
    v_mfma_f32_16x16x32_bf16 v[164:167], a[152:155], v[52:55], v[164:167]
    ds_read_b64_tr_b16 a[166:167], v9 offset:40960
    v_max3_f32 v28, v28, v73, v74
    s_add_u32 m0, s61, 0
    s_mov_b32 s68, 0
    v_mfma_f32_16x16x32_bf16 v[168:171], a[152:155], v[56:59], v[168:171]
    buffer_load_dwordx4 v12, s[24:27], s68 offen offset:0  lds
    s_waitcnt lgkmcnt(5)
    v_mfma_f32_16x16x32_bf16 v[184:187], a[156:159], v[56:59], v[184:187]
    ds_read_b64_tr_b16 a[168:169], v10 offset:32768
    ds_read_b128 a[132:135], v30 offset:1024
    v_mfma_f32_16x16x32_bf16 v[180:183], a[156:159], v[52:55], v[180:183]
    ds_read_b64_tr_b16 a[170:171], v10 offset:40960
    v_max3_f32 v28, v28, v75, v76
    v_mfma_f32_16x16x32_bf16 v[176:179], a[156:159], v[48:51], v[176:179]
    v_max3_f32 v28, v28, v77, v78
    v_max3_f32 v28, v28, v79, v80
    s_waitcnt lgkmcnt(6)
    v_mfma_f32_16x16x32_bf16 v[192:195], a[160:163], v[48:51], v[192:195]
    ds_read_b64_tr_b16 a[172:173], v11 offset:32768
    v_add_f32 v24, v24, v96
    v_mfma_f32_16x16x32_bf16 v[196:199], a[160:163], v[52:55], v[196:199]
    ds_read_b64_tr_b16 a[174:175], v11 offset:40960
    ds_read_b128 a[136:139], v30 offset:2048
    v_mfma_f32_16x16x32_bf16 v[200:203], a[160:163], v[56:59], v[200:203]
    buffer_load_dwordx4 v13, s[24:27], s68 offen offset:1024  lds
    s_waitcnt lgkmcnt(6)
    v_mfma_f32_16x16x32_bf16 v[216:219], a[164:167], v[56:59], v[216:219]
    ds_read_b64_tr_b16 a[144:145], v4 offset:49152
    v_add_f32 v25, v25, v104
    v_mfma_f32_16x16x32_bf16 v[212:215], a[164:167], v[52:55], v[212:215]
    ds_read_b64_tr_b16 a[146:147], v4 offset:57344
    v_add_f32 v26, v26, v112
    v_mfma_f32_16x16x32_bf16 v[208:211], a[164:167], v[48:51], v[208:211]
    buffer_load_dwordx4 v14, s[24:27], s68 offen offset:2048  lds
    s_waitcnt lgkmcnt(5)
    v_mfma_f32_16x16x32_bf16 v[224:227], a[168:171], v[48:51], v[224:227]
    ds_read_b64_tr_b16 a[148:149], v5 offset:49152
    v_max3_f32 v28, v28, v81, v82
    v_mfma_f32_16x16x32_bf16 v[228:231], a[168:171], v[52:55], v[228:231]
    ds_read_b64_tr_b16 a[150:151], v5 offset:57344
    v_add_f32 v24, v24, v97
    v_max3_f32 v28, v28, v83, v84
    v_mfma_f32_16x16x32_bf16 v[232:235], a[168:171], v[56:59], v[232:235]
    v_add_f32 v25, v25, v105
    v_max3_f32 v28, v28, v85, v86
    s_waitcnt lgkmcnt(5)
    v_mfma_f32_16x16x32_bf16 v[248:251], a[172:175], v[56:59], v[248:251]
    ds_read_b64_tr_b16 a[152:153], v6 offset:49152
    v_add_f32 v26, v26, v113
    v_mfma_f32_16x16x32_bf16 v[244:247], a[172:175], v[52:55], v[244:247]
    ds_read_b64_tr_b16 a[154:155], v6 offset:57344
    v_max_f32 v28, v28, v87
    v_mfma_f32_16x16x32_bf16 v[240:243], a[172:175], v[48:51], v[240:243]
    buffer_load_dwordx4 v15, s[24:27], s68 offen offset:3072  lds
    v_cmp_lt_f32 vcc, s66, v28
    s_cbranch_vccnz L_flag_p3_t29
L_flagback_p3_t29:
    s_waitcnt lgkmcnt(4)
    v_mfma_f32_16x16x32_bf16 v[128:131], a[144:147], a[128:131], v[128:131]
    s_waitcnt vmcnt(63)
    s_barrier
    ds_read_b32 v28, v31
    ds_read_b64_tr_b16 a[156:157], v7 offset:49152
    v_mfma_f32_16x16x32_bf16 v[132:135], a[144:147], a[132:135], v[132:135]
    ds_read_b64_tr_b16 a[158:159], v7 offset:57344
    v_add_f32 v24, v24, v98
    v_mfma_f32_16x16x32_bf16 v[136:139], a[144:147], a[136:139], v[136:139]
    v_add_f32 v25, v25, v106
    v_add_f32 v26, v26, v114
    s_waitcnt lgkmcnt(5)
    v_mfma_f32_16x16x32_bf16 v[152:155], a[148:151], a[136:139], v[152:155]
    ds_read_b64_tr_b16 a[160:161], v8 offset:49152
    v_add_f32 v24, v24, v99
    v_mfma_f32_16x16x32_bf16 v[148:151], a[148:151], a[132:135], v[148:151]
    ds_read_b64_tr_b16 a[162:163], v8 offset:57344
    v_add_f32 v25, v25, v107
    s_add_u32 m0, s61, 4096
    s_mov_b32 s68, 28672
    v_mfma_f32_16x16x32_bf16 v[144:147], a[148:151], a[128:131], v[144:147]
    buffer_load_dwordx4 v12, s[24:27], s68 offen offset:0  lds
    s_waitcnt lgkmcnt(5)
    v_mfma_f32_16x16x32_bf16 v[160:163], a[152:155], a[128:131], v[160:163]
    ds_read_b64_tr_b16 a[164:165], v9 offset:49152
    v_add_f32 v26, v26, v115
    v_mfma_f32_16x16x32_bf16 v[164:167], a[152:155], a[132:135], v[164:167]
    ds_read_b64_tr_b16 a[166:167], v9 offset:57344
    v_add_f32 v24, v24, v100
    v_mfma_f32_16x16x32_bf16 v[168:171], a[152:155], a[136:139], v[168:171]
    s_mov_b32 s3, 640
    buffer_load_dwordx4 a[192:195], v21, s[24:27], s3 offen
    s_waitcnt lgkmcnt(4)
    v_mfma_f32_16x16x32_bf16 v[184:187], a[156:159], a[136:139], v[184:187]
    ds_read_b64_tr_b16 a[168:169], v10 offset:49152
    v_add_f32 v25, v25, v108
    v_mfma_f32_16x16x32_bf16 v[180:183], a[156:159], a[132:135], v[180:183]
    ds_read_b64_tr_b16 a[170:171], v10 offset:57344
    v_add_f32 v26, v26, v116
    v_mfma_f32_16x16x32_bf16 v[176:179], a[156:159], a[128:131], v[176:179]
    buffer_load_dwordx4 v13, s[24:27], s68 offen offset:1024  lds
    s_waitcnt lgkmcnt(4)
    v_mfma_f32_16x16x32_bf16 v[192:195], a[160:163], a[128:131], v[192:195]
    ds_read_b64_tr_b16 a[172:173], v11 offset:49152
    v_add_f32 v24, v24, v101
    v_mfma_f32_16x16x32_bf16 v[196:199], a[160:163], a[132:135], v[196:199]
    ds_read_b64_tr_b16 a[174:175], v11 offset:57344
    v_add_f32 v25, v25, v109
    v_mfma_f32_16x16x32_bf16 v[200:203], a[160:163], a[136:139], v[200:203]
    s_mov_b32 s3, 7808
    buffer_load_dwordx4 a[196:199], v21, s[24:27], s3 offen
    s_waitcnt lgkmcnt(4)
    v_mfma_f32_16x16x32_bf16 v[216:219], a[164:167], a[136:139], v[216:219]
    ds_read_b128 a[144:147], v0 offset:32768
    v_add_f32 v26, v26, v117
    v_mfma_f32_16x16x32_bf16 v[212:215], a[164:167], a[132:135], v[212:215]
    buffer_load_dwordx4 v14, s[24:27], s68 offen offset:2048  lds
    v_mfma_f32_16x16x32_bf16 v[208:211], a[164:167], a[128:131], v[208:211]
    s_mov_b32 s3, 14976
    buffer_load_dwordx4 a[200:203], v21, s[24:27], s3 offen
    s_waitcnt lgkmcnt(3)
    v_mfma_f32_16x16x32_bf16 v[224:227], a[168:171], a[128:131], v[224:227]
    ds_read_b128 a[148:151], v0 offset:40960
    v_add_f32 v24, v24, v102
    v_mfma_f32_16x16x32_bf16 v[228:231], a[168:171], a[132:135], v[228:231]
    buffer_load_dwordx4 v15, s[24:27], s68 offen offset:3072  lds
    v_mfma_f32_16x16x32_bf16 v[232:235], a[168:171], a[136:139], v[232:235]
    v_add_f32 v25, v25, v110
    v_add_f32 v26, v26, v118
    s_waitcnt lgkmcnt(2)
    v_mfma_f32_16x16x32_bf16 v[248:251], a[172:175], a[136:139], v[248:251]
    ds_read_b128 a[152:155], v1 offset:32768
    v_add_f32 v24, v24, v103
    v_mfma_f32_16x16x32_bf16 v[244:247], a[172:175], a[132:135], v[244:247]
    v_cmp_ne_u32 vcc, 0, v28
    v_add_f32 v25, v25, v111
    v_mfma_f32_16x16x32_bf16 v[240:243], a[172:175], a[128:131], v[240:243]
    s_mov_b32 s3, 22144
    buffer_load_dwordx4 a[204:207], v21, s[24:27], s3 offen
    v_add_f32 v26, v26, v119
    s_cbranch_vccnz L_rare_p3_t29
L_rareback_p3_t29:
    s_waitcnt lgkmcnt(2)
    v_mfma_f32_16x16x32_bf16 v[96:99], a[144:147], a[0:3], v[32:35]
    s_waitcnt vmcnt(12)
    s_barrier
    ds_read_b128 a[156:159], v1 offset:40960
    v_mfma_f32_16x16x32_bf16 v[104:107], a[144:147], a[32:35], v[36:39]
    v_exp_f32 v64, v64
    s_add_u32 m0, s60, 98304
    v_mfma_f32_16x16x32_bf16 v[112:115], a[144:147], a[64:67], v[40:43]
    buffer_load_dwordx4 v16, s[16:19], s64 offen offset:0 nt lds
    s_waitcnt lgkmcnt(2)
    v_mfma_f32_16x16x32_bf16 v[116:119], a[148:151], a[64:67], v[40:43]
    ds_read_b128 a[160:163], v2 offset:32768
    v_mfma_f32_16x16x32_bf16 v[108:111], a[148:151], a[32:35], v[36:39]
    v_exp_f32 v65, v65
    v_mfma_f32_16x16x32_bf16 v[100:103], a[148:151], a[0:3], v[32:35]
    buffer_load_dwordx4 v17, s[16:19], s64 offen offset:1024 nt lds
    s_waitcnt lgkmcnt(2)
    v_mfma_f32_16x16x32_bf16 v[96:99], a[152:155], a[4:7], v[96:99]
    ds_read_b128 a[164:167], v2 offset:40960
    v_cvt_pk_bf16_f32 v48, v64, v65
    v_mfma_f32_16x16x32_bf16 v[104:107], a[152:155], a[36:39], v[104:107]
    v_exp_f32 v66, v66
    v_mfma_f32_16x16x32_bf16 v[112:115], a[152:155], a[68:71], v[112:115]
    buffer_load_dwordx4 v18, s[16:19], s64 offen offset:2048 nt lds
    s_waitcnt lgkmcnt(2)
    v_mfma_f32_16x16x32_bf16 v[116:119], a[156:159], a[68:71], v[116:119]
    ds_read_b128 a[168:171], v3 offset:32768
    v_mfma_f32_16x16x32_bf16 v[108:111], a[156:159], a[36:39], v[108:111]
    v_exp_f32 v67, v67
    v_mfma_f32_16x16x32_bf16 v[100:103], a[156:159], a[4:7], v[100:103]
    buffer_load_dwordx4 v19, s[16:19], s64 offen offset:3072 nt lds
    s_add_u32 s64, s64, 8192
    s_waitcnt lgkmcnt(2)
    v_mfma_f32_16x16x32_bf16 v[96:99], a[160:163], a[8:11], v[96:99]
    ds_read_b128 a[172:175], v3 offset:40960
    v_cvt_pk_bf16_f32 v49, v66, v67
    v_exp_f32 v68, v68
    v_mfma_f32_16x16x32_bf16 v[104:107], a[160:163], a[40:43], v[104:107]
    v_exp_f32 v69, v69
    s_add_u32 m0, s60, 106496
    v_mfma_f32_16x16x32_bf16 v[112:115], a[160:163], a[72:75], v[112:115]
    buffer_load_dwordx4 v16, s[16:19], s64 offen offset:0 nt lds
    s_waitcnt lgkmcnt(2)
    v_mfma_f32_16x16x32_bf16 v[116:119], a[164:167], a[72:75], v[116:119]
    ds_read_b128 a[144:147], v0 offset:33024
    v_cvt_pk_bf16_f32 v50, v68, v69
    v_exp_f32 v70, v70
    v_mfma_f32_16x16x32_bf16 v[108:111], a[164:167], a[40:43], v[108:111]
    buffer_load_dwordx4 v17, s[16:19], s64 offen offset:1024 nt lds
    v_mfma_f32_16x16x32_bf16 v[100:103], a[164:167], a[8:11], v[100:103]
    v_exp_f32 v71, v71
    s_waitcnt lgkmcnt(2)
    v_mfma_f32_16x16x32_bf16 v[96:99], a[168:171], a[12:15], v[96:99]
    ds_read_b128 a[148:151], v0 offset:41216
    v_cvt_pk_bf16_f32 v51, v70, v71
    v_mfma_f32_16x16x32_bf16 v[104:107], a[168:171], a[44:47], v[104:107]
    ds_write_b128 v29, v[48:51] offset:0
    v_exp_f32 v72, v72
    v_mfma_f32_16x16x32_bf16 v[112:115], a[168:171], a[76:79], v[112:115]
    buffer_load_dwordx4 v18, s[16:19], s64 offen offset:2048 nt lds
    s_waitcnt lgkmcnt(3)
    v_mfma_f32_16x16x32_bf16 v[116:119], a[172:175], a[76:79], v[116:119]
    ds_read_b128 a[152:155], v1 offset:33024
    v_exp_f32 v73, v73
    v_mfma_f32_16x16x32_bf16 v[108:111], a[172:175], a[44:47], v[108:111]
    buffer_load_dwordx4 v19, s[16:19], s64 offen offset:3072 nt lds
    s_add_u32 s64, s64, 24576
    v_mfma_f32_16x16x32_bf16 v[100:103], a[172:175], a[12:15], v[100:103]
    v_exp_f32 v74, v74
    s_waitcnt lgkmcnt(3)
    v_mfma_f32_16x16x32_bf16 v[96:99], a[144:147], a[16:19], v[96:99]
    ds_read_b128 a[156:159], v1 offset:41216
    v_cvt_pk_bf16_f32 v52, v72, v73
    v_mfma_f32_16x16x32_bf16 v[104:107], a[144:147], a[48:51], v[104:107]
    v_exp_f32 v75, v75
    v_mfma_f32_16x16x32_bf16 v[112:115], a[144:147], a[80:83], v[112:115]
    v_exp_f32 v76, v76
    s_waitcnt lgkmcnt(3)
    v_mfma_f32_16x16x32_bf16 v[116:119], a[148:151], a[80:83], v[116:119]
    ds_read_b128 a[160:163], v2 offset:33024
    v_cvt_pk_bf16_f32 v53, v74, v75
    v_mfma_f32_16x16x32_bf16 v[108:111], a[148:151], a[48:51], v[108:111]
    v_exp_f32 v77, v77
    v_mfma_f32_16x16x32_bf16 v[100:103], a[148:151], a[16:19], v[100:103]
    v_exp_f32 v78, v78
    s_waitcnt lgkmcnt(2)
    v_mfma_f32_16x16x32_bf16 v[96:99], a[152:155], a[20:23], v[96:99]
    ds_read_b128 a[164:167], v2 offset:41216
    v_cvt_pk_bf16_f32 v54, v76, v77
    v_mfma_f32_16x16x32_bf16 v[104:107], a[152:155], a[52:55], v[104:107]
    v_exp_f32 v79, v79
    v_mfma_f32_16x16x32_bf16 v[112:115], a[152:155], a[84:87], v[112:115]
    v_exp_f32 v80, v80
    s_waitcnt lgkmcnt(2)
    v_mfma_f32_16x16x32_bf16 v[116:119], a[156:159], a[84:87], v[116:119]
    ds_read_b128 a[168:171], v3 offset:33024
    v_cvt_pk_bf16_f32 v55, v78, v79
    v_mfma_f32_16x16x32_bf16 v[108:111], a[156:159], a[52:55], v[108:111]
    ds_write_b128 v29, v[52:55] offset:1024
    v_mfma_f32_16x16x32_bf16 v[100:103], a[156:159], a[20:23], v[100:103]
    v_exp_f32 v81, v81
    s_waitcnt lgkmcnt(3)
    v_mfma_f32_16x16x32_bf16 v[96:99], a[160:163], a[24:27], v[96:99]
    ds_read_b128 a[172:175], v3 offset:41216
    v_cvt_pk_bf16_f32 v56, v80, v81
    v_mfma_f32_16x16x32_bf16 v[104:107], a[160:163], a[56:59], v[104:107]
    v_exp_f32 v82, v82
    v_mfma_f32_16x16x32_bf16 v[112:115], a[160:163], a[88:91], v[112:115]
    v_exp_f32 v83, v83
    s_waitcnt lgkmcnt(3)
    v_mfma_f32_16x16x32_bf16 v[116:119], a[164:167], a[88:91], v[116:119]
    ds_read_b64_tr_b16 a[144:145], v4 offset:0
    v_cvt_pk_bf16_f32 v57, v82, v83
    v_mfma_f32_16x16x32_bf16 v[108:111], a[164:167], a[56:59], v[108:111]
    ds_read_b64_tr_b16 a[146:147], v4 offset:8192
    v_mfma_f32_16x16x32_bf16 v[100:103], a[164:167], a[24:27], v[100:103]
    v_exp_f32 v84, v84
    s_waitcnt lgkmcnt(4)
    v_mfma_f32_16x16x32_bf16 v[96:99], a[168:171], a[28:31], v[96:99]
    ds_read_b64_tr_b16 a[148:149], v5 offset:0
    v_mfma_f32_16x16x32_bf16 v[104:107], a[168:171], a[60:63], v[104:107]
    ds_read_b64_tr_b16 a[150:151], v5 offset:8192
    v_exp_f32 v85, v85
    v_mfma_f32_16x16x32_bf16 v[112:115], a[168:171], a[92:95], v[112:115]
    v_exp_f32 v86, v86
    s_waitcnt lgkmcnt(4)
    v_mfma_f32_16x16x32_bf16 v[116:119], a[172:175], a[92:95], v[116:119]
    ds_read_b64_tr_b16 a[152:153], v6 offset:0
    v_cvt_pk_bf16_f32 v58, v84, v85
    v_mfma_f32_16x16x32_bf16 v[108:111], a[172:175], a[60:63], v[108:111]
    ds_read_b64_tr_b16 a[154:155], v6 offset:8192
    v_exp_f32 v87, v87
    v_mfma_f32_16x16x32_bf16 v[100:103], a[172:175], a[28:31], v[100:103]
    v_cvt_pk_bf16_f32 v59, v86, v87
    v_accvgpr_read_b32 v28, a180
    buffer_load_dword a180, v28, s[24:27], 0 offen offset:384
    s_waitcnt lgkmcnt(4)
    v_mfma_f32_16x16x32_bf16 v[128:131], a[144:147], v[48:51], v[128:131]
    ds_read_b64_tr_b16 a[156:157], v7 offset:0
    ds_write_b128 v29, v[56:59] offset:2048
    v_mfma_f32_16x16x32_bf16 v[132:135], a[144:147], v[52:55], v[132:135]
    ds_read_b64_tr_b16 a[158:159], v7 offset:8192
    v_mfma_f32_16x16x32_bf16 v[136:139], a[144:147], v[56:59], v[136:139]
    s_waitcnt lgkmcnt(5)
    v_mfma_f32_16x16x32_bf16 v[152:155], a[148:151], v[56:59], v[152:155]
    ds_read_b64_tr_b16 a[160:161], v8 offset:0
    v_max3_f32 v28, v96, v97, v98
    v_mfma_f32_16x16x32_bf16 v[148:151], a[148:151], v[52:55], v[148:151]
    ds_read_b64_tr_b16 a[162:163], v8 offset:8192
    v_max3_f32 v28, v28, v99, v100
    v_mfma_f32_16x16x32_bf16 v[144:147], a[148:151], v[48:51], v[144:147]
    s_waitcnt lgkmcnt(3)
    s_barrier
    v_max3_f32 v28, v28, v101, v102
    v_max3_f32 v28, v28, v103, v104
    v_mfma_f32_16x16x32_bf16 v[160:163], a[152:155], v[48:51], v[160:163]
    ds_read_b64_tr_b16 a[164:165], v9 offset:0
    ds_read_b128 a[128:131], v30 offset:0
    v_mfma_f32_16x16x32_bf16 v[164:167], a[152:155], v[52:55], v[164:167]
    ds_read_b64_tr_b16 a[166:167], v9 offset:8192
    v_max3_f32 v28, v28, v105, v106
    s_add_u32 m0, s61, 32768
    s_mov_b32 s68, 128
    v_mfma_f32_16x16x32_bf16 v[168:171], a[152:155], v[56:59], v[168:171]
    buffer_load_dwordx4 v12, s[24:27], s68 offen offset:0  lds
    s_waitcnt lgkmcnt(5)
    v_mfma_f32_16x16x32_bf16 v[184:187], a[156:159], v[56:59], v[184:187]
    ds_read_b64_tr_b16 a[168:169], v10 offset:0
    ds_read_b128 a[132:135], v30 offset:1024
    v_mfma_f32_16x16x32_bf16 v[180:183], a[156:159], v[52:55], v[180:183]
    ds_read_b64_tr_b16 a[170:171], v10 offset:8192
    v_max3_f32 v28, v28, v107, v108
    v_mfma_f32_16x16x32_bf16 v[176:179], a[156:159], v[48:51], v[176:179]
    v_max3_f32 v28, v28, v109, v110
    v_max3_f32 v28, v28, v111, v112
    s_waitcnt lgkmcnt(6)
    v_mfma_f32_16x16x32_bf16 v[192:195], a[160:163], v[48:51], v[192:195]
    ds_read_b64_tr_b16 a[172:173], v11 offset:0
    v_add_f32 v24, v24, v64
    v_mfma_f32_16x16x32_bf16 v[196:199], a[160:163], v[52:55], v[196:199]
    ds_read_b64_tr_b16 a[174:175], v11 offset:8192
    ds_read_b128 a[136:139], v30 offset:2048
    v_mfma_f32_16x16x32_bf16 v[200:203], a[160:163], v[56:59], v[200:203]
    buffer_load_dwordx4 v13, s[24:27], s68 offen offset:1024  lds
    s_waitcnt lgkmcnt(6)
    v_mfma_f32_16x16x32_bf16 v[216:219], a[164:167], v[56:59], v[216:219]
    ds_read_b64_tr_b16 a[144:145], v4 offset:16384
    v_add_f32 v25, v25, v72
    v_mfma_f32_16x16x32_bf16 v[212:215], a[164:167], v[52:55], v[212:215]
    ds_read_b64_tr_b16 a[146:147], v4 offset:24576
    v_add_f32 v26, v26, v80
    v_mfma_f32_16x16x32_bf16 v[208:211], a[164:167], v[48:51], v[208:211]
    buffer_load_dwordx4 v14, s[24:27], s68 offen offset:2048  lds
    s_waitcnt lgkmcnt(5)
    v_mfma_f32_16x16x32_bf16 v[224:227], a[168:171], v[48:51], v[224:227]
    ds_read_b64_tr_b16 a[148:149], v5 offset:16384
    v_max3_f32 v28, v28, v113, v114
    v_mfma_f32_16x16x32_bf16 v[228:231], a[168:171], v[52:55], v[228:231]
    ds_read_b64_tr_b16 a[150:151], v5 offset:24576
    v_add_f32 v24, v24, v65
    v_max3_f32 v28, v28, v115, v116
    v_mfma_f32_16x16x32_bf16 v[232:235], a[168:171], v[56:59], v[232:235]
    v_add_f32 v25, v25, v73
    v_max3_f32 v28, v28, v117, v118
    s_waitcnt lgkmcnt(5)
    v_mfma_f32_16x16x32_bf16 v[248:251], a[172:175], v[56:59], v[248:251]
    ds_read_b64_tr_b16 a[152:153], v6 offset:16384
    v_add_f32 v26, v26, v81
    v_mfma_f32_16x16x32_bf16 v[244:247], a[172:175], v[52:55], v[244:247]
    ds_read_b64_tr_b16 a[154:155], v6 offset:24576
    v_max_f32 v28, v28, v119
    v_mfma_f32_16x16x32_bf16 v[240:243], a[172:175], v[48:51], v[240:243]
    buffer_load_dwordx4 v15, s[24:27], s68 offen offset:3072  lds
    v_cmp_lt_f32 vcc, s66, v28
    s_cbranch_vccnz L_flag_p3_t30
L_flagback_p3_t30:
    s_waitcnt lgkmcnt(4)
    v_mfma_f32_16x16x32_bf16 v[128:131], a[144:147], a[128:131], v[128:131]
    s_waitcnt vmcnt(5)
    s_barrier
    ds_read_b32 v28, v31
    ds_read_b64_tr_b16 a[156:157], v7 offset:16384
    v_mfma_f32_16x16x32_bf16 v[132:135], a[144:147], a[132:135], v[132:135]
    ds_read_b64_tr_b16 a[158:159], v7 offset:24576
    v_add_f32 v24, v24, v66
    v_mfma_f32_16x16x32_bf16 v[136:139], a[144:147], a[136:139], v[136:139]
    v_add_f32 v25, v25, v74
    v_add_f32 v26, v26, v82
    s_waitcnt lgkmcnt(5)
    v_mfma_f32_16x16x32_bf16 v[152:155], a[148:151], a[136:139], v[152:155]
    ds_read_b64_tr_b16 a[160:161], v8 offset:16384
    v_add_f32 v24, v24, v67
    v_mfma_f32_16x16x32_bf16 v[148:151], a[148:151], a[132:135], v[148:151]
    ds_read_b64_tr_b16 a[162:163], v8 offset:24576
    v_add_f32 v25, v25, v75
    s_add_u32 m0, s61, 36864
    s_mov_b32 s68, 28800
    v_mfma_f32_16x16x32_bf16 v[144:147], a[148:151], a[128:131], v[144:147]
    buffer_load_dwordx4 v12, s[24:27], s68 offen offset:0  lds
    s_waitcnt lgkmcnt(5)
    v_mfma_f32_16x16x32_bf16 v[160:163], a[152:155], a[128:131], v[160:163]
    ds_read_b64_tr_b16 a[164:165], v9 offset:16384
    v_add_f32 v26, v26, v83
    v_mfma_f32_16x16x32_bf16 v[164:167], a[152:155], a[132:135], v[164:167]
    ds_read_b64_tr_b16 a[166:167], v9 offset:24576
    v_add_f32 v24, v24, v68
    v_mfma_f32_16x16x32_bf16 v[168:171], a[152:155], a[136:139], v[168:171]
    s_mov_b32 s3, 29312
    buffer_load_dwordx4 a[208:211], v21, s[24:27], s3 offen
    s_waitcnt lgkmcnt(4)
    v_mfma_f32_16x16x32_bf16 v[184:187], a[156:159], a[136:139], v[184:187]
    ds_read_b64_tr_b16 a[168:169], v10 offset:16384
    v_add_f32 v25, v25, v76
    v_mfma_f32_16x16x32_bf16 v[180:183], a[156:159], a[132:135], v[180:183]
    ds_read_b64_tr_b16 a[170:171], v10 offset:24576
    v_add_f32 v26, v26, v84
    v_mfma_f32_16x16x32_bf16 v[176:179], a[156:159], a[128:131], v[176:179]
    buffer_load_dwordx4 v13, s[24:27], s68 offen offset:1024  lds
    s_waitcnt lgkmcnt(4)
    v_mfma_f32_16x16x32_bf16 v[192:195], a[160:163], a[128:131], v[192:195]
    ds_read_b64_tr_b16 a[172:173], v11 offset:16384
    v_add_f32 v24, v24, v69
    v_mfma_f32_16x16x32_bf16 v[196:199], a[160:163], a[132:135], v[196:199]
    ds_read_b64_tr_b16 a[174:175], v11 offset:24576
    v_add_f32 v25, v25, v77
    v_mfma_f32_16x16x32_bf16 v[200:203], a[160:163], a[136:139], v[200:203]
    s_mov_b32 s3, 36480
    buffer_load_dwordx4 a[212:215], v21, s[24:27], s3 offen
    s_waitcnt lgkmcnt(4)
    v_mfma_f32_16x16x32_bf16 v[216:219], a[164:167], a[136:139], v[216:219]
    ds_read_b64_tr_b16 a[144:145], v4 offset:32768
    v_add_f32 v26, v26, v85
    v_mfma_f32_16x16x32_bf16 v[212:215], a[164:167], a[132:135], v[212:215]
    ds_read_b64_tr_b16 a[146:147], v4 offset:40960
    v_add_f32 v24, v24, v70
    v_mfma_f32_16x16x32_bf16 v[208:211], a[164:167], a[128:131], v[208:211]
    buffer_load_dwordx4 v14, s[24:27], s68 offen offset:2048  lds
    s_waitcnt lgkmcnt(4)
    v_mfma_f32_16x16x32_bf16 v[224:227], a[168:171], a[128:131], v[224:227]
    ds_read_b64_tr_b16 a[148:149], v5 offset:32768
    v_add_f32 v25, v25, v78
    v_mfma_f32_16x16x32_bf16 v[228:231], a[168:171], a[132:135], v[228:231]
    ds_read_b64_tr_b16 a[150:151], v5 offset:40960
    v_add_f32 v26, v26, v86
    v_mfma_f32_16x16x32_bf16 v[232:235], a[168:171], a[136:139], v[232:235]
    s_mov_b32 s3, 43648
    buffer_load_dwordx4 a[216:219], v21, s[24:27], s3 offen
    s_waitcnt lgkmcnt(4)
    v_mfma_f32_16x16x32_bf16 v[248:251], a[172:175], a[136:139], v[248:251]
    ds_read_b64_tr_b16 a[152:153], v6 offset:32768
    v_add_f32 v24, v24, v71
    v_mfma_f32_16x16x32_bf16 v[244:247], a[172:175], a[132:135], v[244:247]
    ds_read_b64_tr_b16 a[154:155], v6 offset:40960
    v_cmp_ne_u32 vcc, 0, v28
    v_mfma_f32_16x16x32_bf16 v[240:243], a[172:175], a[128:131], v[240:243]
    buffer_load_dwordx4 v15, s[24:27], s68 offen offset:3072  lds
    v_add_f32 v25, v25, v79
    v_add_f32 v26, v26, v87
    s_mov_b32 s3, 50816
    buffer_load_dwordx4 a[220:223], v21, s[24:27], s3 offen
    s_cbranch_vccnz L_rare_p3_t30
L_rareback_p3_t30:
    v_exp_f32 v96, v96
    v_exp_f32 v97, v97
    v_exp_f32 v98, v98
    v_cvt_pk_bf16_f32 v48, v96, v97
    v_exp_f32 v99, v99
    v_exp_f32 v100, v100
    v_cvt_pk_bf16_f32 v49, v98, v99
    v_exp_f32 v101, v101
    v_exp_f32 v102, v102
    v_cvt_pk_bf16_f32 v50, v100, v101
    v_exp_f32 v103, v103
    v_exp_f32 v104, v104
    v_cvt_pk_bf16_f32 v51, v102, v103
    ds_write_b128 v29, v[48:51] offset:0
    v_exp_f32 v105, v105
    v_exp_f32 v106, v106
    v_cvt_pk_bf16_f32 v52, v104, v105
    v_exp_f32 v107, v107
    v_exp_f32 v108, v108
    v_cvt_pk_bf16_f32 v53, v106, v107
    v_exp_f32 v109, v109
    v_exp_f32 v110, v110
    v_cvt_pk_bf16_f32 v54, v108, v109
    v_exp_f32 v111, v111
    v_exp_f32 v112, v112
    v_cvt_pk_bf16_f32 v55, v110, v111
    ds_write_b128 v29, v[52:55] offset:1024
    v_exp_f32 v113, v113
    v_exp_f32 v114, v114
    v_cvt_pk_bf16_f32 v56, v112, v113
    v_exp_f32 v115, v115
    v_exp_f32 v116, v116
    v_cvt_pk_bf16_f32 v57, v114, v115
    v_exp_f32 v117, v117
    v_exp_f32 v118, v118
    v_cvt_pk_bf16_f32 v58, v116, v117
    v_exp_f32 v119, v119
    s_nop 0
    v_cvt_pk_bf16_f32 v59, v118, v119
    ds_write_b128 v29, v[56:59] offset:2048
    s_waitcnt lgkmcnt(7)
    v_mfma_f32_16x16x32_bf16 v[128:131], a[144:147], v[48:51], v[128:131]
    ds_read_b64_tr_b16 a[156:157], v7 offset:32768
    v_add_f32 v24, v24, v96
    v_mfma_f32_16x16x32_bf16 v[132:135], a[144:147], v[52:55], v[132:135]
    ds_read_b64_tr_b16 a[158:159], v7 offset:40960
    v_accvgpr_read_b32 v0, a176
    v_mfma_f32_16x16x32_bf16 v[136:139], a[144:147], v[56:59], v[136:139]
    v_xor_b32 v1, 32, v0
    v_add_f32 v25, v25, v104
    s_waitcnt lgkmcnt(7)
    v_mfma_f32_16x16x32_bf16 v[152:155], a[148:151], v[56:59], v[152:155]
    ds_read_b64_tr_b16 a[160:161], v8 offset:32768
    v_add_f32 v26, v26, v112
    v_mfma_f32_16x16x32_bf16 v[148:151], a[148:151], v[52:55], v[148:151]
    ds_read_b64_tr_b16 a[162:163], v8 offset:40960
    v_add_f32 v24, v24, v97
    v_mfma_f32_16x16x32_bf16 v[144:147], a[148:151], v[48:51], v[144:147]
    s_waitcnt lgkmcnt(4)
    s_barrier
    v_add_u32 v2, 65536, v0
    v_add_f32 v25, v25, v105
    v_mfma_f32_16x16x32_bf16 v[160:163], a[152:155], v[48:51], v[160:163]
    ds_read_b64_tr_b16 a[164:165], v9 offset:32768
    v_xor_b32 v3, 32, v2
    v_mfma_f32_16x16x32_bf16 v[164:167], a[152:155], v[52:55], v[164:167]
    ds_read_b64_tr_b16 a[166:167], v9 offset:40960
    ds_read_b128 a[128:131], v30 offset:0
    v_mfma_f32_16x16x32_bf16 v[168:171], a[152:155], v[56:59], v[168:171]
    s_mov_b32 s3, 768
    buffer_load_dwordx4 a[224:227], v21, s[24:27], s3 offen
    s_waitcnt lgkmcnt(5)
    v_mfma_f32_16x16x32_bf16 v[184:187], a[156:159], v[56:59], v[184:187]
    ds_read_b64_tr_b16 a[168:169], v10 offset:32768
    v_and_b32 v17, 0xffffefff, v29
    v_mfma_f32_16x16x32_bf16 v[180:183], a[156:159], v[52:55], v[180:183]
    ds_read_b64_tr_b16 a[170:171], v10 offset:40960
    v_and_b32 v18, 1023, v29
    s_add_u32 m0, s61, 65536
    s_mov_b32 s68, 256
    v_mfma_f32_16x16x32_bf16 v[176:179], a[156:159], v[48:51], v[176:179]
    buffer_load_dwordx4 v12, s[24:27], s68 offen offset:0  lds
    s_waitcnt lgkmcnt(5)
    v_mfma_f32_16x16x32_bf16 v[192:195], a[160:163], v[48:51], v[192:195]
    ds_read_b64_tr_b16 a[172:173], v11 offset:32768
    v_add_f32 v26, v26, v113
    v_mfma_f32_16x16x32_bf16 v[196:199], a[160:163], v[52:55], v[196:199]
    ds_read_b64_tr_b16 a[174:175], v11 offset:40960
    v_add_u32 v18, s61, v18
    v_mfma_f32_16x16x32_bf16 v[200:203], a[160:163], v[56:59], v[200:203]
    buffer_load_dwordx4 v13, s[24:27], s68 offen offset:1024  lds
    s_waitcnt lgkmcnt(5)
    v_mfma_f32_16x16x32_bf16 v[216:219], a[164:167], v[56:59], v[216:219]
    ds_read_b64_tr_b16 a[144:145], v4 offset:49152
    v_add_f32 v24, v24, v98
    v_mfma_f32_16x16x32_bf16 v[212:215], a[164:167], v[52:55], v[212:215]
    ds_read_b64_tr_b16 a[146:147], v4 offset:57344
    ds_read_b128 a[132:135], v30 offset:1024
    v_mfma_f32_16x16x32_bf16 v[208:211], a[164:167], v[48:51], v[208:211]
    buffer_load_dwordx4 v14, s[24:27], s68 offen offset:2048  lds
    s_waitcnt lgkmcnt(5)
    v_mfma_f32_16x16x32_bf16 v[224:227], a[168:171], v[48:51], v[224:227]
    ds_read_b64_tr_b16 a[148:149], v5 offset:49152
    v_add_f32 v25, v25, v106
    v_mfma_f32_16x16x32_bf16 v[228:231], a[168:171], v[52:55], v[228:231]
    ds_read_b64_tr_b16 a[150:151], v5 offset:57344
    v_add_f32 v26, v26, v114
    v_mfma_f32_16x16x32_bf16 v[232:235], a[168:171], v[56:59], v[232:235]
    v_add_f32 v24, v24, v99
    ds_read_b128 a[136:139], v30 offset:2048
    s_waitcnt lgkmcnt(6)
    v_mfma_f32_16x16x32_bf16 v[248:251], a[172:175], v[56:59], v[248:251]
    ds_read_b64_tr_b16 a[152:153], v6 offset:49152
    v_add_f32 v25, v25, v107
    v_mfma_f32_16x16x32_bf16 v[244:247], a[172:175], v[52:55], v[244:247]
    ds_read_b64_tr_b16 a[154:155], v6 offset:57344
    v_add_f32 v26, v26, v115
    v_mfma_f32_16x16x32_bf16 v[240:243], a[172:175], v[48:51], v[240:243]
    buffer_load_dwordx4 v15, s[24:27], s68 offen offset:3072  lds
    s_waitcnt lgkmcnt(6)
    v_mfma_f32_16x16x32_bf16 v[128:131], a[144:147], a[128:131], v[128:131]
    s_waitcnt lgkmcnt(2)
    s_waitcnt vmcnt(63)
    s_barrier
    ds_read_b64_tr_b16 a[156:157], v7 offset:49152
    v_add_f32 v24, v24, v100
    v_mfma_f32_16x16x32_bf16 v[132:135], a[144:147], a[132:135], v[132:135]
    ds_read_b64_tr_b16 a[158:159], v7 offset:57344
    v_add_f32 v25, v25, v108
    v_mfma_f32_16x16x32_bf16 v[136:139], a[144:147], a[136:139], v[136:139]
    s_mov_b32 s3, 7936
    buffer_load_dwordx4 a[228:231], v21, s[24:27], s3 offen
    v_mfma_f32_16x16x32_bf16 v[152:155], a[148:151], a[136:139], v[152:155]
    ds_read_b64_tr_b16 a[160:161], v8 offset:49152
    v_add_f32 v26, v26, v116
    v_mfma_f32_16x16x32_bf16 v[148:151], a[148:151], a[132:135], v[148:151]
    ds_read_b64_tr_b16 a[162:163], v8 offset:57344
    v_add_f32 v24, v24, v101
    v_mfma_f32_16x16x32_bf16 v[144:147], a[148:151], a[128:131], v[144:147]
    v_add_f32 v25, v25, v109
    v_add_f32 v26, v26, v117
    s_waitcnt lgkmcnt(4)
    v_mfma_f32_16x16x32_bf16 v[160:163], a[152:155], a[128:131], v[160:163]
    ds_read_b64_tr_b16 a[164:165], v9 offset:49152
    v_add_f32 v24, v24, v102
    v_mfma_f32_16x16x32_bf16 v[164:167], a[152:155], a[132:135], v[164:167]
    ds_read_b64_tr_b16 a[166:167], v9 offset:57344
    v_add_f32 v25, v25, v110
    s_add_u32 m0, s61, 69632
    s_mov_b32 s68, 28928
    v_mfma_f32_16x16x32_bf16 v[168:171], a[152:155], a[136:139], v[168:171]
    buffer_load_dwordx4 v12, s[24:27], s68 offen offset:0  lds
    s_waitcnt lgkmcnt(4)
    v_mfma_f32_16x16x32_bf16 v[184:187], a[156:159], a[136:139], v[184:187]
    ds_read_b64_tr_b16 a[168:169], v10 offset:49152
    v_add_f32 v26, v26, v118
    v_mfma_f32_16x16x32_bf16 v[180:183], a[156:159], a[132:135], v[180:183]
    ds_read_b64_tr_b16 a[170:171], v10 offset:57344
    v_add_f32 v24, v24, v103
    v_cvt_pk_bf16_f32 v128, v128, v129
    v_mfma_f32_16x16x32_bf16 v[176:179], a[156:159], a[128:131], v[176:179]
    s_mov_b32 s3, 15104
    buffer_load_dwordx4 a[232:235], v21, s[24:27], s3 offen
    v_cvt_pk_bf16_f32 v129, v130, v131
    v_cvt_pk_bf16_f32 v130, v144, v145
    s_waitcnt lgkmcnt(4)
    v_mfma_f32_16x16x32_bf16 v[192:195], a[160:163], a[128:131], v[192:195]
    ds_read_b64_tr_b16 a[172:173], v11 offset:49152
    v_add_f32 v25, v25, v111
    v_cvt_pk_bf16_f32 v131, v146, v147
    ds_write_b128 v29, v[128:131] offset:0
    v_mfma_f32_16x16x32_bf16 v[196:199], a[160:163], a[132:135], v[196:199]
    ds_read_b64_tr_b16 a[174:175], v11 offset:57344
    v_add_f32 v26, v26, v119
    v_cvt_pk_bf16_f32 v132, v132, v133
    v_cvt_pk_bf16_f32 v133, v134, v135
    v_cvt_pk_bf16_f32 v134, v148, v149
    v_mfma_f32_16x16x32_bf16 v[200:203], a[160:163], a[136:139], v[200:203]
    buffer_load_dwordx4 v13, s[24:27], s68 offen offset:1024  lds
    v_cvt_pk_bf16_f32 v135, v150, v151
    ds_write_b128 v29, v[132:135] offset:1024
    s_waitcnt lgkmcnt(6)
    v_mfma_f32_16x16x32_bf16 v[216:219], a[164:167], a[136:139], v[216:219]
    ds_read_b64_tr_b16 a[144:145], v0 offset:0
    v_cvt_pk_bf16_f32 v136, v136, v137
    v_cvt_pk_bf16_f32 v137, v138, v139
    v_mfma_f32_16x16x32_bf16 v[212:215], a[164:167], a[132:135], v[212:215]
    ds_read_b64_tr_b16 a[146:147], v0 offset:2048
    v_cvt_pk_bf16_f32 v138, v152, v153
    v_cvt_pk_bf16_f32 v139, v154, v155
    ds_write_b128 v29, v[136:139] offset:2048
    v_mfma_f32_16x16x32_bf16 v[208:211], a[164:167], a[128:131], v[208:211]
    buffer_load_dwordx4 v14, s[24:27], s68 offen offset:2048  lds
    v_cvt_pk_bf16_f32 v160, v160, v161
    s_waitcnt lgkmcnt(7)
    v_mfma_f32_16x16x32_bf16 v[224:227], a[168:171], a[128:131], v[224:227]
    s_waitcnt lgkmcnt(0)
    s_barrier
    ds_read_b64_tr_b16 a[148:149], v1 offset:0
    ds_read_b128 a[0:3], v17 offset:0
    v_cvt_pk_bf16_f32 v161, v162, v163
    v_cvt_pk_bf16_f32 v162, v176, v177
    v_mfma_f32_16x16x32_bf16 v[228:231], a[168:171], a[132:135], v[228:231]
    ds_read_b64_tr_b16 a[150:151], v1 offset:2048
    ds_read_b128 a[4:7], v17 offset:1024
    v_cvt_pk_bf16_f32 v163, v178, v179
    ds_write_b128 v29, v[160:163] offset:16384
    v_mfma_f32_16x16x32_bf16 v[232:235], a[168:171], a[136:139], v[232:235]
    v_cvt_pk_bf16_f32 v164, v164, v165
    ds_read_b128 a[8:11], v17 offset:2048
    v_cvt_pk_bf16_f32 v165, v166, v167
    v_mfma_f32_16x16x32_bf16 v[248:251], a[172:175], a[136:139], v[248:251]
    ds_read_b64_tr_b16 a[152:153], v0 offset:16384
    ds_read_b128 a[64:67], v17 offset:4096
    v_cvt_pk_bf16_f32 v166, v180, v181
    v_cvt_pk_bf16_f32 v167, v182, v183
    v_mfma_f32_16x16x32_bf16 v[244:247], a[172:175], a[132:135], v[244:247]
    ds_read_b64_tr_b16 a[154:155], v0 offset:18432
    ds_read_b128 a[68:71], v17 offset:5120
    ds_read_b128 a[72:75], v17 offset:6144
    ds_write_b128 v29, v[164:167] offset:17408
    v_mfma_f32_16x16x32_bf16 v[240:243], a[172:175], a[128:131], v[240:243]
    buffer_load_dwordx4 v15, s[24:27], s68 offen offset:3072  lds
    v_cvt_pk_bf16_f32 v168, v168, v169
    v_cvt_pk_bf16_f32 v169, v170, v171
    v_cvt_pk_bf16_f32 v170, v184, v185
    s_mov_b32 s3, 22272
    buffer_load_dwordx4 a[236:239], v21, s[24:27], s3 offen
    v_cvt_pk_bf16_f32 v171, v186, v187
    ds_write_b128 v29, v[168:171] offset:18432
    s_waitcnt lgkmcnt(11)
    v_mfma_f32_16x16x32_bf16 v[64:67], a[144:147], a[0:3], 0
    ds_read_b64_tr_b16 a[156:157], v1 offset:16384
    s_waitcnt lgkmcnt(10)
    v_mfma_f32_16x16x32_bf16 v[68:71], a[144:147], a[4:7], 0
    s_waitcnt lgkmcnt(3)
    s_waitcnt lgkmcnt(1)
    s_barrier
    ds_read_b64_tr_b16 a[158:159], v1 offset:18432
    ds_read_b128 a[16:19], v17 offset:16384
    v_mfma_f32_16x16x32_bf16 v[72:75], a[144:147], a[8:11], 0
    ds_read_b128 a[20:23], v17 offset:17408
    ds_read_b128 a[24:27], v17 offset:18432
    v_mfma_f32_16x16x32_bf16 v[88:91], a[148:151], a[8:11], 0
    ds_read_b64_tr_b16 a[160:161], v0 offset:4096
    ds_read_b128 a[80:83], v17 offset:20480
    v_cvt_pk_bf16_f32 v192, v192, v193
    v_mfma_f32_16x16x32_bf16 v[84:87], a[148:151], a[4:7], 0
    ds_read_b64_tr_b16 a[162:163], v0 offset:6144
    ds_read_b128 a[84:87], v17 offset:21504
    v_cvt_pk_bf16_f32 v193, v194, v195
    v_mfma_f32_16x16x32_bf16 v[80:83], a[148:151], a[0:3], 0
    v_cvt_pk_bf16_f32 v194, v208, v209
    ds_read_b128 a[88:91], v17 offset:22528
    v_cvt_pk_bf16_f32 v195, v210, v211
    v_mfma_f32_16x16x32_bf16 v[64:67], a[152:155], a[64:67], v[64:67]
    ds_read_b64_tr_b16 a[164:165], v1 offset:4096
    ds_write_b128 v29, v[192:195] offset:0
    v_mfma_f32_16x16x32_bf16 v[68:71], a[152:155], a[68:71], v[68:71]
    ds_read_b64_tr_b16 a[166:167], v1 offset:6144
    v_cvt_pk_bf16_f32 v196, v196, v197
    v_cvt_pk_bf16_f32 v197, v198, v199
    v_mfma_f32_16x16x32_bf16 v[72:75], a[152:155], a[72:75], v[72:75]
    s_mov_b32 s3, 29440
    buffer_load_dwordx4 a[240:243], v21, s[24:27], s3 offen
    v_cvt_pk_bf16_f32 v198, v212, v213
    s_waitcnt lgkmcnt(11)
    v_mfma_f32_16x16x32_bf16 v[88:91], a[156:159], a[72:75], v[88:91]
    ds_read_b64_tr_b16 a[168:169], v0 offset:20480
    v_cvt_pk_bf16_f32 v199, v214, v215
    ds_write_b128 v29, v[196:199] offset:1024
    v_mfma_f32_16x16x32_bf16 v[84:87], a[156:159], a[68:71], v[84:87]
    ds_read_b64_tr_b16 a[170:171], v0 offset:22528
    v_cvt_pk_bf16_f32 v200, v200, v201
    v_mfma_f32_16x16x32_bf16 v[80:83], a[156:159], a[64:67], v[80:83]
    v_cvt_pk_bf16_f32 v201, v202, v203
    v_cvt_pk_bf16_f32 v202, v216, v217
    s_waitcnt lgkmcnt(8)
    v_mfma_f32_16x16x32_bf16 v[64:67], a[160:163], a[16:19], v[64:67]
    ds_read_b64_tr_b16 a[172:173], v1 offset:20480
    v_cvt_pk_bf16_f32 v203, v218, v219
    ds_write_b128 v29, v[200:203] offset:2048
    v_mfma_f32_16x16x32_bf16 v[68:71], a[160:163], a[20:23], v[68:71]
    ds_read_b64_tr_b16 a[174:175], v1 offset:22528
    v_mfma_f32_16x16x32_bf16 v[72:75], a[160:163], a[24:27], v[72:75]
    s_waitcnt lgkmcnt(9)
    s_waitcnt lgkmcnt(1)
    s_barrier
    s_mov_b32 s3, 36608
    buffer_load_dwordx4 a[244:247], v21, s[24:27], s3 offen
    v_mfma_f32_16x16x32_bf16 v[88:91], a[164:167], a[24:27], v[88:91]
    ds_read_b64_tr_b16 a[144:145], v0 offset:8192
    ds_read_b128 a[32:35], v17 offset:0
    v_mfma_f32_16x16x32_bf16 v[84:87], a[164:167], a[20:23], v[84:87]
    ds_read_b64_tr_b16 a[146:147], v0 offset:10240
    ds_read_b128 a[36:39], v17 offset:1024
    v_cvt_pk_bf16_f32 v224, v224, v225
    v_mfma_f32_16x16x32_bf16 v[80:83], a[164:167], a[16:19], v[80:83]
    v_cvt_pk_bf16_f32 v225, v226, v227
    ds_read_b128 a[40:43], v17 offset:2048
    v_mfma_f32_16x16x32_bf16 v[64:67], a[168:171], a[80:83], v[64:67]
    ds_read_b64_tr_b16 a[148:149], v1 offset:8192
    ds_read_b128 a[96:99], v17 offset:4096
    v_cvt_pk_bf16_f32 v226, v240, v241
    v_cvt_pk_bf16_f32 v227, v242, v243
    v_mfma_f32_16x16x32_bf16 v[68:71], a[168:171], a[84:87], v[68:71]
    ds_read_b64_tr_b16 a[150:151], v1 offset:10240
    ds_read_b128 a[100:103], v17 offset:5120
    ds_write_b128 v29, v[224:227] offset:16384
    v_cvt_pk_bf16_f32 v228, v228, v229
    v_mfma_f32_16x16x32_bf16 v[72:75], a[168:171], a[88:91], v[72:75]
    s_mov_b32 s3, 43776
    buffer_load_dwordx4 a[248:251], v21, s[24:27], s3 offen
    v_cvt_pk_bf16_f32 v229, v230, v231
    v_cvt_pk_bf16_f32 v230, v244, v245
    s_waitcnt lgkmcnt(10)
    v_mfma_f32_16x16x32_bf16 v[88:91], a[172:175], a[88:91], v[88:91]
    ds_read_b64_tr_b16 a[152:153], v0 offset:24576
    ds_read_b128 a[104:107], v17 offset:6144
    v_cvt_pk_bf16_f32 v231, v246, v247
    v_mfma_f32_16x16x32_bf16 v[84:87], a[172:175], a[84:87], v[84:87]
    ds_read_b64_tr_b16 a[154:155], v0 offset:26624
    ds_write_b128 v29, v[228:231] offset:17408
    v_cvt_pk_bf16_f32 v232, v232, v233
    v_mfma_f32_16x16x32_bf16 v[80:83], a[172:175], a[80:83], v[80:83]
    v_cvt_pk_bf16_f32 v233, v234, v235
    v_cvt_pk_bf16_f32 v234, v248, v249
    s_waitcnt lgkmcnt(11)
    v_mfma_f32_16x16x32_bf16 v[64:67], a[144:147], a[32:35], v[64:67]
    ds_read_b64_tr_b16 a[156:157], v1 offset:24576
    v_cvt_pk_bf16_f32 v235, v250, v251
    ds_write_b128 v29, v[232:235] offset:18432
    s_waitcnt lgkmcnt(12)
    v_mfma_f32_16x16x32_bf16 v[68:71], a[144:147], a[36:39], v[68:71]
    ds_read_b64_tr_b16 a[158:159], v1 offset:26624
    s_waitcnt lgkmcnt(12)
    v_mfma_f32_16x16x32_bf16 v[72:75], a[144:147], a[40:43], v[72:75]
    s_waitcnt lgkmcnt(1)
    s_barrier
    s_mov_b32 s3, 50944
    buffer_load_dwordx4 a[252:255], v21, s[24:27], s3 offen
    v_mfma_f32_16x16x32_bf16 v[88:91], a[148:151], a[40:43], v[88:91]
    ds_read_b64_tr_b16 a[160:161], v0 offset:12288
    ds_read_b128 a[48:51], v17 offset:16384
    v_mov_b32 v36, v24
    v_mfma_f32_16x16x32_bf16 v[84:87], a[148:151], a[36:39], v[84:87]
    ds_read_b64_tr_b16 a[162:163], v0 offset:14336
    ds_read_b128 a[52:55], v17 offset:17408
    v_mov_b32 v37, v25
    v_mov_b32 v38, v26
    s_add_u32 m0, s61, 98304
    s_mov_b32 s68, 384
    v_mfma_f32_16x16x32_bf16 v[80:83], a[148:151], a[32:35], v[80:83]
    buffer_load_dwordx4 v12, s[24:27], s68 offen offset:0  lds
    v_permlane32_swap_b32 v36, v24
    v_permlane32_swap_b32 v37, v25
    v_mfma_f32_16x16x32_bf16 v[64:67], a[152:155], a[96:99], v[64:67]
    ds_read_b64_tr_b16 a[164:165], v1 offset:12288
    ds_read_b128 a[56:59], v17 offset:18432
    v_permlane32_swap_b32 v38, v26
    v_add_f32 v24, v24, v36
    v_mfma_f32_16x16x32_bf16 v[68:71], a[152:155], a[100:103], v[68:71]
    ds_read_b64_tr_b16 a[166:167], v1 offset:14336
    ds_read_b128 a[112:115], v17 offset:20480
    v_add_f32 v25, v25, v37
    v_add_f32 v26, v26, v38
    v_mfma_f32_16x16x32_bf16 v[72:75], a[152:155], a[104:107], v[72:75]
    buffer_load_dwordx4 v13, s[24:27], s68 offen offset:1024  lds
    v_mov_b32 v36, v24
    v_mov_b32 v37, v25
    s_waitcnt lgkmcnt(8)
    v_mfma_f32_16x16x32_bf16 v[88:91], a[156:159], a[104:107], v[88:91]
    ds_read_b64_tr_b16 a[168:169], v0 offset:28672
    ds_read_b128 a[116:119], v17 offset:21504
    v_mov_b32 v38, v26
    v_permlane16_swap_b32 v36, v24
    v_mfma_f32_16x16x32_bf16 v[84:87], a[156:159], a[100:103], v[84:87]
    ds_read_b64_tr_b16 a[170:171], v0 offset:30720
    ds_read_b128 a[120:123], v17 offset:22528
    v_permlane16_swap_b32 v37, v25
    v_permlane16_swap_b32 v38, v26
    v_mfma_f32_16x16x32_bf16 v[80:83], a[156:159], a[96:99], v[80:83]
    buffer_load_dwordx4 v14, s[24:27], s68 offen offset:2048  lds
    v_add_f32 v24, v24, v36
    v_add_f32 v25, v25, v37
    s_waitcnt lgkmcnt(9)
    v_mfma_f32_16x16x32_bf16 v[64:67], a[160:163], a[48:51], v[64:67]
    ds_read_b64_tr_b16 a[172:173], v1 offset:28672
    v_add_f32 v26, v26, v38
    ds_write_b128 v22, v[24:27]
    s_waitcnt lgkmcnt(10)
    v_mfma_f32_16x16x32_bf16 v[68:71], a[160:163], a[52:55], v[68:71]
    ds_read_b64_tr_b16 a[174:175], v1 offset:30720
    s_waitcnt lgkmcnt(9)
    v_mfma_f32_16x16x32_bf16 v[72:75], a[160:163], a[56:59], v[72:75]
    s_waitcnt lgkmcnt(1)
    s_waitcnt vmcnt(20)
    s_barrier
    ds_read_b128 v[36:39], v23
    v_mfma_f32_16x16x32_bf16 v[88:91], a[164:167], a[56:59], v[88:91]
    ds_read_b64_tr_b16 a[144:145], v0 offset:32768
    v_mfma_f32_16x16x32_bf16 v[84:87], a[164:167], a[52:55], v[84:87]
    ds_read_b64_tr_b16 a[146:147], v0 offset:34816
    v_mfma_f32_16x16x32_bf16 v[80:83], a[164:167], a[48:51], v[80:83]
    buffer_load_dwordx4 v15, s[24:27], s68 offen offset:3072  lds
    v_mfma_f32_16x16x32_bf16 v[64:67], a[168:171], a[112:115], v[64:67]
    ds_read_b64_tr_b16 a[148:149], v1 offset:32768
    v_mfma_f32_16x16x32_bf16 v[68:71], a[168:171], a[116:119], v[68:71]
    ds_read_b64_tr_b16 a[150:151], v1 offset:34816
    s_waitcnt lgkmcnt(4)
    v_add_f32 v24, v24, v36
    s_add_u32 m0, s61, 102400
    s_mov_b32 s68, 29056
    v_mfma_f32_16x16x32_bf16 v[72:75], a[168:171], a[120:123], v[72:75]
    buffer_load_dwordx4 v12, s[24:27], s68 offen offset:0  lds
    v_mfma_f32_16x16x32_bf16 v[88:91], a[172:175], a[120:123], v[88:91]
    ds_read_b64_tr_b16 a[152:153], v0 offset:36864
    v_add_f32 v25, v25, v37
    v_mfma_f32_16x16x32_bf16 v[84:87], a[172:175], a[116:119], v[84:87]
    ds_read_b64_tr_b16 a[154:155], v0 offset:38912
    v_add_f32 v26, v26, v38
    v_mfma_f32_16x16x32_bf16 v[80:83], a[172:175], a[112:115], v[80:83]
    buffer_load_dwordx4 v13, s[24:27], s68 offen offset:1024  lds
    v_rcp_f32 v32, v24
    buffer_load_dwordx4 v14, s[24:27], s68 offen offset:2048  lds
    buffer_load_dwordx4 v15, s[24:27], s68 offen offset:3072  lds
    v_rcp_f32 v33, v25
    v_rcp_f32 v34, v26
    s_waitcnt lgkmcnt(4)
    v_mfma_f32_16x16x32_bf16 v[96:99], a[144:147], a[0:3], 0
    s_barrier
    ds_read_b64_tr_b16 a[156:157], v1 offset:36864
    v_mfma_f32_16x16x32_bf16 v[100:103], a[144:147], a[4:7], 0
    ds_read_b64_tr_b16 a[158:159], v1 offset:38912
    s_add_u32 m0, s61, 0
    s_mov_b32 s68, 512
    v_mfma_f32_16x16x32_bf16 v[104:107], a[144:147], a[8:11], 0
    buffer_load_dwordx4 v12, s[24:27], s68 offen offset:0  lds
    s_waitcnt lgkmcnt(4)
    v_mfma_f32_16x16x32_bf16 v[120:123], a[148:151], a[8:11], 0
    ds_read_b64_tr_b16 a[160:161], v0 offset:40960
    v_mul_f32 v64, v32, v64
    v_mfma_f32_16x16x32_bf16 v[116:119], a[148:151], a[4:7], 0
    ds_read_b64_tr_b16 a[162:163], v0 offset:43008
    v_mul_f32 v65, v32, v65
    v_mfma_f32_16x16x32_bf16 v[112:115], a[148:151], a[0:3], 0
    v_mul_f32 v66, v32, v66
    v_mul_f32 v67, v32, v67
    s_waitcnt lgkmcnt(4)
    v_mfma_f32_16x16x32_bf16 v[96:99], a[152:155], a[16:19], v[96:99]
    ds_read_b64_tr_b16 a[164:165], v1 offset:40960
    v_cvt_pk_bf16_f32 v128, v64, v65
    v_mfma_f32_16x16x32_bf16 v[100:103], a[152:155], a[20:23], v[100:103]
    ds_read_b64_tr_b16 a[166:167], v1 offset:43008
    v_cvt_pk_bf16_f32 v129, v66, v67
    v_mfma_f32_16x16x32_bf16 v[104:107], a[152:155], a[24:27], v[104:107]
    buffer_load_dwordx4 v13, s[24:27], s68 offen offset:1024  lds
    s_waitcnt lgkmcnt(4)
    v_mfma_f32_16x16x32_bf16 v[120:123], a[156:159], a[24:27], v[120:123]
    ds_read_b64_tr_b16 a[168:169], v0 offset:45056
    v_mul_f32 v80, v32, v80
    v_mfma_f32_16x16x32_bf16 v[116:119], a[156:159], a[20:23], v[116:119]
    ds_read_b64_tr_b16 a[170:171], v0 offset:47104
    v_mul_f32 v81, v32, v81
    v_mfma_f32_16x16x32_bf16 v[112:115], a[156:159], a[16:19], v[112:115]
    buffer_load_dwordx4 v14, s[24:27], s68 offen offset:2048  lds
    s_waitcnt lgkmcnt(4)
    v_mfma_f32_16x16x32_bf16 v[96:99], a[160:163], a[32:35], v[96:99]
    ds_read_b64_tr_b16 a[172:173], v1 offset:45056
    v_mul_f32 v82, v32, v82
    v_mfma_f32_16x16x32_bf16 v[100:103], a[160:163], a[36:39], v[100:103]
    ds_read_b64_tr_b16 a[174:175], v1 offset:47104
    v_mul_f32 v83, v32, v83
    v_mfma_f32_16x16x32_bf16 v[104:107], a[160:163], a[40:43], v[104:107]
    buffer_load_dwordx4 v15, s[24:27], s68 offen offset:3072  lds
    s_waitcnt lgkmcnt(4)
    v_mfma_f32_16x16x32_bf16 v[120:123], a[164:167], a[40:43], v[120:123]
    ds_read_b64_tr_b16 a[144:145], v0 offset:49152
    v_cvt_pk_bf16_f32 v130, v80, v81
    v_mfma_f32_16x16x32_bf16 v[116:119], a[164:167], a[36:39], v[116:119]
    ds_read_b64_tr_b16 a[146:147], v0 offset:51200
    v_cvt_pk_bf16_f32 v131, v82, v83
    s_add_u32 m0, s61, 4096
    s_mov_b32 s68, 29184
    v_mfma_f32_16x16x32_bf16 v[112:115], a[164:167], a[32:35], v[112:115]
    buffer_load_dwordx4 v12, s[24:27], s68 offen offset:0  lds
    s_waitcnt lgkmcnt(4)
    v_mfma_f32_16x16x32_bf16 v[96:99], a[168:171], a[48:51], v[96:99]
    ds_read_b64_tr_b16 a[148:149], v1 offset:49152
    v_mul_f32 v68, v33, v68
    v_mfma_f32_16x16x32_bf16 v[100:103], a[168:171], a[52:55], v[100:103]
    ds_read_b64_tr_b16 a[150:151], v1 offset:51200
    v_mul_f32 v69, v33, v69
    v_mfma_f32_16x16x32_bf16 v[104:107], a[168:171], a[56:59], v[104:107]
    buffer_load_dwordx4 v13, s[24:27], s68 offen offset:1024  lds
    s_waitcnt lgkmcnt(4)
    v_mfma_f32_16x16x32_bf16 v[120:123], a[172:175], a[56:59], v[120:123]
    ds_read_b64_tr_b16 a[152:153], v0 offset:53248
    v_mul_f32 v70, v33, v70
    v_mfma_f32_16x16x32_bf16 v[116:119], a[172:175], a[52:55], v[116:119]
    ds_read_b64_tr_b16 a[154:155], v0 offset:55296
    v_mul_f32 v71, v33, v71
    v_mfma_f32_16x16x32_bf16 v[112:115], a[172:175], a[48:51], v[112:115]
    buffer_load_dwordx4 v14, s[24:27], s68 offen offset:2048  lds
    s_waitcnt lgkmcnt(4)
    v_mfma_f32_16x16x32_bf16 v[96:99], a[144:147], a[64:67], v[96:99]
    s_waitcnt vmcnt(20)
    s_barrier
    ds_read_b64_tr_b16 a[156:157], v1 offset:53248
    v_cvt_pk_bf16_f32 v132, v68, v69
    v_mfma_f32_16x16x32_bf16 v[100:103], a[144:147], a[68:71], v[100:103]
    ds_read_b64_tr_b16 a[158:159], v1 offset:55296
    v_cvt_pk_bf16_f32 v133, v70, v71
    v_mfma_f32_16x16x32_bf16 v[104:107], a[144:147], a[72:75], v[104:107]
    buffer_load_dwordx4 v15, s[24:27], s68 offen offset:3072  lds
    s_waitcnt lgkmcnt(4)
    v_mfma_f32_16x16x32_bf16 v[120:123], a[148:151], a[72:75], v[120:123]
    ds_read_b64_tr_b16 a[160:161], v0 offset:57344
    v_mul_f32 v84, v33, v84
    v_mfma_f32_16x16x32_bf16 v[116:119], a[148:151], a[68:71], v[116:119]
    ds_read_b64_tr_b16 a[162:163], v0 offset:59392
    v_mul_f32 v85, v33, v85
    v_mfma_f32_16x16x32_bf16 v[112:115], a[148:151], a[64:67], v[112:115]
    v_mul_f32 v86, v33, v86
    v_mul_f32 v87, v33, v87
    s_waitcnt lgkmcnt(4)
    v_mfma_f32_16x16x32_bf16 v[96:99], a[152:155], a[80:83], v[96:99]
    ds_read_b64_tr_b16 a[164:165], v1 offset:57344
    v_cvt_pk_bf16_f32 v134, v84, v85
    v_mfma_f32_16x16x32_bf16 v[100:103], a[152:155], a[84:87], v[100:103]
    ds_read_b64_tr_b16 a[166:167], v1 offset:59392
    v_cvt_pk_bf16_f32 v135, v86, v87
    v_mfma_f32_16x16x32_bf16 v[104:107], a[152:155], a[88:91], v[104:107]
    v_mul_f32 v72, v34, v72
    v_mul_f32 v73, v34, v73
    s_waitcnt lgkmcnt(4)
    v_mfma_f32_16x16x32_bf16 v[120:123], a[156:159], a[88:91], v[120:123]
    ds_read_b64_tr_b16 a[168:169], v0 offset:61440
    v_mul_f32 v74, v34, v74
    v_mfma_f32_16x16x32_bf16 v[116:119], a[156:159], a[84:87], v[116:119]
    ds_read_b64_tr_b16 a[170:171], v0 offset:63488
    v_mul_f32 v75, v34, v75
    v_mfma_f32_16x16x32_bf16 v[112:115], a[156:159], a[80:83], v[112:115]
    v_cvt_pk_bf16_f32 v136, v72, v73
    s_waitcnt lgkmcnt(4)
    v_mfma_f32_16x16x32_bf16 v[96:99], a[160:163], a[96:99], v[96:99]
    ds_read_b64_tr_b16 a[172:173], v1 offset:61440
    v_cvt_pk_bf16_f32 v137, v74, v75
    v_mfma_f32_16x16x32_bf16 v[100:103], a[160:163], a[100:103], v[100:103]
    ds_read_b64_tr_b16 a[174:175], v1 offset:63488
    v_mul_f32 v88, v34, v88
    v_mfma_f32_16x16x32_bf16 v[104:107], a[160:163], a[104:107], v[104:107]
    s_waitcnt lgkmcnt(4)
    v_mfma_f32_16x16x32_bf16 v[120:123], a[164:167], a[104:107], v[120:123]
    ds_read_b64_tr_b16 a[144:145], v2 offset:0
    v_mul_f32 v89, v34, v89
    v_mfma_f32_16x16x32_bf16 v[116:119], a[164:167], a[100:103], v[116:119]
    ds_read_b64_tr_b16 a[146:147], v2 offset:2048
    v_mul_f32 v90, v34, v90
    v_mfma_f32_16x16x32_bf16 v[112:115], a[164:167], a[96:99], v[112:115]
    v_mul_f32 v91, v34, v91
    s_waitcnt lgkmcnt(4)
    v_mfma_f32_16x16x32_bf16 v[96:99], a[168:171], a[112:115], v[96:99]
    ds_read_b64_tr_b16 a[148:149], v3 offset:0
    v_cvt_pk_bf16_f32 v138, v88, v89
    v_mfma_f32_16x16x32_bf16 v[100:103], a[168:171], a[116:119], v[100:103]
    ds_read_b64_tr_b16 a[150:151], v3 offset:2048
    v_cvt_pk_bf16_f32 v139, v90, v91
    v_mfma_f32_16x16x32_bf16 v[104:107], a[168:171], a[120:123], v[104:107]
    s_waitcnt lgkmcnt(4)
    v_mfma_f32_16x16x32_bf16 v[120:123], a[172:175], a[120:123], v[120:123]
    ds_read_b64_tr_b16 a[152:153], v2 offset:4096
    v_mfma_f32_16x16x32_bf16 v[116:119], a[172:175], a[116:119], v[116:119]
    ds_read_b64_tr_b16 a[154:155], v2 offset:6144
    v_mfma_f32_16x16x32_bf16 v[112:115], a[172:175], a[112:115], v[112:115]
    s_waitcnt lgkmcnt(4)
    v_mfma_f32_16x16x32_bf16 v[64:67], a[144:147], a[0:3], 0
    s_barrier
    ds_read_b64_tr_b16 a[156:157], v3 offset:4096
    v_mfma_f32_16x16x32_bf16 v[68:71], a[144:147], a[4:7], 0
    ds_read_b64_tr_b16 a[158:159], v3 offset:6144
    v_mfma_f32_16x16x32_bf16 v[72:75], a[144:147], a[8:11], 0
    ds_write_b128 v18, a[192:195] offset:32768
    s_waitcnt lgkmcnt(5)
    v_mfma_f32_16x16x32_bf16 v[88:91], a[148:151], a[8:11], 0
    ds_read_b64_tr_b16 a[160:161], v2 offset:8192
    v_mul_f32 v96, v32, v96
    v_mfma_f32_16x16x32_bf16 v[84:87], a[148:151], a[4:7], 0
    ds_read_b64_tr_b16 a[162:163], v2 offset:10240
    v_mul_f32 v97, v32, v97
    v_mfma_f32_16x16x32_bf16 v[80:83], a[148:151], a[0:3], 0
    s_mov_b32 s69, 0
    buffer_store_dwordx4 v[128:131], v20, s[28:31], s69 offen sc1
    s_waitcnt lgkmcnt(5)
    v_mfma_f32_16x16x32_bf16 v[64:67], a[152:155], a[16:19], v[64:67]
    ds_read_b64_tr_b16 a[164:165], v3 offset:8192
    v_mul_f32 v98, v32, v98
    v_mfma_f32_16x16x32_bf16 v[68:71], a[152:155], a[20:23], v[68:71]
    ds_read_b64_tr_b16 a[166:167], v3 offset:10240
    v_mul_f32 v99, v32, v99
    v_mfma_f32_16x16x32_bf16 v[72:75], a[152:155], a[24:27], v[72:75]
    ds_write_b128 v18, a[196:199] offset:33792
    s_waitcnt lgkmcnt(6)
    v_mfma_f32_16x16x32_bf16 v[88:91], a[156:159], a[24:27], v[88:91]
    ds_read_b64_tr_b16 a[168:169], v2 offset:12288
    v_cvt_pk_bf16_f32 v144, v96, v97
    v_mfma_f32_16x16x32_bf16 v[84:87], a[156:159], a[20:23], v[84:87]
    ds_read_b64_tr_b16 a[170:171], v2 offset:14336
    v_cvt_pk_bf16_f32 v145, v98, v99
    v_mfma_f32_16x16x32_bf16 v[80:83], a[156:159], a[16:19], v[80:83]
    v_mul_f32 v112, v32, v112
    v_mul_f32 v113, v32, v113
    s_waitcnt lgkmcnt(5)
    v_mfma_f32_16x16x32_bf16 v[64:67], a[160:163], a[32:35], v[64:67]
    ds_read_b64_tr_b16 a[172:173], v3 offset:12288
    v_mul_f32 v114, v32, v114
    v_mfma_f32_16x16x32_bf16 v[68:71], a[160:163], a[36:39], v[68:71]
    ds_read_b64_tr_b16 a[174:175], v3 offset:14336
    v_mul_f32 v115, v32, v115
    v_mfma_f32_16x16x32_bf16 v[72:75], a[160:163], a[40:43], v[72:75]
    ds_write_b128 v18, a[200:203] offset:34816
    s_waitcnt lgkmcnt(6)
    v_mfma_f32_16x16x32_bf16 v[88:91], a[164:167], a[40:43], v[88:91]
    ds_read_b64_tr_b16 a[144:145], v2 offset:16384
    v_cvt_pk_bf16_f32 v146, v112, v113
    v_mfma_f32_16x16x32_bf16 v[84:87], a[164:167], a[36:39], v[84:87]
    ds_read_b64_tr_b16 a[146:147], v2 offset:18432
    v_cvt_pk_bf16_f32 v147, v114, v115
    v_mfma_f32_16x16x32_bf16 v[80:83], a[164:167], a[32:35], v[80:83]
    ds_write_b128 v18, a[204:207] offset:35840
    s_waitcnt lgkmcnt(6)
    v_mfma_f32_16x16x32_bf16 v[64:67], a[168:171], a[48:51], v[64:67]
    ds_read_b64_tr_b16 a[148:149], v3 offset:16384
    v_mfma_f32_16x16x32_bf16 v[68:71], a[168:171], a[52:55], v[68:71]
    ds_read_b64_tr_b16 a[150:151], v3 offset:18432
    v_mfma_f32_16x16x32_bf16 v[72:75], a[168:171], a[56:59], v[72:75]
    s_mov_b32 s69, 2048
    buffer_store_dwordx4 v[144:147], v20, s[28:31], s69 offen sc1
    s_waitcnt lgkmcnt(6)
    v_mfma_f32_16x16x32_bf16 v[88:91], a[172:175], a[56:59], v[88:91]
    ds_read_b64_tr_b16 a[152:153], v2 offset:20480
    v_mul_f32 v100, v33, v100
    v_mfma_f32_16x16x32_bf16 v[84:87], a[172:175], a[52:55], v[84:87]
    ds_read_b64_tr_b16 a[154:155], v2 offset:22528
    v_mul_f32 v101, v33, v101
    v_mfma_f32_16x16x32_bf16 v[80:83], a[172:175], a[48:51], v[80:83]
    ds_write_b128 v18, a[208:211] offset:36864
    s_waitcnt lgkmcnt(6)
    v_mfma_f32_16x16x32_bf16 v[64:67], a[144:147], a[64:67], v[64:67]
    s_waitcnt vmcnt(10)
    s_barrier
    ds_read_b64_tr_b16 a[156:157], v3 offset:20480
    v_mul_f32 v102, v33, v102
    v_mfma_f32_16x16x32_bf16 v[68:71], a[144:147], a[68:71], v[68:71]
    ds_read_b64_tr_b16 a[158:159], v3 offset:22528
    v_mul_f32 v103, v33, v103
    v_mfma_f32_16x16x32_bf16 v[72:75], a[144:147], a[72:75], v[72:75]
    s_mov_b32 s69, 14336
    buffer_store_dwordx4 v[132:135], v20, s[28:31], s69 offen
    s_waitcnt lgkmcnt(5)
    v_mfma_f32_16x16x32_bf16 v[88:91], a[148:151], a[72:75], v[88:91]
    ds_read_b64_tr_b16 a[160:161], v2 offset:24576
    v_cvt_pk_bf16_f32 v148, v100, v101
    v_mfma_f32_16x16x32_bf16 v[84:87], a[148:151], a[68:71], v[84:87]
    ds_read_b64_tr_b16 a[162:163], v2 offset:26624
    v_cvt_pk_bf16_f32 v149, v102, v103
    v_mfma_f32_16x16x32_bf16 v[80:83], a[148:151], a[64:67], v[80:83]
    ds_write_b128 v18, a[212:215] offset:37888
    s_waitcnt lgkmcnt(6)
    v_mfma_f32_16x16x32_bf16 v[64:67], a[152:155], a[80:83], v[64:67]
    ds_read_b64_tr_b16 a[164:165], v3 offset:24576
    v_mul_f32 v116, v33, v116
    v_mfma_f32_16x16x32_bf16 v[68:71], a[152:155], a[84:87], v[68:71]
    ds_read_b64_tr_b16 a[166:167], v3 offset:26624
    v_mul_f32 v117, v33, v117
    v_mfma_f32_16x16x32_bf16 v[72:75], a[152:155], a[88:91], v[72:75]
    ds_write_b128 v18, a[216:219] offset:38912
    s_waitcnt lgkmcnt(6)
    v_mfma_f32_16x16x32_bf16 v[88:91], a[156:159], a[88:91], v[88:91]
    ds_read_b64_tr_b16 a[168:169], v2 offset:28672
    v_mul_f32 v118, v33, v118
    v_mfma_f32_16x16x32_bf16 v[84:87], a[156:159], a[84:87], v[84:87]
    ds_read_b64_tr_b16 a[170:171], v2 offset:30720
    v_mul_f32 v119, v33, v119
    v_mfma_f32_16x16x32_bf16 v[80:83], a[156:159], a[80:83], v[80:83]
    v_cvt_pk_bf16_f32 v150, v116, v117
    v_cvt_pk_bf16_f32 v151, v118, v119
    s_waitcnt lgkmcnt(6)
    v_mfma_f32_16x16x32_bf16 v[64:67], a[160:163], a[96:99], v[64:67]
    ds_read_b64_tr_b16 a[172:173], v3 offset:28672
    v_mfma_f32_16x16x32_bf16 v[68:71], a[160:163], a[100:103], v[68:71]
    ds_read_b64_tr_b16 a[174:175], v3 offset:30720
    v_mfma_f32_16x16x32_bf16 v[72:75], a[160:163], a[104:107], v[72:75]
    s_mov_b32 s69, 16384
    buffer_store_dwordx4 v[148:151], v20, s[28:31], s69 offen
    s_waitcnt lgkmcnt(5)
    v_mfma_f32_16x16x32_bf16 v[88:91], a[164:167], a[104:107], v[88:91]
    ds_read_b64_tr_b16 a[144:145], v2 offset:32768
    v_mul_f32 v104, v34, v104
    v_mfma_f32_16x16x32_bf16 v[84:87], a[164:167], a[100:103], v[84:87]
    ds_read_b64_tr_b16 a[146:147], v2 offset:34816
    v_mul_f32 v105, v34, v105
    v_mfma_f32_16x16x32_bf16 v[80:83], a[164:167], a[96:99], v[80:83]
    ds_write_b128 v18, a[220:223] offset:39936
    s_waitcnt lgkmcnt(5)
    v_mfma_f32_16x16x32_bf16 v[64:67], a[168:171], a[112:115], v[64:67]
    ds_read_b64_tr_b16 a[148:149], v3 offset:32768
    v_mul_f32 v106, v34, v106
    v_mfma_f32_16x16x32_bf16 v[68:71], a[168:171], a[116:119], v[68:71]
    ds_read_b64_tr_b16 a[150:151], v3 offset:34816
    v_mul_f32 v107, v34, v107
    v_mfma_f32_16x16x32_bf16 v[72:75], a[168:171], a[120:123], v[72:75]
    s_mov_b32 s69, 28672
    buffer_store_dwordx4 v[136:139], v20, s[28:31], s69 offen
    s_waitcnt lgkmcnt(5)
    v_mfma_f32_16x16x32_bf16 v[88:91], a[172:175], a[120:123], v[88:91]
    ds_read_b64_tr_b16 a[152:153], v2 offset:36864
    v_cvt_pk_bf16_f32 v152, v104, v105
    v_mfma_f32_16x16x32_bf16 v[84:87], a[172:175], a[116:119], v[84:87]
    ds_read_b64_tr_b16 a[154:155], v2 offset:38912
    v_cvt_pk_bf16_f32 v153, v106, v107
    v_mfma_f32_16x16x32_bf16 v[80:83], a[172:175], a[112:115], v[80:83]
    v_mul_f32 v120, v34, v120
    v_mul_f32 v121, v34, v121
    v_mul_f32 v122, v34, v122
    v_mul_f32 v123, v34, v123
    v_cvt_pk_bf16_f32 v154, v120, v121
    v_cvt_pk_bf16_f32 v155, v122, v123
    s_mov_b32 s69, 30720
    buffer_store_dwordx4 v[152:155], v20, s[28:31], s69 offen
    s_waitcnt lgkmcnt(5)
    v_mfma_f32_16x16x32_bf16 v[96:99], a[144:147], a[0:3], 0
    s_barrier
    ds_read_b64_tr_b16 a[156:157], v3 offset:36864
    v_mfma_f32_16x16x32_bf16 v[100:103], a[144:147], a[4:7], 0
    ds_read_b64_tr_b16 a[158:159], v3 offset:38912
    v_mfma_f32_16x16x32_bf16 v[104:107], a[144:147], a[8:11], 0
    v_add_u32 v18, 65536, v18
    s_waitcnt lgkmcnt(4)
    v_mfma_f32_16x16x32_bf16 v[120:123], a[148:151], a[8:11], 0
    ds_read_b64_tr_b16 a[160:161], v2 offset:40960
    v_mul_f32 v64, v32, v64
    v_mfma_f32_16x16x32_bf16 v[116:119], a[148:151], a[4:7], 0
    ds_read_b64_tr_b16 a[162:163], v2 offset:43008
    v_mul_f32 v65, v32, v65
    v_mfma_f32_16x16x32_bf16 v[112:115], a[148:151], a[0:3], 0
    v_mul_f32 v66, v32, v66
    v_mul_f32 v67, v32, v67
    s_waitcnt lgkmcnt(4)
    v_mfma_f32_16x16x32_bf16 v[96:99], a[152:155], a[16:19], v[96:99]
    ds_read_b64_tr_b16 a[164:165], v3 offset:40960
    v_cvt_pk_bf16_f32 v160, v64, v65
    v_mfma_f32_16x16x32_bf16 v[100:103], a[152:155], a[20:23], v[100:103]
    ds_read_b64_tr_b16 a[166:167], v3 offset:43008
    v_cvt_pk_bf16_f32 v161, v66, v67
    v_mfma_f32_16x16x32_bf16 v[104:107], a[152:155], a[24:27], v[104:107]
    ds_write_b128 v18, a[224:227] offset:0
    s_waitcnt lgkmcnt(5)
    v_mfma_f32_16x16x32_bf16 v[120:123], a[156:159], a[24:27], v[120:123]
    ds_read_b64_tr_b16 a[168:169], v2 offset:45056
    v_mul_f32 v80, v32, v80
    v_mfma_f32_16x16x32_bf16 v[116:119], a[156:159], a[20:23], v[116:119]
    ds_read_b64_tr_b16 a[170:171], v2 offset:47104
    v_mul_f32 v81, v32, v81
    v_mfma_f32_16x16x32_bf16 v[112:115], a[156:159], a[16:19], v[112:115]
    ds_write_b128 v18, a[228:231] offset:1024
    s_waitcnt lgkmcnt(6)
    v_mfma_f32_16x16x32_bf16 v[96:99], a[160:163], a[32:35], v[96:99]
    ds_read_b64_tr_b16 a[172:173], v3 offset:45056
    v_mul_f32 v82, v32, v82
    v_mfma_f32_16x16x32_bf16 v[100:103], a[160:163], a[36:39], v[100:103]
    ds_read_b64_tr_b16 a[174:175], v3 offset:47104
    v_mul_f32 v83, v32, v83
    v_mfma_f32_16x16x32_bf16 v[104:107], a[160:163], a[40:43], v[104:107]
    v_cvt_pk_bf16_f32 v162, v80, v81
    v_cvt_pk_bf16_f32 v163, v82, v83
    s_waitcnt lgkmcnt(6)
    v_mfma_f32_16x16x32_bf16 v[120:123], a[164:167], a[40:43], v[120:123]
    ds_read_b64_tr_b16 a[144:145], v2 offset:49152
    v_mfma_f32_16x16x32_bf16 v[116:119], a[164:167], a[36:39], v[116:119]
    ds_read_b64_tr_b16 a[146:147], v2 offset:51200
    v_mfma_f32_16x16x32_bf16 v[112:115], a[164:167], a[32:35], v[112:115]
    ds_write_b128 v18, a[232:235] offset:2048
    s_waitcnt lgkmcnt(6)
    v_mfma_f32_16x16x32_bf16 v[96:99], a[168:171], a[48:51], v[96:99]
    ds_read_b64_tr_b16 a[148:149], v3 offset:49152
    v_mfma_f32_16x16x32_bf16 v[100:103], a[168:171], a[52:55], v[100:103]
    ds_read_b64_tr_b16 a[150:151], v3 offset:51200
    v_mfma_f32_16x16x32_bf16 v[104:107], a[168:171], a[56:59], v[104:107]
    s_mov_b32 s69, 4096
    buffer_store_dwordx4 v[160:163], v20, s[28:31], s69 offen sc1
    s_waitcnt lgkmcnt(5)
    v_mfma_f32_16x16x32_bf16 v[120:123], a[172:175], a[56:59], v[120:123]
    ds_read_b64_tr_b16 a[152:153], v2 offset:53248
    v_mul_f32 v68, v33, v68
    v_mfma_f32_16x16x32_bf16 v[116:119], a[172:175], a[52:55], v[116:119]
    ds_read_b64_tr_b16 a[154:155], v2 offset:55296
    v_mul_f32 v69, v33, v69
    v_mfma_f32_16x16x32_bf16 v[112:115], a[172:175], a[48:51], v[112:115]
    ds_write_b128 v18, a[236:239] offset:3072
    s_waitcnt lgkmcnt(6)
    v_mfma_f32_16x16x32_bf16 v[96:99], a[144:147], a[64:67], v[96:99]
    s_waitcnt vmcnt(7)
    s_barrier
    ds_read_b64_tr_b16 a[156:157], v3 offset:53248
    v_mul_f32 v70, v33, v70
    v_mfma_f32_16x16x32_bf16 v[100:103], a[144:147], a[68:71], v[100:103]
    ds_read_b64_tr_b16 a[158:159], v3 offset:55296
    v_mul_f32 v71, v33, v71
    v_mfma_f32_16x16x32_bf16 v[104:107], a[144:147], a[72:75], v[104:107]
    ds_write_b128 v18, a[240:243] offset:4096
    s_waitcnt lgkmcnt(6)
    v_mfma_f32_16x16x32_bf16 v[120:123], a[148:151], a[72:75], v[120:123]
    ds_read_b64_tr_b16 a[160:161], v2 offset:57344
    v_cvt_pk_bf16_f32 v164, v68, v69
    v_mfma_f32_16x16x32_bf16 v[116:119], a[148:151], a[68:71], v[116:119]
    ds_read_b64_tr_b16 a[162:163], v2 offset:59392
    v_cvt_pk_bf16_f32 v165, v70, v71
    v_mfma_f32_16x16x32_bf16 v[112:115], a[148:151], a[64:67], v[112:115]
    ds_write_b128 v18, a[244:247] offset:5120
    s_waitcnt lgkmcnt(7)
    v_mfma_f32_16x16x32_bf16 v[96:99], a[152:155], a[80:83], v[96:99]
    ds_read_b64_tr_b16 a[164:165], v3 offset:57344
    v_mul_f32 v84, v33, v84
    v_mfma_f32_16x16x32_bf16 v[100:103], a[152:155], a[84:87], v[100:103]
    ds_read_b64_tr_b16 a[166:167], v3 offset:59392
    v_mul_f32 v85, v33, v85
    v_mfma_f32_16x16x32_bf16 v[104:107], a[152:155], a[88:91], v[104:107]
    ds_write_b128 v18, a[248:251] offset:6144
    s_waitcnt lgkmcnt(7)
    v_mfma_f32_16x16x32_bf16 v[120:123], a[156:159], a[88:91], v[120:123]
    ds_read_b64_tr_b16 a[168:169], v2 offset:61440
    v_mul_f32 v86, v33, v86
    v_mfma_f32_16x16x32_bf16 v[116:119], a[156:159], a[84:87], v[116:119]
    ds_read_b64_tr_b16 a[170:171], v2 offset:63488
    v_mul_f32 v87, v33, v87
    v_mfma_f32_16x16x32_bf16 v[112:115], a[156:159], a[80:83], v[112:115]
    v_cvt_pk_bf16_f32 v166, v84, v85
    v_cvt_pk_bf16_f32 v167, v86, v87
    s_waitcnt lgkmcnt(6)
    v_mfma_f32_16x16x32_bf16 v[96:99], a[160:163], a[96:99], v[96:99]
    ds_read_b64_tr_b16 a[172:173], v3 offset:61440
    v_mfma_f32_16x16x32_bf16 v[100:103], a[160:163], a[100:103], v[100:103]
    ds_read_b64_tr_b16 a[174:175], v3 offset:63488
    v_mfma_f32_16x16x32_bf16 v[104:107], a[160:163], a[104:107], v[104:107]
    s_mov_b32 s69, 18432
    buffer_store_dwordx4 v[164:167], v20, s[28:31], s69 offen
    s_waitcnt lgkmcnt(5)
    v_mfma_f32_16x16x32_bf16 v[120:123], a[164:167], a[104:107], v[120:123]
    ds_read_b64_tr_b16 a[144:145], v0 offset:0
    v_mul_f32 v72, v34, v72
    v_mfma_f32_16x16x32_bf16 v[116:119], a[164:167], a[100:103], v[116:119]
    ds_read_b64_tr_b16 a[146:147], v0 offset:2048
    v_mul_f32 v73, v34, v73
    v_mfma_f32_16x16x32_bf16 v[112:115], a[164:167], a[96:99], v[112:115]
    ds_write_b128 v18, a[252:255] offset:7168
    s_waitcnt lgkmcnt(5)
    v_mfma_f32_16x16x32_bf16 v[96:99], a[168:171], a[112:115], v[96:99]
    ds_read_b64_tr_b16 a[148:149], v1 offset:0
    v_mul_f32 v74, v34, v74
    v_mfma_f32_16x16x32_bf16 v[100:103], a[168:171], a[116:119], v[100:103]
    ds_read_b64_tr_b16 a[150:151], v1 offset:2048
    v_mul_f32 v75, v34, v75
    v_mfma_f32_16x16x32_bf16 v[104:107], a[168:171], a[120:123], v[104:107]
    v_cvt_pk_bf16_f32 v168, v72, v73
    v_cvt_pk_bf16_f32 v169, v74, v75
    s_waitcnt lgkmcnt(5)
    v_mfma_f32_16x16x32_bf16 v[120:123], a[172:175], a[120:123], v[120:123]
    ds_read_b64_tr_b16 a[152:153], v0 offset:4096
    v_mul_f32 v88, v34, v88
    v_mfma_f32_16x16x32_bf16 v[116:119], a[172:175], a[116:119], v[116:119]
    ds_read_b64_tr_b16 a[154:155], v0 offset:6144
    v_mul_f32 v89, v34, v89
    v_mfma_f32_16x16x32_bf16 v[112:115], a[172:175], a[112:115], v[112:115]
    v_mul_f32 v90, v34, v90
    v_mul_f32 v91, v34, v91
    v_cvt_pk_bf16_f32 v170, v88, v89
    v_cvt_pk_bf16_f32 v171, v90, v91
    s_mov_b32 s69, 32768
    buffer_store_dwordx4 v[168:171], v20, s[28:31], s69 offen
    s_waitcnt lgkmcnt(5)
    v_mfma_f32_16x16x32_bf16 v[64:67], a[144:147], a[0:3], 0
    ds_read_b64_tr_b16 a[156:157], v1 offset:4096
    v_mfma_f32_16x16x32_bf16 v[68:71], a[144:147], a[4:7], 0
    ds_read_b64_tr_b16 a[158:159], v1 offset:6144
    v_mfma_f32_16x16x32_bf16 v[72:75], a[144:147], a[8:11], 0
    s_waitcnt lgkmcnt(4)
    v_mfma_f32_16x16x32_bf16 v[88:91], a[148:151], a[8:11], 0
    ds_read_b64_tr_b16 a[160:161], v0 offset:8192
    v_mul_f32 v96, v32, v96
    v_mfma_f32_16x16x32_bf16 v[84:87], a[148:151], a[4:7], 0
    ds_read_b64_tr_b16 a[162:163], v0 offset:10240
    v_mul_f32 v97, v32, v97
    v_mfma_f32_16x16x32_bf16 v[80:83], a[148:151], a[0:3], 0
    v_mul_f32 v98, v32, v98
    v_mul_f32 v99, v32, v99
    s_waitcnt lgkmcnt(4)
    v_mfma_f32_16x16x32_bf16 v[64:67], a[152:155], a[16:19], v[64:67]
    ds_read_b64_tr_b16 a[164:165], v1 offset:8192
    v_cvt_pk_bf16_f32 v176, v96, v97
    v_mfma_f32_16x16x32_bf16 v[68:71], a[152:155], a[20:23], v[68:71]
    ds_read_b64_tr_b16 a[166:167], v1 offset:10240
    v_cvt_pk_bf16_f32 v177, v98, v99
    v_mfma_f32_16x16x32_bf16 v[72:75], a[152:155], a[24:27], v[72:75]
    v_mul_f32 v112, v32, v112
    v_mul_f32 v113, v32, v113
    s_waitcnt lgkmcnt(4)
    v_mfma_f32_16x16x32_bf16 v[88:91], a[156:159], a[24:27], v[88:91]
    ds_read_b64_tr_b16 a[168:169], v0 offset:12288
    v_mfma_f32_16x16x32_bf16 v[84:87], a[156:159], a[20:23], v[84:87]
    ds_read_b64_tr_b16 a[170:171], v0 offset:14336
    v_mul_f32 v114, v32, v114
    v_mfma_f32_16x16x32_bf16 v[80:83], a[156:159], a[16:19], v[80:83]
    v_mul_f32 v115, v32, v115
    s_waitcnt lgkmcnt(4)
    v_mfma_f32_16x16x32_bf16 v[64:67], a[160:163], a[32:35], v[64:67]
    ds_read_b64_tr_b16 a[172:173], v1 offset:12288
    v_cvt_pk_bf16_f32 v178, v112, v113
    v_mfma_f32_16x16x32_bf16 v[68:71], a[160:163], a[36:39], v[68:71]
    ds_read_b64_tr_b16 a[174:175], v1 offset:14336
    v_cvt_pk_bf16_f32 v179, v114, v115
    v_mfma_f32_16x16x32_bf16 v[72:75], a[160:163], a[40:43], v[72:75]
    s_mov_b32 s69, 6144
    buffer_store_dwordx4 v[176:179], v20, s[28:31], s69 offen sc1
    s_waitcnt lgkmcnt(4)
    v_mfma_f32_16x16x32_bf16 v[88:91], a[164:167], a[40:43], v[88:91]
    ds_read_b64_tr_b16 a[144:145], v0 offset:16384
    v_mul_f32 v100, v33, v100
    v_mfma_f32_16x16x32_bf16 v[84:87], a[164:167], a[36:39], v[84:87]
    ds_read_b64_tr_b16 a[146:147], v0 offset:18432
    v_mul_f32 v101, v33, v101
    v_mfma_f32_16x16x32_bf16 v[80:83], a[164:167], a[32:35], v[80:83]
    v_mul_f32 v102, v33, v102
    s_waitcnt lgkmcnt(4)
    v_mfma_f32_16x16x32_bf16 v[64:67], a[168:171], a[48:51], v[64:67]
    ds_read_b64_tr_b16 a[148:149], v1 offset:16384
    v_mfma_f32_16x16x32_bf16 v[68:71], a[168:171], a[52:55], v[68:71]
    ds_read_b64_tr_b16 a[150:151], v1 offset:18432
    v_mul_f32 v103, v33, v103
    v_mfma_f32_16x16x32_bf16 v[72:75], a[168:171], a[56:59], v[72:75]
    v_cvt_pk_bf16_f32 v180, v100, v101
    s_waitcnt lgkmcnt(4)
    v_mfma_f32_16x16x32_bf16 v[88:91], a[172:175], a[56:59], v[88:91]
    ds_read_b64_tr_b16 a[152:153], v0 offset:20480
    v_cvt_pk_bf16_f32 v181, v102, v103
    v_mfma_f32_16x16x32_bf16 v[84:87], a[172:175], a[52:55], v[84:87]
    ds_read_b64_tr_b16 a[154:155], v0 offset:22528
    v_mul_f32 v116, v33, v116
    v_mfma_f32_16x16x32_bf16 v[80:83], a[172:175], a[48:51], v[80:83]
    v_mul_f32 v117, v33, v117
    s_waitcnt lgkmcnt(4)
    v_mfma_f32_16x16x32_bf16 v[64:67], a[144:147], a[64:67], v[64:67]
    s_barrier
    ds_read_b64_tr_b16 a[156:157], v1 offset:20480
    v_mul_f32 v118, v33, v118
    v_mfma_f32_16x16x32_bf16 v[68:71], a[144:147], a[68:71], v[68:71]
    ds_read_b64_tr_b16 a[158:159], v1 offset:22528
    v_mul_f32 v119, v33, v119
    v_mfma_f32_16x16x32_bf16 v[72:75], a[144:147], a[72:75], v[72:75]
    s_waitcnt lgkmcnt(4)
    v_mfma_f32_16x16x32_bf16 v[88:91], a[148:151], a[72:75], v[88:91]
    ds_read_b64_tr_b16 a[160:161], v0 offset:24576
    v_cvt_pk_bf16_f32 v182, v116, v117
    v_mfma_f32_16x16x32_bf16 v[84:87], a[148:151], a[68:71], v[84:87]
    ds_read_b64_tr_b16 a[162:163], v0 offset:26624
    v_cvt_pk_bf16_f32 v183, v118, v119
    v_mfma_f32_16x16x32_bf16 v[80:83], a[148:151], a[64:67], v[80:83]
    s_mov_b32 s69, 20480
    buffer_store_dwordx4 v[180:183], v20, s[28:31], s69 offen
    s_waitcnt lgkmcnt(4)
    v_mfma_f32_16x16x32_bf16 v[64:67], a[152:155], a[80:83], v[64:67]
    ds_read_b64_tr_b16 a[164:165], v1 offset:24576
    v_mul_f32 v104, v34, v104
    v_mfma_f32_16x16x32_bf16 v[68:71], a[152:155], a[84:87], v[68:71]
    ds_read_b64_tr_b16 a[166:167], v1 offset:26624
    v_mul_f32 v105, v34, v105
    v_mfma_f32_16x16x32_bf16 v[72:75], a[152:155], a[88:91], v[72:75]
    v_mul_f32 v106, v34, v106
    s_waitcnt lgkmcnt(4)
    v_mfma_f32_16x16x32_bf16 v[88:91], a[156:159], a[88:91], v[88:91]
    ds_read_b64_tr_b16 a[168:169], v0 offset:28672
    v_mul_f32 v107, v34, v107
    v_mfma_f32_16x16x32_bf16 v[84:87], a[156:159], a[84:87], v[84:87]
    ds_read_b64_tr_b16 a[170:171], v0 offset:30720
    v_cvt_pk_bf16_f32 v184, v104, v105
    v_mfma_f32_16x16x32_bf16 v[80:83], a[156:159], a[80:83], v[80:83]
    s_waitcnt lgkmcnt(4)
    v_mfma_f32_16x16x32_bf16 v[64:67], a[160:163], a[96:99], v[64:67]
    ds_read_b64_tr_b16 a[172:173], v1 offset:28672
    v_cvt_pk_bf16_f32 v185, v106, v107
    v_mfma_f32_16x16x32_bf16 v[68:71], a[160:163], a[100:103], v[68:71]
    ds_read_b64_tr_b16 a[174:175], v1 offset:30720
    v_mul_f32 v120, v34, v120
    v_mfma_f32_16x16x32_bf16 v[72:75], a[160:163], a[104:107], v[72:75]
    v_mul_f32 v121, v34, v121
    s_waitcnt lgkmcnt(4)
    v_mfma_f32_16x16x32_bf16 v[88:91], a[164:167], a[104:107], v[88:91]
    ds_read_b64_tr_b16 a[144:145], v0 offset:32768
    v_mul_f32 v122, v34, v122
    v_mfma_f32_16x16x32_bf16 v[84:87], a[164:167], a[100:103], v[84:87]
    ds_read_b64_tr_b16 a[146:147], v0 offset:34816
    v_mul_f32 v123, v34, v123
    v_mfma_f32_16x16x32_bf16 v[80:83], a[164:167], a[96:99], v[80:83]
    v_cvt_pk_bf16_f32 v186, v120, v121
    s_waitcnt lgkmcnt(4)
    v_mfma_f32_16x16x32_bf16 v[64:67], a[168:171], a[112:115], v[64:67]
    ds_read_b64_tr_b16 a[148:149], v1 offset:32768
    v_cvt_pk_bf16_f32 v187, v122, v123
    v_mfma_f32_16x16x32_bf16 v[68:71], a[168:171], a[116:119], v[68:71]
    ds_read_b64_tr_b16 a[150:151], v1 offset:34816
    v_mfma_f32_16x16x32_bf16 v[72:75], a[168:171], a[120:123], v[72:75]
    s_mov_b32 s69, 34816
    buffer_store_dwordx4 v[184:187], v20, s[28:31], s69 offen
    s_waitcnt lgkmcnt(4)
    v_mfma_f32_16x16x32_bf16 v[88:91], a[172:175], a[120:123], v[88:91]
    ds_read_b64_tr_b16 a[152:153], v0 offset:36864
    v_mfma_f32_16x16x32_bf16 v[84:87], a[172:175], a[116:119], v[84:87]
    ds_read_b64_tr_b16 a[154:155], v0 offset:38912
    v_mfma_f32_16x16x32_bf16 v[80:83], a[172:175], a[112:115], v[80:83]
    s_waitcnt lgkmcnt(4)
    v_mfma_f32_16x16x32_bf16 v[96:99], a[144:147], a[0:3], 0
    ds_read_b64_tr_b16 a[156:157], v1 offset:36864
    v_mfma_f32_16x16x32_bf16 v[100:103], a[144:147], a[4:7], 0
    ds_read_b64_tr_b16 a[158:159], v1 offset:38912
    v_mfma_f32_16x16x32_bf16 v[104:107], a[144:147], a[8:11], 0
    s_waitcnt lgkmcnt(4)
    v_mfma_f32_16x16x32_bf16 v[120:123], a[148:151], a[8:11], 0
    ds_read_b64_tr_b16 a[160:161], v0 offset:40960
    v_mul_f32 v64, v32, v64
    v_mfma_f32_16x16x32_bf16 v[116:119], a[148:151], a[4:7], 0
    ds_read_b64_tr_b16 a[162:163], v0 offset:43008
    v_mul_f32 v65, v32, v65
    v_mfma_f32_16x16x32_bf16 v[112:115], a[148:151], a[0:3], 0
    v_mul_f32 v66, v32, v66
    v_mul_f32 v67, v32, v67
    s_waitcnt lgkmcnt(4)
    v_mfma_f32_16x16x32_bf16 v[96:99], a[152:155], a[16:19], v[96:99]
    ds_read_b64_tr_b16 a[164:165], v1 offset:40960
    v_cvt_pk_bf16_f32 v192, v64, v65
    v_mfma_f32_16x16x32_bf16 v[100:103], a[152:155], a[20:23], v[100:103]
    ds_read_b64_tr_b16 a[166:167], v1 offset:43008
    v_cvt_pk_bf16_f32 v193, v66, v67
    v_mfma_f32_16x16x32_bf16 v[104:107], a[152:155], a[24:27], v[104:107]
    v_mul_f32 v80, v32, v80
    v_mul_f32 v81, v32, v81
    s_waitcnt lgkmcnt(4)
    v_mfma_f32_16x16x32_bf16 v[120:123], a[156:159], a[24:27], v[120:123]
    ds_read_b64_tr_b16 a[168:169], v0 offset:45056
    v_mfma_f32_16x16x32_bf16 v[116:119], a[156:159], a[20:23], v[116:119]
    ds_read_b64_tr_b16 a[170:171], v0 offset:47104
    v_mul_f32 v82, v32, v82
    v_mfma_f32_16x16x32_bf16 v[112:115], a[156:159], a[16:19], v[112:115]
    v_mul_f32 v83, v32, v83
    s_waitcnt lgkmcnt(4)
    v_mfma_f32_16x16x32_bf16 v[96:99], a[160:163], a[32:35], v[96:99]
    ds_read_b64_tr_b16 a[172:173], v1 offset:45056
    v_cvt_pk_bf16_f32 v194, v80, v81
    v_mfma_f32_16x16x32_bf16 v[100:103], a[160:163], a[36:39], v[100:103]
    ds_read_b64_tr_b16 a[174:175], v1 offset:47104
    v_cvt_pk_bf16_f32 v195, v82, v83
    v_mfma_f32_16x16x32_bf16 v[104:107], a[160:163], a[40:43], v[104:107]
    s_mov_b32 s69, 8192
    buffer_store_dwordx4 v[192:195], v20, s[28:31], s69 offen sc1
    s_waitcnt lgkmcnt(4)
    v_mfma_f32_16x16x32_bf16 v[120:123], a[164:167], a[40:43], v[120:123]
    ds_read_b64_tr_b16 a[144:145], v0 offset:49152
    v_mul_f32 v68, v33, v68
    v_mfma_f32_16x16x32_bf16 v[116:119], a[164:167], a[36:39], v[116:119]
    ds_read_b64_tr_b16 a[146:147], v0 offset:51200
    v_mul_f32 v69, v33, v69
    v_mfma_f32_16x16x32_bf16 v[112:115], a[164:167], a[32:35], v[112:115]
    v_mul_f32 v70, v33, v70
    s_waitcnt lgkmcnt(4)
    v_mfma_f32_16x16x32_bf16 v[96:99], a[168:171], a[48:51], v[96:99]
    ds_read_b64_tr_b16 a[148:149], v1 offset:49152
    v_mfma_f32_16x16x32_bf16 v[100:103], a[168:171], a[52:55], v[100:103]
    ds_read_b64_tr_b16 a[150:151], v1 offset:51200
    v_mul_f32 v71, v33, v71
    v_mfma_f32_16x16x32_bf16 v[104:107], a[168:171], a[56:59], v[104:107]
    v_cvt_pk_bf16_f32 v196, v68, v69
    s_waitcnt lgkmcnt(4)
    v_mfma_f32_16x16x32_bf16 v[120:123], a[172:175], a[56:59], v[120:123]
    ds_read_b64_tr_b16 a[152:153], v0 offset:53248
    v_cvt_pk_bf16_f32 v197, v70, v71
    v_mfma_f32_16x16x32_bf16 v[116:119], a[172:175], a[52:55], v[116:119]
    ds_read_b64_tr_b16 a[154:155], v0 offset:55296
    v_mul_f32 v84, v33, v84
    v_mfma_f32_16x16x32_bf16 v[112:115], a[172:175], a[48:51], v[112:115]
    v_mul_f32 v85, v33, v85
    s_waitcnt lgkmcnt(4)
    v_mfma_f32_16x16x32_bf16 v[96:99], a[144:147], a[64:67], v[96:99]
    s_barrier
    ds_read_b64_tr_b16 a[156:157], v1 offset:53248
    v_mul_f32 v86, v33, v86
    v_mfma_f32_16x16x32_bf16 v[100:103], a[144:147], a[68:71], v[100:103]
    ds_read_b64_tr_b16 a[158:159], v1 offset:55296
    v_mul_f32 v87, v33, v87
    v_mfma_f32_16x16x32_bf16 v[104:107], a[144:147], a[72:75], v[104:107]
    s_waitcnt lgkmcnt(4)
    v_mfma_f32_16x16x32_bf16 v[120:123], a[148:151], a[72:75], v[120:123]
    ds_read_b64_tr_b16 a[160:161], v0 offset:57344
    v_cvt_pk_bf16_f32 v198, v84, v85
    v_mfma_f32_16x16x32_bf16 v[116:119], a[148:151], a[68:71], v[116:119]
    ds_read_b64_tr_b16 a[162:163], v0 offset:59392
    v_cvt_pk_bf16_f32 v199, v86, v87
    v_mfma_f32_16x16x32_bf16 v[112:115], a[148:151], a[64:67], v[112:115]
    s_mov_b32 s69, 22528
    buffer_store_dwordx4 v[196:199], v20, s[28:31], s69 offen
    s_waitcnt lgkmcnt(4)
    v_mfma_f32_16x16x32_bf16 v[96:99], a[152:155], a[80:83], v[96:99]
    ds_read_b64_tr_b16 a[164:165], v1 offset:57344
    v_mul_f32 v72, v34, v72
    v_mfma_f32_16x16x32_bf16 v[100:103], a[152:155], a[84:87], v[100:103]
    ds_read_b64_tr_b16 a[166:167], v1 offset:59392
    v_mul_f32 v73, v34, v73
    v_mfma_f32_16x16x32_bf16 v[104:107], a[152:155], a[88:91], v[104:107]
    v_mul_f32 v74, v34, v74
    s_waitcnt lgkmcnt(4)
    v_mfma_f32_16x16x32_bf16 v[120:123], a[156:159], a[88:91], v[120:123]
    ds_read_b64_tr_b16 a[168:169], v0 offset:61440
    v_mul_f32 v75, v34, v75
    v_mfma_f32_16x16x32_bf16 v[116:119], a[156:159], a[84:87], v[116:119]
    ds_read_b64_tr_b16 a[170:171], v0 offset:63488
    v_cvt_pk_bf16_f32 v200, v72, v73
    v_mfma_f32_16x16x32_bf16 v[112:115], a[156:159], a[80:83], v[112:115]
    s_waitcnt lgkmcnt(4)
    v_mfma_f32_16x16x32_bf16 v[96:99], a[160:163], a[96:99], v[96:99]
    ds_read_b64_tr_b16 a[172:173], v1 offset:61440
    v_cvt_pk_bf16_f32 v201, v74, v75
    v_mfma_f32_16x16x32_bf16 v[100:103], a[160:163], a[100:103], v[100:103]
    ds_read_b64_tr_b16 a[174:175], v1 offset:63488
    v_mul_f32 v88, v34, v88
    v_mfma_f32_16x16x32_bf16 v[104:107], a[160:163], a[104:107], v[104:107]
    v_mul_f32 v89, v34, v89
    s_waitcnt lgkmcnt(4)
    v_mfma_f32_16x16x32_bf16 v[120:123], a[164:167], a[104:107], v[120:123]
    ds_read_b64_tr_b16 a[144:145], v2 offset:0
    v_mul_f32 v90, v34, v90
    v_mfma_f32_16x16x32_bf16 v[116:119], a[164:167], a[100:103], v[116:119]
    ds_read_b64_tr_b16 a[146:147], v2 offset:2048
    v_mul_f32 v91, v34, v91
    v_mfma_f32_16x16x32_bf16 v[112:115], a[164:167], a[96:99], v[112:115]
    v_cvt_pk_bf16_f32 v202, v88, v89
    s_waitcnt lgkmcnt(4)
    v_mfma_f32_16x16x32_bf16 v[96:99], a[168:171], a[112:115], v[96:99]
    ds_read_b64_tr_b16 a[148:149], v3 offset:0
    v_cvt_pk_bf16_f32 v203, v90, v91
    v_mfma_f32_16x16x32_bf16 v[100:103], a[168:171], a[116:119], v[100:103]
    ds_read_b64_tr_b16 a[150:151], v3 offset:2048
    v_mfma_f32_16x16x32_bf16 v[104:107], a[168:171], a[120:123], v[104:107]
    s_mov_b32 s69, 36864
    buffer_store_dwordx4 v[200:203], v20, s[28:31], s69 offen
    s_waitcnt lgkmcnt(4)
    v_mfma_f32_16x16x32_bf16 v[120:123], a[172:175], a[120:123], v[120:123]
    ds_read_b64_tr_b16 a[152:153], v2 offset:4096
    v_mfma_f32_16x16x32_bf16 v[116:119], a[172:175], a[116:119], v[116:119]
    ds_read_b64_tr_b16 a[154:155], v2 offset:6144
    v_mfma_f32_16x16x32_bf16 v[112:115], a[172:175], a[112:115], v[112:115]
    s_waitcnt lgkmcnt(4)
    v_mfma_f32_16x16x32_bf16 v[64:67], a[144:147], a[0:3], 0
    ds_read_b64_tr_b16 a[156:157], v3 offset:4096
    v_mfma_f32_16x16x32_bf16 v[68:71], a[144:147], a[4:7], 0
    ds_read_b64_tr_b16 a[158:159], v3 offset:6144
    v_mfma_f32_16x16x32_bf16 v[72:75], a[144:147], a[8:11], 0
    s_waitcnt lgkmcnt(4)
    v_mfma_f32_16x16x32_bf16 v[88:91], a[148:151], a[8:11], 0
    ds_read_b64_tr_b16 a[160:161], v2 offset:8192
    v_mul_f32 v96, v32, v96
    v_mfma_f32_16x16x32_bf16 v[84:87], a[148:151], a[4:7], 0
    ds_read_b64_tr_b16 a[162:163], v2 offset:10240
    v_mul_f32 v97, v32, v97
    v_mfma_f32_16x16x32_bf16 v[80:83], a[148:151], a[0:3], 0
    v_mul_f32 v98, v32, v98
    v_mul_f32 v99, v32, v99
    s_waitcnt lgkmcnt(4)
    v_mfma_f32_16x16x32_bf16 v[64:67], a[152:155], a[16:19], v[64:67]
    ds_read_b64_tr_b16 a[164:165], v3 offset:8192
    v_cvt_pk_bf16_f32 v208, v96, v97
    v_mfma_f32_16x16x32_bf16 v[68:71], a[152:155], a[20:23], v[68:71]
    ds_read_b64_tr_b16 a[166:167], v3 offset:10240
    v_cvt_pk_bf16_f32 v209, v98, v99
    v_mfma_f32_16x16x32_bf16 v[72:75], a[152:155], a[24:27], v[72:75]
    v_mul_f32 v112, v32, v112
    v_mul_f32 v113, v32, v113
    s_waitcnt lgkmcnt(4)
    v_mfma_f32_16x16x32_bf16 v[88:91], a[156:159], a[24:27], v[88:91]
    ds_read_b64_tr_b16 a[168:169], v2 offset:12288
    v_mfma_f32_16x16x32_bf16 v[84:87], a[156:159], a[20:23], v[84:87]
    ds_read_b64_tr_b16 a[170:171], v2 offset:14336
    v_mul_f32 v114, v32, v114
    v_mfma_f32_16x16x32_bf16 v[80:83], a[156:159], a[16:19], v[80:83]
    v_mul_f32 v115, v32, v115
    s_waitcnt lgkmcnt(4)
    v_mfma_f32_16x16x32_bf16 v[64:67], a[160:163], a[32:35], v[64:67]
    ds_read_b64_tr_b16 a[172:173], v3 offset:12288
    v_cvt_pk_bf16_f32 v210, v112, v113
    v_mfma_f32_16x16x32_bf16 v[68:71], a[160:163], a[36:39], v[68:71]
    ds_read_b64_tr_b16 a[174:175], v3 offset:14336
    v_cvt_pk_bf16_f32 v211, v114, v115
    v_mfma_f32_16x16x32_bf16 v[72:75], a[160:163], a[40:43], v[72:75]
    s_mov_b32 s69, 10240
    buffer_store_dwordx4 v[208:211], v20, s[28:31], s69 offen sc1
    s_waitcnt lgkmcnt(4)
    v_mfma_f32_16x16x32_bf16 v[88:91], a[164:167], a[40:43], v[88:91]
    ds_read_b64_tr_b16 a[144:145], v2 offset:16384
    v_mul_f32 v100, v33, v100
    v_mfma_f32_16x16x32_bf16 v[84:87], a[164:167], a[36:39], v[84:87]
    ds_read_b64_tr_b16 a[146:147], v2 offset:18432
    v_mul_f32 v101, v33, v101
    v_mfma_f32_16x16x32_bf16 v[80:83], a[164:167], a[32:35], v[80:83]
    v_mul_f32 v102, v33, v102
    s_waitcnt lgkmcnt(4)
    v_mfma_f32_16x16x32_bf16 v[64:67], a[168:171], a[48:51], v[64:67]
    ds_read_b64_tr_b16 a[148:149], v3 offset:16384
    v_mfma_f32_16x16x32_bf16 v[68:71], a[168:171], a[52:55], v[68:71]
    ds_read_b64_tr_b16 a[150:151], v3 offset:18432
    v_mul_f32 v103, v33, v103
    v_mfma_f32_16x16x32_bf16 v[72:75], a[168:171], a[56:59], v[72:75]
    v_cvt_pk_bf16_f32 v212, v100, v101
    s_waitcnt lgkmcnt(4)
    v_mfma_f32_16x16x32_bf16 v[88:91], a[172:175], a[56:59], v[88:91]
    ds_read_b64_tr_b16 a[152:153], v2 offset:20480
    v_cvt_pk_bf16_f32 v213, v102, v103
    v_mfma_f32_16x16x32_bf16 v[84:87], a[172:175], a[52:55], v[84:87]
    ds_read_b64_tr_b16 a[154:155], v2 offset:22528
    v_mul_f32 v116, v33, v116
    v_mfma_f32_16x16x32_bf16 v[80:83], a[172:175], a[48:51], v[80:83]
    v_mul_f32 v117, v33, v117
    s_waitcnt lgkmcnt(4)
    v_mfma_f32_16x16x32_bf16 v[64:67], a[144:147], a[64:67], v[64:67]
    ds_read_b64_tr_b16 a[156:157], v3 offset:20480
    v_mul_f32 v118, v33, v118
    v_mfma_f32_16x16x32_bf16 v[68:71], a[144:147], a[68:71], v[68:71]
    ds_read_b64_tr_b16 a[158:159], v3 offset:22528
    v_mul_f32 v119, v33, v119
    v_mfma_f32_16x16x32_bf16 v[72:75], a[144:147], a[72:75], v[72:75]
    s_waitcnt lgkmcnt(4)
    v_mfma_f32_16x16x32_bf16 v[88:91], a[148:151], a[72:75], v[88:91]
    ds_read_b64_tr_b16 a[160:161], v2 offset:24576
    v_cvt_pk_bf16_f32 v214, v116, v117
    v_mfma_f32_16x16x32_bf16 v[84:87], a[148:151], a[68:71], v[84:87]
    ds_read_b64_tr_b16 a[162:163], v2 offset:26624
    v_cvt_pk_bf16_f32 v215, v118, v119
    v_mfma_f32_16x16x32_bf16 v[80:83], a[148:151], a[64:67], v[80:83]
    s_mov_b32 s69, 24576
    buffer_store_dwordx4 v[212:215], v20, s[28:31], s69 offen
    s_waitcnt lgkmcnt(4)
    v_mfma_f32_16x16x32_bf16 v[64:67], a[152:155], a[80:83], v[64:67]
    ds_read_b64_tr_b16 a[164:165], v3 offset:24576
    v_mul_f32 v104, v34, v104
    v_mfma_f32_16x16x32_bf16 v[68:71], a[152:155], a[84:87], v[68:71]
    ds_read_b64_tr_b16 a[166:167], v3 offset:26624
    v_mul_f32 v105, v34, v105
    v_mfma_f32_16x16x32_bf16 v[72:75], a[152:155], a[88:91], v[72:75]
    v_mul_f32 v106, v34, v106
    s_waitcnt lgkmcnt(4)
    v_mfma_f32_16x16x32_bf16 v[88:91], a[156:159], a[88:91], v[88:91]
    ds_read_b64_tr_b16 a[168:169], v2 offset:28672
    v_mul_f32 v107, v34, v107
    v_mfma_f32_16x16x32_bf16 v[84:87], a[156:159], a[84:87], v[84:87]
    ds_read_b64_tr_b16 a[170:171], v2 offset:30720
    v_cvt_pk_bf16_f32 v216, v104, v105
    v_mfma_f32_16x16x32_bf16 v[80:83], a[156:159], a[80:83], v[80:83]
    s_waitcnt lgkmcnt(4)
    v_mfma_f32_16x16x32_bf16 v[64:67], a[160:163], a[96:99], v[64:67]
    ds_read_b64_tr_b16 a[172:173], v3 offset:28672
    v_cvt_pk_bf16_f32 v217, v106, v107
    v_mfma_f32_16x16x32_bf16 v[68:71], a[160:163], a[100:103], v[68:71]
    ds_read_b64_tr_b16 a[174:175], v3 offset:30720
    v_mul_f32 v120, v34, v120
    v_mfma_f32_16x16x32_bf16 v[72:75], a[160:163], a[104:107], v[72:75]
    v_mul_f32 v121, v34, v121
    s_waitcnt lgkmcnt(4)
    v_mfma_f32_16x16x32_bf16 v[88:91], a[164:167], a[104:107], v[88:91]
    v_mul_f32 v122, v34, v122
    v_mfma_f32_16x16x32_bf16 v[84:87], a[164:167], a[100:103], v[84:87]
    v_mul_f32 v123, v34, v123
    v_mfma_f32_16x16x32_bf16 v[80:83], a[164:167], a[96:99], v[80:83]
    v_cvt_pk_bf16_f32 v218, v120, v121
    s_waitcnt lgkmcnt(2)
    v_mfma_f32_16x16x32_bf16 v[64:67], a[168:171], a[112:115], v[64:67]
    v_cvt_pk_bf16_f32 v219, v122, v123
    v_mfma_f32_16x16x32_bf16 v[68:71], a[168:171], a[116:119], v[68:71]
    s_mov_b32 s69, 38912
    buffer_store_dwordx4 v[216:219], v20, s[28:31], s69 offen
    v_mfma_f32_16x16x32_bf16 v[72:75], a[168:171], a[120:123], v[72:75]
    s_waitcnt lgkmcnt(0)
    v_mfma_f32_16x16x32_bf16 v[88:91], a[172:175], a[120:123], v[88:91]
    v_mfma_f32_16x16x32_bf16 v[84:87], a[172:175], a[116:119], v[84:87]
    v_mfma_f32_16x16x32_bf16 v[80:83], a[172:175], a[112:115], v[80:83]
    v_mul_f32 v64, v32, v64
    v_mul_f32 v65, v32, v65
    v_mul_f32 v66, v32, v66
    v_mul_f32 v67, v32, v67
    v_cvt_pk_bf16_f32 v224, v64, v65
    v_cvt_pk_bf16_f32 v225, v66, v67
    s_nop 1
    v_mul_f32 v80, v32, v80
    v_mul_f32 v81, v32, v81
    v_mul_f32 v82, v32, v82
    v_mul_f32 v83, v32, v83
    v_cvt_pk_bf16_f32 v226, v80, v81
    v_cvt_pk_bf16_f32 v227, v82, v83
    s_mov_b32 s69, 12288
    buffer_store_dwordx4 v[224:227], v20, s[28:31], s69 offen sc1
    v_mul_f32 v68, v33, v68
    v_mul_f32 v69, v33, v69
    v_mul_f32 v70, v33, v70
    v_mul_f32 v71, v33, v71
    v_cvt_pk_bf16_f32 v228, v68, v69
    v_cvt_pk_bf16_f32 v229, v70, v71
    v_mul_f32 v84, v33, v84
    v_mul_f32 v85, v33, v85
    v_mul_f32 v86, v33, v86
    v_mul_f32 v87, v33, v87
    v_cvt_pk_bf16_f32 v230, v84, v85
    v_cvt_pk_bf16_f32 v231, v86, v87
    s_mov_b32 s69, 26624
    buffer_store_dwordx4 v[228:231], v20, s[28:31], s69 offen
    v_mul_f32 v72, v34, v72
    v_mul_f32 v73, v34, v73
    v_mul_f32 v74, v34, v74
    v_mul_f32 v75, v34, v75
    v_cvt_pk_bf16_f32 v232, v72, v73
    v_cvt_pk_bf16_f32 v233, v74, v75
    v_mul_f32 v88, v34, v88
    v_mul_f32 v89, v34, v89
    v_mul_f32 v90, v34, v90
    v_mul_f32 v91, v34, v91
    v_cvt_pk_bf16_f32 v234, v88, v89
    v_cvt_pk_bf16_f32 v235, v90, v91
    s_mov_b32 s69, 40960
    buffer_store_dwordx4 v[232:235], v20, s[28:31], s69 offen
    s_waitcnt vmcnt(0)
    s_branch L_fin
L_flag_p3_t0:
    s_mov_b64 exec, vcc
    ds_write_b32 v31, v28
    s_mov_b64 exec, -1
    s_waitcnt lgkmcnt(0)
    s_branch L_flagback_p3_t0
L_rare_p3_t0:
    s_call_b64 s[70:71], L_rescale1_p3
    s_branch L_rareback_p3_t0
L_flag_p3_l1:
    s_mov_b64 exec, vcc
    ds_write_b32 v31, v28
    s_mov_b64 exec, -1
    s_waitcnt lgkmcnt(0)
    s_branch L_flagback_p3_l1
L_rare_p3_l1:
    s_call_b64 s[70:71], L_rescale0_p3
    s_branch L_rareback_p3_l1
L_flag_p3_l0:
    s_mov_b64 exec, vcc
    ds_write_b32 v31, v28
    s_mov_b64 exec, -1
    s_waitcnt lgkmcnt(0)
    s_branch L_flagback_p3_l0
L_rare_p3_l0:
    s_call_b64 s[70:71], L_rescale1_p3
    s_branch L_rareback_p3_l0
L_flag_p3_t29:
    s_mov_b64 exec, vcc
    ds_write_b32 v31, v28
    s_mov_b64 exec, -1
    s_waitcnt lgkmcnt(0)
    s_branch L_flagback_p3_t29
L_rare_p3_t29:
    s_call_b64 s[70:71], L_rescale0_p3
    s_branch L_rareback_p3_t29
L_flag_p3_t30:
    s_mov_b64 exec, vcc
    ds_write_b32 v31, v28
    s_mov_b64 exec, -1
    s_waitcnt lgkmcnt(0)
    s_branch L_flagback_p3_t30
L_rare_p3_t30:
    s_call_b64 s[70:71], L_rescale1_p3
    s_branch L_rareback_p3_t30
L_rescale0_p3:
    s_nop 7
    s_waitcnt lgkmcnt(0)
    s_barrier
    v_max3_f32 v48, v64, v65, v66
    v_max3_f32 v49, v72, v73, v74
    v_max3_f32 v50, v80, v81, v82
    v_max3_f32 v48, v48, v67, v68
    v_max3_f32 v49, v49, v75, v76
    v_max3_f32 v50, v50, v83, v84
    v_max3_f32 v48, v48, v69, v70
    v_max3_f32 v49, v49, v77, v78
    v_max3_f32 v50, v50, v85, v86
    v_max_f32 v48, v48, v71
    v_max_f32 v49, v49, v79
    v_max_f32 v50, v50, v87
    v_mov_b32 v52, v48
    v_mov_b32 v53, v49
    v_mov_b32 v54, v50
    v_permlane32_swap_b32 v52, v48
    v_permlane32_swap_b32 v53, v49
    v_permlane32_swap_b32 v54, v50
    v_max_f32 v48, v48, v52
    v_max_f32 v49, v49, v53
    v_max_f32 v50, v50, v54
    v_mov_b32 v52, v48
    v_mov_b32 v53, v49
    v_mov_b32 v54, v50
    v_permlane16_swap_b32 v52, v48
    v_permlane16_swap_b32 v53, v49
    v_permlane16_swap_b32 v54, v50
    v_max_f32 v48, v48, v52
    v_max_f32 v49, v49, v53
    v_max_f32 v50, v50, v54
    v_mov_b32 v56, 0
    ds_write_b128 v22, v[48:51]
    ds_write_b32 v31, v56
    s_waitcnt lgkmcnt(0)
    s_barrier
    ds_read_b128 v[52:55], v23
    s_waitcnt lgkmcnt(0)
    v_max3_f32 v48, 0, v48, v52
    v_sub_f32 v56, 0, v48
    v_exp_f32 v56, v56
    v_max3_f32 v49, 0, v49, v53
    v_sub_f32 v57, 0, v49
    v_exp_f32 v57, v57
    v_max3_f32 v50, 0, v50, v54
    v_sub_f32 v58, 0, v50
    v_exp_f32 v58, v58
    s_nop 0
    v_mul_f32 v24, v56, v24
    v_mul_f32 v128, v56, v128
    v_mul_f32 v129, v56, v129
    v_mul_f32 v130, v56, v130
    v_mul_f32 v131, v56, v131
    v_mul_f32 v144, v56, v144
    v_mul_f32 v145, v56, v145
    v_mul_f32 v146, v56, v146
    v_mul_f32 v147, v56, v147
    v_mul_f32 v160, v56, v160
    v_mul_f32 v161, v56, v161
    v_mul_f32 v162, v56, v162
    v_mul_f32 v163, v56, v163
    v_mul_f32 v176, v56, v176
    v_mul_f32 v177, v56, v177
    v_mul_f32 v178, v56, v178
    v_mul_f32 v179, v56, v179
    v_mul_f32 v192, v56, v192
    v_mul_f32 v193, v56, v193
    v_mul_f32 v194, v56, v194
    v_mul_f32 v195, v56, v195
    v_mul_f32 v208, v56, v208
    v_mul_f32 v209, v56, v209
    v_mul_f32 v210, v56, v210
    v_mul_f32 v211, v56, v211
    v_mul_f32 v224, v56, v224
    v_mul_f32 v225, v56, v225
    v_mul_f32 v226, v56, v226
    v_mul_f32 v227, v56, v227
    v_mul_f32 v240, v56, v240
    v_mul_f32 v241, v56, v241
    v_mul_f32 v242, v56, v242
    v_mul_f32 v243, v56, v243
    v_mul_f32 v25, v57, v25
    v_mul_f32 v132, v57, v132
    v_mul_f32 v133, v57, v133
    v_mul_f32 v134, v57, v134
    v_mul_f32 v135, v57, v135
    v_mul_f32 v148, v57, v148
    v_mul_f32 v149, v57, v149
    v_mul_f32 v150, v57, v150
    v_mul_f32 v151, v57, v151
    v_mul_f32 v164, v57, v164
    v_mul_f32 v165, v57, v165
    v_mul_f32 v166, v57, v166
    v_mul_f32 v167, v57, v167
    v_mul_f32 v180, v57, v180
    v_mul_f32 v181, v57, v181
    v_mul_f32 v182, v57, v182
    v_mul_f32 v183, v57, v183
    v_mul_f32 v196, v57, v196
    v_mul_f32 v197, v57, v197
    v_mul_f32 v198, v57, v198
    v_mul_f32 v199, v57, v199
    v_mul_f32 v212, v57, v212
    v_mul_f32 v213, v57, v213
    v_mul_f32 v214, v57, v214
    v_mul_f32 v215, v57, v215
    v_mul_f32 v228, v57, v228
    v_mul_f32 v229, v57, v229
    v_mul_f32 v230, v57, v230
    v_mul_f32 v231, v57, v231
    v_mul_f32 v244, v57, v244
    v_mul_f32 v245, v57, v245
    v_mul_f32 v246, v57, v246
    v_mul_f32 v247, v57, v247
    v_mul_f32 v26, v58, v26
    v_mul_f32 v136, v58, v136
    v_mul_f32 v137, v58, v137
    v_mul_f32 v138, v58, v138
    v_mul_f32 v139, v58, v139
    v_mul_f32 v152, v58, v152
    v_mul_f32 v153, v58, v153
    v_mul_f32 v154, v58, v154
    v_mul_f32 v155, v58, v155
    v_mul_f32 v168, v58, v168
    v_mul_f32 v169, v58, v169
    v_mul_f32 v170, v58, v170
    v_mul_f32 v171, v58, v171
    v_mul_f32 v184, v58, v184
    v_mul_f32 v185, v58, v185
    v_mul_f32 v186, v58, v186
    v_mul_f32 v187, v58, v187
    v_mul_f32 v200, v58, v200
    v_mul_f32 v201, v58, v201
    v_mul_f32 v202, v58, v202
    v_mul_f32 v203, v58, v203
    v_mul_f32 v216, v58, v216
    v_mul_f32 v217, v58, v217
    v_mul_f32 v218, v58, v218
    v_mul_f32 v219, v58, v219
    v_mul_f32 v232, v58, v232
    v_mul_f32 v233, v58, v233
    v_mul_f32 v234, v58, v234
    v_mul_f32 v235, v58, v235
    v_mul_f32 v248, v58, v248
    v_mul_f32 v249, v58, v249
    v_mul_f32 v250, v58, v250
    v_mul_f32 v251, v58, v251
    v_sub_f32 v64, v64, v48
    v_sub_f32 v65, v65, v48
    v_sub_f32 v66, v66, v48
    v_sub_f32 v67, v67, v48
    v_sub_f32 v68, v68, v48
    v_sub_f32 v69, v69, v48
    v_sub_f32 v70, v70, v48
    v_sub_f32 v71, v71, v48
    v_sub_f32 v32, v32, v48
    v_sub_f32 v33, v33, v48
    v_sub_f32 v34, v34, v48
    v_sub_f32 v35, v35, v48
    v_sub_f32 v72, v72, v49
    v_sub_f32 v73, v73, v49
    v_sub_f32 v74, v74, v49
    v_sub_f32 v75, v75, v49
    v_sub_f32 v76, v76, v49
    v_sub_f32 v77, v77, v49
    v_sub_f32 v78, v78, v49
    v_sub_f32 v79, v79, v49
    v_sub_f32 v36, v36, v49
    v_sub_f32 v37, v37, v49
    v_sub_f32 v38, v38, v49
    v_sub_f32 v39, v39, v49
    v_sub_f32 v80, v80, v50
    v_sub_f32 v81, v81, v50
    v_sub_f32 v82, v82, v50
    v_sub_f32 v83, v83, v50
    v_sub_f32 v84, v84, v50
    v_sub_f32 v85, v85, v50
    v_sub_f32 v86, v86, v50
    v_sub_f32 v87, v87, v50
    v_sub_f32 v40, v40, v50
    v_sub_f32 v41, v41, v50
    v_sub_f32 v42, v42, v50
    v_sub_f32 v43, v43, v50
    s_nop 3
    s_setpc_b64 s[70:71]
L_rescale1_p3:
    s_nop 7
    s_waitcnt lgkmcnt(0)
    s_barrier
    v_max3_f32 v48, v96, v97, v98
    v_max3_f32 v49, v104, v105, v106
    v_max3_f32 v50, v112, v113, v114
    v_max3_f32 v48, v48, v99, v100
    v_max3_f32 v49, v49, v107, v108
    v_max3_f32 v50, v50, v115, v116
    v_max3_f32 v48, v48, v101, v102
    v_max3_f32 v49, v49, v109, v110
    v_max3_f32 v50, v50, v117, v118
    v_max_f32 v48, v48, v103
    v_max_f32 v49, v49, v111
    v_max_f32 v50, v50, v119
    v_mov_b32 v52, v48
    v_mov_b32 v53, v49
    v_mov_b32 v54, v50
    v_permlane32_swap_b32 v52, v48
    v_permlane32_swap_b32 v53, v49
    v_permlane32_swap_b32 v54, v50
    v_max_f32 v48, v48, v52
    v_max_f32 v49, v49, v53
    v_max_f32 v50, v50, v54
    v_mov_b32 v52, v48
    v_mov_b32 v53, v49
    v_mov_b32 v54, v50
    v_permlane16_swap_b32 v52, v48
    v_permlane16_swap_b32 v53, v49
    v_permlane16_swap_b32 v54, v50
    v_max_f32 v48, v48, v52
    v_max_f32 v49, v49, v53
    v_max_f32 v50, v50, v54
    v_mov_b32 v56, 0
    ds_write_b128 v22, v[48:51]
    ds_write_b32 v31, v56
    s_waitcnt lgkmcnt(0)
    s_barrier
    ds_read_b128 v[52:55], v23
    s_waitcnt lgkmcnt(0)
    v_max3_f32 v48, 0, v48, v52
    v_sub_f32 v56, 0, v48
    v_exp_f32 v56, v56
    v_max3_f32 v49, 0, v49, v53
    v_sub_f32 v57, 0, v49
    v_exp_f32 v57, v57
    v_max3_f32 v50, 0, v50, v54
    v_sub_f32 v58, 0, v50
    v_exp_f32 v58, v58
    s_nop 0
    v_mul_f32 v24, v56, v24
    v_mul_f32 v128, v56, v128
    v_mul_f32 v129, v56, v129
    v_mul_f32 v130, v56, v130
    v_mul_f32 v131, v56, v131
    v_mul_f32 v144, v56, v144
    v_mul_f32 v145, v56, v145
    v_mul_f32 v146, v56, v146
    v_mul_f32 v147, v56, v147
    v_mul_f32 v160, v56, v160
    v_mul_f32 v161, v56, v161
    v_mul_f32 v162, v56, v162
    v_mul_f32 v163, v56, v163
    v_mul_f32 v176, v56, v176
    v_mul_f32 v177, v56, v177
    v_mul_f32 v178, v56, v178
    v_mul_f32 v179, v56, v179
    v_mul_f32 v192, v56, v192
    v_mul_f32 v193, v56, v193
    v_mul_f32 v194, v56, v194
    v_mul_f32 v195, v56, v195
    v_mul_f32 v208, v56, v208
    v_mul_f32 v209, v56, v209
    v_mul_f32 v210, v56, v210
    v_mul_f32 v211, v56, v211
    v_mul_f32 v224, v56, v224
    v_mul_f32 v225, v56, v225
    v_mul_f32 v226, v56, v226
    v_mul_f32 v227, v56, v227
    v_mul_f32 v240, v56, v240
    v_mul_f32 v241, v56, v241
    v_mul_f32 v242, v56, v242
    v_mul_f32 v243, v56, v243
    v_mul_f32 v25, v57, v25
    v_mul_f32 v132, v57, v132
    v_mul_f32 v133, v57, v133
    v_mul_f32 v134, v57, v134
    v_mul_f32 v135, v57, v135
    v_mul_f32 v148, v57, v148
    v_mul_f32 v149, v57, v149
    v_mul_f32 v150, v57, v150
    v_mul_f32 v151, v57, v151
    v_mul_f32 v164, v57, v164
    v_mul_f32 v165, v57, v165
    v_mul_f32 v166, v57, v166
    v_mul_f32 v167, v57, v167
    v_mul_f32 v180, v57, v180
    v_mul_f32 v181, v57, v181
    v_mul_f32 v182, v57, v182
    v_mul_f32 v183, v57, v183
    v_mul_f32 v196, v57, v196
    v_mul_f32 v197, v57, v197
    v_mul_f32 v198, v57, v198
    v_mul_f32 v199, v57, v199
    v_mul_f32 v212, v57, v212
    v_mul_f32 v213, v57, v213
    v_mul_f32 v214, v57, v214
    v_mul_f32 v215, v57, v215
    v_mul_f32 v228, v57, v228
    v_mul_f32 v229, v57, v229
    v_mul_f32 v230, v57, v230
    v_mul_f32 v231, v57, v231
    v_mul_f32 v244, v57, v244
    v_mul_f32 v245, v57, v245
    v_mul_f32 v246, v57, v246
    v_mul_f32 v247, v57, v247
    v_mul_f32 v26, v58, v26
    v_mul_f32 v136, v58, v136
    v_mul_f32 v137, v58, v137
    v_mul_f32 v138, v58, v138
    v_mul_f32 v139, v58, v139
    v_mul_f32 v152, v58, v152
    v_mul_f32 v153, v58, v153
    v_mul_f32 v154, v58, v154
    v_mul_f32 v155, v58, v155
    v_mul_f32 v168, v58, v168
    v_mul_f32 v169, v58, v169
    v_mul_f32 v170, v58, v170
    v_mul_f32 v171, v58, v171
    v_mul_f32 v184, v58, v184
    v_mul_f32 v185, v58, v185
    v_mul_f32 v186, v58, v186
    v_mul_f32 v187, v58, v187
    v_mul_f32 v200, v58, v200
    v_mul_f32 v201, v58, v201
    v_mul_f32 v202, v58, v202
    v_mul_f32 v203, v58, v203
    v_mul_f32 v216, v58, v216
    v_mul_f32 v217, v58, v217
    v_mul_f32 v218, v58, v218
    v_mul_f32 v219, v58, v219
    v_mul_f32 v232, v58, v232
    v_mul_f32 v233, v58, v233
    v_mul_f32 v234, v58, v234
    v_mul_f32 v235, v58, v235
    v_mul_f32 v248, v58, v248
    v_mul_f32 v249, v58, v249
    v_mul_f32 v250, v58, v250
    v_mul_f32 v251, v58, v251
    v_sub_f32 v96, v96, v48
    v_sub_f32 v97, v97, v48
    v_sub_f32 v98, v98, v48
    v_sub_f32 v99, v99, v48
    v_sub_f32 v100, v100, v48
    v_sub_f32 v101, v101, v48
    v_sub_f32 v102, v102, v48
    v_sub_f32 v103, v103, v48
    v_sub_f32 v32, v32, v48
    v_sub_f32 v33, v33, v48
    v_sub_f32 v34, v34, v48
    v_sub_f32 v35, v35, v48
    v_sub_f32 v104, v104, v49
    v_sub_f32 v105, v105, v49
    v_sub_f32 v106, v106, v49
    v_sub_f32 v107, v107, v49
    v_sub_f32 v108, v108, v49
    v_sub_f32 v109, v109, v49
    v_sub_f32 v110, v110, v49
    v_sub_f32 v111, v111, v49
    v_sub_f32 v36, v36, v49
    v_sub_f32 v37, v37, v49
    v_sub_f32 v38, v38, v49
    v_sub_f32 v39, v39, v49
    v_sub_f32 v112, v112, v50
    v_sub_f32 v113, v113, v50
    v_sub_f32 v114, v114, v50
    v_sub_f32 v115, v115, v50
    v_sub_f32 v116, v116, v50
    v_sub_f32 v117, v117, v50
    v_sub_f32 v118, v118, v50
    v_sub_f32 v119, v119, v50
    v_sub_f32 v40, v40, v50
    v_sub_f32 v41, v41, v50
    v_sub_f32 v42, v42, v50
    v_sub_f32 v43, v43, v50
    s_nop 3
    s_setpc_b64 s[70:71]
L_fin:
L_end:
    s_endpgm
.globl reduce_kernel
.p2align 8
.type reduce_kernel,@function
reduce_kernel:
    s_cmp_ge_u32 s2, 224
    s_cbranch_scc1 L2_end
    s_load_dwordx2 s[4:5], s[0:1], 80
    s_load_dwordx2 s[6:7], s[0:1], 96
    v_lshrrev_b32 v1, 6, v0
    v_and_b32 v2, 63, v0
    v_readfirstlane_b32 s3, v1
    s_mul_i32 s17, s2, 7
    s_add_u32 s17, s17, s3
    s_mul_i32 s16, s17, 42800
    s_lshr_b32 s16, s16, 22
    s_mul_i32 s18, s16, 98
    s_sub_u32 s17, s17, s18
    s_lshl_b32 s18, s17, 10
    v_lshl_add_u32 v5, v2, 4, s18
    s_mul_i32 s18, s17, 4682
    s_lshr_b32 s18, s18, 16
    s_mul_i32 s19, s18, 14
    s_sub_u32 s19, s17, s19
    s_lshr_b32 s20, s16, 3
    s_and_b32 s21, s16, 7
    s_mul_i32 s21, s21, 112
    s_lshl_b32 s18, s18, 4
    s_add_u32 s21, s21, s18
    v_and_b32 v3, 15, v2
    v_add_u32 v3, s21, v3
    v_mul_u32_u24 v3, 1792, v3
    s_mul_i32 s20, s20, 896
    s_lshl_b32 s19, s19, 6
    s_add_u32 s20, s20, s19
    v_lshrrev_b32 v4, 4, v2
    v_lshl_add_u32 v3, v4, 3, v3
    v_add_u32 v3, s20, v3
    s_waitcnt lgkmcnt(0)
    s_mul_i32 s22, s16, 1605632
    s_add_u32 s8, s6, s22
    s_addc_u32 s9, s7, 0
    s_mov_b32 s10, 1605632
    s_mov_b32 s11, 0x20000
    s_mov_b32 s12, s4
    s_mov_b32 s13, s5
    s_mov_b32 s14, 1605632
    s_mov_b32 s15, 0x20000
    s_mov_b32 s24, 0
    buffer_load_dwordx4 v[16:19], v5, s[8:11], s24 offen
    s_mov_b32 s25, 100352
    buffer_load_dwordx4 v[20:23], v5, s[8:11], s25 offen
    s_mov_b32 s26, 200704
    buffer_load_dwordx4 v[24:27], v5, s[8:11], s26 offen
    s_mov_b32 s27, 301056
    buffer_load_dwordx4 v[28:31], v5, s[8:11], s27 offen
    s_mov_b32 s28, 401408
    buffer_load_dwordx4 v[32:35], v5, s[8:11], s28 offen
    s_mov_b32 s29, 501760
    buffer_load_dwordx4 v[36:39], v5, s[8:11], s29 offen
    s_mov_b32 s30, 602112
    buffer_load_dwordx4 v[40:43], v5, s[8:11], s30 offen
    s_mov_b32 s31, 702464
    buffer_load_dwordx4 v[44:47], v5, s[8:11], s31 offen
    s_mov_b32 s32, 802816
    buffer_load_dwordx4 v[48:51], v5, s[8:11], s32 offen
    s_mov_b32 s33, 903168
    buffer_load_dwordx4 v[52:55], v5, s[8:11], s33 offen
    s_mov_b32 s34, 1003520
    buffer_load_dwordx4 v[56:59], v5, s[8:11], s34 offen
    s_mov_b32 s35, 1103872
    buffer_load_dwordx4 v[60:63], v5, s[8:11], s35 offen
    s_mov_b32 s36, 1204224
    buffer_load_dwordx4 v[64:67], v5, s[8:11], s36 offen
    s_mov_b32 s37, 1304576
    buffer_load_dwordx4 v[68:71], v5, s[8:11], s37 offen
    s_mov_b32 s38, 1404928
    buffer_load_dwordx4 v[72:75], v5, s[8:11], s38 offen
    s_mov_b32 s39, 1505280
    buffer_load_dwordx4 v[76:79], v5, s[8:11], s39 offen
    s_waitcnt vmcnt(15)
    v_lshlrev_b32 v8, 16, v16
    v_and_b32 v9, 0xffff0000, v16
    v_lshlrev_b32 v10, 16, v17
    v_and_b32 v11, 0xffff0000, v17
    v_lshlrev_b32 v12, 16, v18
    v_and_b32 v13, 0xffff0000, v18
    v_lshlrev_b32 v14, 16, v19
    v_and_b32 v15, 0xffff0000, v19
    s_waitcnt vmcnt(14)
    v_lshlrev_b32 v6, 16, v20
    v_and_b32 v7, 0xffff0000, v20
    v_add_f32 v8, v8, v6
    v_add_f32 v9, v9, v7
    v_lshlrev_b32 v6, 16, v21
    v_and_b32 v7, 0xffff0000, v21
    v_add_f32 v10, v10, v6
    v_add_f32 v11, v11, v7
    v_lshlrev_b32 v6, 16, v22
    v_and_b32 v7, 0xffff0000, v22
    v_add_f32 v12, v12, v6
    v_add_f32 v13, v13, v7
    v_lshlrev_b32 v6, 16, v23
    v_and_b32 v7, 0xffff0000, v23
    v_add_f32 v14, v14, v6
    v_add_f32 v15, v15, v7
    s_waitcnt vmcnt(13)
    v_lshlrev_b32 v6, 16, v24
    v_and_b32 v7, 0xffff0000, v24
    v_add_f32 v8, v8, v6
    v_add_f32 v9, v9, v7
    v_lshlrev_b32 v6, 16, v25
    v_and_b32 v7, 0xffff0000, v25
    v_add_f32 v10, v10, v6
    v_add_f32 v11, v11, v7
    v_lshlrev_b32 v6, 16, v26
    v_and_b32 v7, 0xffff0000, v26
    v_add_f32 v12, v12, v6
    v_add_f32 v13, v13, v7
    v_lshlrev_b32 v6, 16, v27
    v_and_b32 v7, 0xffff0000, v27
    v_add_f32 v14, v14, v6
    v_add_f32 v15, v15, v7
    s_waitcnt vmcnt(12)
    v_lshlrev_b32 v6, 16, v28
    v_and_b32 v7, 0xffff0000, v28
    v_add_f32 v8, v8, v6
    v_add_f32 v9, v9, v7
    v_lshlrev_b32 v6, 16, v29
    v_and_b32 v7, 0xffff0000, v29
    v_add_f32 v10, v10, v6
    v_add_f32 v11, v11, v7
    v_lshlrev_b32 v6, 16, v30
    v_and_b32 v7, 0xffff0000, v30
    v_add_f32 v12, v12, v6
    v_add_f32 v13, v13, v7
    v_lshlrev_b32 v6, 16, v31
    v_and_b32 v7, 0xffff0000, v31
    v_add_f32 v14, v14, v6
    v_add_f32 v15, v15, v7
    s_waitcnt vmcnt(11)
    v_lshlrev_b32 v6, 16, v32
    v_and_b32 v7, 0xffff0000, v32
    v_add_f32 v8, v8, v6
    v_add_f32 v9, v9, v7
    v_lshlrev_b32 v6, 16, v33
    v_and_b32 v7, 0xffff0000, v33
    v_add_f32 v10, v10, v6
    v_add_f32 v11, v11, v7
    v_lshlrev_b32 v6, 16, v34
    v_and_b32 v7, 0xffff0000, v34
    v_add_f32 v12, v12, v6
    v_add_f32 v13, v13, v7
    v_lshlrev_b32 v6, 16, v35
    v_and_b32 v7, 0xffff0000, v35
    v_add_f32 v14, v14, v6
    v_add_f32 v15, v15, v7
    s_waitcnt vmcnt(10)
    v_lshlrev_b32 v6, 16, v36
    v_and_b32 v7, 0xffff0000, v36
    v_add_f32 v8, v8, v6
    v_add_f32 v9, v9, v7
    v_lshlrev_b32 v6, 16, v37
    v_and_b32 v7, 0xffff0000, v37
    v_add_f32 v10, v10, v6
    v_add_f32 v11, v11, v7
    v_lshlrev_b32 v6, 16, v38
    v_and_b32 v7, 0xffff0000, v38
    v_add_f32 v12, v12, v6
    v_add_f32 v13, v13, v7
    v_lshlrev_b32 v6, 16, v39
    v_and_b32 v7, 0xffff0000, v39
    v_add_f32 v14, v14, v6
    v_add_f32 v15, v15, v7
    s_waitcnt vmcnt(9)
    v_lshlrev_b32 v6, 16, v40
    v_and_b32 v7, 0xffff0000, v40
    v_add_f32 v8, v8, v6
    v_add_f32 v9, v9, v7
    v_lshlrev_b32 v6, 16, v41
    v_and_b32 v7, 0xffff0000, v41
    v_add_f32 v10, v10, v6
    v_add_f32 v11, v11, v7
    v_lshlrev_b32 v6, 16, v42
    v_and_b32 v7, 0xffff0000, v42
    v_add_f32 v12, v12, v6
    v_add_f32 v13, v13, v7
    v_lshlrev_b32 v6, 16, v43
    v_and_b32 v7, 0xffff0000, v43
    v_add_f32 v14, v14, v6
    v_add_f32 v15, v15, v7
    s_waitcnt vmcnt(8)
    v_lshlrev_b32 v6, 16, v44
    v_and_b32 v7, 0xffff0000, v44
    v_add_f32 v8, v8, v6
    v_add_f32 v9, v9, v7
    v_lshlrev_b32 v6, 16, v45
    v_and_b32 v7, 0xffff0000, v45
    v_add_f32 v10, v10, v6
    v_add_f32 v11, v11, v7
    v_lshlrev_b32 v6, 16, v46
    v_and_b32 v7, 0xffff0000, v46
    v_add_f32 v12, v12, v6
    v_add_f32 v13, v13, v7
    v_lshlrev_b32 v6, 16, v47
    v_and_b32 v7, 0xffff0000, v47
    v_add_f32 v14, v14, v6
    v_add_f32 v15, v15, v7
    s_waitcnt vmcnt(7)
    v_lshlrev_b32 v6, 16, v48
    v_and_b32 v7, 0xffff0000, v48
    v_add_f32 v8, v8, v6
    v_add_f32 v9, v9, v7
    v_lshlrev_b32 v6, 16, v49
    v_and_b32 v7, 0xffff0000, v49
    v_add_f32 v10, v10, v6
    v_add_f32 v11, v11, v7
    v_lshlrev_b32 v6, 16, v50
    v_and_b32 v7, 0xffff0000, v50
    v_add_f32 v12, v12, v6
    v_add_f32 v13, v13, v7
    v_lshlrev_b32 v6, 16, v51
    v_and_b32 v7, 0xffff0000, v51
    v_add_f32 v14, v14, v6
    v_add_f32 v15, v15, v7
    s_waitcnt vmcnt(6)
    v_lshlrev_b32 v6, 16, v52
    v_and_b32 v7, 0xffff0000, v52
    v_add_f32 v8, v8, v6
    v_add_f32 v9, v9, v7
    v_lshlrev_b32 v6, 16, v53
    v_and_b32 v7, 0xffff0000, v53
    v_add_f32 v10, v10, v6
    v_add_f32 v11, v11, v7
    v_lshlrev_b32 v6, 16, v54
    v_and_b32 v7, 0xffff0000, v54
    v_add_f32 v12, v12, v6
    v_add_f32 v13, v13, v7
    v_lshlrev_b32 v6, 16, v55
    v_and_b32 v7, 0xffff0000, v55
    v_add_f32 v14, v14, v6
    v_add_f32 v15, v15, v7
    s_waitcnt vmcnt(5)
    v_lshlrev_b32 v6, 16, v56
    v_and_b32 v7, 0xffff0000, v56
    v_add_f32 v8, v8, v6
    v_add_f32 v9, v9, v7
    v_lshlrev_b32 v6, 16, v57
    v_and_b32 v7, 0xffff0000, v57
    v_add_f32 v10, v10, v6
    v_add_f32 v11, v11, v7
    v_lshlrev_b32 v6, 16, v58
    v_and_b32 v7, 0xffff0000, v58
    v_add_f32 v12, v12, v6
    v_add_f32 v13, v13, v7
    v_lshlrev_b32 v6, 16, v59
    v_and_b32 v7, 0xffff0000, v59
    v_add_f32 v14, v14, v6
    v_add_f32 v15, v15, v7
    s_waitcnt vmcnt(4)
    v_lshlrev_b32 v6, 16, v60
    v_and_b32 v7, 0xffff0000, v60
    v_add_f32 v8, v8, v6
    v_add_f32 v9, v9, v7
    v_lshlrev_b32 v6, 16, v61
    v_and_b32 v7, 0xffff0000, v61
    v_add_f32 v10, v10, v6
    v_add_f32 v11, v11, v7
    v_lshlrev_b32 v6, 16, v62
    v_and_b32 v7, 0xffff0000, v62
    v_add_f32 v12, v12, v6
    v_add_f32 v13, v13, v7
    v_lshlrev_b32 v6, 16, v63
    v_and_b32 v7, 0xffff0000, v63
    v_add_f32 v14, v14, v6
    v_add_f32 v15, v15, v7
    s_waitcnt vmcnt(3)
    v_lshlrev_b32 v6, 16, v64
    v_and_b32 v7, 0xffff0000, v64
    v_add_f32 v8, v8, v6
    v_add_f32 v9, v9, v7
    v_lshlrev_b32 v6, 16, v65
    v_and_b32 v7, 0xffff0000, v65
    v_add_f32 v10, v10, v6
    v_add_f32 v11, v11, v7
    v_lshlrev_b32 v6, 16, v66
    v_and_b32 v7, 0xffff0000, v66
    v_add_f32 v12, v12, v6
    v_add_f32 v13, v13, v7
    v_lshlrev_b32 v6, 16, v67
    v_and_b32 v7, 0xffff0000, v67
    v_add_f32 v14, v14, v6
    v_add_f32 v15, v15, v7
    s_waitcnt vmcnt(2)
    v_lshlrev_b32 v6, 16, v68
    v_and_b32 v7, 0xffff0000, v68
    v_add_f32 v8, v8, v6
    v_add_f32 v9, v9, v7
    v_lshlrev_b32 v6, 16, v69
    v_and_b32 v7, 0xffff0000, v69
    v_add_f32 v10, v10, v6
    v_add_f32 v11, v11, v7
    v_lshlrev_b32 v6, 16, v70
    v_and_b32 v7, 0xffff0000, v70
    v_add_f32 v12, v12, v6
    v_add_f32 v13, v13, v7
    v_lshlrev_b32 v6, 16, v71
    v_and_b32 v7, 0xffff0000, v71
    v_add_f32 v14, v14, v6
    v_add_f32 v15, v15, v7
    s_waitcnt vmcnt(1)
    v_lshlrev_b32 v6, 16, v72
    v_and_b32 v7, 0xffff0000, v72
    v_add_f32 v8, v8, v6
    v_add_f32 v9, v9, v7
    v_lshlrev_b32 v6, 16, v73
    v_and_b32 v7, 0xffff0000, v73
    v_add_f32 v10, v10, v6
    v_add_f32 v11, v11, v7
    v_lshlrev_b32 v6, 16, v74
    v_and_b32 v7, 0xffff0000, v74
    v_add_f32 v12, v12, v6
    v_add_f32 v13, v13, v7
    v_lshlrev_b32 v6, 16, v75
    v_and_b32 v7, 0xffff0000, v75
    v_add_f32 v14, v14, v6
    v_add_f32 v15, v15, v7
    s_waitcnt vmcnt(0)
    v_lshlrev_b32 v6, 16, v76
    v_and_b32 v7, 0xffff0000, v76
    v_add_f32 v8, v8, v6
    v_add_f32 v9, v9, v7
    v_lshlrev_b32 v6, 16, v77
    v_and_b32 v7, 0xffff0000, v77
    v_add_f32 v10, v10, v6
    v_add_f32 v11, v11, v7
    v_lshlrev_b32 v6, 16, v78
    v_and_b32 v7, 0xffff0000, v78
    v_add_f32 v12, v12, v6
    v_add_f32 v13, v13, v7
    v_lshlrev_b32 v6, 16, v79
    v_and_b32 v7, 0xffff0000, v79
    v_add_f32 v14, v14, v6
    v_add_f32 v15, v15, v7
    v_cvt_pk_bf16_f32 v80, v8, v9
    v_cvt_pk_bf16_f32 v81, v10, v11
    v_cvt_pk_bf16_f32 v82, v12, v13
    v_cvt_pk_bf16_f32 v83, v14, v15
    buffer_store_dwordx2 v[80:81], v3, s[12:15], 0 offen
    buffer_store_dwordx2 v[82:83], v3, s[12:15], 0 offen offset:32
L2_end:
    s_endpgm
.section .rodata,"a"
.p2align 6
.amdhsa_kernel concat_heads__gqa_block_cached__mha_block_cached__near_ridge_kernel
  .amdhsa_next_free_vgpr 512
  .amdhsa_next_free_sgpr 102
  .amdhsa_accum_offset 256
  .amdhsa_group_segment_fixed_size 0
  .amdhsa_kernarg_size 104
  .amdhsa_user_sgpr_count 2
  .amdhsa_user_sgpr_kernarg_segment_ptr 1
  .amdhsa_system_sgpr_workgroup_id_x 1
.end_amdhsa_kernel
.p2align 6
.amdhsa_kernel reduce_kernel
  .amdhsa_next_free_vgpr 96
  .amdhsa_next_free_sgpr 48
  .amdhsa_accum_offset 96
  .amdhsa_group_segment_fixed_size 0
  .amdhsa_kernarg_size 104
  .amdhsa_user_sgpr_count 2
  .amdhsa_user_sgpr_kernarg_segment_ptr 1
  .amdhsa_system_sgpr_workgroup_id_x 1
.end_amdhsa_kernel
```
